```python
import torch

def _softmax(x, axis=-1):
    return torch.softmax(x, dim=axis)
def _gelu(x):
    return torch.nn.functional.gelu(x, approximate="tanh")
def _silu(x):
    return torch.nn.functional.silu(x)
def _sigmoid(x):
    return torch.sigmoid(x)
def _layernorm(x, axis=-1, eps=1e-5):
    m = x.mean(dim=axis, keepdim=True)
    v = x.var(dim=axis, keepdim=True, unbiased=False)
    return (x - m) / torch.sqrt(v + eps)
def _scatter_add(tgt, idx, src, axis=0):
    return tgt.clone().index_add_(axis, idx, src)
def _segment_sum(src, seg, n):
    out = torch.zeros((n,) + src.shape[1:], dtype=src.dtype)
    return out.index_add_(0, seg, src)
def _pad(x, pw):
    flat = tuple(v for pair in reversed(pw) for v in pair)
    return torch.nn.functional.pad(x, flat)

kernel_name = 'parallel_sum__compressed_kv_cla__mixer_channel_mlp__prompt'

def setup_inputs():

    _w = (lambda a: (lambda t: t.to(torch.bfloat16) if t.is_floating_point() else t)(torch.as_tensor(a)))
    def _A_setup():
        B, H, Sq, Sk, D, M = 1, 32, 2048, 2048, 128, 640
        Dc = 4 * D
        return {
            "x": _w((lambda *s: torch.randn(*s, dtype=torch.bfloat16) * 0.05)(B, Sq, M)),
            "c_kv": _w((lambda *s: torch.randn(*s, dtype=torch.bfloat16) * 0.4)(B, Sk, Dc)),
            "w_q": _w((lambda *s: torch.randn(*s, dtype=torch.bfloat16) * 3.2)(M, H, D) * (M ** -0.5)),
            "w_uk": _w((lambda *s: torch.randn(*s, dtype=torch.bfloat16) * 3.2)(Dc, H, D) * (Dc ** -0.5)),
            "w_uv": _w((lambda *s: torch.randn(*s, dtype=torch.bfloat16) * 0.4)(Dc, H, D) * (Dc ** -0.5)),
            "w_o": _w((lambda *s: torch.randn(*s, dtype=torch.bfloat16) * 0.4)(H, D, M) * ((H * D) ** -0.5)),
        }
    _A_in = _A_setup()

    def _B_setup():
        B, S, D, F = 1, 2048, 640, 1728
        return {
            "x": _w((lambda *s: torch.randn(*s, dtype=torch.bfloat16) * 0.05)(B, S, D)),
            "w1": _w((lambda *s: torch.randn(*s, dtype=torch.bfloat16) * 0.8)(D, F) * (D ** -0.5)),
            "b1": _w((lambda *s: torch.randn(*s, dtype=torch.bfloat16) * 0.4)(F)),
            "w2": _w((lambda *s: torch.randn(*s, dtype=torch.bfloat16) * 0.05)(F, D) * (F ** -0.5)),
            "b2": _w((lambda *s: torch.randn(*s, dtype=torch.bfloat16) * 0.05)(D)),
        }
    _B_in = _B_setup()

    return {
        "A_x": _A_in["x"],
        "A_c_kv": _A_in["c_kv"],
        "A_w_q": _A_in["w_q"],
        "A_w_uk": _A_in["w_uk"],
        "A_w_uv": _A_in["w_uv"],
        "A_w_o": _A_in["w_o"],
        "B_x": _B_in["x"],
        "B_w1": _B_in["w1"],
        "B_b1": _B_in["b1"],
        "B_w2": _B_in["w2"],
        "B_b2": _B_in["b2"],
    }

def reference(A_x, A_c_kv, A_w_q, A_w_uk, A_w_uv, A_w_o, B_x, B_w1, B_b1, B_w2, B_b2):
    def _A_ref(x, c_kv, w_q, w_uk, w_uv, w_o):
        B, Sq, M = x.shape[0], x.shape[1], x.shape[2]
        Sk = c_kv.shape[1]
        H, D = w_q.shape[1], w_q.shape[2]
        q = torch.einsum("bqm,mhd->bhqd", x, w_q)
        k = torch.einsum("bkc,chd->bhkd", c_kv, w_uk)
        v = torch.einsum("bkc,chd->bhkd", c_kv, w_uv)
        scores = torch.einsum("bhqd,bhkd->bhqk", q, k) * (D ** -0.5)
        off = Sk - Sq
        qi = torch.arange(Sq)[:, None]
        kj = torch.arange(Sk)[None, :]
        cmask = kj <= (qi + off)
        scores = torch.where(cmask[None, None], scores, -1e9)
        p = _softmax(scores, axis=-1)
        ctx = torch.einsum("bhqk,bhkd->bhqd", p, v)
        return torch.einsum("bhqd,hdm->bqm", ctx, w_o)

    def _B_ref(x, w1, b1, w2, b2):
        y = _layernorm(x, axis=-1)
        h = _gelu(torch.einsum("bsd,df->bsf", y, w1) + b1)
        return torch.einsum("bsf,fd->bsd", h, w2) + b2

    x = A_x
    xn = _layernorm(x, axis=-1)
    return x + _A_ref(xn, A_c_kv, A_w_q, A_w_uk, A_w_uv, A_w_o) + _B_ref(xn, B_w1, B_b1, B_w2, B_b2)
```

```asm
; @launch grid=(256,1,1) block=(256,1,1) lds=163840
.amdgcn_target "amdgcn-amd-amdhsa--gfx950"
.text
.globl parallel_sum__compressed_kv_cla__mixer_channel_mlp__prompt_kernel
.p2align 8
.type parallel_sum__compressed_kv_cla__mixer_channel_mlp__prompt_kernel,@function
parallel_sum__compressed_kv_cla__mixer_channel_mlp__prompt_kernel:
 s_cmp_ge_u32 s2, 256
 s_cbranch_scc1 L_done
 s_load_dwordx2 s[8:9], s[0:1], 8
 s_load_dwordx2 s[12:13], s[0:1], 24
 s_load_dwordx2 s[16:17], s[0:1], 32
 s_load_dwordx2 s[20:21], s[0:1], 0
 s_load_dwordx2 s[4:5], s[0:1], 104
 s_load_dwordx2 s[28:29], s[0:1], 16
 s_load_dwordx2 s[32:33], s[0:1], 56
 s_load_dwordx2 s[36:37], s[0:1], 64
 v_lshrrev_b32 v1, 6, v0
 v_and_b32 v0, 63, v0
 v_readfirstlane_b32 s44, v1
 s_getpc_b64 s[88:89]
L_pc:
 s_sub_u32 s88, s88, L_pc-parallel_sum__compressed_kv_cla__mixer_channel_mlp__prompt_kernel
 s_subb_u32 s89, s89, 0
 s_mov_b32 s90, L_end-parallel_sum__compressed_kv_cla__mixer_channel_mlp__prompt_kernel
 s_mov_b32 s91, 0x20000
 v_min_u32 v26, 7, v0
 v_lshlrev_b32 v26, 7, v26
 s_mul_i32 s50, s44, 1024
 buffer_load_dword a255, v26, s[88:91], s50 offen
 s_lshr_b32 s49, s2, 3
 s_lshl_b32 s49, s49, 2
 s_add_u32 s49, s49, s44
 s_mul_i32 s49, s49, 768
 v_min_u32 v26, 640, v26
 buffer_load_dword a255, v26, s[88:91], s49 offen
 s_mov_b32 s10, 2097152
 s_mov_b32 s11, s91
 s_mov_b32 s14, 4194304
 s_mov_b32 s15, s91
 s_mov_b32 s18, s14
 s_mov_b32 s19, s91
 s_and_b32 s47, s2, 7
 s_lshr_b32 s49, s2, 6
 s_lshl_b32 s64, s49, 3
 s_add_u32 s64, s64, s47
 s_lshl_b32 s47, s47, 2
 s_add_u32 s47, s47, s49
 s_bfe_u32 s48, s2, 0x30003
 s_and_b32 s45, s44, 1
 s_lshr_b32 s46, s44, 1
 v_and_b32 v20, 15, v0
 v_lshrrev_b32 v21, 4, v0
 s_lshl_b32 s49, s45, 2
 v_or_b32 v26, s49, v21
 v_lshlrev_b32 v26, 1, v26
 v_xor_b32 v26, v26, v20
 v_lshlrev_b32 v26, 4, v26
 v_lshl_add_u32 v10, v21, 13, v26
 v_add_u32 v11, 32768, v10
 v_lshrrev_b32 v26, 3, v0
 v_and_b32 v27, 7, v0
 v_xor_b32 v27, v27, v21
 v_lshlrev_b32 v27, 4, v27
 v_lshl_add_u32 v12, v26, 10, v27
 v_xor_b32 v13, 64, v12
 s_lshl_b32 s49, s48, 8
 s_lshl_b32 s50, s44, 6
 s_add_u32 s49, s49, s50
 s_lshl_b32 s70, s49, 10
 s_lshl_b32 s55, s49, 8
 s_lshl_b32 s67, s47, 8
 s_lshl_b32 s50, s44, 16
 s_add_u32 s67, s67, s50
 s_lshl_b32 s65, s44, 10
 s_lshl_b32 s59, s44, 11
 s_mul_i32 s69, s44, 24576
 s_add_u32 s69, s69, 65536
 s_waitcnt lgkmcnt(0)
 s_add_u32 m0, s59, 0
 s_add_u32 s49, s67, 0
 buffer_load_dwordx4 v10, s[12:15], s49 offen nt lds
 s_add_u32 m0, s59, 1024
 s_add_u32 s49, s67, 0
 buffer_load_dwordx4 v11, s[12:15], s49 offen nt lds
 s_add_u32 m0, s59, 8192
 s_add_u32 s49, s67, 0
 buffer_load_dwordx4 v10, s[16:19], s49 offen nt lds
 s_add_u32 m0, s59, 9216
 s_add_u32 s49, s67, 0
 buffer_load_dwordx4 v11, s[16:19], s49 offen nt lds
 s_add_u32 m0, s69, 0
 s_add_u32 s49, s70, 0
 buffer_load_dwordx4 v12, s[8:11], s49 offen lds
 s_add_u32 m0, s69, 1024
 s_add_u32 s49, s70, 8192
 buffer_load_dwordx4 v13, s[8:11], s49 offen lds
 s_add_u32 m0, s69, 2048
 s_add_u32 s49, s70, 16384
 buffer_load_dwordx4 v12, s[8:11], s49 offen lds
 s_add_u32 m0, s69, 3072
 s_add_u32 s49, s70, 24576
 buffer_load_dwordx4 v13, s[8:11], s49 offen lds
 s_add_u32 m0, s69, 4096
 s_add_u32 s49, s70, 32768
 buffer_load_dwordx4 v12, s[8:11], s49 offen lds
 s_add_u32 m0, s69, 5120
 s_add_u32 s49, s70, 40960
 buffer_load_dwordx4 v13, s[8:11], s49 offen lds
 s_add_u32 m0, s69, 6144
 s_add_u32 s49, s70, 49152
 buffer_load_dwordx4 v12, s[8:11], s49 offen lds
 s_add_u32 m0, s69, 7168
 s_add_u32 s49, s70, 57344
 buffer_load_dwordx4 v13, s[8:11], s49 offen lds
 s_mov_b32 s22, 2621440
 s_mov_b32 s23, 0x20000
 s_mov_b32 s6, 142606336
 s_mov_b32 s7, 0x20000
 s_mov_b32 s30, 5242880
 s_mov_b32 s31, 0x20000
 s_mov_b32 s34, 2211840
 s_mov_b32 s35, 0x20000
 s_mov_b32 s38, 3456
 s_mov_b32 s39, 0x20000
 s_mov_b32 s51, 0x40000000
 v_lshlrev_b32 v1, 4, v0
 s_mov_b32 s49, 3211136
 s_load_dword s100, s[4:5], s49
 s_sub_u32 s49, 15, s48
 s_cmp_lt_u32 s47, 16
 s_cselect_b32 s49, s48, s49
 s_lshl_b32 s49, s49, 7
 s_and_b32 s50, s47, 15
 s_lshl_b32 s50, s50, 3
 s_add_u32 s49, s49, s50
 s_lshl_b32 s50, s44, 1
 s_add_u32 s54, s49, s50
 s_mul_i32 s52, s54, 1280
 v_and_b32 v24, 31, v0
 v_lshrrev_b32 v25, 5, v0
 v_mul_u32_u24 v26, 1280, v25
 v_lshl_add_u32 v57, v24, 3, v26
 v_lshrrev_b32 v26, 1, v24
 v_lshlrev_b32 v26, 8, v26
 v_and_b32 v27, 1, v24
 v_lshl_add_u32 v26, v27, 3, v26
 v_lshl_add_u32 v58, v25, 4, v26
 v_and_b32 v22, 7, v20
 v_and_b32 v23, 8, v20
 v_lshl_add_u32 v22, v23, 1, v22
 v_lshrrev_b32 v26, 2, v20
 v_lshl_add_u32 v27, v21, 3, v26
 v_lshlrev_b32 v27, 8, v27
 v_and_b32 v28, 3, v20
 v_lshl_add_u32 v27, v28, 3, v27
 v_and_b32 v28, 1, v21
 v_lshl_or_b32 v28, v28, 2, v26
 v_xor_b32 v29, 0, v28
 v_lshl_add_u32 v2, v29, 5, v27
 v_xor_b32 v29, 1, v28
 v_lshl_add_u32 v3, v29, 5, v27
 v_xor_b32 v29, 2, v28
 v_lshl_add_u32 v4, v29, 5, v27
 v_xor_b32 v29, 3, v28
 v_lshl_add_u32 v5, v29, 5, v27
 v_xor_b32 v29, 4, v28
 v_lshl_add_u32 v6, v29, 5, v27
 v_xor_b32 v29, 5, v28
 v_lshl_add_u32 v7, v29, 5, v27
 v_xor_b32 v29, 6, v28
 v_lshl_add_u32 v8, v29, 5, v27
 v_xor_b32 v29, 7, v28
 v_lshl_add_u32 v9, v29, 5, v27
 v_lshlrev_b32 v26, 9, v21
 v_mov_b32 v16, v1
 v_add_u32 v17, 16777216, v1
 v_lshrrev_b32 v26, 1, v20
 v_xor_b32 v26, v26, v21
 v_lshlrev_b32 v26, 4, v26
 v_lshl_add_u32 v26, v20, 7, v26
 v_add_u32 v14, s69, v26
 v_xor_b32 v15, 64, v14
 s_lshr_b32 s50, s54, 4
 s_mul_i32 s53, s50, 20480
 s_and_b32 s50, s54, 15
 s_lshl_b32 s50, s50, 4
 s_add_u32 s53, s53, s50
 s_lshl_b32 s54, s54, 3
 s_add_u32 s54, s54, 3145728
 s_lshl_b32 s50, s47, 19
 s_add_u32 s55, s55, s50
 s_add_u32 s55, s55, 16777216
 s_add_u32 s56, s55, 4096
 s_add_u32 s57, s55, 8192
 s_add_u32 s58, s55, 12288
 v_or_b32 v26, s44, v0
 v_cmp_eq_u32 vcc, 0, v26
 v_mov_b32 v27, s51
 s_nop 0
 v_cndmask_b32 v18, v27, 0, vcc
 s_lshl_b32 s60, s47, 7
 s_lshl_b32 s49, s48, 2
 s_add_u32 s60, s60, s49
 s_add_u32 s60, s60, 3211264
 s_lshl_b32 s3, s48, 9
 s_lshl_b32 s49, s47, 2
 s_add_u32 s3, s3, s49
 s_add_u32 s3, s3, 3219456
 s_lshr_b32 s62, s2, 3
 s_lshl_b32 s62, s62, 2
 s_add_u32 s62, s62, s44
 s_mul_i32 s62, s62, 40960
 s_and_b32 s63, s2, 7
 s_lshl_b32 s63, s63, 10
 s_add_u32 s62, s62, s63
 v_min_u32 v59, 39, v0
 v_lshrrev_b32 v63, 3, v59
 v_and_b32 v59, 7, v59
 v_lshlrev_b32 v59, 7, v59
 v_lshl_add_u32 v59, v63, 13, v59
 s_lshl_b32 s63, s48, 2
 s_add_u32 s63, s63, s44
 s_mul_i32 s63, s63, 69120
 s_lshl_b32 s49, s64, 7
 s_add_u32 s63, s63, s49
 s_cmp_lt_u32 s64, 27
 s_cselect_b32 s63, s63, s51
 v_min_u32 v63, 19, v0
 v_mul_u32_u24 v63, 3456, v63
 s_add_u32 m0, s59, 16384
 s_add_u32 s49, s67, 262144
 buffer_load_dwordx4 v10, s[12:15], s49 offen nt lds
 s_add_u32 m0, s59, 17408
 s_add_u32 s49, s67, 262144
 buffer_load_dwordx4 v11, s[12:15], s49 offen nt lds
 s_add_u32 m0, s59, 24576
 s_add_u32 s49, s67, 262144
 buffer_load_dwordx4 v10, s[16:19], s49 offen nt lds
 s_add_u32 m0, s59, 25600
 s_add_u32 s49, s67, 262144
 buffer_load_dwordx4 v11, s[16:19], s49 offen nt lds
 buffer_load_dwordx2 v[22:23], v57, s[20:23], s52 offen
 buffer_load_dwordx2 v[24:25], v57, s[20:23], s52 offen offset:256
 buffer_load_dwordx2 v[26:27], v57, s[20:23], s52 offen offset:512
 buffer_load_dwordx2 v[28:29], v57, s[20:23], s52 offen offset:768
 buffer_load_dwordx2 v[30:31], v57, s[20:23], s52 offen offset:1024
 s_waitcnt lgkmcnt(0)
 s_add_u32 s100, s100, 0x9e3779b9
 v_mov_b32 v61, s100
 s_waitcnt vmcnt(17)
 s_barrier
 s_waitcnt vmcnt(9)
 ds_read_b128 a[32:35], v14
 ds_read_b128 a[36:39], v14 offset:2048
 ds_read_b128 a[40:43], v14 offset:4096
 ds_read_b128 a[44:47], v14 offset:6144
 ds_read_b64_tr_b16 a[0:1], v2
 ds_read_b64_tr_b16 a[2:3], v2 offset:1024
 ds_read_b64_tr_b16 a[4:5], v3
 ds_read_b64_tr_b16 a[6:7], v3 offset:1024
 ds_read_b64_tr_b16 a[8:9], v4
 ds_read_b64_tr_b16 a[10:11], v4 offset:1024
 ds_read_b64_tr_b16 a[12:13], v5
 ds_read_b64_tr_b16 a[14:15], v5 offset:1024
 s_waitcnt lgkmcnt(6)
 v_mfma_f32_16x16x32_bf16 v[64:67], a[0:3], a[32:35], 0
 ds_read_b64_tr_b16 a[16:17], v6
 s_add_u32 m0, s59, 32768
 v_mfma_f32_16x16x32_bf16 v[68:71], a[0:3], a[36:39], 0
 ds_read_b64_tr_b16 a[18:19], v6 offset:1024
 s_add_u32 s27, s67, 524288
 v_mfma_f32_16x16x32_bf16 v[72:75], a[0:3], a[40:43], 0
 buffer_load_dwordx4 v10, s[12:15], s27 offen nt lds
 v_mfma_f32_16x16x32_bf16 v[76:79], a[0:3], a[44:47], 0
 s_waitcnt lgkmcnt(6)
 v_mfma_f32_16x16x32_bf16 v[80:83], a[4:7], a[32:35], 0
 ds_read_b64_tr_b16 a[20:21], v7
 s_add_u32 m0, s69, 8192
 v_mfma_f32_16x16x32_bf16 v[84:87], a[4:7], a[36:39], 0
 ds_read_b64_tr_b16 a[22:23], v7 offset:1024
 s_add_u32 s27, s70, 128
 v_mfma_f32_16x16x32_bf16 v[88:91], a[4:7], a[40:43], 0
 buffer_load_dwordx4 v12, s[8:11], s27 offen lds
 v_mfma_f32_16x16x32_bf16 v[92:95], a[4:7], a[44:47], 0
 s_waitcnt lgkmcnt(6)
 v_mfma_f32_16x16x32_bf16 v[96:99], a[8:11], a[32:35], 0
 ds_read_b64_tr_b16 a[24:25], v8
 v_mfma_f32_16x16x32_bf16 v[100:103], a[8:11], a[36:39], 0
 ds_read_b64_tr_b16 a[26:27], v8 offset:1024
 v_mfma_f32_16x16x32_bf16 v[104:107], a[8:11], a[40:43], 0
 v_mfma_f32_16x16x32_bf16 v[108:111], a[8:11], a[44:47], 0
 s_add_u32 m0, s69, 9216
 s_waitcnt lgkmcnt(6)
 v_mfma_f32_16x16x32_bf16 v[112:115], a[12:15], a[32:35], 0
 ds_read_b64_tr_b16 a[28:29], v9
 s_add_u32 s27, s70, 8320
 v_mfma_f32_16x16x32_bf16 v[116:119], a[12:15], a[36:39], 0
 ds_read_b64_tr_b16 a[30:31], v9 offset:1024
 buffer_load_dwordx4 v13, s[8:11], s27 offen lds
 v_mfma_f32_16x16x32_bf16 v[120:123], a[12:15], a[40:43], 0
 v_mfma_f32_16x16x32_bf16 v[124:127], a[12:15], a[44:47], 0
 s_waitcnt lgkmcnt(6)
 v_mfma_f32_16x16x32_bf16 a[64:67], a[16:19], a[32:35], 0
 ds_read_b64_tr_b16 a[0:1], v2 offset:8192
 s_add_u32 m0, s59, 33792
 v_mfma_f32_16x16x32_bf16 a[68:71], a[16:19], a[36:39], 0
 ds_read_b64_tr_b16 a[2:3], v2 offset:9216
 s_add_u32 s27, s67, 524288
 v_mfma_f32_16x16x32_bf16 a[72:75], a[16:19], a[40:43], 0
 buffer_load_dwordx4 v11, s[12:15], s27 offen nt lds
 v_mfma_f32_16x16x32_bf16 a[76:79], a[16:19], a[44:47], 0
 s_add_u32 m0, s69, 10240
 s_waitcnt lgkmcnt(6)
 v_mfma_f32_16x16x32_bf16 a[80:83], a[20:23], a[32:35], 0
 ds_read_b64_tr_b16 a[4:5], v3 offset:8192
 s_add_u32 s27, s70, 16512
 v_mfma_f32_16x16x32_bf16 a[84:87], a[20:23], a[36:39], 0
 ds_read_b64_tr_b16 a[6:7], v3 offset:9216
 buffer_load_dwordx4 v12, s[8:11], s27 offen lds
 v_mfma_f32_16x16x32_bf16 a[88:91], a[20:23], a[40:43], 0
 v_mfma_f32_16x16x32_bf16 a[92:95], a[20:23], a[44:47], 0
 s_waitcnt lgkmcnt(6)
 v_mfma_f32_16x16x32_bf16 a[96:99], a[24:27], a[32:35], 0
 ds_read_b64_tr_b16 a[8:9], v4 offset:8192
 v_mfma_f32_16x16x32_bf16 a[100:103], a[24:27], a[36:39], 0
 ds_read_b64_tr_b16 a[10:11], v4 offset:9216
 s_add_u32 m0, s69, 11264
 v_mfma_f32_16x16x32_bf16 a[104:107], a[24:27], a[40:43], 0
 s_add_u32 s27, s70, 24704
 v_mfma_f32_16x16x32_bf16 a[108:111], a[24:27], a[44:47], 0
 buffer_load_dwordx4 v13, s[8:11], s27 offen lds
 s_waitcnt lgkmcnt(6)
 v_mfma_f32_16x16x32_bf16 a[112:115], a[28:31], a[32:35], 0
 ds_read_b64_tr_b16 a[12:13], v5 offset:8192
 v_mfma_f32_16x16x32_bf16 a[116:119], a[28:31], a[36:39], 0
 ds_read_b64_tr_b16 a[14:15], v5 offset:9216
 v_mfma_f32_16x16x32_bf16 a[120:123], a[28:31], a[40:43], 0
 v_mfma_f32_16x16x32_bf16 a[124:127], a[28:31], a[44:47], 0
 s_waitcnt lgkmcnt(6)
 v_mfma_f32_16x16x32_bf16 v[128:131], a[32:35], a[0:3], 0
 ds_read_b64_tr_b16 a[16:17], v6 offset:8192
 s_add_u32 m0, s59, 40960
 v_mfma_f32_16x16x32_bf16 v[132:135], a[36:39], a[0:3], 0
 ds_read_b64_tr_b16 a[18:19], v6 offset:9216
 s_add_u32 s27, s67, 524288
 v_mfma_f32_16x16x32_bf16 v[136:139], a[40:43], a[0:3], 0
 ds_read_b128 a[48:51], v15
 buffer_load_dwordx4 v10, s[16:19], s27 offen nt lds
 v_mfma_f32_16x16x32_bf16 v[140:143], a[44:47], a[0:3], 0
 s_add_u32 m0, s69, 12288
 s_waitcnt lgkmcnt(7)
 v_mfma_f32_16x16x32_bf16 v[144:147], a[32:35], a[4:7], 0
 ds_read_b64_tr_b16 a[20:21], v7 offset:8192
 s_add_u32 s27, s70, 32896
 v_mfma_f32_16x16x32_bf16 v[148:151], a[36:39], a[4:7], 0
 ds_read_b64_tr_b16 a[22:23], v7 offset:9216
 buffer_load_dwordx4 v12, s[8:11], s27 offen lds
 v_mfma_f32_16x16x32_bf16 v[152:155], a[40:43], a[4:7], 0
 ds_read_b128 a[52:55], v15 offset:2048
 v_mfma_f32_16x16x32_bf16 v[156:159], a[44:47], a[4:7], 0
 s_add_u32 m0, s69, 13312
 s_waitcnt lgkmcnt(8)
 v_mfma_f32_16x16x32_bf16 v[160:163], a[32:35], a[8:11], 0
 ds_read_b64_tr_b16 a[24:25], v8 offset:8192
 s_add_u32 s27, s70, 41088
 v_mfma_f32_16x16x32_bf16 v[164:167], a[36:39], a[8:11], 0
 ds_read_b64_tr_b16 a[26:27], v8 offset:9216
 buffer_load_dwordx4 v13, s[8:11], s27 offen lds
 v_mfma_f32_16x16x32_bf16 v[168:171], a[40:43], a[8:11], 0
 ds_read_b128 a[56:59], v15 offset:4096
 v_mfma_f32_16x16x32_bf16 v[172:175], a[44:47], a[8:11], 0
 s_waitcnt lgkmcnt(9)
 v_mfma_f32_16x16x32_bf16 v[176:179], a[32:35], a[12:15], 0
 s_waitcnt vmcnt(14)
 s_barrier
 ds_read_b64_tr_b16 a[28:29], v9 offset:8192
 v_mfma_f32_16x16x32_bf16 v[180:183], a[36:39], a[12:15], 0
 ds_read_b64_tr_b16 a[30:31], v9 offset:9216
 v_mfma_f32_16x16x32_bf16 v[184:187], a[40:43], a[12:15], 0
 ds_read_b128 a[60:63], v15 offset:6144
 s_add_u32 m0, s69, 14336
 v_mfma_f32_16x16x32_bf16 v[188:191], a[44:47], a[12:15], 0
 s_add_u32 s27, s70, 49280
 s_waitcnt lgkmcnt(10)
 v_mfma_f32_16x16x32_bf16 v[192:195], a[32:35], a[16:19], 0
 ds_read_b64_tr_b16 a[0:1], v2 offset:16384
 buffer_load_dwordx4 v12, s[8:11], s27 offen lds
 v_mfma_f32_16x16x32_bf16 v[196:199], a[36:39], a[16:19], 0
 ds_read_b64_tr_b16 a[2:3], v2 offset:17408
 s_add_u32 m0, s59, 41984
 v_mfma_f32_16x16x32_bf16 v[200:203], a[40:43], a[16:19], 0
 s_add_u32 s27, s67, 524288
 v_mfma_f32_16x16x32_bf16 v[204:207], a[44:47], a[16:19], 0
 buffer_load_dwordx4 v11, s[16:19], s27 offen nt lds
 s_waitcnt lgkmcnt(9)
 v_mfma_f32_16x16x32_bf16 v[208:211], a[32:35], a[20:23], 0
 ds_read_b64_tr_b16 a[4:5], v3 offset:16384
 v_mfma_f32_16x16x32_bf16 v[212:215], a[36:39], a[20:23], 0
 ds_read_b64_tr_b16 a[6:7], v3 offset:17408
 s_add_u32 m0, s69, 15360
 v_mfma_f32_16x16x32_bf16 v[216:219], a[40:43], a[20:23], 0
 s_add_u32 s27, s70, 57472
 v_mfma_f32_16x16x32_bf16 v[220:223], a[44:47], a[20:23], 0
 buffer_load_dwordx4 v13, s[8:11], s27 offen lds
 s_waitcnt lgkmcnt(8)
 v_mfma_f32_16x16x32_bf16 v[224:227], a[32:35], a[24:27], 0
 ds_read_b64_tr_b16 a[8:9], v4 offset:16384
 v_mfma_f32_16x16x32_bf16 v[228:231], a[36:39], a[24:27], 0
 ds_read_b64_tr_b16 a[10:11], v4 offset:17408
 v_mfma_f32_16x16x32_bf16 v[232:235], a[40:43], a[24:27], 0
 v_mfma_f32_16x16x32_bf16 v[236:239], a[44:47], a[24:27], 0
 s_waitcnt lgkmcnt(7)
 v_mfma_f32_16x16x32_bf16 v[240:243], a[32:35], a[28:31], 0
 ds_read_b64_tr_b16 a[12:13], v5 offset:16384
 v_mfma_f32_16x16x32_bf16 v[244:247], a[36:39], a[28:31], 0
 ds_read_b64_tr_b16 a[14:15], v5 offset:17408
 v_mfma_f32_16x16x32_bf16 v[248:251], a[40:43], a[28:31], 0
 v_mfma_f32_16x16x32_bf16 v[252:255], a[44:47], a[28:31], 0
 s_waitcnt lgkmcnt(6)
 v_mfma_f32_16x16x32_bf16 v[64:67], a[0:3], a[48:51], v[64:67]
 ds_read_b64_tr_b16 a[16:17], v6 offset:16384
 s_add_u32 m0, s59, 49152
 s_mov_b32 s61, 0xffff0000
 v_mfma_f32_16x16x32_bf16 v[68:71], a[0:3], a[52:55], v[68:71]
 ds_read_b64_tr_b16 a[18:19], v6 offset:17408
 s_waitcnt vmcnt(16)
 v_lshlrev_b32 v32, 16, v22
 s_add_u32 s27, s67, 786432
 v_mfma_f32_16x16x32_bf16 v[72:75], a[0:3], a[56:59], v[72:75]
 buffer_load_dwordx4 v10, s[12:15], s27 offen nt lds
 v_and_b32 v33, s61, v22
 v_mfma_f32_16x16x32_bf16 v[76:79], a[0:3], a[60:63], v[76:79]
 v_lshlrev_b32 v34, 16, v23
 s_waitcnt lgkmcnt(6)
 v_mfma_f32_16x16x32_bf16 v[80:83], a[4:7], a[48:51], v[80:83]
 ds_read_b64_tr_b16 a[20:21], v7 offset:16384
 v_and_b32 v35, s61, v23
 s_add_u32 m0, s69, 16384
 v_mfma_f32_16x16x32_bf16 v[84:87], a[4:7], a[52:55], v[84:87]
 ds_read_b64_tr_b16 a[22:23], v7 offset:17408
 s_waitcnt vmcnt(16)
 v_lshlrev_b32 v36, 16, v24
 s_add_u32 s27, s70, 256
 v_mfma_f32_16x16x32_bf16 v[88:91], a[4:7], a[56:59], v[88:91]
 buffer_load_dwordx4 v12, s[8:11], s27 offen lds
 v_and_b32 v37, s61, v24
 v_mfma_f32_16x16x32_bf16 v[92:95], a[4:7], a[60:63], v[92:95]
 v_lshlrev_b32 v38, 16, v25
 s_waitcnt lgkmcnt(6)
 v_mfma_f32_16x16x32_bf16 v[96:99], a[8:11], a[48:51], v[96:99]
 ds_read_b64_tr_b16 a[24:25], v8 offset:16384
 v_and_b32 v39, s61, v25
 v_mfma_f32_16x16x32_bf16 v[100:103], a[8:11], a[52:55], v[100:103]
 ds_read_b64_tr_b16 a[26:27], v8 offset:17408
 s_waitcnt vmcnt(16)
 v_lshlrev_b32 v40, 16, v26
 v_mfma_f32_16x16x32_bf16 v[104:107], a[8:11], a[56:59], v[104:107]
 v_and_b32 v41, s61, v26
 v_mfma_f32_16x16x32_bf16 v[108:111], a[8:11], a[60:63], v[108:111]
 s_add_u32 m0, s69, 17408
 v_lshlrev_b32 v42, 16, v27
 s_waitcnt lgkmcnt(6)
 v_mfma_f32_16x16x32_bf16 v[112:115], a[12:15], a[48:51], v[112:115]
 ds_read_b64_tr_b16 a[28:29], v9 offset:16384
 v_and_b32 v43, s61, v27
 s_add_u32 s27, s70, 8448
 v_mfma_f32_16x16x32_bf16 v[116:119], a[12:15], a[52:55], v[116:119]
 ds_read_b64_tr_b16 a[30:31], v9 offset:17408
 s_waitcnt vmcnt(15)
 v_lshlrev_b32 v44, 16, v28
 buffer_load_dwordx4 v13, s[8:11], s27 offen lds
 v_mfma_f32_16x16x32_bf16 v[120:123], a[12:15], a[56:59], v[120:123]
 v_and_b32 v45, s61, v28
 v_mfma_f32_16x16x32_bf16 v[124:127], a[12:15], a[60:63], v[124:127]
 v_lshlrev_b32 v46, 16, v29
 s_waitcnt lgkmcnt(6)
 v_mfma_f32_16x16x32_bf16 a[64:67], a[16:19], a[48:51], a[64:67]
 ds_read_b64_tr_b16 a[0:1], v2 offset:24576
 v_and_b32 v47, s61, v29
 s_add_u32 m0, s59, 50176
 v_mfma_f32_16x16x32_bf16 a[68:71], a[16:19], a[52:55], a[68:71]
 ds_read_b64_tr_b16 a[2:3], v2 offset:25600
 s_waitcnt vmcnt(15)
 v_lshlrev_b32 v48, 16, v30
 s_add_u32 s27, s67, 786432
 v_mfma_f32_16x16x32_bf16 a[72:75], a[16:19], a[56:59], a[72:75]
 buffer_load_dwordx4 v11, s[12:15], s27 offen nt lds
 v_and_b32 v49, s61, v30
 v_mfma_f32_16x16x32_bf16 a[76:79], a[16:19], a[60:63], a[76:79]
 s_add_u32 m0, s69, 18432
 v_lshlrev_b32 v50, 16, v31
 s_waitcnt lgkmcnt(6)
 v_mfma_f32_16x16x32_bf16 a[80:83], a[20:23], a[48:51], a[80:83]
 ds_read_b64_tr_b16 a[4:5], v3 offset:24576
 v_and_b32 v51, s61, v31
 s_add_u32 s27, s70, 16640
 v_mfma_f32_16x16x32_bf16 a[84:87], a[20:23], a[52:55], a[84:87]
 ds_read_b64_tr_b16 a[6:7], v3 offset:25600
 v_add_f32 v52, v32, v33
 buffer_load_dwordx4 v12, s[8:11], s27 offen lds
 v_mfma_f32_16x16x32_bf16 a[88:91], a[20:23], a[56:59], a[88:91]
 v_add_f32 v53, v34, v35
 v_mfma_f32_16x16x32_bf16 a[92:95], a[20:23], a[60:63], a[92:95]
 v_add_f32 v52, v52, v36
 s_waitcnt lgkmcnt(6)
 v_mfma_f32_16x16x32_bf16 a[96:99], a[24:27], a[48:51], a[96:99]
 ds_read_b64_tr_b16 a[8:9], v4 offset:24576
 v_add_f32 v53, v53, v37
 v_mfma_f32_16x16x32_bf16 a[100:103], a[24:27], a[52:55], a[100:103]
 ds_read_b64_tr_b16 a[10:11], v4 offset:25600
 v_add_f32 v52, v52, v38
 s_add_u32 m0, s69, 19456
 v_mfma_f32_16x16x32_bf16 a[104:107], a[24:27], a[56:59], a[104:107]
 s_add_u32 s27, s70, 24832
 v_add_f32 v53, v53, v39
 v_mfma_f32_16x16x32_bf16 a[108:111], a[24:27], a[60:63], a[108:111]
 buffer_load_dwordx4 v13, s[8:11], s27 offen lds
 v_add_f32 v52, v52, v40
 s_waitcnt lgkmcnt(6)
 v_mfma_f32_16x16x32_bf16 a[112:115], a[28:31], a[48:51], a[112:115]
 ds_read_b64_tr_b16 a[12:13], v5 offset:24576
 v_add_f32 v53, v53, v41
 v_mfma_f32_16x16x32_bf16 a[116:119], a[28:31], a[52:55], a[116:119]
 ds_read_b64_tr_b16 a[14:15], v5 offset:25600
 v_add_f32 v52, v52, v42
 v_mfma_f32_16x16x32_bf16 a[120:123], a[28:31], a[56:59], a[120:123]
 v_add_f32 v53, v53, v43
 v_mfma_f32_16x16x32_bf16 a[124:127], a[28:31], a[60:63], a[124:127]
 v_add_f32 v52, v52, v44
 s_waitcnt lgkmcnt(6)
 v_mfma_f32_16x16x32_bf16 v[128:131], a[48:51], a[0:3], v[128:131]
 ds_read_b64_tr_b16 a[16:17], v6 offset:24576
 v_add_f32 v53, v53, v45
 s_add_u32 m0, s59, 57344
 v_mfma_f32_16x16x32_bf16 v[132:135], a[52:55], a[0:3], v[132:135]
 ds_read_b64_tr_b16 a[18:19], v6 offset:25600
 v_add_f32 v52, v52, v46
 s_add_u32 s27, s67, 786432
 v_mfma_f32_16x16x32_bf16 v[136:139], a[56:59], a[0:3], v[136:139]
 s_waitcnt vmcnt(6)
 ds_read_b128 a[32:35], v14 offset:8192
 v_add_f32 v53, v53, v47
 buffer_load_dwordx4 v10, s[16:19], s27 offen nt lds
 v_mfma_f32_16x16x32_bf16 v[140:143], a[60:63], a[0:3], v[140:143]
 s_add_u32 m0, s69, 20480
 v_add_f32 v52, v52, v48
 s_waitcnt lgkmcnt(7)
 v_mfma_f32_16x16x32_bf16 v[144:147], a[48:51], a[4:7], v[144:147]
 ds_read_b64_tr_b16 a[20:21], v7 offset:24576
 v_add_f32 v53, v53, v49
 s_add_u32 s27, s70, 33024
 v_mfma_f32_16x16x32_bf16 v[148:151], a[52:55], a[4:7], v[148:151]
 ds_read_b64_tr_b16 a[22:23], v7 offset:25600
 v_add_f32 v52, v52, v50
 buffer_load_dwordx4 v12, s[8:11], s27 offen lds
 v_mfma_f32_16x16x32_bf16 v[152:155], a[56:59], a[4:7], v[152:155]
 ds_read_b128 a[36:39], v14 offset:10240
 v_add_f32 v53, v53, v51
 v_mfma_f32_16x16x32_bf16 v[156:159], a[60:63], a[4:7], v[156:159]
 s_add_u32 m0, s69, 21504
 v_add_f32 v52, v52, v53
 s_waitcnt lgkmcnt(8)
 v_mfma_f32_16x16x32_bf16 v[160:163], a[48:51], a[8:11], v[160:163]
 ds_read_b64_tr_b16 a[24:25], v8 offset:24576
 v_add_f32 v52, v52, v52 row_ror:8
 s_add_u32 s27, s70, 41216
 v_mfma_f32_16x16x32_bf16 v[164:167], a[52:55], a[8:11], v[164:167]
 ds_read_b64_tr_b16 a[26:27], v8 offset:25600
 v_add_f32 v52, v52, v52 row_ror:4
 buffer_load_dwordx4 v13, s[8:11], s27 offen lds
 v_mfma_f32_16x16x32_bf16 v[168:171], a[56:59], a[8:11], v[168:171]
 ds_read_b128 a[40:43], v14 offset:12288
 v_add_f32 v52, v52, v52 row_ror:2
 v_mfma_f32_16x16x32_bf16 v[172:175], a[60:63], a[8:11], v[172:175]
 s_nop 0
 v_add_f32 v52, v52, v52 row_ror:1
 s_waitcnt lgkmcnt(9)
 v_mfma_f32_16x16x32_bf16 v[176:179], a[48:51], a[12:15], v[176:179]
 s_barrier
 ds_read_b64_tr_b16 a[28:29], v9 offset:24576
 s_add_u32 m0, s59, 0
 v_mfma_f32_16x16x32_bf16 v[180:183], a[52:55], a[12:15], v[180:183]
 ds_read_b64_tr_b16 a[30:31], v9 offset:25600
 v_mov_b32 v55, v52
 s_add_u32 s27, s67, 1048576
 v_mfma_f32_16x16x32_bf16 v[184:187], a[56:59], a[12:15], v[184:187]
 ds_read_b128 a[44:47], v14 offset:14336
 v_permlane16_swap_b32 v55, v52
 buffer_load_dwordx4 v10, s[12:15], s27 offen nt lds
 v_mfma_f32_16x16x32_bf16 v[188:191], a[60:63], a[12:15], v[188:191]
 s_add_u32 m0, s69, 0
 v_add_f32 v52, v52, v55
 s_waitcnt lgkmcnt(10)
 v_mfma_f32_16x16x32_bf16 v[192:195], a[48:51], a[16:19], v[192:195]
 ds_read_b64_tr_b16 a[0:1], v2 offset:32768
 v_mul_f32 v52, 0.0015625, v52
 s_add_u32 s27, s70, 384
 v_mfma_f32_16x16x32_bf16 v[196:199], a[52:55], a[16:19], v[196:199]
 ds_read_b64_tr_b16 a[2:3], v2 offset:33792
 v_sub_f32 v54, v32, v52
 buffer_load_dwordx4 v12, s[8:11], s27 offen lds
 v_mfma_f32_16x16x32_bf16 v[200:203], a[56:59], a[16:19], v[200:203]
 s_add_u32 m0, s69, 22528
 v_mul_f32 v53, v54, v54
 v_mfma_f32_16x16x32_bf16 v[204:207], a[60:63], a[16:19], v[204:207]
 s_add_u32 s27, s70, 49408
 v_sub_f32 v56, v33, v52
 s_waitcnt lgkmcnt(9)
 v_mfma_f32_16x16x32_bf16 v[208:211], a[48:51], a[20:23], v[208:211]
 ds_read_b64_tr_b16 a[4:5], v3 offset:32768
 v_fmac_f32 v53, v56, v56
 buffer_load_dwordx4 v12, s[8:11], s27 offen lds
 v_mfma_f32_16x16x32_bf16 v[212:215], a[52:55], a[20:23], v[212:215]
 ds_read_b64_tr_b16 a[6:7], v3 offset:33792
 v_sub_f32 v54, v34, v52
 s_add_u32 m0, s59, 58368
 v_mfma_f32_16x16x32_bf16 v[216:219], a[56:59], a[20:23], v[216:219]
 s_add_u32 s27, s67, 786432
 v_fmac_f32 v53, v54, v54
 v_mfma_f32_16x16x32_bf16 v[220:223], a[60:63], a[20:23], v[220:223]
 buffer_load_dwordx4 v11, s[16:19], s27 offen nt lds
 v_sub_f32 v56, v35, v52
 s_waitcnt lgkmcnt(8)
 v_mfma_f32_16x16x32_bf16 v[224:227], a[48:51], a[24:27], v[224:227]
 ds_read_b64_tr_b16 a[8:9], v4 offset:32768
 v_fmac_f32 v53, v56, v56
 s_add_u32 m0, s69, 23552
 v_mfma_f32_16x16x32_bf16 v[228:231], a[52:55], a[24:27], v[228:231]
 ds_read_b64_tr_b16 a[10:11], v4 offset:33792
 v_sub_f32 v54, v36, v52
 s_add_u32 s27, s70, 57600
 v_mfma_f32_16x16x32_bf16 v[232:235], a[56:59], a[24:27], v[232:235]
 buffer_load_dwordx4 v13, s[8:11], s27 offen lds
 v_fmac_f32 v53, v54, v54
 v_mfma_f32_16x16x32_bf16 v[236:239], a[60:63], a[24:27], v[236:239]
 s_add_u32 m0, s69, 1024
 v_sub_f32 v56, v37, v52
 s_waitcnt lgkmcnt(7)
 v_mfma_f32_16x16x32_bf16 v[240:243], a[48:51], a[28:31], v[240:243]
 ds_read_b64_tr_b16 a[12:13], v5 offset:32768
 v_fmac_f32 v53, v56, v56
 s_add_u32 s27, s70, 8576
 v_mfma_f32_16x16x32_bf16 v[244:247], a[52:55], a[28:31], v[244:247]
 ds_read_b64_tr_b16 a[14:15], v5 offset:33792
 v_sub_f32 v54, v38, v52
 buffer_load_dwordx4 v13, s[8:11], s27 offen lds
 v_mfma_f32_16x16x32_bf16 v[248:251], a[56:59], a[28:31], v[248:251]
 s_add_u32 m0, s59, 1024
 v_fmac_f32 v53, v54, v54
 v_mfma_f32_16x16x32_bf16 v[252:255], a[60:63], a[28:31], v[252:255]
 s_add_u32 s27, s67, 1048576
 v_sub_f32 v56, v39, v52
 s_waitcnt lgkmcnt(6)
 v_mfma_f32_16x16x32_bf16 v[64:67], a[0:3], a[32:35], v[64:67]
 ds_read_b64_tr_b16 a[16:17], v6 offset:32768
 v_fmac_f32 v53, v56, v56
 buffer_load_dwordx4 v11, s[12:15], s27 offen nt lds
 v_mfma_f32_16x16x32_bf16 v[68:71], a[0:3], a[36:39], v[68:71]
 ds_read_b64_tr_b16 a[18:19], v6 offset:33792
 v_sub_f32 v54, v40, v52
 v_mfma_f32_16x16x32_bf16 v[72:75], a[0:3], a[40:43], v[72:75]
 v_fmac_f32 v53, v54, v54
 v_mfma_f32_16x16x32_bf16 v[76:79], a[0:3], a[44:47], v[76:79]
 v_sub_f32 v56, v41, v52
 s_waitcnt lgkmcnt(6)
 v_mfma_f32_16x16x32_bf16 v[80:83], a[4:7], a[32:35], v[80:83]
 ds_read_b64_tr_b16 a[20:21], v7 offset:32768
 v_fmac_f32 v53, v56, v56
 v_mfma_f32_16x16x32_bf16 v[84:87], a[4:7], a[36:39], v[84:87]
 ds_read_b64_tr_b16 a[22:23], v7 offset:33792
 v_sub_f32 v54, v42, v52
 v_mfma_f32_16x16x32_bf16 v[88:91], a[4:7], a[40:43], v[88:91]
 v_fmac_f32 v53, v54, v54
 v_mfma_f32_16x16x32_bf16 v[92:95], a[4:7], a[44:47], v[92:95]
 v_sub_f32 v56, v43, v52
 s_waitcnt lgkmcnt(6)
 v_mfma_f32_16x16x32_bf16 v[96:99], a[8:11], a[32:35], v[96:99]
 ds_read_b64_tr_b16 a[24:25], v8 offset:32768
 v_fmac_f32 v53, v56, v56
 v_mfma_f32_16x16x32_bf16 v[100:103], a[8:11], a[36:39], v[100:103]
 ds_read_b64_tr_b16 a[26:27], v8 offset:33792
 v_sub_f32 v54, v44, v52
 v_mfma_f32_16x16x32_bf16 v[104:107], a[8:11], a[40:43], v[104:107]
 s_add_u32 m0, s69, 2048
 v_fmac_f32 v53, v54, v54
 v_mfma_f32_16x16x32_bf16 v[108:111], a[8:11], a[44:47], v[108:111]
 s_add_u32 s27, s70, 16768
 v_sub_f32 v56, v45, v52
 s_waitcnt lgkmcnt(6)
 v_mfma_f32_16x16x32_bf16 v[112:115], a[12:15], a[32:35], v[112:115]
 ds_read_b64_tr_b16 a[28:29], v9 offset:32768
 v_fmac_f32 v53, v56, v56
 buffer_load_dwordx4 v12, s[8:11], s27 offen lds
 v_mfma_f32_16x16x32_bf16 v[116:119], a[12:15], a[36:39], v[116:119]
 ds_read_b64_tr_b16 a[30:31], v9 offset:33792
 v_sub_f32 v54, v46, v52
 s_add_u32 m0, s59, 8192
 v_mfma_f32_16x16x32_bf16 v[120:123], a[12:15], a[40:43], v[120:123]
 s_add_u32 s27, s67, 1048576
 v_fmac_f32 v53, v54, v54
 v_mfma_f32_16x16x32_bf16 v[124:127], a[12:15], a[44:47], v[124:127]
 buffer_load_dwordx4 v10, s[16:19], s27 offen nt lds
 v_sub_f32 v56, v47, v52
 s_waitcnt lgkmcnt(6)
 v_mfma_f32_16x16x32_bf16 a[64:67], a[16:19], a[32:35], a[64:67]
 ds_read_b64_tr_b16 a[0:1], v2 offset:40960
 v_fmac_f32 v53, v56, v56
 v_mfma_f32_16x16x32_bf16 a[68:71], a[16:19], a[36:39], a[68:71]
 ds_read_b64_tr_b16 a[2:3], v2 offset:41984
 v_sub_f32 v54, v48, v52
 v_mfma_f32_16x16x32_bf16 a[72:75], a[16:19], a[40:43], a[72:75]
 v_fmac_f32 v53, v54, v54
 v_mfma_f32_16x16x32_bf16 a[76:79], a[16:19], a[44:47], a[76:79]
 v_sub_f32 v56, v49, v52
 s_waitcnt lgkmcnt(6)
 v_mfma_f32_16x16x32_bf16 a[80:83], a[20:23], a[32:35], a[80:83]
 ds_read_b64_tr_b16 a[4:5], v3 offset:40960
 v_fmac_f32 v53, v56, v56
 v_mfma_f32_16x16x32_bf16 a[84:87], a[20:23], a[36:39], a[84:87]
 ds_read_b64_tr_b16 a[6:7], v3 offset:41984
 v_sub_f32 v54, v50, v52
 v_mfma_f32_16x16x32_bf16 a[88:91], a[20:23], a[40:43], a[88:91]
 v_fmac_f32 v53, v54, v54
 v_mfma_f32_16x16x32_bf16 a[92:95], a[20:23], a[44:47], a[92:95]
 v_sub_f32 v56, v51, v52
 s_waitcnt lgkmcnt(6)
 v_mfma_f32_16x16x32_bf16 a[96:99], a[24:27], a[32:35], a[96:99]
 ds_read_b64_tr_b16 a[8:9], v4 offset:40960
 v_fmac_f32 v53, v56, v56
 v_mfma_f32_16x16x32_bf16 a[100:103], a[24:27], a[36:39], a[100:103]
 ds_read_b64_tr_b16 a[10:11], v4 offset:41984
 v_add_f32 v53, v53, v53 row_ror:8
 s_add_u32 m0, s69, 3072
 v_mfma_f32_16x16x32_bf16 a[104:107], a[24:27], a[40:43], a[104:107]
 s_add_u32 s27, s70, 24960
 v_add_f32 v53, v53, v53 row_ror:4
 v_mfma_f32_16x16x32_bf16 a[108:111], a[24:27], a[44:47], a[108:111]
 buffer_load_dwordx4 v13, s[8:11], s27 offen lds
 v_add_f32 v53, v53, v53 row_ror:2
 s_waitcnt lgkmcnt(6)
 v_mfma_f32_16x16x32_bf16 a[112:115], a[28:31], a[32:35], a[112:115]
 ds_read_b64_tr_b16 a[12:13], v5 offset:40960
 v_add_f32 v53, v53, v53 row_ror:1
 s_add_u32 m0, s59, 9216
 v_mfma_f32_16x16x32_bf16 a[116:119], a[28:31], a[36:39], a[116:119]
 ds_read_b64_tr_b16 a[14:15], v5 offset:41984
 v_mov_b32 v55, v53
 s_add_u32 s27, s67, 1048576
 v_mfma_f32_16x16x32_bf16 a[120:123], a[28:31], a[40:43], a[120:123]
 buffer_load_dwordx4 v11, s[16:19], s27 offen nt lds
 v_permlane16_swap_b32 v55, v53
 v_mfma_f32_16x16x32_bf16 a[124:127], a[28:31], a[44:47], a[124:127]
 v_add_f32 v53, v53, v55
 s_waitcnt lgkmcnt(6)
 v_mfma_f32_16x16x32_bf16 v[128:131], a[32:35], a[0:3], v[128:131]
 ds_read_b64_tr_b16 a[16:17], v6 offset:40960
 v_mul_f32 v53, 0.0015625, v53
 v_mfma_f32_16x16x32_bf16 v[132:135], a[36:39], a[0:3], v[132:135]
 ds_read_b64_tr_b16 a[18:19], v6 offset:41984
 v_cvt_pk_bf16_f32 v52, v52, v52
 v_mfma_f32_16x16x32_bf16 v[136:139], a[40:43], a[0:3], v[136:139]
 ds_read_b128 a[48:51], v15 offset:8192
 v_and_b32 v52, s61, v52
 v_mfma_f32_16x16x32_bf16 v[140:143], a[44:47], a[0:3], v[140:143]
 v_cvt_pk_bf16_f32 v53, v53, v53
 s_waitcnt lgkmcnt(7)
 v_mfma_f32_16x16x32_bf16 v[144:147], a[32:35], a[4:7], v[144:147]
 ds_read_b64_tr_b16 a[20:21], v7 offset:40960
 v_and_b32 v53, s61, v53
 v_mfma_f32_16x16x32_bf16 v[148:151], a[36:39], a[4:7], v[148:151]
 ds_read_b64_tr_b16 a[22:23], v7 offset:41984
 v_add_f32 v53, 1e-05, v53
 v_mfma_f32_16x16x32_bf16 v[152:155], a[40:43], a[4:7], v[152:155]
 ds_read_b128 a[52:55], v15 offset:10240
 v_cvt_pk_bf16_f32 v53, v53, v53
 v_mfma_f32_16x16x32_bf16 v[156:159], a[44:47], a[4:7], v[156:159]
 v_and_b32 v53, s61, v53
 s_waitcnt lgkmcnt(8)
 v_mfma_f32_16x16x32_bf16 v[160:163], a[32:35], a[8:11], v[160:163]
 ds_read_b64_tr_b16 a[24:25], v8 offset:40960
 v_sqrt_f32 v53, v53
 s_add_u32 m0, s69, 4096
 v_mfma_f32_16x16x32_bf16 v[164:167], a[36:39], a[8:11], v[164:167]
 ds_read_b64_tr_b16 a[26:27], v8 offset:41984
 v_cvt_pk_bf16_f32 v53, v53, v53
 s_add_u32 s27, s70, 33152
 v_mfma_f32_16x16x32_bf16 v[168:171], a[40:43], a[8:11], v[168:171]
 ds_read_b128 a[56:59], v15 offset:12288
 v_and_b32 v53, s61, v53
 buffer_load_dwordx4 v12, s[8:11], s27 offen lds
 v_mfma_f32_16x16x32_bf16 v[172:175], a[44:47], a[8:11], v[172:175]
 v_rcp_f32 v53, v53
 s_waitcnt lgkmcnt(9)
 v_mfma_f32_16x16x32_bf16 v[176:179], a[32:35], a[12:15], v[176:179]
 s_waitcnt vmcnt(8)
 s_barrier
 ds_read_b64_tr_b16 a[28:29], v9 offset:40960
 s_add_u32 m0, s59, 16384
 v_mfma_f32_16x16x32_bf16 v[180:183], a[36:39], a[12:15], v[180:183]
 ds_read_b64_tr_b16 a[30:31], v9 offset:41984
 v_sub_f32 v32, v32, v52
 s_add_u32 s27, s67, 1310720
 v_mfma_f32_16x16x32_bf16 v[184:187], a[40:43], a[12:15], v[184:187]
 ds_read_b128 a[60:63], v15 offset:14336
 v_sub_f32 v33, v33, v52
 buffer_load_dwordx4 v10, s[12:15], s27 offen nt lds
 v_mfma_f32_16x16x32_bf16 v[188:191], a[44:47], a[12:15], v[188:191]
 v_sub_f32 v34, v34, v52
 s_waitcnt lgkmcnt(10)
 v_mfma_f32_16x16x32_bf16 v[192:195], a[32:35], a[16:19], v[192:195]
 ds_read_b64_tr_b16 a[0:1], v2 offset:49152
 v_sub_f32 v35, v35, v52
 v_mfma_f32_16x16x32_bf16 v[196:199], a[36:39], a[16:19], v[196:199]
 ds_read_b64_tr_b16 a[2:3], v2 offset:50176
 v_sub_f32 v36, v36, v52
 v_mfma_f32_16x16x32_bf16 v[200:203], a[40:43], a[16:19], v[200:203]
 v_sub_f32 v37, v37, v52
 v_mfma_f32_16x16x32_bf16 v[204:207], a[44:47], a[16:19], v[204:207]
 v_sub_f32 v38, v38, v52
 s_waitcnt lgkmcnt(9)
 v_mfma_f32_16x16x32_bf16 v[208:211], a[32:35], a[20:23], v[208:211]
 ds_read_b64_tr_b16 a[4:5], v3 offset:49152
 v_sub_f32 v39, v39, v52
 v_mfma_f32_16x16x32_bf16 v[212:215], a[36:39], a[20:23], v[212:215]
 ds_read_b64_tr_b16 a[6:7], v3 offset:50176
 v_sub_f32 v40, v40, v52
 v_mfma_f32_16x16x32_bf16 v[216:219], a[40:43], a[20:23], v[216:219]
 v_sub_f32 v41, v41, v52
 v_mfma_f32_16x16x32_bf16 v[220:223], a[44:47], a[20:23], v[220:223]
 s_add_u32 m0, s69, 5120
 v_sub_f32 v42, v42, v52
 s_waitcnt lgkmcnt(8)
 v_mfma_f32_16x16x32_bf16 v[224:227], a[32:35], a[24:27], v[224:227]
 ds_read_b64_tr_b16 a[8:9], v4 offset:49152
 v_sub_f32 v43, v43, v52
 s_add_u32 s27, s70, 41344
 v_mfma_f32_16x16x32_bf16 v[228:231], a[36:39], a[24:27], v[228:231]
 ds_read_b64_tr_b16 a[10:11], v4 offset:50176
 v_sub_f32 v44, v44, v52
 buffer_load_dwordx4 v13, s[8:11], s27 offen lds
 v_mfma_f32_16x16x32_bf16 v[232:235], a[40:43], a[24:27], v[232:235]
 v_sub_f32 v45, v45, v52
 v_mfma_f32_16x16x32_bf16 v[236:239], a[44:47], a[24:27], v[236:239]
 v_sub_f32 v46, v46, v52
 s_waitcnt lgkmcnt(7)
 v_mfma_f32_16x16x32_bf16 v[240:243], a[32:35], a[28:31], v[240:243]
 ds_read_b64_tr_b16 a[12:13], v5 offset:49152
 v_sub_f32 v47, v47, v52
 s_add_u32 m0, s59, 17408
 v_mfma_f32_16x16x32_bf16 v[244:247], a[36:39], a[28:31], v[244:247]
 ds_read_b64_tr_b16 a[14:15], v5 offset:50176
 v_sub_f32 v48, v48, v52
 s_add_u32 s27, s67, 1310720
 v_mfma_f32_16x16x32_bf16 v[248:251], a[40:43], a[28:31], v[248:251]
 buffer_load_dwordx4 v11, s[12:15], s27 offen nt lds
 v_sub_f32 v49, v49, v52
 v_mfma_f32_16x16x32_bf16 v[252:255], a[44:47], a[28:31], v[252:255]
 v_sub_f32 v50, v50, v52
 s_waitcnt lgkmcnt(6)
 v_mfma_f32_16x16x32_bf16 v[64:67], a[0:3], a[48:51], v[64:67]
 ds_read_b64_tr_b16 a[16:17], v6 offset:49152
 v_sub_f32 v51, v51, v52
 v_mfma_f32_16x16x32_bf16 v[68:71], a[0:3], a[52:55], v[68:71]
 ds_read_b64_tr_b16 a[18:19], v6 offset:50176
 v_cvt_pk_bf16_f32 v22, v32, v33
 v_mfma_f32_16x16x32_bf16 v[72:75], a[0:3], a[56:59], v[72:75]
 v_cvt_pk_bf16_f32 v23, v34, v35
 v_mfma_f32_16x16x32_bf16 v[76:79], a[0:3], a[60:63], v[76:79]
 v_cvt_pk_bf16_f32 v24, v36, v37
 s_waitcnt lgkmcnt(6)
 v_mfma_f32_16x16x32_bf16 v[80:83], a[4:7], a[48:51], v[80:83]
 ds_read_b64_tr_b16 a[20:21], v7 offset:49152
 v_cvt_pk_bf16_f32 v25, v38, v39
 s_add_u32 m0, s69, 8192
 v_mfma_f32_16x16x32_bf16 v[84:87], a[4:7], a[52:55], v[84:87]
 ds_read_b64_tr_b16 a[22:23], v7 offset:50176
 v_cvt_pk_bf16_f32 v26, v40, v41
 s_add_u32 s27, s70, 512
 v_mfma_f32_16x16x32_bf16 v[88:91], a[4:7], a[56:59], v[88:91]
 buffer_load_dwordx4 v12, s[8:11], s27 offen lds
 v_cvt_pk_bf16_f32 v27, v42, v43
 v_mfma_f32_16x16x32_bf16 v[92:95], a[4:7], a[60:63], v[92:95]
 s_add_u32 m0, s69, 6144
 v_cvt_pk_bf16_f32 v28, v44, v45
 s_waitcnt lgkmcnt(6)
 v_mfma_f32_16x16x32_bf16 v[96:99], a[8:11], a[48:51], v[96:99]
 ds_read_b64_tr_b16 a[24:25], v8 offset:49152
 v_cvt_pk_bf16_f32 v29, v46, v47
 s_add_u32 s27, s70, 49536
 v_mfma_f32_16x16x32_bf16 v[100:103], a[8:11], a[52:55], v[100:103]
 ds_read_b64_tr_b16 a[26:27], v8 offset:50176
 v_cvt_pk_bf16_f32 v30, v48, v49
 buffer_load_dwordx4 v12, s[8:11], s27 offen lds
 v_mfma_f32_16x16x32_bf16 v[104:107], a[8:11], a[56:59], v[104:107]
 v_cvt_pk_bf16_f32 v31, v50, v51
 v_mfma_f32_16x16x32_bf16 v[108:111], a[8:11], a[60:63], v[108:111]
 v_lshlrev_b32 v32, 16, v22
 s_waitcnt lgkmcnt(6)
 v_mfma_f32_16x16x32_bf16 v[112:115], a[12:15], a[48:51], v[112:115]
 ds_read_b64_tr_b16 a[28:29], v9 offset:49152
 v_and_b32 v33, s61, v22
 s_add_u32 m0, s59, 24576
 v_mfma_f32_16x16x32_bf16 v[116:119], a[12:15], a[52:55], v[116:119]
 ds_read_b64_tr_b16 a[30:31], v9 offset:50176
 v_lshlrev_b32 v34, 16, v23
 s_add_u32 s27, s67, 1310720
 v_mfma_f32_16x16x32_bf16 v[120:123], a[12:15], a[56:59], v[120:123]
 buffer_load_dwordx4 v10, s[16:19], s27 offen nt lds
 v_and_b32 v35, s61, v23
 v_mfma_f32_16x16x32_bf16 v[124:127], a[12:15], a[60:63], v[124:127]
 v_lshlrev_b32 v36, 16, v24
 s_waitcnt lgkmcnt(6)
 v_mfma_f32_16x16x32_bf16 a[64:67], a[16:19], a[48:51], a[64:67]
 ds_read_b64_tr_b16 a[0:1], v2 offset:57344
 v_and_b32 v37, s61, v24
 v_mfma_f32_16x16x32_bf16 a[68:71], a[16:19], a[52:55], a[68:71]
 ds_read_b64_tr_b16 a[2:3], v2 offset:58368
 v_lshlrev_b32 v38, 16, v25
 v_mfma_f32_16x16x32_bf16 a[72:75], a[16:19], a[56:59], a[72:75]
 v_and_b32 v39, s61, v25
 v_mfma_f32_16x16x32_bf16 a[76:79], a[16:19], a[60:63], a[76:79]
 s_add_u32 m0, s69, 9216
 v_lshlrev_b32 v40, 16, v26
 s_waitcnt lgkmcnt(6)
 v_mfma_f32_16x16x32_bf16 a[80:83], a[20:23], a[48:51], a[80:83]
 ds_read_b64_tr_b16 a[4:5], v3 offset:57344
 v_and_b32 v41, s61, v26
 s_add_u32 s27, s70, 8704
 v_mfma_f32_16x16x32_bf16 a[84:87], a[20:23], a[52:55], a[84:87]
 ds_read_b64_tr_b16 a[6:7], v3 offset:58368
 v_lshlrev_b32 v42, 16, v27
 buffer_load_dwordx4 v13, s[8:11], s27 offen lds
 v_mfma_f32_16x16x32_bf16 a[88:91], a[20:23], a[56:59], a[88:91]
 s_add_u32 m0, s69, 7168
 v_and_b32 v43, s61, v27
 v_mfma_f32_16x16x32_bf16 a[92:95], a[20:23], a[60:63], a[92:95]
 s_add_u32 s27, s70, 57728
 v_lshlrev_b32 v44, 16, v28
 s_waitcnt lgkmcnt(6)
 v_mfma_f32_16x16x32_bf16 a[96:99], a[24:27], a[48:51], a[96:99]
 ds_read_b64_tr_b16 a[8:9], v4 offset:57344
 v_and_b32 v45, s61, v28
 buffer_load_dwordx4 v13, s[8:11], s27 offen lds
 v_mfma_f32_16x16x32_bf16 a[100:103], a[24:27], a[52:55], a[100:103]
 ds_read_b64_tr_b16 a[10:11], v4 offset:58368
 v_lshlrev_b32 v46, 16, v29
 v_mfma_f32_16x16x32_bf16 a[104:107], a[24:27], a[56:59], a[104:107]
 v_and_b32 v47, s61, v29
 v_mfma_f32_16x16x32_bf16 a[108:111], a[24:27], a[60:63], a[108:111]
 v_lshlrev_b32 v48, 16, v30
 s_waitcnt lgkmcnt(6)
 v_mfma_f32_16x16x32_bf16 a[112:115], a[28:31], a[48:51], a[112:115]
 ds_read_b64_tr_b16 a[12:13], v5 offset:57344
 v_and_b32 v49, s61, v30
 s_add_u32 m0, s59, 25600
 v_mfma_f32_16x16x32_bf16 a[116:119], a[28:31], a[52:55], a[116:119]
 ds_read_b64_tr_b16 a[14:15], v5 offset:58368
 v_lshlrev_b32 v50, 16, v31
 s_add_u32 s27, s67, 1310720
 v_mfma_f32_16x16x32_bf16 a[120:123], a[28:31], a[56:59], a[120:123]
 buffer_load_dwordx4 v11, s[16:19], s27 offen nt lds
 v_and_b32 v51, s61, v31
 v_mfma_f32_16x16x32_bf16 a[124:127], a[28:31], a[60:63], a[124:127]
 v_mul_f32 v32, v32, v53
 s_waitcnt lgkmcnt(6)
 v_mfma_f32_16x16x32_bf16 v[128:131], a[48:51], a[0:3], v[128:131]
 ds_read_b64_tr_b16 a[16:17], v6 offset:57344
 v_mul_f32 v33, v33, v53
 v_mfma_f32_16x16x32_bf16 v[132:135], a[52:55], a[0:3], v[132:135]
 ds_read_b64_tr_b16 a[18:19], v6 offset:58368
 v_mul_f32 v34, v34, v53
 v_mfma_f32_16x16x32_bf16 v[136:139], a[56:59], a[0:3], v[136:139]
 s_waitcnt vmcnt(16)
 ds_read_b128 a[32:35], v14 offset:16384
 v_mul_f32 v35, v35, v53
 s_add_u32 m0, s69, 10240
 v_mfma_f32_16x16x32_bf16 v[140:143], a[60:63], a[0:3], v[140:143]
 s_add_u32 s27, s70, 16896
 v_mul_f32 v36, v36, v53
 s_waitcnt lgkmcnt(7)
 v_mfma_f32_16x16x32_bf16 v[144:147], a[48:51], a[4:7], v[144:147]
 ds_read_b64_tr_b16 a[20:21], v7 offset:57344
 v_mul_f32 v37, v37, v53
 buffer_load_dwordx4 v12, s[8:11], s27 offen lds
 v_mfma_f32_16x16x32_bf16 v[148:151], a[52:55], a[4:7], v[148:151]
 ds_read_b64_tr_b16 a[22:23], v7 offset:58368
 v_mul_f32 v38, v38, v53
 v_mfma_f32_16x16x32_bf16 v[152:155], a[56:59], a[4:7], v[152:155]
 ds_read_b128 a[36:39], v14 offset:18432
 v_mul_f32 v39, v39, v53
 v_mfma_f32_16x16x32_bf16 v[156:159], a[60:63], a[4:7], v[156:159]
 v_mul_f32 v40, v40, v53
 s_waitcnt lgkmcnt(8)
 v_mfma_f32_16x16x32_bf16 v[160:163], a[48:51], a[8:11], v[160:163]
 ds_read_b64_tr_b16 a[24:25], v8 offset:57344
 v_mul_f32 v41, v41, v53
 v_mfma_f32_16x16x32_bf16 v[164:167], a[52:55], a[8:11], v[164:167]
 ds_read_b64_tr_b16 a[26:27], v8 offset:58368
 v_mul_f32 v42, v42, v53
 v_mfma_f32_16x16x32_bf16 v[168:171], a[56:59], a[8:11], v[168:171]
 ds_read_b128 a[40:43], v14 offset:20480
 v_mul_f32 v43, v43, v53
 v_mfma_f32_16x16x32_bf16 v[172:175], a[60:63], a[8:11], v[172:175]
 v_mul_f32 v44, v44, v53
 s_waitcnt lgkmcnt(9)
 v_mfma_f32_16x16x32_bf16 v[176:179], a[48:51], a[12:15], v[176:179]
 s_waitcnt vmcnt(11)
 s_barrier
 ds_read_b64_tr_b16 a[28:29], v9 offset:57344
 s_add_u32 m0, s59, 32768
 v_mfma_f32_16x16x32_bf16 v[180:183], a[52:55], a[12:15], v[180:183]
 ds_read_b64_tr_b16 a[30:31], v9 offset:58368
 v_mul_f32 v45, v45, v53
 s_add_u32 s27, s67, 1572864
 v_mfma_f32_16x16x32_bf16 v[184:187], a[56:59], a[12:15], v[184:187]
 ds_read_b128 a[44:47], v14 offset:22528
 v_mul_f32 v46, v46, v53
 buffer_load_dwordx4 v10, s[12:15], s27 offen nt lds
 v_mfma_f32_16x16x32_bf16 v[188:191], a[60:63], a[12:15], v[188:191]
 v_mul_f32 v47, v47, v53
 s_waitcnt lgkmcnt(10)
 v_mfma_f32_16x16x32_bf16 v[192:195], a[48:51], a[16:19], v[192:195]
 ds_read_b64_tr_b16 a[0:1], v2
 v_mul_f32 v48, v48, v53
 v_mfma_f32_16x16x32_bf16 v[196:199], a[52:55], a[16:19], v[196:199]
 ds_read_b64_tr_b16 a[2:3], v2 offset:1024
 v_mul_f32 v49, v49, v53
 s_add_u32 m0, s69, 11264
 v_mfma_f32_16x16x32_bf16 v[200:203], a[56:59], a[16:19], v[200:203]
 s_add_u32 s27, s70, 25088
 v_mul_f32 v50, v50, v53
 v_mfma_f32_16x16x32_bf16 v[204:207], a[60:63], a[16:19], v[204:207]
 buffer_load_dwordx4 v13, s[8:11], s27 offen lds
 v_mul_f32 v51, v51, v53
 s_waitcnt lgkmcnt(9)
 v_mfma_f32_16x16x32_bf16 v[208:211], a[48:51], a[20:23], v[208:211]
 ds_read_b64_tr_b16 a[4:5], v3
 v_cvt_pk_bf16_f32 v22, v32, v33
 v_mfma_f32_16x16x32_bf16 v[212:215], a[52:55], a[20:23], v[212:215]
 ds_read_b64_tr_b16 a[6:7], v3 offset:1024
 v_cvt_pk_bf16_f32 v23, v34, v35
 v_mfma_f32_16x16x32_bf16 v[216:219], a[56:59], a[20:23], v[216:219]
 v_cvt_pk_bf16_f32 v24, v36, v37
 v_mfma_f32_16x16x32_bf16 v[220:223], a[60:63], a[20:23], v[220:223]
 v_cvt_pk_bf16_f32 v25, v38, v39
 s_waitcnt lgkmcnt(8)
 v_mfma_f32_16x16x32_bf16 v[224:227], a[48:51], a[24:27], v[224:227]
 ds_read_b64_tr_b16 a[8:9], v4
 v_cvt_pk_bf16_f32 v26, v40, v41
 v_mfma_f32_16x16x32_bf16 v[228:231], a[52:55], a[24:27], v[228:231]
 ds_read_b64_tr_b16 a[10:11], v4 offset:1024
 v_cvt_pk_bf16_f32 v27, v42, v43
 v_mfma_f32_16x16x32_bf16 v[232:235], a[56:59], a[24:27], v[232:235]
 v_cvt_pk_bf16_f32 v28, v44, v45
 v_mfma_f32_16x16x32_bf16 v[236:239], a[60:63], a[24:27], v[236:239]
 v_cvt_pk_bf16_f32 v29, v46, v47
 s_waitcnt lgkmcnt(7)
 v_mfma_f32_16x16x32_bf16 v[240:243], a[48:51], a[28:31], v[240:243]
 ds_read_b64_tr_b16 a[12:13], v5
 v_cvt_pk_bf16_f32 v30, v48, v49
 s_add_u32 m0, s59, 33792
 v_mfma_f32_16x16x32_bf16 v[244:247], a[52:55], a[28:31], v[244:247]
 ds_read_b64_tr_b16 a[14:15], v5 offset:1024
 v_cvt_pk_bf16_f32 v31, v50, v51
 s_add_u32 s27, s67, 1572864
 v_mfma_f32_16x16x32_bf16 v[248:251], a[56:59], a[28:31], v[248:251]
 buffer_load_dwordx4 v11, s[12:15], s27 offen nt lds
 v_bfe_u32 v58, v0, 1, 4
 v_mfma_f32_16x16x32_bf16 v[252:255], a[60:63], a[28:31], v[252:255]
 v_lshrrev_b32 v57, 5, v0
 s_waitcnt lgkmcnt(6)
 v_mfma_f32_16x16x32_bf16 v[64:67], a[0:3], a[32:35], v[64:67]
 ds_read_b64_tr_b16 a[16:17], v6
 s_add_u32 m0, s69, 12288
 s_lshl_b32 s52, s44, 1
 v_mfma_f32_16x16x32_bf16 v[68:71], a[0:3], a[36:39], v[68:71]
 ds_read_b64_tr_b16 a[18:19], v6 offset:1024
 v_add_u32 v57, s52, v57
 s_add_u32 s27, s70, 33280
 v_mfma_f32_16x16x32_bf16 v[72:75], a[0:3], a[40:43], v[72:75]
 buffer_load_dwordx4 v12, s[8:11], s27 offen lds
 v_and_b32 v60, 7, v58
 v_mfma_f32_16x16x32_bf16 v[76:79], a[0:3], a[44:47], v[76:79]
 v_xor_b32 v57, v57, v60
 s_waitcnt lgkmcnt(6)
 v_mfma_f32_16x16x32_bf16 v[80:83], a[4:7], a[32:35], v[80:83]
 ds_read_b64_tr_b16 a[20:21], v7
 v_lshlrev_b32 v58, 7, v58
 v_mfma_f32_16x16x32_bf16 v[84:87], a[4:7], a[36:39], v[84:87]
 ds_read_b64_tr_b16 a[22:23], v7 offset:1024
 v_lshl_add_u32 v58, v57, 4, v58
 v_mfma_f32_16x16x32_bf16 v[88:91], a[4:7], a[40:43], v[88:91]
 v_and_b32 v57, 1, v0
 v_mfma_f32_16x16x32_bf16 v[92:95], a[4:7], a[44:47], v[92:95]
 v_lshl_add_u32 v58, v57, 3, v58
 s_waitcnt lgkmcnt(6)
 v_mfma_f32_16x16x32_bf16 v[96:99], a[8:11], a[32:35], v[96:99]
 ds_read_b64_tr_b16 a[24:25], v8
 s_lshl_b32 s52, s44, 5
 v_mfma_f32_16x16x32_bf16 v[100:103], a[8:11], a[36:39], v[100:103]
 ds_read_b64_tr_b16 a[26:27], v8 offset:1024
 s_sub_u32 s53, s53, s52
 v_mfma_f32_16x16x32_bf16 v[104:107], a[8:11], a[40:43], v[104:107]
 v_add_u32 v57, s65, v1
 v_mfma_f32_16x16x32_bf16 v[108:111], a[8:11], a[44:47], v[108:111]
 v_min_u32 v59, 7, v0
 v_lshlrev_b32 v59, 7, v59
 s_add_u32 s53, s53, s59
 s_waitcnt lgkmcnt(6)
 v_mfma_f32_16x16x32_bf16 v[112:115], a[12:15], a[32:35], v[112:115]
 ds_read_b64_tr_b16 a[28:29], v9
 v_lshrrev_b32 v60, 3, v0
 s_add_u32 m0, s59, 40960
 v_mfma_f32_16x16x32_bf16 v[116:119], a[12:15], a[36:39], v[116:119]
 ds_read_b64_tr_b16 a[30:31], v9 offset:1024
 v_and_b32 v62, 7, v0
 s_add_u32 s27, s67, 1572864
 v_mfma_f32_16x16x32_bf16 v[120:123], a[12:15], a[40:43], v[120:123]
 buffer_load_dwordx4 v10, s[16:19], s27 offen nt lds
 v_xor_b32 v62, v62, v60
 v_mfma_f32_16x16x32_bf16 v[124:127], a[12:15], a[44:47], v[124:127]
 s_add_u32 m0, s69, 13312
 v_lshlrev_b32 v60, 8, v60
 s_waitcnt lgkmcnt(6)
 v_mfma_f32_16x16x32_bf16 a[64:67], a[16:19], a[32:35], a[64:67]
 ds_read_b64_tr_b16 a[0:1], v2 offset:8192
 v_lshl_add_u32 v60, v62, 4, v60
 s_add_u32 s27, s70, 41472
 v_mfma_f32_16x16x32_bf16 a[68:71], a[16:19], a[36:39], a[68:71]
 ds_read_b64_tr_b16 a[2:3], v2 offset:9216
 buffer_load_dwordx4 v13, s[8:11], s27 offen lds
 v_mfma_f32_16x16x32_bf16 a[72:75], a[16:19], a[40:43], a[72:75]
 v_min_u32 v63, 4, v0
 v_mul_u32_u24 v63, 3456, v63
 v_mfma_f32_16x16x32_bf16 a[76:79], a[16:19], a[44:47], a[76:79]
 buffer_load_dword a255, v59, s[28:31], s62 offen
 s_add_u32 s62, s62, 8192
 s_waitcnt lgkmcnt(6)
 v_mfma_f32_16x16x32_bf16 a[80:83], a[20:23], a[32:35], a[80:83]
 buffer_load_dword a255, v63, s[32:35], s63 offen
 s_add_u32 s63, s63, 17280
 ds_read_b64_tr_b16 a[4:5], v3 offset:8192
 v_mfma_f32_16x16x32_bf16 a[84:87], a[20:23], a[36:39], a[84:87]
 ds_read_b64_tr_b16 a[6:7], v3 offset:9216
 v_mfma_f32_16x16x32_bf16 a[88:91], a[20:23], a[40:43], a[88:91]
 v_mfma_f32_16x16x32_bf16 a[92:95], a[20:23], a[44:47], a[92:95]
 s_waitcnt lgkmcnt(6)
 v_mfma_f32_16x16x32_bf16 a[96:99], a[24:27], a[32:35], a[96:99]
 ds_read_b64_tr_b16 a[8:9], v4 offset:8192
 v_mfma_f32_16x16x32_bf16 a[100:103], a[24:27], a[36:39], a[100:103]
 ds_read_b64_tr_b16 a[10:11], v4 offset:9216
 v_mfma_f32_16x16x32_bf16 a[104:107], a[24:27], a[40:43], a[104:107]
 v_mfma_f32_16x16x32_bf16 a[108:111], a[24:27], a[44:47], a[108:111]
 s_waitcnt lgkmcnt(6)
 v_mfma_f32_16x16x32_bf16 a[112:115], a[28:31], a[32:35], a[112:115]
 ds_read_b64_tr_b16 a[12:13], v5 offset:8192
 s_add_u32 m0, s59, 41984
 v_mfma_f32_16x16x32_bf16 a[116:119], a[28:31], a[36:39], a[116:119]
 ds_read_b64_tr_b16 a[14:15], v5 offset:9216
 s_add_u32 s27, s67, 1572864
 v_mfma_f32_16x16x32_bf16 a[120:123], a[28:31], a[40:43], a[120:123]
 buffer_load_dwordx4 v11, s[16:19], s27 offen nt lds
 v_mfma_f32_16x16x32_bf16 a[124:127], a[28:31], a[44:47], a[124:127]
 s_add_u32 m0, s69, 14336
 s_waitcnt lgkmcnt(6)
 v_mfma_f32_16x16x32_bf16 v[128:131], a[32:35], a[0:3], v[128:131]
 ds_read_b64_tr_b16 a[16:17], v6 offset:8192
 s_add_u32 s27, s70, 49664
 v_mfma_f32_16x16x32_bf16 v[132:135], a[36:39], a[0:3], v[132:135]
 ds_read_b64_tr_b16 a[18:19], v6 offset:9216
 buffer_load_dwordx4 v12, s[8:11], s27 offen lds
 v_mfma_f32_16x16x32_bf16 v[136:139], a[40:43], a[0:3], v[136:139]
 ds_read_b128 a[48:51], v15 offset:16384
 v_mfma_f32_16x16x32_bf16 v[140:143], a[44:47], a[0:3], v[140:143]
 s_waitcnt lgkmcnt(7)
 v_mfma_f32_16x16x32_bf16 v[144:147], a[32:35], a[4:7], v[144:147]
 ds_read_b64_tr_b16 a[20:21], v7 offset:8192
 v_mfma_f32_16x16x32_bf16 v[148:151], a[36:39], a[4:7], v[148:151]
 ds_read_b64_tr_b16 a[22:23], v7 offset:9216
 v_mfma_f32_16x16x32_bf16 v[152:155], a[40:43], a[4:7], v[152:155]
 ds_read_b128 a[52:55], v15 offset:18432
 v_mfma_f32_16x16x32_bf16 v[156:159], a[44:47], a[4:7], v[156:159]
 s_waitcnt lgkmcnt(8)
 v_mfma_f32_16x16x32_bf16 v[160:163], a[32:35], a[8:11], v[160:163]
 ds_read_b64_tr_b16 a[24:25], v8 offset:8192
 v_mfma_f32_16x16x32_bf16 v[164:167], a[36:39], a[8:11], v[164:167]
 ds_read_b64_tr_b16 a[26:27], v8 offset:9216
 v_mfma_f32_16x16x32_bf16 v[168:171], a[40:43], a[8:11], v[168:171]
 ds_read_b128 a[56:59], v15 offset:20480
 v_mfma_f32_16x16x32_bf16 v[172:175], a[44:47], a[8:11], v[172:175]
 s_waitcnt lgkmcnt(9)
 v_mfma_f32_16x16x32_bf16 v[176:179], a[32:35], a[12:15], v[176:179]
 s_waitcnt vmcnt(11)
 s_barrier
 ds_read_b64_tr_b16 a[28:29], v9 offset:8192
 v_mfma_f32_16x16x32_bf16 v[180:183], a[36:39], a[12:15], v[180:183]
 ds_read_b64_tr_b16 a[30:31], v9 offset:9216
 s_add_u32 m0, s69, 15360
 ds_write_b64 v58, v[22:23] offset:49152
 v_mfma_f32_16x16x32_bf16 v[184:187], a[40:43], a[12:15], v[184:187]
 ds_read_b128 a[60:63], v15 offset:22528
 s_add_u32 s27, s70, 57856
 ds_write_b64 v58, v[24:25] offset:51200
 v_mfma_f32_16x16x32_bf16 v[188:191], a[44:47], a[12:15], v[188:191]
 buffer_load_dwordx4 v13, s[8:11], s27 offen lds
 ds_write_b64 v58, v[26:27] offset:53248
 s_waitcnt lgkmcnt(13)
 v_mfma_f32_16x16x32_bf16 v[192:195], a[32:35], a[16:19], v[192:195]
 ds_read_b64_tr_b16 a[0:1], v2 offset:16384
 ds_write_b64 v58, v[28:29] offset:55296
 v_mfma_f32_16x16x32_bf16 v[196:199], a[36:39], a[16:19], v[196:199]
 s_waitcnt lgkmcnt(12)
 ds_read_b64_tr_b16 a[2:3], v2 offset:17408
 ds_write_b64 v58, v[30:31] offset:57344
 v_mfma_f32_16x16x32_bf16 v[200:203], a[40:43], a[16:19], v[200:203]
 buffer_load_dword a255, v59, s[28:31], s62 offen
 s_add_u32 s62, s62, 8192
 v_mfma_f32_16x16x32_bf16 v[204:207], a[44:47], a[16:19], v[204:207]
 v_mfma_f32_16x16x32_bf16 v[208:211], a[32:35], a[20:23], v[208:211]
 ds_read_b64_tr_b16 a[4:5], v3 offset:16384
 v_mfma_f32_16x16x32_bf16 v[212:215], a[36:39], a[20:23], v[212:215]
 s_waitcnt lgkmcnt(12)
 ds_read_b64_tr_b16 a[6:7], v3 offset:17408
 v_mfma_f32_16x16x32_bf16 v[216:219], a[40:43], a[20:23], v[216:219]
 v_mfma_f32_16x16x32_bf16 v[220:223], a[44:47], a[20:23], v[220:223]
 v_mfma_f32_16x16x32_bf16 v[224:227], a[32:35], a[24:27], v[224:227]
 ds_read_b64_tr_b16 a[8:9], v4 offset:16384
 s_waitcnt lgkmcnt(3)
 s_barrier
 v_mfma_f32_16x16x32_bf16 v[228:231], a[36:39], a[24:27], v[228:231]
 ds_read_b64_tr_b16 a[10:11], v4 offset:17408
 ds_read_b128 a[128:131], v57 offset:49152
 v_mfma_f32_16x16x32_bf16 v[232:235], a[40:43], a[24:27], v[232:235]
 ds_read_b128 a[132:135], v57 offset:53248
 v_mfma_f32_16x16x32_bf16 v[236:239], a[44:47], a[24:27], v[236:239]
 ds_read_b128 a[136:139], v57 offset:57344
 v_mfma_f32_16x16x32_bf16 v[240:243], a[32:35], a[28:31], v[240:243]
 ds_read_b64_tr_b16 a[12:13], v5 offset:16384
 v_mfma_f32_16x16x32_bf16 v[244:247], a[36:39], a[28:31], v[244:247]
 ds_read_b64_tr_b16 a[14:15], v5 offset:17408
 v_mfma_f32_16x16x32_bf16 v[248:251], a[40:43], a[28:31], v[248:251]
 v_mfma_f32_16x16x32_bf16 v[252:255], a[44:47], a[28:31], v[252:255]
 v_mfma_f32_16x16x32_bf16 v[64:67], a[0:3], a[48:51], v[64:67]
 ds_read_b64_tr_b16 a[16:17], v6 offset:16384
 v_mfma_f32_16x16x32_bf16 v[68:71], a[0:3], a[52:55], v[68:71]
 ds_read_b64_tr_b16 a[18:19], v6 offset:17408
 v_mfma_f32_16x16x32_bf16 v[72:75], a[0:3], a[56:59], v[72:75]
 v_mfma_f32_16x16x32_bf16 v[76:79], a[0:3], a[60:63], v[76:79]
 s_waitcnt lgkmcnt(9)
 v_mfma_f32_16x16x32_bf16 v[80:83], a[4:7], a[48:51], v[80:83]
 ds_read_b64_tr_b16 a[20:21], v7 offset:16384
 s_add_u32 m0, s69, 16384
 s_waitcnt lgkmcnt(5)
 s_barrier
 v_mfma_f32_16x16x32_bf16 v[84:87], a[4:7], a[52:55], v[84:87]
 ds_read_b64_tr_b16 a[22:23], v7 offset:17408
 s_add_u32 s27, s70, 640
 v_mfma_f32_16x16x32_bf16 v[88:91], a[4:7], a[56:59], v[88:91]
 buffer_load_dwordx4 v12, s[8:11], s27 offen lds
 v_mfma_f32_16x16x32_bf16 v[92:95], a[4:7], a[60:63], v[92:95]
 s_add_u32 m0, s59, 49152
 v_mfma_f32_16x16x32_bf16 v[96:99], a[8:11], a[48:51], v[96:99]
 ds_read_b64_tr_b16 a[24:25], v8 offset:16384
 s_add_u32 s27, s67, 1835008
 v_mfma_f32_16x16x32_bf16 v[100:103], a[8:11], a[52:55], v[100:103]
 ds_read_b64_tr_b16 a[26:27], v8 offset:17408
 buffer_load_dwordx4 v10, s[12:15], s27 offen nt lds
 v_mfma_f32_16x16x32_bf16 v[104:107], a[8:11], a[56:59], v[104:107]
 s_add_u32 m0, s59, 50176
 v_mfma_f32_16x16x32_bf16 v[108:111], a[8:11], a[60:63], v[108:111]
 s_add_u32 s27, s67, 1835008
 s_waitcnt lgkmcnt(6)
 v_mfma_f32_16x16x32_bf16 v[112:115], a[12:15], a[48:51], v[112:115]
 ds_read_b64_tr_b16 a[28:29], v9 offset:16384
 buffer_load_dwordx4 v11, s[12:15], s27 offen nt lds
 v_mfma_f32_16x16x32_bf16 v[116:119], a[12:15], a[52:55], v[116:119]
 ds_read_b64_tr_b16 a[30:31], v9 offset:17408
 s_add_u32 m0, s59, 57344
 v_mfma_f32_16x16x32_bf16 v[120:123], a[12:15], a[56:59], v[120:123]
 s_add_u32 s27, s67, 1835008
 v_mfma_f32_16x16x32_bf16 v[124:127], a[12:15], a[60:63], v[124:127]
 buffer_load_dwordx4 v10, s[16:19], s27 offen nt lds
 s_waitcnt lgkmcnt(6)
 v_mfma_f32_16x16x32_bf16 a[64:67], a[16:19], a[48:51], a[64:67]
 ds_read_b64_tr_b16 a[0:1], v2 offset:24576
 v_mfma_f32_16x16x32_bf16 a[68:71], a[16:19], a[52:55], a[68:71]
 ds_read_b64_tr_b16 a[2:3], v2 offset:25600
 s_add_u32 m0, s59, 58368
 v_mfma_f32_16x16x32_bf16 a[72:75], a[16:19], a[56:59], a[72:75]
 s_add_u32 s27, s67, 1835008
 v_mfma_f32_16x16x32_bf16 a[76:79], a[16:19], a[60:63], a[76:79]
 buffer_load_dwordx4 v11, s[16:19], s27 offen nt lds
 s_waitcnt lgkmcnt(6)
 v_mfma_f32_16x16x32_bf16 a[80:83], a[20:23], a[48:51], a[80:83]
 ds_read_b64_tr_b16 a[4:5], v3 offset:24576
 s_add_u32 m0, s69, 17408
 v_mfma_f32_16x16x32_bf16 a[84:87], a[20:23], a[52:55], a[84:87]
 ds_read_b64_tr_b16 a[6:7], v3 offset:25600
 s_add_u32 s27, s70, 8832
 v_mfma_f32_16x16x32_bf16 a[88:91], a[20:23], a[56:59], a[88:91]
 buffer_load_dwordx4 v13, s[8:11], s27 offen lds
 v_mfma_f32_16x16x32_bf16 a[92:95], a[20:23], a[60:63], a[92:95]
 s_waitcnt lgkmcnt(6)
 v_mfma_f32_16x16x32_bf16 a[96:99], a[24:27], a[48:51], a[96:99]
 ds_read_b64_tr_b16 a[8:9], v4 offset:24576
 v_mfma_f32_16x16x32_bf16 a[100:103], a[24:27], a[52:55], a[100:103]
 ds_read_b64_tr_b16 a[10:11], v4 offset:25600
 buffer_store_dwordx4 a[128:131], v60, s[4:7], s53 offen sc1
 v_mfma_f32_16x16x32_bf16 a[104:107], a[24:27], a[56:59], a[104:107]
 v_mfma_f32_16x16x32_bf16 a[108:111], a[24:27], a[60:63], a[108:111]
 s_waitcnt lgkmcnt(6)
 v_mfma_f32_16x16x32_bf16 a[112:115], a[28:31], a[48:51], a[112:115]
 ds_read_b64_tr_b16 a[12:13], v5 offset:24576
 v_mfma_f32_16x16x32_bf16 a[116:119], a[28:31], a[52:55], a[116:119]
 ds_read_b64_tr_b16 a[14:15], v5 offset:25600
 v_mfma_f32_16x16x32_bf16 a[120:123], a[28:31], a[56:59], a[120:123]
 s_add_u32 s52, s53, 8192
 buffer_store_dwordx4 a[132:135], v60, s[4:7], s52 offen sc1
 v_mfma_f32_16x16x32_bf16 a[124:127], a[28:31], a[60:63], a[124:127]
 s_waitcnt lgkmcnt(6)
 v_mfma_f32_16x16x32_bf16 v[128:131], a[48:51], a[0:3], v[128:131]
 ds_read_b64_tr_b16 a[16:17], v6 offset:24576
 v_mfma_f32_16x16x32_bf16 v[132:135], a[52:55], a[0:3], v[132:135]
 ds_read_b64_tr_b16 a[18:19], v6 offset:25600
 v_mfma_f32_16x16x32_bf16 v[136:139], a[56:59], a[0:3], v[136:139]
 ds_read_b128 a[32:35], v14
 s_add_u32 m0, s69, 18432
 v_mfma_f32_16x16x32_bf16 v[140:143], a[60:63], a[0:3], v[140:143]
 s_add_u32 s27, s70, 17024
 s_waitcnt lgkmcnt(7)
 v_mfma_f32_16x16x32_bf16 v[144:147], a[48:51], a[4:7], v[144:147]
 ds_read_b64_tr_b16 a[20:21], v7 offset:24576
 buffer_load_dwordx4 v12, s[8:11], s27 offen lds
 v_mfma_f32_16x16x32_bf16 v[148:151], a[52:55], a[4:7], v[148:151]
 ds_read_b64_tr_b16 a[22:23], v7 offset:25600
 v_mfma_f32_16x16x32_bf16 v[152:155], a[56:59], a[4:7], v[152:155]
 ds_read_b128 a[36:39], v14 offset:2048
 v_mfma_f32_16x16x32_bf16 v[156:159], a[60:63], a[4:7], v[156:159]
 s_add_u32 s52, s53, 16384
 s_cmp_lt_u32 s44, 2
 s_cselect_b32 s52, s52, s51
 s_waitcnt lgkmcnt(8)
 v_mfma_f32_16x16x32_bf16 v[160:163], a[48:51], a[8:11], v[160:163]
 ds_read_b64_tr_b16 a[24:25], v8 offset:24576
 buffer_store_dwordx4 a[136:139], v60, s[4:7], s52 offen sc1
 v_mfma_f32_16x16x32_bf16 v[164:167], a[52:55], a[8:11], v[164:167]
 ds_read_b64_tr_b16 a[26:27], v8 offset:25600
 v_lshlrev_b32 v32, 16, v22
 v_mfma_f32_16x16x32_bf16 v[168:171], a[56:59], a[8:11], v[168:171]
 ds_read_b128 a[40:43], v14 offset:4096
 v_and_b32 v33, s61, v22
 v_mfma_f32_16x16x32_bf16 v[172:175], a[60:63], a[8:11], v[172:175]
 v_lshlrev_b32 v34, 16, v23
 s_waitcnt lgkmcnt(9)
 v_mfma_f32_16x16x32_bf16 v[176:179], a[48:51], a[12:15], v[176:179]
 s_waitcnt vmcnt(13)
 s_barrier
 ds_read_b64_tr_b16 a[28:29], v9 offset:24576
 s_add_u32 m0, s59, 0
 v_mfma_f32_16x16x32_bf16 v[180:183], a[52:55], a[12:15], v[180:183]
 ds_read_b64_tr_b16 a[30:31], v9 offset:25600
 v_and_b32 v35, s61, v23
 s_add_u32 s27, s67, 2097152
 v_mfma_f32_16x16x32_bf16 v[184:187], a[56:59], a[12:15], v[184:187]
 ds_read_b128 a[44:47], v14 offset:6144
 v_lshlrev_b32 v36, 16, v24
 buffer_load_dwordx4 v10, s[12:15], s27 offen nt lds
 v_mfma_f32_16x16x32_bf16 v[188:191], a[60:63], a[12:15], v[188:191]
 v_and_b32 v37, s61, v24
 s_waitcnt lgkmcnt(10)
 v_mfma_f32_16x16x32_bf16 v[192:195], a[48:51], a[16:19], v[192:195]
 ds_read_b64_tr_b16 a[0:1], v2 offset:32768
 v_lshlrev_b32 v38, 16, v25
 v_mfma_f32_16x16x32_bf16 v[196:199], a[52:55], a[16:19], v[196:199]
 ds_read_b64_tr_b16 a[2:3], v2 offset:33792
 v_and_b32 v39, s61, v25
 s_add_u32 m0, s69, 19456
 v_mfma_f32_16x16x32_bf16 v[200:203], a[56:59], a[16:19], v[200:203]
 s_add_u32 s27, s70, 25216
 v_lshlrev_b32 v40, 16, v26
 v_mfma_f32_16x16x32_bf16 v[204:207], a[60:63], a[16:19], v[204:207]
 buffer_load_dwordx4 v13, s[8:11], s27 offen lds
 v_and_b32 v41, s61, v26
 s_waitcnt lgkmcnt(9)
 v_mfma_f32_16x16x32_bf16 v[208:211], a[48:51], a[20:23], v[208:211]
 ds_read_b64_tr_b16 a[4:5], v3 offset:32768
 v_lshlrev_b32 v42, 16, v27
 v_mfma_f32_16x16x32_bf16 v[212:215], a[52:55], a[20:23], v[212:215]
 ds_read_b64_tr_b16 a[6:7], v3 offset:33792
 v_and_b32 v43, s61, v27
 v_mfma_f32_16x16x32_bf16 v[216:219], a[56:59], a[20:23], v[216:219]
 buffer_load_dword a255, v63, s[32:35], s63 offen
 s_add_u32 s63, s63, 17280
 v_lshlrev_b32 v44, 16, v28
 v_mfma_f32_16x16x32_bf16 v[220:223], a[60:63], a[20:23], v[220:223]
 v_and_b32 v45, s61, v28
 s_waitcnt lgkmcnt(8)
 v_mfma_f32_16x16x32_bf16 v[224:227], a[48:51], a[24:27], v[224:227]
 ds_read_b64_tr_b16 a[8:9], v4 offset:32768
 v_lshlrev_b32 v46, 16, v29
 v_mfma_f32_16x16x32_bf16 v[228:231], a[52:55], a[24:27], v[228:231]
 ds_read_b64_tr_b16 a[10:11], v4 offset:33792
 v_and_b32 v47, s61, v29
 v_mfma_f32_16x16x32_bf16 v[232:235], a[56:59], a[24:27], v[232:235]
 v_lshlrev_b32 v48, 16, v30
 v_mfma_f32_16x16x32_bf16 v[236:239], a[60:63], a[24:27], v[236:239]
 v_and_b32 v49, s61, v30
 s_waitcnt lgkmcnt(7)
 v_mfma_f32_16x16x32_bf16 v[240:243], a[48:51], a[28:31], v[240:243]
 ds_read_b64_tr_b16 a[12:13], v5 offset:32768
 v_lshlrev_b32 v50, 16, v31
 s_add_u32 m0, s59, 1024
 v_mfma_f32_16x16x32_bf16 v[244:247], a[52:55], a[28:31], v[244:247]
 ds_read_b64_tr_b16 a[14:15], v5 offset:33792
 v_and_b32 v51, s61, v31
 s_add_u32 s27, s67, 2097152
 v_mfma_f32_16x16x32_bf16 v[248:251], a[56:59], a[28:31], v[248:251]
 buffer_load_dwordx4 v11, s[12:15], s27 offen nt lds
 v_add_f32 v52, v32, v33
 v_mfma_f32_16x16x32_bf16 v[252:255], a[60:63], a[28:31], v[252:255]
 v_add_f32 v53, v34, v35
 s_waitcnt lgkmcnt(6)
 v_mfma_f32_16x16x32_bf16 v[64:67], a[0:3], a[32:35], v[64:67]
 ds_read_b64_tr_b16 a[16:17], v6 offset:32768
 v_add_f32 v52, v52, v36
 s_add_u32 m0, s69, 20480
 v_mfma_f32_16x16x32_bf16 v[68:71], a[0:3], a[36:39], v[68:71]
 ds_read_b64_tr_b16 a[18:19], v6 offset:33792
 v_add_f32 v53, v53, v37
 s_add_u32 s27, s70, 33408
 v_mfma_f32_16x16x32_bf16 v[72:75], a[0:3], a[40:43], v[72:75]
 buffer_load_dwordx4 v12, s[8:11], s27 offen lds
 v_add_f32 v52, v52, v38
 v_mfma_f32_16x16x32_bf16 v[76:79], a[0:3], a[44:47], v[76:79]
 v_add_f32 v53, v53, v39
 s_waitcnt lgkmcnt(6)
 v_mfma_f32_16x16x32_bf16 v[80:83], a[4:7], a[32:35], v[80:83]
 ds_read_b64_tr_b16 a[20:21], v7 offset:32768
 v_add_f32 v52, v52, v40
 v_mfma_f32_16x16x32_bf16 v[84:87], a[4:7], a[36:39], v[84:87]
 ds_read_b64_tr_b16 a[22:23], v7 offset:33792
 v_add_f32 v53, v53, v41
 v_mfma_f32_16x16x32_bf16 v[88:91], a[4:7], a[40:43], v[88:91]
 v_add_f32 v52, v52, v42
 v_mfma_f32_16x16x32_bf16 v[92:95], a[4:7], a[44:47], v[92:95]
 v_add_f32 v53, v53, v43
 s_waitcnt lgkmcnt(6)
 v_mfma_f32_16x16x32_bf16 v[96:99], a[8:11], a[32:35], v[96:99]
 ds_read_b64_tr_b16 a[24:25], v8 offset:32768
 v_add_f32 v52, v52, v44
 v_mfma_f32_16x16x32_bf16 v[100:103], a[8:11], a[36:39], v[100:103]
 ds_read_b64_tr_b16 a[26:27], v8 offset:33792
 v_add_f32 v53, v53, v45
 v_mfma_f32_16x16x32_bf16 v[104:107], a[8:11], a[40:43], v[104:107]
 v_add_f32 v52, v52, v46
 v_mfma_f32_16x16x32_bf16 v[108:111], a[8:11], a[44:47], v[108:111]
 v_add_f32 v53, v53, v47
 s_waitcnt lgkmcnt(6)
 v_mfma_f32_16x16x32_bf16 v[112:115], a[12:15], a[32:35], v[112:115]
 ds_read_b64_tr_b16 a[28:29], v9 offset:32768
 v_add_f32 v52, v52, v48
 s_add_u32 m0, s59, 8192
 v_mfma_f32_16x16x32_bf16 v[116:119], a[12:15], a[36:39], v[116:119]
 ds_read_b64_tr_b16 a[30:31], v9 offset:33792
 v_add_f32 v53, v53, v49
 s_add_u32 s27, s67, 2097152
 v_mfma_f32_16x16x32_bf16 v[120:123], a[12:15], a[40:43], v[120:123]
 buffer_load_dwordx4 v10, s[16:19], s27 offen nt lds
 v_add_f32 v52, v52, v50
 v_mfma_f32_16x16x32_bf16 v[124:127], a[12:15], a[44:47], v[124:127]
 s_add_u32 m0, s69, 21504
 v_add_f32 v53, v53, v51
 s_waitcnt lgkmcnt(6)
 v_mfma_f32_16x16x32_bf16 a[64:67], a[16:19], a[32:35], a[64:67]
 ds_read_b64_tr_b16 a[0:1], v2 offset:40960
 v_add_f32 v52, v52, v53
 s_add_u32 s27, s70, 41600
 v_mfma_f32_16x16x32_bf16 a[68:71], a[16:19], a[36:39], a[68:71]
 ds_read_b64_tr_b16 a[2:3], v2 offset:41984
 v_add_f32 v52, v52, v52 row_ror:8
 buffer_load_dwordx4 v13, s[8:11], s27 offen lds
 v_mfma_f32_16x16x32_bf16 a[72:75], a[16:19], a[40:43], a[72:75]
 v_add_f32 v52, v52, v52 row_ror:4
 v_mfma_f32_16x16x32_bf16 a[76:79], a[16:19], a[44:47], a[76:79]
 s_nop 0
 v_add_f32 v52, v52, v52 row_ror:2
 s_waitcnt lgkmcnt(6)
 v_mfma_f32_16x16x32_bf16 a[80:83], a[20:23], a[32:35], a[80:83]
 ds_read_b64_tr_b16 a[4:5], v3 offset:40960
 v_add_f32 v52, v52, v52 row_ror:1
 v_mfma_f32_16x16x32_bf16 a[84:87], a[20:23], a[36:39], a[84:87]
 ds_read_b64_tr_b16 a[6:7], v3 offset:41984
 v_mov_b32 v55, v52
 v_mfma_f32_16x16x32_bf16 a[88:91], a[20:23], a[40:43], a[88:91]
 s_nop 0
 v_permlane16_swap_b32 v55, v52
 v_mfma_f32_16x16x32_bf16 a[92:95], a[20:23], a[44:47], a[92:95]
 v_add_f32 v52, v52, v55
 s_waitcnt lgkmcnt(6)
 v_mfma_f32_16x16x32_bf16 a[96:99], a[24:27], a[32:35], a[96:99]
 ds_read_b64_tr_b16 a[8:9], v4 offset:40960
 v_mul_f32 v52, 0.0015625, v52
 v_mfma_f32_16x16x32_bf16 a[100:103], a[24:27], a[36:39], a[100:103]
 ds_read_b64_tr_b16 a[10:11], v4 offset:41984
 v_sub_f32 v54, v32, v52
 v_mfma_f32_16x16x32_bf16 a[104:107], a[24:27], a[40:43], a[104:107]
 v_mul_f32 v53, v54, v54
 v_mfma_f32_16x16x32_bf16 a[108:111], a[24:27], a[44:47], a[108:111]
 v_sub_f32 v56, v33, v52
 s_waitcnt lgkmcnt(6)
 v_mfma_f32_16x16x32_bf16 a[112:115], a[28:31], a[32:35], a[112:115]
 ds_read_b64_tr_b16 a[12:13], v5 offset:40960
 v_fmac_f32 v53, v56, v56
 s_add_u32 m0, s59, 9216
 v_mfma_f32_16x16x32_bf16 a[116:119], a[28:31], a[36:39], a[116:119]
 ds_read_b64_tr_b16 a[14:15], v5 offset:41984
 v_sub_f32 v54, v34, v52
 s_add_u32 s27, s67, 2097152
 v_mfma_f32_16x16x32_bf16 a[120:123], a[28:31], a[40:43], a[120:123]
 buffer_load_dwordx4 v11, s[16:19], s27 offen nt lds
 v_fmac_f32 v53, v54, v54
 v_mfma_f32_16x16x32_bf16 a[124:127], a[28:31], a[44:47], a[124:127]
 s_add_u32 m0, s69, 22528
 v_sub_f32 v56, v35, v52
 s_waitcnt lgkmcnt(6)
 v_mfma_f32_16x16x32_bf16 v[128:131], a[32:35], a[0:3], v[128:131]
 ds_read_b64_tr_b16 a[16:17], v6 offset:40960
 v_fmac_f32 v53, v56, v56
 s_add_u32 s27, s70, 49792
 v_mfma_f32_16x16x32_bf16 v[132:135], a[36:39], a[0:3], v[132:135]
 ds_read_b64_tr_b16 a[18:19], v6 offset:41984
 v_sub_f32 v54, v36, v52
 buffer_load_dwordx4 v12, s[8:11], s27 offen lds
 v_mfma_f32_16x16x32_bf16 v[136:139], a[40:43], a[0:3], v[136:139]
 ds_read_b128 a[48:51], v15
 v_fmac_f32 v53, v54, v54
 v_mfma_f32_16x16x32_bf16 v[140:143], a[44:47], a[0:3], v[140:143]
 v_sub_f32 v56, v37, v52
 s_waitcnt lgkmcnt(7)
 v_mfma_f32_16x16x32_bf16 v[144:147], a[32:35], a[4:7], v[144:147]
 ds_read_b64_tr_b16 a[20:21], v7 offset:40960
 v_fmac_f32 v53, v56, v56
 v_mfma_f32_16x16x32_bf16 v[148:151], a[36:39], a[4:7], v[148:151]
 ds_read_b64_tr_b16 a[22:23], v7 offset:41984
 v_sub_f32 v54, v38, v52
 v_mfma_f32_16x16x32_bf16 v[152:155], a[40:43], a[4:7], v[152:155]
 ds_read_b128 a[52:55], v15 offset:2048
 v_fmac_f32 v53, v54, v54
 v_mfma_f32_16x16x32_bf16 v[156:159], a[44:47], a[4:7], v[156:159]
 v_sub_f32 v56, v39, v52
 s_waitcnt lgkmcnt(8)
 v_mfma_f32_16x16x32_bf16 v[160:163], a[32:35], a[8:11], v[160:163]
 ds_read_b64_tr_b16 a[24:25], v8 offset:40960
 v_fmac_f32 v53, v56, v56
 v_mfma_f32_16x16x32_bf16 v[164:167], a[36:39], a[8:11], v[164:167]
 ds_read_b64_tr_b16 a[26:27], v8 offset:41984
 v_sub_f32 v54, v40, v52
 v_mfma_f32_16x16x32_bf16 v[168:171], a[40:43], a[8:11], v[168:171]
 ds_read_b128 a[56:59], v15 offset:4096
 v_fmac_f32 v53, v54, v54
 v_mfma_f32_16x16x32_bf16 v[172:175], a[44:47], a[8:11], v[172:175]
 v_sub_f32 v56, v41, v52
 s_waitcnt lgkmcnt(9)
 v_mfma_f32_16x16x32_bf16 v[176:179], a[32:35], a[12:15], v[176:179]
 s_waitcnt vmcnt(14)
 s_barrier
 ds_read_b64_tr_b16 a[28:29], v9 offset:40960
 s_add_u32 m0, s59, 16384
 v_mfma_f32_16x16x32_bf16 v[180:183], a[36:39], a[12:15], v[180:183]
 ds_read_b64_tr_b16 a[30:31], v9 offset:41984
 v_fmac_f32 v53, v56, v56
 s_add_u32 s27, s67, 2359296
 v_mfma_f32_16x16x32_bf16 v[184:187], a[40:43], a[12:15], v[184:187]
 ds_read_b128 a[60:63], v15 offset:6144
 v_sub_f32 v54, v42, v52
 buffer_load_dwordx4 v10, s[12:15], s27 offen nt lds
 v_mfma_f32_16x16x32_bf16 v[188:191], a[44:47], a[12:15], v[188:191]
 s_add_u32 m0, s69, 23552
 v_fmac_f32 v53, v54, v54
 s_waitcnt lgkmcnt(10)
 v_mfma_f32_16x16x32_bf16 v[192:195], a[32:35], a[16:19], v[192:195]
 ds_read_b64_tr_b16 a[0:1], v2 offset:49152
 v_sub_f32 v56, v43, v52
 s_add_u32 s27, s70, 57984
 v_mfma_f32_16x16x32_bf16 v[196:199], a[36:39], a[16:19], v[196:199]
 ds_read_b64_tr_b16 a[2:3], v2 offset:50176
 v_fmac_f32 v53, v56, v56
 buffer_load_dwordx4 v13, s[8:11], s27 offen lds
 v_mfma_f32_16x16x32_bf16 v[200:203], a[40:43], a[16:19], v[200:203]
 buffer_load_dword a255, v59, s[28:31], s62 offen
 s_add_u32 s62, s62, 8192
 v_sub_f32 v54, v44, v52
 v_mfma_f32_16x16x32_bf16 v[204:207], a[44:47], a[16:19], v[204:207]
 v_fmac_f32 v53, v54, v54
 s_waitcnt lgkmcnt(9)
 v_mfma_f32_16x16x32_bf16 v[208:211], a[32:35], a[20:23], v[208:211]
 ds_read_b64_tr_b16 a[4:5], v3 offset:49152
 v_sub_f32 v56, v45, v52
 v_mfma_f32_16x16x32_bf16 v[212:215], a[36:39], a[20:23], v[212:215]
 ds_read_b64_tr_b16 a[6:7], v3 offset:50176
 v_fmac_f32 v53, v56, v56
 v_mfma_f32_16x16x32_bf16 v[216:219], a[40:43], a[20:23], v[216:219]
 v_sub_f32 v54, v46, v52
 v_mfma_f32_16x16x32_bf16 v[220:223], a[44:47], a[20:23], v[220:223]
 v_fmac_f32 v53, v54, v54
 s_waitcnt lgkmcnt(8)
 v_mfma_f32_16x16x32_bf16 v[224:227], a[32:35], a[24:27], v[224:227]
 ds_read_b64_tr_b16 a[8:9], v4 offset:49152
 v_sub_f32 v56, v47, v52
 v_mfma_f32_16x16x32_bf16 v[228:231], a[36:39], a[24:27], v[228:231]
 ds_read_b64_tr_b16 a[10:11], v4 offset:50176
 v_fmac_f32 v53, v56, v56
 v_mfma_f32_16x16x32_bf16 v[232:235], a[40:43], a[24:27], v[232:235]
 v_sub_f32 v54, v48, v52
 v_mfma_f32_16x16x32_bf16 v[236:239], a[44:47], a[24:27], v[236:239]
 v_fmac_f32 v53, v54, v54
 s_waitcnt lgkmcnt(7)
 v_mfma_f32_16x16x32_bf16 v[240:243], a[32:35], a[28:31], v[240:243]
 ds_read_b64_tr_b16 a[12:13], v5 offset:49152
 v_sub_f32 v56, v49, v52
 s_add_u32 m0, s59, 17408
 v_mfma_f32_16x16x32_bf16 v[244:247], a[36:39], a[28:31], v[244:247]
 ds_read_b64_tr_b16 a[14:15], v5 offset:50176
 v_fmac_f32 v53, v56, v56
 s_add_u32 s27, s67, 2359296
 v_mfma_f32_16x16x32_bf16 v[248:251], a[40:43], a[28:31], v[248:251]
 buffer_load_dwordx4 v11, s[12:15], s27 offen nt lds
 v_sub_f32 v54, v50, v52
 v_mfma_f32_16x16x32_bf16 v[252:255], a[44:47], a[28:31], v[252:255]
 v_fmac_f32 v53, v54, v54
 s_waitcnt lgkmcnt(6)
 v_mfma_f32_16x16x32_bf16 v[64:67], a[0:3], a[48:51], v[64:67]
 ds_read_b64_tr_b16 a[16:17], v6 offset:49152
 v_sub_f32 v56, v51, v52
 v_mfma_f32_16x16x32_bf16 v[68:71], a[0:3], a[52:55], v[68:71]
 ds_read_b64_tr_b16 a[18:19], v6 offset:50176
 v_fmac_f32 v53, v56, v56
 v_mfma_f32_16x16x32_bf16 v[72:75], a[0:3], a[56:59], v[72:75]
 s_nop 0
 v_add_f32 v53, v53, v53 row_ror:8
 v_mfma_f32_16x16x32_bf16 v[76:79], a[0:3], a[60:63], v[76:79]
 s_nop 0
 v_add_f32 v53, v53, v53 row_ror:4
 s_waitcnt lgkmcnt(6)
 v_mfma_f32_16x16x32_bf16 v[80:83], a[4:7], a[48:51], v[80:83]
 ds_read_b64_tr_b16 a[20:21], v7 offset:49152
 v_add_f32 v53, v53, v53 row_ror:2
 s_add_u32 m0, s69, 0
 v_mfma_f32_16x16x32_bf16 v[84:87], a[4:7], a[52:55], v[84:87]
 ds_read_b64_tr_b16 a[22:23], v7 offset:50176
 v_add_f32 v53, v53, v53 row_ror:1
 s_add_u32 s27, s70, 768
 v_mfma_f32_16x16x32_bf16 v[88:91], a[4:7], a[56:59], v[88:91]
 buffer_load_dwordx4 v12, s[8:11], s27 offen lds
 v_mov_b32 v55, v53
 v_mfma_f32_16x16x32_bf16 v[92:95], a[4:7], a[60:63], v[92:95]
 s_nop 0
 v_permlane16_swap_b32 v55, v53
 s_waitcnt lgkmcnt(6)
 v_mfma_f32_16x16x32_bf16 v[96:99], a[8:11], a[48:51], v[96:99]
 ds_read_b64_tr_b16 a[24:25], v8 offset:49152
 v_add_f32 v53, v53, v55
 v_mfma_f32_16x16x32_bf16 v[100:103], a[8:11], a[52:55], v[100:103]
 ds_read_b64_tr_b16 a[26:27], v8 offset:50176
 v_mul_f32 v53, 0.0015625, v53
 v_mfma_f32_16x16x32_bf16 v[104:107], a[8:11], a[56:59], v[104:107]
 v_cvt_pk_bf16_f32 v52, v52, v52
 v_mfma_f32_16x16x32_bf16 v[108:111], a[8:11], a[60:63], v[108:111]
 v_and_b32 v52, s61, v52
 s_waitcnt lgkmcnt(6)
 v_mfma_f32_16x16x32_bf16 v[112:115], a[12:15], a[48:51], v[112:115]
 ds_read_b64_tr_b16 a[28:29], v9 offset:49152
 v_cvt_pk_bf16_f32 v53, v53, v53
 s_add_u32 m0, s59, 24576
 v_mfma_f32_16x16x32_bf16 v[116:119], a[12:15], a[52:55], v[116:119]
 ds_read_b64_tr_b16 a[30:31], v9 offset:50176
 v_and_b32 v53, s61, v53
 s_add_u32 s27, s67, 2359296
 v_mfma_f32_16x16x32_bf16 v[120:123], a[12:15], a[56:59], v[120:123]
 buffer_load_dwordx4 v10, s[16:19], s27 offen nt lds
 v_add_f32 v53, 1e-05, v53
 v_mfma_f32_16x16x32_bf16 v[124:127], a[12:15], a[60:63], v[124:127]
 v_cvt_pk_bf16_f32 v53, v53, v53
 s_waitcnt lgkmcnt(6)
 v_mfma_f32_16x16x32_bf16 a[64:67], a[16:19], a[48:51], a[64:67]
 ds_read_b64_tr_b16 a[0:1], v2 offset:57344
 v_and_b32 v53, s61, v53
 v_mfma_f32_16x16x32_bf16 a[68:71], a[16:19], a[52:55], a[68:71]
 ds_read_b64_tr_b16 a[2:3], v2 offset:58368
 v_sqrt_f32 v53, v53
 v_mfma_f32_16x16x32_bf16 a[72:75], a[16:19], a[56:59], a[72:75]
 v_cvt_pk_bf16_f32 v53, v53, v53
 v_mfma_f32_16x16x32_bf16 a[76:79], a[16:19], a[60:63], a[76:79]
 s_add_u32 m0, s69, 1024
 v_and_b32 v53, s61, v53
 s_waitcnt lgkmcnt(6)
 v_mfma_f32_16x16x32_bf16 a[80:83], a[20:23], a[48:51], a[80:83]
 ds_read_b64_tr_b16 a[4:5], v3 offset:57344
 v_rcp_f32 v53, v53
 s_add_u32 s27, s70, 8960
 v_mfma_f32_16x16x32_bf16 a[84:87], a[20:23], a[52:55], a[84:87]
 ds_read_b64_tr_b16 a[6:7], v3 offset:58368
 v_lshrrev_b32 v54, 5, v0
 buffer_load_dwordx4 v13, s[8:11], s27 offen lds
 v_mfma_f32_16x16x32_bf16 a[88:91], a[20:23], a[56:59], a[88:91]
 v_lshlrev_b32 v54, 3, v54
 v_mfma_f32_16x16x32_bf16 a[92:95], a[20:23], a[60:63], a[92:95]
 buffer_store_dwordx2 v[52:53], v54, s[4:7], s54 offen sc1
 s_waitcnt lgkmcnt(6)
 v_mfma_f32_16x16x32_bf16 a[96:99], a[24:27], a[48:51], a[96:99]
 ds_read_b64_tr_b16 a[8:9], v4 offset:57344
 v_mfma_f32_16x16x32_bf16 a[100:103], a[24:27], a[52:55], a[100:103]
 ds_read_b64_tr_b16 a[10:11], v4 offset:58368
 v_mfma_f32_16x16x32_bf16 a[104:107], a[24:27], a[56:59], a[104:107]
 v_mfma_f32_16x16x32_bf16 a[108:111], a[24:27], a[60:63], a[108:111]
 s_waitcnt lgkmcnt(6)
 v_mfma_f32_16x16x32_bf16 a[112:115], a[28:31], a[48:51], a[112:115]
 ds_read_b64_tr_b16 a[12:13], v5 offset:57344
 s_add_u32 m0, s59, 25600
 v_mfma_f32_16x16x32_bf16 a[116:119], a[28:31], a[52:55], a[116:119]
 ds_read_b64_tr_b16 a[14:15], v5 offset:58368
 s_add_u32 s27, s67, 2359296
 v_mfma_f32_16x16x32_bf16 a[120:123], a[28:31], a[56:59], a[120:123]
 buffer_load_dwordx4 v11, s[16:19], s27 offen nt lds
 v_mfma_f32_16x16x32_bf16 a[124:127], a[28:31], a[60:63], a[124:127]
 s_waitcnt lgkmcnt(6)
 v_mfma_f32_16x16x32_bf16 v[128:131], a[48:51], a[0:3], v[128:131]
 ds_read_b64_tr_b16 a[16:17], v6 offset:57344
 v_mfma_f32_16x16x32_bf16 v[132:135], a[52:55], a[0:3], v[132:135]
 ds_read_b64_tr_b16 a[18:19], v6 offset:58368
 v_mfma_f32_16x16x32_bf16 v[136:139], a[56:59], a[0:3], v[136:139]
 ds_read_b128 a[32:35], v14 offset:8192
 s_add_u32 m0, s69, 2048
 v_mfma_f32_16x16x32_bf16 v[140:143], a[60:63], a[0:3], v[140:143]
 s_add_u32 s27, s70, 17152
 s_waitcnt lgkmcnt(7)
 v_mfma_f32_16x16x32_bf16 v[144:147], a[48:51], a[4:7], v[144:147]
 ds_read_b64_tr_b16 a[20:21], v7 offset:57344
 buffer_load_dwordx4 v12, s[8:11], s27 offen lds
 v_mfma_f32_16x16x32_bf16 v[148:151], a[52:55], a[4:7], v[148:151]
 ds_read_b64_tr_b16 a[22:23], v7 offset:58368
 v_mfma_f32_16x16x32_bf16 v[152:155], a[56:59], a[4:7], v[152:155]
 ds_read_b128 a[36:39], v14 offset:10240
 v_mfma_f32_16x16x32_bf16 v[156:159], a[60:63], a[4:7], v[156:159]
 s_waitcnt lgkmcnt(8)
 v_mfma_f32_16x16x32_bf16 v[160:163], a[48:51], a[8:11], v[160:163]
 ds_read_b64_tr_b16 a[24:25], v8 offset:57344
 v_mfma_f32_16x16x32_bf16 v[164:167], a[52:55], a[8:11], v[164:167]
 ds_read_b64_tr_b16 a[26:27], v8 offset:58368
 v_mfma_f32_16x16x32_bf16 v[168:171], a[56:59], a[8:11], v[168:171]
 ds_read_b128 a[40:43], v14 offset:12288
 v_mfma_f32_16x16x32_bf16 v[172:175], a[60:63], a[8:11], v[172:175]
 s_waitcnt lgkmcnt(9)
 v_mfma_f32_16x16x32_bf16 v[176:179], a[48:51], a[12:15], v[176:179]
 s_waitcnt vmcnt(11)
 s_barrier
 ds_read_b64_tr_b16 a[28:29], v9 offset:57344
 s_add_u32 m0, s59, 32768
 v_mfma_f32_16x16x32_bf16 v[180:183], a[52:55], a[12:15], v[180:183]
 ds_read_b64_tr_b16 a[30:31], v9 offset:58368
 s_add_u32 s27, s67, 2621440
 v_mfma_f32_16x16x32_bf16 v[184:187], a[56:59], a[12:15], v[184:187]
 ds_read_b128 a[44:47], v14 offset:14336
 buffer_load_dwordx4 v10, s[12:15], s27 offen nt lds
 v_mfma_f32_16x16x32_bf16 v[188:191], a[60:63], a[12:15], v[188:191]
 s_waitcnt lgkmcnt(10)
 v_mfma_f32_16x16x32_bf16 v[192:195], a[48:51], a[16:19], v[192:195]
 ds_read_b64_tr_b16 a[0:1], v2
 v_mfma_f32_16x16x32_bf16 v[196:199], a[52:55], a[16:19], v[196:199]
 ds_read_b64_tr_b16 a[2:3], v2 offset:1024
 s_add_u32 m0, s69, 3072
 v_mfma_f32_16x16x32_bf16 v[200:203], a[56:59], a[16:19], v[200:203]
 s_add_u32 s27, s70, 25344
 buffer_load_dword a255, v63, s[32:35], s63 offen
 s_add_u32 s63, s63, 17280
 v_mfma_f32_16x16x32_bf16 v[204:207], a[60:63], a[16:19], v[204:207]
 buffer_load_dwordx4 v13, s[8:11], s27 offen lds
 s_waitcnt lgkmcnt(9)
 v_mfma_f32_16x16x32_bf16 v[208:211], a[48:51], a[20:23], v[208:211]
 ds_read_b64_tr_b16 a[4:5], v3
 v_mfma_f32_16x16x32_bf16 v[212:215], a[52:55], a[20:23], v[212:215]
 ds_read_b64_tr_b16 a[6:7], v3 offset:1024
 v_mfma_f32_16x16x32_bf16 v[216:219], a[56:59], a[20:23], v[216:219]
 v_mfma_f32_16x16x32_bf16 v[220:223], a[60:63], a[20:23], v[220:223]
 s_waitcnt lgkmcnt(8)
 v_mfma_f32_16x16x32_bf16 v[224:227], a[48:51], a[24:27], v[224:227]
 ds_read_b64_tr_b16 a[8:9], v4
 v_mfma_f32_16x16x32_bf16 v[228:231], a[52:55], a[24:27], v[228:231]
 ds_read_b64_tr_b16 a[10:11], v4 offset:1024
 v_mfma_f32_16x16x32_bf16 v[232:235], a[56:59], a[24:27], v[232:235]
 v_mfma_f32_16x16x32_bf16 v[236:239], a[60:63], a[24:27], v[236:239]
 s_waitcnt lgkmcnt(7)
 v_mfma_f32_16x16x32_bf16 v[240:243], a[48:51], a[28:31], v[240:243]
 ds_read_b64_tr_b16 a[12:13], v5
 s_add_u32 m0, s59, 33792
 v_mfma_f32_16x16x32_bf16 v[244:247], a[52:55], a[28:31], v[244:247]
 ds_read_b64_tr_b16 a[14:15], v5 offset:1024
 s_add_u32 s27, s67, 2621440
 v_mfma_f32_16x16x32_bf16 v[248:251], a[56:59], a[28:31], v[248:251]
 buffer_load_dwordx4 v11, s[12:15], s27 offen nt lds
 v_mfma_f32_16x16x32_bf16 v[252:255], a[60:63], a[28:31], v[252:255]
 s_waitcnt lgkmcnt(6)
 v_mfma_f32_16x16x32_bf16 v[64:67], a[0:3], a[32:35], v[64:67]
 ds_read_b64_tr_b16 a[16:17], v6
 s_add_u32 m0, s69, 4096
 v_mfma_f32_16x16x32_bf16 v[68:71], a[0:3], a[36:39], v[68:71]
 ds_read_b64_tr_b16 a[18:19], v6 offset:1024
 s_add_u32 s27, s70, 33536
 v_mfma_f32_16x16x32_bf16 v[72:75], a[0:3], a[40:43], v[72:75]
 buffer_load_dwordx4 v12, s[8:11], s27 offen lds
 v_mfma_f32_16x16x32_bf16 v[76:79], a[0:3], a[44:47], v[76:79]
 s_waitcnt lgkmcnt(6)
 v_mfma_f32_16x16x32_bf16 v[80:83], a[4:7], a[32:35], v[80:83]
 ds_read_b64_tr_b16 a[20:21], v7
 v_mfma_f32_16x16x32_bf16 v[84:87], a[4:7], a[36:39], v[84:87]
 ds_read_b64_tr_b16 a[22:23], v7 offset:1024
 v_mfma_f32_16x16x32_bf16 v[88:91], a[4:7], a[40:43], v[88:91]
 v_mfma_f32_16x16x32_bf16 v[92:95], a[4:7], a[44:47], v[92:95]
 s_waitcnt lgkmcnt(6)
 v_mfma_f32_16x16x32_bf16 v[96:99], a[8:11], a[32:35], v[96:99]
 ds_read_b64_tr_b16 a[24:25], v8
 v_mfma_f32_16x16x32_bf16 v[100:103], a[8:11], a[36:39], v[100:103]
 ds_read_b64_tr_b16 a[26:27], v8 offset:1024
 v_mfma_f32_16x16x32_bf16 v[104:107], a[8:11], a[40:43], v[104:107]
 v_mfma_f32_16x16x32_bf16 v[108:111], a[8:11], a[44:47], v[108:111]
 s_waitcnt lgkmcnt(6)
 v_mfma_f32_16x16x32_bf16 v[112:115], a[12:15], a[32:35], v[112:115]
 ds_read_b64_tr_b16 a[28:29], v9
 s_add_u32 m0, s59, 40960
 v_mfma_f32_16x16x32_bf16 v[116:119], a[12:15], a[36:39], v[116:119]
 ds_read_b64_tr_b16 a[30:31], v9 offset:1024
 s_add_u32 s27, s67, 2621440
 v_mfma_f32_16x16x32_bf16 v[120:123], a[12:15], a[40:43], v[120:123]
 buffer_load_dwordx4 v10, s[16:19], s27 offen nt lds
 v_mfma_f32_16x16x32_bf16 v[124:127], a[12:15], a[44:47], v[124:127]
 s_add_u32 m0, s69, 5120
 s_waitcnt lgkmcnt(6)
 v_mfma_f32_16x16x32_bf16 a[64:67], a[16:19], a[32:35], a[64:67]
 ds_read_b64_tr_b16 a[0:1], v2 offset:8192
 s_add_u32 s27, s70, 41728
 v_mfma_f32_16x16x32_bf16 a[68:71], a[16:19], a[36:39], a[68:71]
 ds_read_b64_tr_b16 a[2:3], v2 offset:9216
 buffer_load_dwordx4 v13, s[8:11], s27 offen lds
 v_mfma_f32_16x16x32_bf16 a[72:75], a[16:19], a[40:43], a[72:75]
 v_mfma_f32_16x16x32_bf16 a[76:79], a[16:19], a[44:47], a[76:79]
 s_waitcnt lgkmcnt(6)
 v_mfma_f32_16x16x32_bf16 a[80:83], a[20:23], a[32:35], a[80:83]
 ds_read_b64_tr_b16 a[4:5], v3 offset:8192
 v_mfma_f32_16x16x32_bf16 a[84:87], a[20:23], a[36:39], a[84:87]
 ds_read_b64_tr_b16 a[6:7], v3 offset:9216
 v_mfma_f32_16x16x32_bf16 a[88:91], a[20:23], a[40:43], a[88:91]
 v_mfma_f32_16x16x32_bf16 a[92:95], a[20:23], a[44:47], a[92:95]
 s_waitcnt lgkmcnt(6)
 v_mfma_f32_16x16x32_bf16 a[96:99], a[24:27], a[32:35], a[96:99]
 ds_read_b64_tr_b16 a[8:9], v4 offset:8192
 v_mfma_f32_16x16x32_bf16 a[100:103], a[24:27], a[36:39], a[100:103]
 ds_read_b64_tr_b16 a[10:11], v4 offset:9216
 v_mfma_f32_16x16x32_bf16 a[104:107], a[24:27], a[40:43], a[104:107]
 v_mfma_f32_16x16x32_bf16 a[108:111], a[24:27], a[44:47], a[108:111]
 s_waitcnt lgkmcnt(6)
 v_mfma_f32_16x16x32_bf16 a[112:115], a[28:31], a[32:35], a[112:115]
 ds_read_b64_tr_b16 a[12:13], v5 offset:8192
 s_add_u32 m0, s59, 41984
 v_mfma_f32_16x16x32_bf16 a[116:119], a[28:31], a[36:39], a[116:119]
 ds_read_b64_tr_b16 a[14:15], v5 offset:9216
 s_add_u32 s27, s67, 2621440
 v_mfma_f32_16x16x32_bf16 a[120:123], a[28:31], a[40:43], a[120:123]
 buffer_load_dwordx4 v11, s[16:19], s27 offen nt lds
 v_mfma_f32_16x16x32_bf16 a[124:127], a[28:31], a[44:47], a[124:127]
 s_add_u32 m0, s69, 6144
 s_waitcnt lgkmcnt(6)
 v_mfma_f32_16x16x32_bf16 v[128:131], a[32:35], a[0:3], v[128:131]
 ds_read_b64_tr_b16 a[16:17], v6 offset:8192
 s_add_u32 s27, s70, 49920
 v_mfma_f32_16x16x32_bf16 v[132:135], a[36:39], a[0:3], v[132:135]
 ds_read_b64_tr_b16 a[18:19], v6 offset:9216
 buffer_load_dwordx4 v12, s[8:11], s27 offen lds
 v_mfma_f32_16x16x32_bf16 v[136:139], a[40:43], a[0:3], v[136:139]
 ds_read_b128 a[48:51], v15 offset:8192
 v_mfma_f32_16x16x32_bf16 v[140:143], a[44:47], a[0:3], v[140:143]
 s_waitcnt lgkmcnt(7)
 v_mfma_f32_16x16x32_bf16 v[144:147], a[32:35], a[4:7], v[144:147]
 ds_read_b64_tr_b16 a[20:21], v7 offset:8192
 v_mfma_f32_16x16x32_bf16 v[148:151], a[36:39], a[4:7], v[148:151]
 ds_read_b64_tr_b16 a[22:23], v7 offset:9216
 v_mfma_f32_16x16x32_bf16 v[152:155], a[40:43], a[4:7], v[152:155]
 ds_read_b128 a[52:55], v15 offset:10240
 v_mfma_f32_16x16x32_bf16 v[156:159], a[44:47], a[4:7], v[156:159]
 s_waitcnt lgkmcnt(8)
 v_mfma_f32_16x16x32_bf16 v[160:163], a[32:35], a[8:11], v[160:163]
 ds_read_b64_tr_b16 a[24:25], v8 offset:8192
 v_mfma_f32_16x16x32_bf16 v[164:167], a[36:39], a[8:11], v[164:167]
 ds_read_b64_tr_b16 a[26:27], v8 offset:9216
 v_mfma_f32_16x16x32_bf16 v[168:171], a[40:43], a[8:11], v[168:171]
 ds_read_b128 a[56:59], v15 offset:12288
 v_mfma_f32_16x16x32_bf16 v[172:175], a[44:47], a[8:11], v[172:175]
 s_waitcnt lgkmcnt(9)
 v_mfma_f32_16x16x32_bf16 v[176:179], a[32:35], a[12:15], v[176:179]
 s_waitcnt vmcnt(10)
 s_barrier
 ds_read_b64_tr_b16 a[28:29], v9 offset:8192
 s_add_u32 m0, s59, 49152
 v_mfma_f32_16x16x32_bf16 v[180:183], a[36:39], a[12:15], v[180:183]
 ds_read_b64_tr_b16 a[30:31], v9 offset:9216
 s_add_u32 s27, s67, 2883584
 v_mfma_f32_16x16x32_bf16 v[184:187], a[40:43], a[12:15], v[184:187]
 ds_read_b128 a[60:63], v15 offset:14336
 buffer_load_dwordx4 v10, s[12:15], s27 offen nt lds
 v_mfma_f32_16x16x32_bf16 v[188:191], a[44:47], a[12:15], v[188:191]
 s_add_u32 m0, s69, 7168
 s_waitcnt lgkmcnt(10)
 v_mfma_f32_16x16x32_bf16 v[192:195], a[32:35], a[16:19], v[192:195]
 ds_read_b64_tr_b16 a[0:1], v2 offset:16384
 s_add_u32 s27, s70, 58112
 v_mfma_f32_16x16x32_bf16 v[196:199], a[36:39], a[16:19], v[196:199]
 ds_read_b64_tr_b16 a[2:3], v2 offset:17408
 buffer_load_dwordx4 v13, s[8:11], s27 offen lds
 v_mfma_f32_16x16x32_bf16 v[200:203], a[40:43], a[16:19], v[200:203]
 buffer_load_dword a255, v59, s[28:31], s62 offen
 s_add_u32 s62, s62, 8192
 v_mfma_f32_16x16x32_bf16 v[204:207], a[44:47], a[16:19], v[204:207]
 s_waitcnt lgkmcnt(9)
 v_mfma_f32_16x16x32_bf16 v[208:211], a[32:35], a[20:23], v[208:211]
 ds_read_b64_tr_b16 a[4:5], v3 offset:16384
 v_mfma_f32_16x16x32_bf16 v[212:215], a[36:39], a[20:23], v[212:215]
 ds_read_b64_tr_b16 a[6:7], v3 offset:17408
 v_mfma_f32_16x16x32_bf16 v[216:219], a[40:43], a[20:23], v[216:219]
 v_mfma_f32_16x16x32_bf16 v[220:223], a[44:47], a[20:23], v[220:223]
 s_waitcnt lgkmcnt(8)
 v_mfma_f32_16x16x32_bf16 v[224:227], a[32:35], a[24:27], v[224:227]
 ds_read_b64_tr_b16 a[8:9], v4 offset:16384
 v_mfma_f32_16x16x32_bf16 v[228:231], a[36:39], a[24:27], v[228:231]
 ds_read_b64_tr_b16 a[10:11], v4 offset:17408
 v_mfma_f32_16x16x32_bf16 v[232:235], a[40:43], a[24:27], v[232:235]
 v_mfma_f32_16x16x32_bf16 v[236:239], a[44:47], a[24:27], v[236:239]
 s_waitcnt lgkmcnt(7)
 v_mfma_f32_16x16x32_bf16 v[240:243], a[32:35], a[28:31], v[240:243]
 ds_read_b64_tr_b16 a[12:13], v5 offset:16384
 s_add_u32 m0, s59, 50176
 v_mfma_f32_16x16x32_bf16 v[244:247], a[36:39], a[28:31], v[244:247]
 ds_read_b64_tr_b16 a[14:15], v5 offset:17408
 s_add_u32 s27, s67, 2883584
 v_mfma_f32_16x16x32_bf16 v[248:251], a[40:43], a[28:31], v[248:251]
 buffer_load_dwordx4 v11, s[12:15], s27 offen nt lds
 v_mfma_f32_16x16x32_bf16 v[252:255], a[44:47], a[28:31], v[252:255]
 s_waitcnt lgkmcnt(6)
 v_mfma_f32_16x16x32_bf16 v[64:67], a[0:3], a[48:51], v[64:67]
 ds_read_b64_tr_b16 a[16:17], v6 offset:16384
 v_mfma_f32_16x16x32_bf16 v[68:71], a[0:3], a[52:55], v[68:71]
 ds_read_b64_tr_b16 a[18:19], v6 offset:17408
 v_mfma_f32_16x16x32_bf16 v[72:75], a[0:3], a[56:59], v[72:75]
 v_mfma_f32_16x16x32_bf16 v[76:79], a[0:3], a[60:63], v[76:79]
 s_waitcnt lgkmcnt(6)
 v_mfma_f32_16x16x32_bf16 v[80:83], a[4:7], a[48:51], v[80:83]
 ds_read_b64_tr_b16 a[20:21], v7 offset:16384
 s_add_u32 m0, s69, 8192
 v_mfma_f32_16x16x32_bf16 v[84:87], a[4:7], a[52:55], v[84:87]
 ds_read_b64_tr_b16 a[22:23], v7 offset:17408
 s_add_u32 s27, s70, 896
 v_mfma_f32_16x16x32_bf16 v[88:91], a[4:7], a[56:59], v[88:91]
 buffer_load_dwordx4 v12, s[8:11], s27 offen lds
 v_mfma_f32_16x16x32_bf16 v[92:95], a[4:7], a[60:63], v[92:95]
 s_waitcnt lgkmcnt(6)
 v_mfma_f32_16x16x32_bf16 v[96:99], a[8:11], a[48:51], v[96:99]
 ds_read_b64_tr_b16 a[24:25], v8 offset:16384
 v_mfma_f32_16x16x32_bf16 v[100:103], a[8:11], a[52:55], v[100:103]
 ds_read_b64_tr_b16 a[26:27], v8 offset:17408
 v_mfma_f32_16x16x32_bf16 v[104:107], a[8:11], a[56:59], v[104:107]
 v_mfma_f32_16x16x32_bf16 v[108:111], a[8:11], a[60:63], v[108:111]
 s_waitcnt lgkmcnt(6)
 v_mfma_f32_16x16x32_bf16 v[112:115], a[12:15], a[48:51], v[112:115]
 ds_read_b64_tr_b16 a[28:29], v9 offset:16384
 s_add_u32 m0, s59, 57344
 v_mfma_f32_16x16x32_bf16 v[116:119], a[12:15], a[52:55], v[116:119]
 ds_read_b64_tr_b16 a[30:31], v9 offset:17408
 s_add_u32 s27, s67, 2883584
 v_mfma_f32_16x16x32_bf16 v[120:123], a[12:15], a[56:59], v[120:123]
 buffer_load_dwordx4 v10, s[16:19], s27 offen nt lds
 v_mfma_f32_16x16x32_bf16 v[124:127], a[12:15], a[60:63], v[124:127]
 s_waitcnt lgkmcnt(6)
 v_mfma_f32_16x16x32_bf16 a[64:67], a[16:19], a[48:51], a[64:67]
 ds_read_b64_tr_b16 a[0:1], v2 offset:24576
 v_mfma_f32_16x16x32_bf16 a[68:71], a[16:19], a[52:55], a[68:71]
 ds_read_b64_tr_b16 a[2:3], v2 offset:25600
 v_mfma_f32_16x16x32_bf16 a[72:75], a[16:19], a[56:59], a[72:75]
 v_mfma_f32_16x16x32_bf16 a[76:79], a[16:19], a[60:63], a[76:79]
 s_add_u32 m0, s69, 9216
 s_waitcnt lgkmcnt(6)
 v_mfma_f32_16x16x32_bf16 a[80:83], a[20:23], a[48:51], a[80:83]
 ds_read_b64_tr_b16 a[4:5], v3 offset:24576
 s_add_u32 s27, s70, 9088
 v_mfma_f32_16x16x32_bf16 a[84:87], a[20:23], a[52:55], a[84:87]
 ds_read_b64_tr_b16 a[6:7], v3 offset:25600
 buffer_load_dwordx4 v13, s[8:11], s27 offen lds
 v_mfma_f32_16x16x32_bf16 a[88:91], a[20:23], a[56:59], a[88:91]
 v_mfma_f32_16x16x32_bf16 a[92:95], a[20:23], a[60:63], a[92:95]
 s_waitcnt lgkmcnt(6)
 v_mfma_f32_16x16x32_bf16 a[96:99], a[24:27], a[48:51], a[96:99]
 ds_read_b64_tr_b16 a[8:9], v4 offset:24576
 v_mfma_f32_16x16x32_bf16 a[100:103], a[24:27], a[52:55], a[100:103]
 ds_read_b64_tr_b16 a[10:11], v4 offset:25600
 v_mfma_f32_16x16x32_bf16 a[104:107], a[24:27], a[56:59], a[104:107]
 v_mfma_f32_16x16x32_bf16 a[108:111], a[24:27], a[60:63], a[108:111]
 s_waitcnt lgkmcnt(6)
 v_mfma_f32_16x16x32_bf16 a[112:115], a[28:31], a[48:51], a[112:115]
 ds_read_b64_tr_b16 a[12:13], v5 offset:24576
 s_add_u32 m0, s59, 58368
 v_mfma_f32_16x16x32_bf16 a[116:119], a[28:31], a[52:55], a[116:119]
 ds_read_b64_tr_b16 a[14:15], v5 offset:25600
 s_add_u32 s27, s67, 2883584
 v_mfma_f32_16x16x32_bf16 a[120:123], a[28:31], a[56:59], a[120:123]
 buffer_load_dwordx4 v11, s[16:19], s27 offen nt lds
 v_mfma_f32_16x16x32_bf16 a[124:127], a[28:31], a[60:63], a[124:127]
 s_waitcnt lgkmcnt(6)
 v_mfma_f32_16x16x32_bf16 v[128:131], a[48:51], a[0:3], v[128:131]
 ds_read_b64_tr_b16 a[16:17], v6 offset:24576
 v_mfma_f32_16x16x32_bf16 v[132:135], a[52:55], a[0:3], v[132:135]
 ds_read_b64_tr_b16 a[18:19], v6 offset:25600
 v_mfma_f32_16x16x32_bf16 v[136:139], a[56:59], a[0:3], v[136:139]
 ds_read_b128 a[32:35], v14 offset:16384
 s_add_u32 m0, s69, 10240
 v_mfma_f32_16x16x32_bf16 v[140:143], a[60:63], a[0:3], v[140:143]
 s_add_u32 s27, s70, 17280
 s_waitcnt lgkmcnt(7)
 v_mfma_f32_16x16x32_bf16 v[144:147], a[48:51], a[4:7], v[144:147]
 ds_read_b64_tr_b16 a[20:21], v7 offset:24576
 buffer_load_dwordx4 v12, s[8:11], s27 offen lds
 v_mfma_f32_16x16x32_bf16 v[148:151], a[52:55], a[4:7], v[148:151]
 ds_read_b64_tr_b16 a[22:23], v7 offset:25600
 v_mfma_f32_16x16x32_bf16 v[152:155], a[56:59], a[4:7], v[152:155]
 ds_read_b128 a[36:39], v14 offset:18432
 v_mfma_f32_16x16x32_bf16 v[156:159], a[60:63], a[4:7], v[156:159]
 s_waitcnt lgkmcnt(8)
 v_mfma_f32_16x16x32_bf16 v[160:163], a[48:51], a[8:11], v[160:163]
 ds_read_b64_tr_b16 a[24:25], v8 offset:24576
 v_mfma_f32_16x16x32_bf16 v[164:167], a[52:55], a[8:11], v[164:167]
 ds_read_b64_tr_b16 a[26:27], v8 offset:25600
 v_mfma_f32_16x16x32_bf16 v[168:171], a[56:59], a[8:11], v[168:171]
 ds_read_b128 a[40:43], v14 offset:20480
 v_mfma_f32_16x16x32_bf16 v[172:175], a[60:63], a[8:11], v[172:175]
 s_waitcnt lgkmcnt(9)
 v_mfma_f32_16x16x32_bf16 v[176:179], a[48:51], a[12:15], v[176:179]
 s_waitcnt vmcnt(10)
 s_barrier
 ds_read_b64_tr_b16 a[28:29], v9 offset:24576
 s_add_u32 m0, s59, 0
 v_mfma_f32_16x16x32_bf16 v[180:183], a[52:55], a[12:15], v[180:183]
 ds_read_b64_tr_b16 a[30:31], v9 offset:25600
 s_add_u32 s27, s67, 3145728
 v_mfma_f32_16x16x32_bf16 v[184:187], a[56:59], a[12:15], v[184:187]
 buffer_store_dword v61, v18, s[4:7], s3 offen offset:384 sc1
 ds_read_b128 a[44:47], v14 offset:22528
 buffer_load_dwordx4 v10, s[12:15], s27 offen nt lds
 v_mfma_f32_16x16x32_bf16 v[188:191], a[60:63], a[12:15], v[188:191]
 s_waitcnt lgkmcnt(10)
 v_mfma_f32_16x16x32_bf16 v[192:195], a[48:51], a[16:19], v[192:195]
 ds_read_b64_tr_b16 a[0:1], v2 offset:32768
 v_mfma_f32_16x16x32_bf16 v[196:199], a[52:55], a[16:19], v[196:199]
 ds_read_b64_tr_b16 a[2:3], v2 offset:33792
 s_add_u32 m0, s69, 11264
 v_mfma_f32_16x16x32_bf16 v[200:203], a[56:59], a[16:19], v[200:203]
 s_add_u32 s27, s70, 25472
 buffer_load_dword a255, v63, s[32:35], s63 offen
 s_add_u32 s63, s63, 17280
 v_mfma_f32_16x16x32_bf16 v[204:207], a[60:63], a[16:19], v[204:207]
 buffer_load_dwordx4 v13, s[8:11], s27 offen lds
 s_waitcnt lgkmcnt(9)
 v_mfma_f32_16x16x32_bf16 v[208:211], a[48:51], a[20:23], v[208:211]
 ds_read_b64_tr_b16 a[4:5], v3 offset:32768
 v_mfma_f32_16x16x32_bf16 v[212:215], a[52:55], a[20:23], v[212:215]
 ds_read_b64_tr_b16 a[6:7], v3 offset:33792
 v_mfma_f32_16x16x32_bf16 v[216:219], a[56:59], a[20:23], v[216:219]
 v_mfma_f32_16x16x32_bf16 v[220:223], a[60:63], a[20:23], v[220:223]
 s_waitcnt lgkmcnt(8)
 v_mfma_f32_16x16x32_bf16 v[224:227], a[48:51], a[24:27], v[224:227]
 ds_read_b64_tr_b16 a[8:9], v4 offset:32768
 v_mfma_f32_16x16x32_bf16 v[228:231], a[52:55], a[24:27], v[228:231]
 ds_read_b64_tr_b16 a[10:11], v4 offset:33792
 v_mfma_f32_16x16x32_bf16 v[232:235], a[56:59], a[24:27], v[232:235]
 v_mfma_f32_16x16x32_bf16 v[236:239], a[60:63], a[24:27], v[236:239]
 s_waitcnt lgkmcnt(7)
 v_mfma_f32_16x16x32_bf16 v[240:243], a[48:51], a[28:31], v[240:243]
 ds_read_b64_tr_b16 a[12:13], v5 offset:32768
 s_add_u32 m0, s59, 1024
 v_mfma_f32_16x16x32_bf16 v[244:247], a[52:55], a[28:31], v[244:247]
 ds_read_b64_tr_b16 a[14:15], v5 offset:33792
 s_add_u32 s27, s67, 3145728
 v_mfma_f32_16x16x32_bf16 v[248:251], a[56:59], a[28:31], v[248:251]
 buffer_load_dwordx4 v11, s[12:15], s27 offen nt lds
 v_mfma_f32_16x16x32_bf16 v[252:255], a[60:63], a[28:31], v[252:255]
 s_waitcnt lgkmcnt(6)
 v_mfma_f32_16x16x32_bf16 v[64:67], a[0:3], a[32:35], v[64:67]
 ds_read_b64_tr_b16 a[16:17], v6 offset:32768
 v_lshrrev_b32 v24, 3, v0
 s_add_u32 m0, s69, 12288
 v_mfma_f32_16x16x32_bf16 v[68:71], a[0:3], a[36:39], v[68:71]
 ds_read_b64_tr_b16 a[18:19], v6 offset:33792
 v_bfe_u32 v25, v0, 4, 1
 s_add_u32 s27, s70, 33664
 v_mfma_f32_16x16x32_bf16 v[72:75], a[0:3], a[40:43], v[72:75]
 buffer_load_dwordx4 v12, s[8:11], s27 offen lds
 s_lshl_b32 s50, s45, 1
 v_mfma_f32_16x16x32_bf16 v[76:79], a[0:3], a[44:47], v[76:79]
 v_or_b32 v25, s50, v25
 s_waitcnt lgkmcnt(6)
 v_mfma_f32_16x16x32_bf16 v[80:83], a[4:7], a[32:35], v[80:83]
 ds_read_b64_tr_b16 a[20:21], v7 offset:32768
 v_lshlrev_b32 v25, 1, v25
 v_mfma_f32_16x16x32_bf16 v[84:87], a[4:7], a[36:39], v[84:87]
 ds_read_b64_tr_b16 a[22:23], v7 offset:33792
 v_and_b32 v26, 7, v0
 v_mfma_f32_16x16x32_bf16 v[88:91], a[4:7], a[40:43], v[88:91]
 v_xor_b32 v25, v25, v26
 v_mfma_f32_16x16x32_bf16 v[92:95], a[4:7], a[44:47], v[92:95]
 v_mul_u32_u24 v24, 3456, v24
 s_waitcnt lgkmcnt(6)
 v_mfma_f32_16x16x32_bf16 v[96:99], a[8:11], a[32:35], v[96:99]
 ds_read_b64_tr_b16 a[24:25], v8 offset:32768
 v_lshl_add_u32 v37, v25, 4, v24
 v_mfma_f32_16x16x32_bf16 v[100:103], a[8:11], a[36:39], v[100:103]
 ds_read_b64_tr_b16 a[26:27], v8 offset:33792
 v_lshrrev_b32 v24, 2, v20
 v_mfma_f32_16x16x32_bf16 v[104:107], a[8:11], a[40:43], v[104:107]
 v_lshl_add_u32 v25, v21, 3, v24
 v_mfma_f32_16x16x32_bf16 v[108:111], a[8:11], a[44:47], v[108:111]
 v_lshlrev_b32 v27, 7, v25
 s_waitcnt lgkmcnt(6)
 v_mfma_f32_16x16x32_bf16 v[112:115], a[12:15], a[32:35], v[112:115]
 ds_read_b64_tr_b16 a[28:29], v9 offset:32768
 v_and_b32 v30, 3, v20
 s_add_u32 m0, s59, 8192
 v_mfma_f32_16x16x32_bf16 v[116:119], a[12:15], a[36:39], v[116:119]
 ds_read_b64_tr_b16 a[30:31], v9 offset:33792
 v_lshl_add_u32 v27, v30, 3, v27
 s_add_u32 s27, s67, 3145728
 v_mfma_f32_16x16x32_bf16 v[120:123], a[12:15], a[40:43], v[120:123]
 buffer_load_dwordx4 v10, s[16:19], s27 offen nt lds
 v_add_u32 v27, 8192, v27
 v_mfma_f32_16x16x32_bf16 v[124:127], a[12:15], a[44:47], v[124:127]
 s_add_u32 m0, s69, 13312
 v_and_b32 v28, 1, v21
 s_waitcnt lgkmcnt(6)
 v_mfma_f32_16x16x32_bf16 a[64:67], a[16:19], a[32:35], a[64:67]
 ds_read_b64_tr_b16 a[0:1], v2 offset:40960
 v_bfe_u32 v29, v20, 3, 1
 s_add_u32 s27, s70, 41856
 v_mfma_f32_16x16x32_bf16 a[68:71], a[16:19], a[36:39], a[68:71]
 ds_read_b64_tr_b16 a[2:3], v2 offset:41984
 v_lshl_or_b32 v29, v28, 1, v29
 buffer_load_dwordx4 v13, s[8:11], s27 offen lds
 v_mfma_f32_16x16x32_bf16 a[72:75], a[16:19], a[40:43], a[72:75]
 v_lshl_add_u32 v32, v29, 5, v27
 v_mfma_f32_16x16x32_bf16 a[76:79], a[16:19], a[44:47], a[76:79]
 v_xor_b32 v30, 1, v29
 s_waitcnt lgkmcnt(6)
 v_mfma_f32_16x16x32_bf16 a[80:83], a[20:23], a[32:35], a[80:83]
 ds_read_b64_tr_b16 a[4:5], v3 offset:40960
 v_lshl_add_u32 v33, v30, 5, v27
 v_mfma_f32_16x16x32_bf16 a[84:87], a[20:23], a[36:39], a[84:87]
 ds_read_b64_tr_b16 a[6:7], v3 offset:41984
 v_xor_b32 v30, 2, v29
 v_mfma_f32_16x16x32_bf16 a[88:91], a[20:23], a[40:43], a[88:91]
 v_lshl_add_u32 v34, v30, 5, v27
 v_mfma_f32_16x16x32_bf16 a[92:95], a[20:23], a[44:47], a[92:95]
 v_xor_b32 v30, 3, v29
 s_waitcnt lgkmcnt(6)
 v_mfma_f32_16x16x32_bf16 a[96:99], a[24:27], a[32:35], a[96:99]
 ds_read_b64_tr_b16 a[8:9], v4 offset:40960
 v_lshl_add_u32 v35, v30, 5, v27
 v_mfma_f32_16x16x32_bf16 a[100:103], a[24:27], a[36:39], a[100:103]
 ds_read_b64_tr_b16 a[10:11], v4 offset:41984
 v_xor_b32 v30, s44, v29
 v_mfma_f32_16x16x32_bf16 a[104:107], a[24:27], a[40:43], a[104:107]
 v_lshl_add_u32 v36, v30, 5, v27
 v_mfma_f32_16x16x32_bf16 a[108:111], a[24:27], a[44:47], a[108:111]
 s_sub_u32 s66, 15, s48
 s_waitcnt lgkmcnt(6)
 v_mfma_f32_16x16x32_bf16 a[112:115], a[28:31], a[32:35], a[112:115]
 ds_read_b64_tr_b16 a[12:13], v5 offset:40960
 s_add_u32 m0, s59, 9216
 s_lshl_b32 s66, s66, 3
 v_mfma_f32_16x16x32_bf16 a[116:119], a[28:31], a[36:39], a[116:119]
 ds_read_b64_tr_b16 a[14:15], v5 offset:41984
 s_add_u32 s27, s67, 3145728
 s_add_u32 s66, s66, s44
 v_mfma_f32_16x16x32_bf16 a[120:123], a[28:31], a[40:43], a[120:123]
 buffer_load_dwordx4 v11, s[16:19], s27 offen nt lds
 s_lshl_b32 s54, s48, 3
 v_mfma_f32_16x16x32_bf16 a[124:127], a[28:31], a[44:47], a[124:127]
 s_add_u32 m0, s69, 14336
 s_add_u32 s54, s54, s44
 s_waitcnt lgkmcnt(6)
 v_mfma_f32_16x16x32_bf16 v[128:131], a[32:35], a[0:3], v[128:131]
 ds_read_b64_tr_b16 a[16:17], v6 offset:40960
 s_add_u32 s27, s70, 50048
 s_mul_i32 s50, s66, 20480
 v_mfma_f32_16x16x32_bf16 v[132:135], a[36:39], a[0:3], v[132:135]
 ds_read_b64_tr_b16 a[18:19], v6 offset:41984
 v_add_u32 v40, s50, v1
 buffer_load_dwordx4 v12, s[8:11], s27 offen lds
 v_mfma_f32_16x16x32_bf16 v[136:139], a[40:43], a[0:3], v[136:139]
 ds_read_b128 a[48:51], v15 offset:16384
 v_add_u32 v41, 81920, v40
 v_mfma_f32_16x16x32_bf16 v[140:143], a[44:47], a[0:3], v[140:143]
 s_mul_i32 s50, s54, 20480
 s_waitcnt lgkmcnt(7)
 v_mfma_f32_16x16x32_bf16 v[144:147], a[32:35], a[4:7], v[144:147]
 ds_read_b64_tr_b16 a[20:21], v7 offset:40960
 v_add_u32 v42, s50, v1
 v_mfma_f32_16x16x32_bf16 v[148:151], a[36:39], a[4:7], v[148:151]
 ds_read_b64_tr_b16 a[22:23], v7 offset:41984
 v_add_u32 v43, 81920, v42
 v_mfma_f32_16x16x32_bf16 v[152:155], a[40:43], a[4:7], v[152:155]
 ds_read_b128 a[52:55], v15 offset:18432
 s_lshl_b32 s68, s64, 7
 v_mfma_f32_16x16x32_bf16 v[156:159], a[44:47], a[4:7], v[156:159]
 s_mul_i32 s50, s44, 27648
 s_waitcnt lgkmcnt(8)
 v_mfma_f32_16x16x32_bf16 v[160:163], a[32:35], a[8:11], v[160:163]
 ds_read_b64_tr_b16 a[24:25], v8 offset:40960
 s_add_u32 s68, s68, s50
 v_mfma_f32_16x16x32_bf16 v[164:167], a[36:39], a[8:11], v[164:167]
 s_cmp_lt_u32 s64, 27
 s_cselect_b32 s68, s68, s51
 ds_read_b64_tr_b16 a[26:27], v8 offset:41984
 v_mfma_f32_16x16x32_bf16 v[168:171], a[40:43], a[8:11], v[168:171]
 ds_read_b128 a[56:59], v15 offset:20480
 v_mov_b32 v44, 0x3f803f80
 v_mfma_f32_16x16x32_bf16 v[172:175], a[44:47], a[8:11], v[172:175]
 v_mov_b32 v45, 0x3f803f80
 s_waitcnt lgkmcnt(9)
 v_mfma_f32_16x16x32_bf16 v[176:179], a[32:35], a[12:15], v[176:179]
 s_waitcnt vmcnt(11)
 s_barrier
 ds_read_b64_tr_b16 a[28:29], v9 offset:40960
 s_add_u32 m0, s59, 16384
 v_mfma_f32_16x16x32_bf16 v[180:183], a[36:39], a[12:15], v[180:183]
 ds_read_b64_tr_b16 a[30:31], v9 offset:41984
 v_mov_b32 v46, 0x3f803f80
 s_add_u32 s27, s67, 3407872
 v_mfma_f32_16x16x32_bf16 v[184:187], a[40:43], a[12:15], v[184:187]
 ds_read_b128 a[60:63], v15 offset:22528
 v_mov_b32 v47, 0x3f803f80
 buffer_load_dwordx4 v10, s[12:15], s27 offen nt lds
 v_mfma_f32_16x16x32_bf16 v[188:191], a[44:47], a[12:15], v[188:191]
 s_add_u32 m0, s69, 15360
 s_waitcnt lgkmcnt(10)
 v_mfma_f32_16x16x32_bf16 v[192:195], a[32:35], a[16:19], v[192:195]
 ds_read_b64_tr_b16 a[0:1], v2 offset:49152
 s_add_u32 s27, s70, 58240
 v_mfma_f32_16x16x32_bf16 v[196:199], a[36:39], a[16:19], v[196:199]
 ds_read_b64_tr_b16 a[2:3], v2 offset:50176
 buffer_load_dwordx4 v13, s[8:11], s27 offen lds
 v_mfma_f32_16x16x32_bf16 v[200:203], a[40:43], a[16:19], v[200:203]
 buffer_load_dword a255, v59, s[28:31], s62 offen
 s_add_u32 s62, s62, 8192
 v_mfma_f32_16x16x32_bf16 v[204:207], a[44:47], a[16:19], v[204:207]
 s_waitcnt lgkmcnt(9)
 v_mfma_f32_16x16x32_bf16 v[208:211], a[32:35], a[20:23], v[208:211]
 ds_read_b64_tr_b16 a[4:5], v3 offset:49152
 v_mfma_f32_16x16x32_bf16 v[212:215], a[36:39], a[20:23], v[212:215]
 ds_read_b64_tr_b16 a[6:7], v3 offset:50176
 v_mfma_f32_16x16x32_bf16 v[216:219], a[40:43], a[20:23], v[216:219]
 v_mfma_f32_16x16x32_bf16 v[220:223], a[44:47], a[20:23], v[220:223]
 s_waitcnt lgkmcnt(8)
 v_mfma_f32_16x16x32_bf16 v[224:227], a[32:35], a[24:27], v[224:227]
 ds_read_b64_tr_b16 a[8:9], v4 offset:49152
 v_mfma_f32_16x16x32_bf16 v[228:231], a[36:39], a[24:27], v[228:231]
 ds_read_b64_tr_b16 a[10:11], v4 offset:50176
 v_mfma_f32_16x16x32_bf16 v[232:235], a[40:43], a[24:27], v[232:235]
 v_mfma_f32_16x16x32_bf16 v[236:239], a[44:47], a[24:27], v[236:239]
 s_waitcnt lgkmcnt(7)
 v_mfma_f32_16x16x32_bf16 v[240:243], a[32:35], a[28:31], v[240:243]
 ds_read_b64_tr_b16 a[12:13], v5 offset:49152
 s_add_u32 m0, s59, 17408
 v_mfma_f32_16x16x32_bf16 v[244:247], a[36:39], a[28:31], v[244:247]
 ds_read_b64_tr_b16 a[14:15], v5 offset:50176
 s_add_u32 s27, s67, 3407872
 v_mfma_f32_16x16x32_bf16 v[248:251], a[40:43], a[28:31], v[248:251]
 buffer_load_dwordx4 v11, s[12:15], s27 offen nt lds
 v_mfma_f32_16x16x32_bf16 v[252:255], a[44:47], a[28:31], v[252:255]
 s_waitcnt lgkmcnt(6)
 v_mfma_f32_16x16x32_bf16 v[64:67], a[0:3], a[48:51], v[64:67]
 ds_read_b64_tr_b16 a[16:17], v6 offset:49152
 v_mfma_f32_16x16x32_bf16 v[68:71], a[0:3], a[52:55], v[68:71]
 ds_read_b64_tr_b16 a[18:19], v6 offset:50176
 v_mfma_f32_16x16x32_bf16 v[72:75], a[0:3], a[56:59], v[72:75]
 v_mfma_f32_16x16x32_bf16 v[76:79], a[0:3], a[60:63], v[76:79]
 s_waitcnt lgkmcnt(6)
 v_mfma_f32_16x16x32_bf16 v[80:83], a[4:7], a[48:51], v[80:83]
 ds_read_b64_tr_b16 a[20:21], v7 offset:49152
 v_mfma_f32_16x16x32_bf16 v[84:87], a[4:7], a[52:55], v[84:87]
 ds_read_b64_tr_b16 a[22:23], v7 offset:50176
 v_mfma_f32_16x16x32_bf16 v[88:91], a[4:7], a[56:59], v[88:91]
 v_mfma_f32_16x16x32_bf16 v[92:95], a[4:7], a[60:63], v[92:95]
 s_waitcnt lgkmcnt(6)
 v_mfma_f32_16x16x32_bf16 v[96:99], a[8:11], a[48:51], v[96:99]
 ds_read_b64_tr_b16 a[24:25], v8 offset:49152
 v_mfma_f32_16x16x32_bf16 v[100:103], a[8:11], a[52:55], v[100:103]
 ds_read_b64_tr_b16 a[26:27], v8 offset:50176
 v_mfma_f32_16x16x32_bf16 v[104:107], a[8:11], a[56:59], v[104:107]
 v_lshlrev_b32 v19, 2, v0
 s_and_b32 s62, s3, 0xfffffe00
 s_add_u32 s62, s62, 384
 v_mfma_f32_16x16x32_bf16 v[108:111], a[8:11], a[60:63], v[108:111]
 s_waitcnt lgkmcnt(6)
 v_mfma_f32_16x16x32_bf16 v[112:115], a[12:15], a[48:51], v[112:115]
 ds_read_b64_tr_b16 a[28:29], v9 offset:49152
 s_add_u32 m0, s59, 24576
 v_mfma_f32_16x16x32_bf16 v[116:119], a[12:15], a[52:55], v[116:119]
 ds_read_b64_tr_b16 a[30:31], v9 offset:50176
 s_add_u32 s27, s67, 3407872
 v_mfma_f32_16x16x32_bf16 v[120:123], a[12:15], a[56:59], v[120:123]
 buffer_load_dwordx4 v10, s[16:19], s27 offen nt lds
 v_mfma_f32_16x16x32_bf16 v[124:127], a[12:15], a[60:63], v[124:127]
 s_waitcnt lgkmcnt(6)
 v_mfma_f32_16x16x32_bf16 a[64:67], a[16:19], a[48:51], a[64:67]
 ds_read_b64_tr_b16 a[0:1], v2 offset:57344
 v_mfma_f32_16x16x32_bf16 a[68:71], a[16:19], a[52:55], a[68:71]
 ds_read_b64_tr_b16 a[2:3], v2 offset:58368
 v_mfma_f32_16x16x32_bf16 a[72:75], a[16:19], a[56:59], a[72:75]
 v_mfma_f32_16x16x32_bf16 a[76:79], a[16:19], a[60:63], a[76:79]
 s_waitcnt lgkmcnt(6)
 v_mfma_f32_16x16x32_bf16 a[80:83], a[20:23], a[48:51], a[80:83]
 ds_read_b64_tr_b16 a[4:5], v3 offset:57344
 v_mfma_f32_16x16x32_bf16 a[84:87], a[20:23], a[52:55], a[84:87]
 ds_read_b64_tr_b16 a[6:7], v3 offset:58368
 v_mfma_f32_16x16x32_bf16 a[88:91], a[20:23], a[56:59], a[88:91]
 v_mfma_f32_16x16x32_bf16 a[92:95], a[20:23], a[60:63], a[92:95]
 s_waitcnt lgkmcnt(6)
 v_mfma_f32_16x16x32_bf16 a[96:99], a[24:27], a[48:51], a[96:99]
 ds_read_b64_tr_b16 a[8:9], v4 offset:57344
 v_mfma_f32_16x16x32_bf16 a[100:103], a[24:27], a[52:55], a[100:103]
 ds_read_b64_tr_b16 a[10:11], v4 offset:58368
 v_mfma_f32_16x16x32_bf16 a[104:107], a[24:27], a[56:59], a[104:107]
 v_mfma_f32_16x16x32_bf16 a[108:111], a[24:27], a[60:63], a[108:111]
 s_waitcnt lgkmcnt(6)
 v_mfma_f32_16x16x32_bf16 a[112:115], a[28:31], a[48:51], a[112:115]
 ds_read_b64_tr_b16 a[12:13], v5 offset:57344
 s_add_u32 m0, s59, 25600
 v_mfma_f32_16x16x32_bf16 a[116:119], a[28:31], a[52:55], a[116:119]
 ds_read_b64_tr_b16 a[14:15], v5 offset:58368
 s_add_u32 s27, s67, 3407872
 v_mfma_f32_16x16x32_bf16 a[120:123], a[28:31], a[56:59], a[120:123]
 buffer_load_dwordx4 v11, s[16:19], s27 offen nt lds
 v_mfma_f32_16x16x32_bf16 a[124:127], a[28:31], a[60:63], a[124:127]
 s_waitcnt lgkmcnt(6)
 v_mfma_f32_16x16x32_bf16 v[128:131], a[48:51], a[0:3], v[128:131]
 ds_read_b64_tr_b16 a[16:17], v6 offset:57344
 v_mfma_f32_16x16x32_bf16 v[132:135], a[52:55], a[0:3], v[132:135]
 ds_read_b64_tr_b16 a[18:19], v6 offset:58368
 v_mfma_f32_16x16x32_bf16 v[136:139], a[56:59], a[0:3], v[136:139]
 ds_read_b128 a[32:35], v14
 v_mfma_f32_16x16x32_bf16 v[140:143], a[60:63], a[0:3], v[140:143]
 s_waitcnt lgkmcnt(7)
 v_mfma_f32_16x16x32_bf16 v[144:147], a[48:51], a[4:7], v[144:147]
 ds_read_b64_tr_b16 a[20:21], v7 offset:57344
 v_mfma_f32_16x16x32_bf16 v[148:151], a[52:55], a[4:7], v[148:151]
 ds_read_b64_tr_b16 a[22:23], v7 offset:58368
 v_mfma_f32_16x16x32_bf16 v[152:155], a[56:59], a[4:7], v[152:155]
 ds_read_b128 a[36:39], v14 offset:2048
 v_mfma_f32_16x16x32_bf16 v[156:159], a[60:63], a[4:7], v[156:159]
 s_waitcnt lgkmcnt(8)
 v_mfma_f32_16x16x32_bf16 v[160:163], a[48:51], a[8:11], v[160:163]
 ds_read_b64_tr_b16 a[24:25], v8 offset:57344
 v_mfma_f32_16x16x32_bf16 v[164:167], a[52:55], a[8:11], v[164:167]
 ds_read_b64_tr_b16 a[26:27], v8 offset:58368
 v_mfma_f32_16x16x32_bf16 v[168:171], a[56:59], a[8:11], v[168:171]
 ds_read_b128 a[40:43], v14 offset:4096
 v_mfma_f32_16x16x32_bf16 v[172:175], a[60:63], a[8:11], v[172:175]
 s_waitcnt lgkmcnt(9)
 v_mfma_f32_16x16x32_bf16 v[176:179], a[48:51], a[12:15], v[176:179]
 s_waitcnt vmcnt(7)
 s_barrier
 ds_read_b64_tr_b16 a[28:29], v9 offset:57344
 s_add_u32 m0, s59, 32768
 v_mfma_f32_16x16x32_bf16 v[180:183], a[52:55], a[12:15], v[180:183]
 ds_read_b64_tr_b16 a[30:31], v9 offset:58368
 s_add_u32 s27, s67, 3670016
 v_mfma_f32_16x16x32_bf16 v[184:187], a[56:59], a[12:15], v[184:187]
 ds_read_b128 a[44:47], v14 offset:6144
 buffer_load_dwordx4 v10, s[12:15], s27 offen nt lds
 v_mfma_f32_16x16x32_bf16 v[188:191], a[60:63], a[12:15], v[188:191]
 s_waitcnt lgkmcnt(10)
 v_mfma_f32_16x16x32_bf16 v[192:195], a[48:51], a[16:19], v[192:195]
 ds_read_b64_tr_b16 a[0:1], v2
 v_mfma_f32_16x16x32_bf16 v[196:199], a[52:55], a[16:19], v[196:199]
 ds_read_b64_tr_b16 a[2:3], v2 offset:1024
 v_mfma_f32_16x16x32_bf16 v[200:203], a[56:59], a[16:19], v[200:203]
 v_mfma_f32_16x16x32_bf16 v[204:207], a[60:63], a[16:19], v[204:207]
 s_waitcnt lgkmcnt(9)
 v_mfma_f32_16x16x32_bf16 v[208:211], a[48:51], a[20:23], v[208:211]
 ds_read_b64_tr_b16 a[4:5], v3
 v_mfma_f32_16x16x32_bf16 v[212:215], a[52:55], a[20:23], v[212:215]
 ds_read_b64_tr_b16 a[6:7], v3 offset:1024
 v_mfma_f32_16x16x32_bf16 v[216:219], a[56:59], a[20:23], v[216:219]
 v_mfma_f32_16x16x32_bf16 v[220:223], a[60:63], a[20:23], v[220:223]
 s_waitcnt lgkmcnt(8)
 v_mfma_f32_16x16x32_bf16 v[224:227], a[48:51], a[24:27], v[224:227]
 ds_read_b64_tr_b16 a[8:9], v4
 v_mfma_f32_16x16x32_bf16 v[228:231], a[52:55], a[24:27], v[228:231]
 ds_read_b64_tr_b16 a[10:11], v4 offset:1024
 v_mfma_f32_16x16x32_bf16 v[232:235], a[56:59], a[24:27], v[232:235]
 v_mfma_f32_16x16x32_bf16 v[236:239], a[60:63], a[24:27], v[236:239]
 s_waitcnt lgkmcnt(7)
 v_mfma_f32_16x16x32_bf16 v[240:243], a[48:51], a[28:31], v[240:243]
 ds_read_b64_tr_b16 a[12:13], v5
 s_add_u32 m0, s59, 33792
 v_mfma_f32_16x16x32_bf16 v[244:247], a[52:55], a[28:31], v[244:247]
 ds_read_b64_tr_b16 a[14:15], v5 offset:1024
 s_add_u32 s27, s67, 3670016
 v_mfma_f32_16x16x32_bf16 v[248:251], a[56:59], a[28:31], v[248:251]
 buffer_load_dwordx4 v11, s[12:15], s27 offen nt lds
 v_mfma_f32_16x16x32_bf16 v[252:255], a[60:63], a[28:31], v[252:255]
 s_waitcnt lgkmcnt(6)
 v_mfma_f32_16x16x32_bf16 v[64:67], a[0:3], a[32:35], v[64:67]
 ds_read_b64_tr_b16 a[16:17], v6
 v_mfma_f32_16x16x32_bf16 v[68:71], a[0:3], a[36:39], v[68:71]
 ds_read_b64_tr_b16 a[18:19], v6 offset:1024
 v_mfma_f32_16x16x32_bf16 v[72:75], a[0:3], a[40:43], v[72:75]
 v_mfma_f32_16x16x32_bf16 v[76:79], a[0:3], a[44:47], v[76:79]
 s_waitcnt lgkmcnt(6)
 v_mfma_f32_16x16x32_bf16 v[80:83], a[4:7], a[32:35], v[80:83]
 ds_read_b64_tr_b16 a[20:21], v7
 v_mfma_f32_16x16x32_bf16 v[84:87], a[4:7], a[36:39], v[84:87]
 ds_read_b64_tr_b16 a[22:23], v7 offset:1024
 v_mfma_f32_16x16x32_bf16 v[88:91], a[4:7], a[40:43], v[88:91]
 v_mfma_f32_16x16x32_bf16 v[92:95], a[4:7], a[44:47], v[92:95]
 s_waitcnt lgkmcnt(6)
 v_mfma_f32_16x16x32_bf16 v[96:99], a[8:11], a[32:35], v[96:99]
 ds_read_b64_tr_b16 a[24:25], v8
 v_mfma_f32_16x16x32_bf16 v[100:103], a[8:11], a[36:39], v[100:103]
 ds_read_b64_tr_b16 a[26:27], v8 offset:1024
 v_mfma_f32_16x16x32_bf16 v[104:107], a[8:11], a[40:43], v[104:107]
 buffer_load_dword v62, v19, s[4:7], s62 offen sc1
 v_mfma_f32_16x16x32_bf16 v[108:111], a[8:11], a[44:47], v[108:111]
 s_waitcnt lgkmcnt(6)
 v_mfma_f32_16x16x32_bf16 v[112:115], a[12:15], a[32:35], v[112:115]
 ds_read_b64_tr_b16 a[28:29], v9
 s_add_u32 m0, s59, 40960
 v_mfma_f32_16x16x32_bf16 v[116:119], a[12:15], a[36:39], v[116:119]
 ds_read_b64_tr_b16 a[30:31], v9 offset:1024
 s_add_u32 s27, s67, 3670016
 v_mfma_f32_16x16x32_bf16 v[120:123], a[12:15], a[40:43], v[120:123]
 buffer_load_dwordx4 v10, s[16:19], s27 offen nt lds
 v_mfma_f32_16x16x32_bf16 v[124:127], a[12:15], a[44:47], v[124:127]
 s_waitcnt lgkmcnt(6)
 v_mfma_f32_16x16x32_bf16 a[64:67], a[16:19], a[32:35], a[64:67]
 ds_read_b64_tr_b16 a[0:1], v2 offset:8192
 v_mfma_f32_16x16x32_bf16 a[68:71], a[16:19], a[36:39], a[68:71]
 ds_read_b64_tr_b16 a[2:3], v2 offset:9216
 v_mfma_f32_16x16x32_bf16 a[72:75], a[16:19], a[40:43], a[72:75]
 v_mfma_f32_16x16x32_bf16 a[76:79], a[16:19], a[44:47], a[76:79]
 s_waitcnt lgkmcnt(6)
 v_mfma_f32_16x16x32_bf16 a[80:83], a[20:23], a[32:35], a[80:83]
 ds_read_b64_tr_b16 a[4:5], v3 offset:8192
 v_mfma_f32_16x16x32_bf16 a[84:87], a[20:23], a[36:39], a[84:87]
 ds_read_b64_tr_b16 a[6:7], v3 offset:9216
 v_mfma_f32_16x16x32_bf16 a[88:91], a[20:23], a[40:43], a[88:91]
 v_mfma_f32_16x16x32_bf16 a[92:95], a[20:23], a[44:47], a[92:95]
 s_waitcnt lgkmcnt(6)
 v_mfma_f32_16x16x32_bf16 a[96:99], a[24:27], a[32:35], a[96:99]
 ds_read_b64_tr_b16 a[8:9], v4 offset:8192
 v_mfma_f32_16x16x32_bf16 a[100:103], a[24:27], a[36:39], a[100:103]
 ds_read_b64_tr_b16 a[10:11], v4 offset:9216
 v_mfma_f32_16x16x32_bf16 a[104:107], a[24:27], a[40:43], a[104:107]
 v_mfma_f32_16x16x32_bf16 a[108:111], a[24:27], a[44:47], a[108:111]
 s_waitcnt lgkmcnt(6)
 v_mfma_f32_16x16x32_bf16 a[112:115], a[28:31], a[32:35], a[112:115]
 ds_read_b64_tr_b16 a[12:13], v5 offset:8192
 s_add_u32 m0, s59, 41984
 v_mfma_f32_16x16x32_bf16 a[116:119], a[28:31], a[36:39], a[116:119]
 ds_read_b64_tr_b16 a[14:15], v5 offset:9216
 s_add_u32 s27, s67, 3670016
 v_mfma_f32_16x16x32_bf16 a[120:123], a[28:31], a[40:43], a[120:123]
 buffer_load_dwordx4 v11, s[16:19], s27 offen nt lds
 v_mfma_f32_16x16x32_bf16 a[124:127], a[28:31], a[44:47], a[124:127]
 s_waitcnt lgkmcnt(6)
 v_mfma_f32_16x16x32_bf16 v[128:131], a[32:35], a[0:3], v[128:131]
 ds_read_b64_tr_b16 a[16:17], v6 offset:8192
 v_mfma_f32_16x16x32_bf16 v[132:135], a[36:39], a[0:3], v[132:135]
 ds_read_b64_tr_b16 a[18:19], v6 offset:9216
 v_mfma_f32_16x16x32_bf16 v[136:139], a[40:43], a[0:3], v[136:139]
 ds_read_b128 a[48:51], v15
 v_mfma_f32_16x16x32_bf16 v[140:143], a[44:47], a[0:3], v[140:143]
 s_waitcnt lgkmcnt(7)
 v_mfma_f32_16x16x32_bf16 v[144:147], a[32:35], a[4:7], v[144:147]
 ds_read_b64_tr_b16 a[20:21], v7 offset:8192
 v_mfma_f32_16x16x32_bf16 v[148:151], a[36:39], a[4:7], v[148:151]
 ds_read_b64_tr_b16 a[22:23], v7 offset:9216
 v_mfma_f32_16x16x32_bf16 v[152:155], a[40:43], a[4:7], v[152:155]
 ds_read_b128 a[52:55], v15 offset:2048
 v_mfma_f32_16x16x32_bf16 v[156:159], a[44:47], a[4:7], v[156:159]
 s_waitcnt lgkmcnt(8)
 v_mfma_f32_16x16x32_bf16 v[160:163], a[32:35], a[8:11], v[160:163]
 ds_read_b64_tr_b16 a[24:25], v8 offset:8192
 v_mfma_f32_16x16x32_bf16 v[164:167], a[36:39], a[8:11], v[164:167]
 ds_read_b64_tr_b16 a[26:27], v8 offset:9216
 v_mfma_f32_16x16x32_bf16 v[168:171], a[40:43], a[8:11], v[168:171]
 ds_read_b128 a[56:59], v15 offset:4096
 v_mfma_f32_16x16x32_bf16 v[172:175], a[44:47], a[8:11], v[172:175]
 s_waitcnt lgkmcnt(9)
 v_mfma_f32_16x16x32_bf16 v[176:179], a[32:35], a[12:15], v[176:179]
 s_waitcnt vmcnt(5)
 s_barrier
 ds_read_b64_tr_b16 a[28:29], v9 offset:8192
 s_add_u32 m0, s59, 49152
 v_mfma_f32_16x16x32_bf16 v[180:183], a[36:39], a[12:15], v[180:183]
 ds_read_b64_tr_b16 a[30:31], v9 offset:9216
 s_add_u32 s27, s67, 3932160
 v_mfma_f32_16x16x32_bf16 v[184:187], a[40:43], a[12:15], v[184:187]
 ds_read_b128 a[60:63], v15 offset:6144
 buffer_load_dwordx4 v10, s[12:15], s27 offen nt lds
 v_mfma_f32_16x16x32_bf16 v[188:191], a[44:47], a[12:15], v[188:191]
 s_waitcnt lgkmcnt(10)
 v_mfma_f32_16x16x32_bf16 v[192:195], a[32:35], a[16:19], v[192:195]
 ds_read_b64_tr_b16 a[0:1], v2 offset:16384
 v_mfma_f32_16x16x32_bf16 v[196:199], a[36:39], a[16:19], v[196:199]
 ds_read_b64_tr_b16 a[2:3], v2 offset:17408
 v_mfma_f32_16x16x32_bf16 v[200:203], a[40:43], a[16:19], v[200:203]
 v_mfma_f32_16x16x32_bf16 v[204:207], a[44:47], a[16:19], v[204:207]
 s_waitcnt lgkmcnt(9)
 v_mfma_f32_16x16x32_bf16 v[208:211], a[32:35], a[20:23], v[208:211]
 ds_read_b64_tr_b16 a[4:5], v3 offset:16384
 v_mfma_f32_16x16x32_bf16 v[212:215], a[36:39], a[20:23], v[212:215]
 ds_read_b64_tr_b16 a[6:7], v3 offset:17408
 v_mfma_f32_16x16x32_bf16 v[216:219], a[40:43], a[20:23], v[216:219]
 v_mfma_f32_16x16x32_bf16 v[220:223], a[44:47], a[20:23], v[220:223]
 s_waitcnt lgkmcnt(8)
 v_mfma_f32_16x16x32_bf16 v[224:227], a[32:35], a[24:27], v[224:227]
 ds_read_b64_tr_b16 a[8:9], v4 offset:16384
 v_mfma_f32_16x16x32_bf16 v[228:231], a[36:39], a[24:27], v[228:231]
 ds_read_b64_tr_b16 a[10:11], v4 offset:17408
 v_mfma_f32_16x16x32_bf16 v[232:235], a[40:43], a[24:27], v[232:235]
 v_mfma_f32_16x16x32_bf16 v[236:239], a[44:47], a[24:27], v[236:239]
 s_waitcnt lgkmcnt(7)
 v_mfma_f32_16x16x32_bf16 v[240:243], a[32:35], a[28:31], v[240:243]
 ds_read_b64_tr_b16 a[12:13], v5 offset:16384
 s_add_u32 m0, s59, 50176
 v_mfma_f32_16x16x32_bf16 v[244:247], a[36:39], a[28:31], v[244:247]
 ds_read_b64_tr_b16 a[14:15], v5 offset:17408
 s_add_u32 s27, s67, 3932160
 v_mfma_f32_16x16x32_bf16 v[248:251], a[40:43], a[28:31], v[248:251]
 buffer_load_dwordx4 v11, s[12:15], s27 offen nt lds
 v_mfma_f32_16x16x32_bf16 v[252:255], a[44:47], a[28:31], v[252:255]
 s_waitcnt lgkmcnt(6)
 v_mfma_f32_16x16x32_bf16 v[64:67], a[0:3], a[48:51], v[64:67]
 ds_read_b64_tr_b16 a[16:17], v6 offset:16384
 v_mfma_f32_16x16x32_bf16 v[68:71], a[0:3], a[52:55], v[68:71]
 ds_read_b64_tr_b16 a[18:19], v6 offset:17408
 v_mfma_f32_16x16x32_bf16 v[72:75], a[0:3], a[56:59], v[72:75]
 v_mfma_f32_16x16x32_bf16 v[76:79], a[0:3], a[60:63], v[76:79]
 s_waitcnt lgkmcnt(6)
 v_mfma_f32_16x16x32_bf16 v[80:83], a[4:7], a[48:51], v[80:83]
 ds_read_b64_tr_b16 a[20:21], v7 offset:16384
 v_mfma_f32_16x16x32_bf16 v[84:87], a[4:7], a[52:55], v[84:87]
 ds_read_b64_tr_b16 a[22:23], v7 offset:17408
 v_mfma_f32_16x16x32_bf16 v[88:91], a[4:7], a[56:59], v[88:91]
 v_mfma_f32_16x16x32_bf16 v[92:95], a[4:7], a[60:63], v[92:95]
 s_waitcnt lgkmcnt(6)
 v_mfma_f32_16x16x32_bf16 v[96:99], a[8:11], a[48:51], v[96:99]
 ds_read_b64_tr_b16 a[24:25], v8 offset:16384
 v_mfma_f32_16x16x32_bf16 v[100:103], a[8:11], a[52:55], v[100:103]
 ds_read_b64_tr_b16 a[26:27], v8 offset:17408
 v_mfma_f32_16x16x32_bf16 v[104:107], a[8:11], a[56:59], v[104:107]
 s_waitcnt vmcnt(4)
 v_cmp_eq_u32 vcc, s100, v62
 s_nop 1
 s_and_b32 s71, vcc_lo, -1
 s_cmp_eq_u32 s71, -1
 s_cbranch_scc0 L_slow_ln
L_back_ln:
 v_mfma_f32_16x16x32_bf16 v[108:111], a[8:11], a[60:63], v[108:111]
 s_waitcnt lgkmcnt(6)
 v_mfma_f32_16x16x32_bf16 v[112:115], a[12:15], a[48:51], v[112:115]
 ds_read_b64_tr_b16 a[28:29], v9 offset:16384
 s_add_u32 m0, s59, 57344
 v_mfma_f32_16x16x32_bf16 v[116:119], a[12:15], a[52:55], v[116:119]
 ds_read_b64_tr_b16 a[30:31], v9 offset:17408
 s_add_u32 s27, s67, 3932160
 s_mov_b32 s50, 0
 v_mfma_f32_16x16x32_bf16 v[120:123], a[12:15], a[56:59], v[120:123]
 buffer_load_dwordx4 v10, s[16:19], s27 offen nt lds
 buffer_load_dwordx4 a[128:131], v40, s[4:7], s50 offen sc1
 v_mfma_f32_16x16x32_bf16 v[124:127], a[12:15], a[60:63], v[124:127]
 s_waitcnt lgkmcnt(6)
 v_mfma_f32_16x16x32_bf16 a[64:67], a[16:19], a[48:51], a[64:67]
 ds_read_b64_tr_b16 a[0:1], v2 offset:24576
 v_mfma_f32_16x16x32_bf16 a[68:71], a[16:19], a[52:55], a[68:71]
 ds_read_b64_tr_b16 a[2:3], v2 offset:25600
 v_mfma_f32_16x16x32_bf16 a[72:75], a[16:19], a[56:59], a[72:75]
 v_mfma_f32_16x16x32_bf16 a[76:79], a[16:19], a[60:63], a[76:79]
 s_waitcnt lgkmcnt(6)
 v_mfma_f32_16x16x32_bf16 a[80:83], a[20:23], a[48:51], a[80:83]
 ds_read_b64_tr_b16 a[4:5], v3 offset:24576
 v_mfma_f32_16x16x32_bf16 a[84:87], a[20:23], a[52:55], a[84:87]
 ds_read_b64_tr_b16 a[6:7], v3 offset:25600
 v_mfma_f32_16x16x32_bf16 a[88:91], a[20:23], a[56:59], a[88:91]
 v_mfma_f32_16x16x32_bf16 a[92:95], a[20:23], a[60:63], a[92:95]
 s_waitcnt lgkmcnt(6)
 v_mfma_f32_16x16x32_bf16 a[96:99], a[24:27], a[48:51], a[96:99]
 ds_read_b64_tr_b16 a[8:9], v4 offset:24576
 v_mfma_f32_16x16x32_bf16 a[100:103], a[24:27], a[52:55], a[100:103]
 ds_read_b64_tr_b16 a[10:11], v4 offset:25600
 buffer_load_dwordx4 a[132:135], v41, s[4:7], s50 offen sc1
 v_mfma_f32_16x16x32_bf16 a[104:107], a[24:27], a[56:59], a[104:107]
 v_mfma_f32_16x16x32_bf16 a[108:111], a[24:27], a[60:63], a[108:111]
 s_waitcnt lgkmcnt(6)
 v_mfma_f32_16x16x32_bf16 a[112:115], a[28:31], a[48:51], a[112:115]
 ds_read_b64_tr_b16 a[12:13], v5 offset:24576
 s_add_u32 m0, s59, 58368
 v_mfma_f32_16x16x32_bf16 a[116:119], a[28:31], a[52:55], a[116:119]
 ds_read_b64_tr_b16 a[14:15], v5 offset:25600
 s_add_u32 s27, s67, 3932160
 v_mfma_f32_16x16x32_bf16 a[120:123], a[28:31], a[56:59], a[120:123]
 buffer_load_dwordx4 v11, s[16:19], s27 offen nt lds
 v_mfma_f32_16x16x32_bf16 a[124:127], a[28:31], a[60:63], a[124:127]
 s_waitcnt lgkmcnt(6)
 v_mfma_f32_16x16x32_bf16 v[128:131], a[48:51], a[0:3], v[128:131]
 ds_read_b64_tr_b16 a[16:17], v6 offset:24576
 v_mfma_f32_16x16x32_bf16 v[132:135], a[52:55], a[0:3], v[132:135]
 ds_read_b64_tr_b16 a[18:19], v6 offset:25600
 v_mfma_f32_16x16x32_bf16 v[136:139], a[56:59], a[0:3], v[136:139]
 ds_read_b128 a[32:35], v14 offset:8192
 v_mfma_f32_16x16x32_bf16 v[140:143], a[60:63], a[0:3], v[140:143]
 s_waitcnt lgkmcnt(7)
 v_mfma_f32_16x16x32_bf16 v[144:147], a[48:51], a[4:7], v[144:147]
 ds_read_b64_tr_b16 a[20:21], v7 offset:24576
 buffer_load_dwordx4 a[136:139], v42, s[4:7], s50 offen sc1
 v_mfma_f32_16x16x32_bf16 v[148:151], a[52:55], a[4:7], v[148:151]
 ds_read_b64_tr_b16 a[22:23], v7 offset:25600
 v_mfma_f32_16x16x32_bf16 v[152:155], a[56:59], a[4:7], v[152:155]
 ds_read_b128 a[36:39], v14 offset:10240
 v_mfma_f32_16x16x32_bf16 v[156:159], a[60:63], a[4:7], v[156:159]
 s_waitcnt lgkmcnt(8)
 v_mfma_f32_16x16x32_bf16 v[160:163], a[48:51], a[8:11], v[160:163]
 ds_read_b64_tr_b16 a[24:25], v8 offset:24576
 v_mfma_f32_16x16x32_bf16 v[164:167], a[52:55], a[8:11], v[164:167]
 ds_read_b64_tr_b16 a[26:27], v8 offset:25600
 v_mfma_f32_16x16x32_bf16 v[168:171], a[56:59], a[8:11], v[168:171]
 ds_read_b128 a[40:43], v14 offset:12288
 v_mfma_f32_16x16x32_bf16 v[172:175], a[60:63], a[8:11], v[172:175]
 s_waitcnt lgkmcnt(9)
 v_mfma_f32_16x16x32_bf16 v[176:179], a[48:51], a[12:15], v[176:179]
 s_waitcnt vmcnt(7)
 s_barrier
 ds_read_b64_tr_b16 a[28:29], v9 offset:24576
 s_add_u32 m0, s59, 0
 v_mfma_f32_16x16x32_bf16 v[180:183], a[52:55], a[12:15], v[180:183]
 ds_read_b64_tr_b16 a[30:31], v9 offset:25600
 s_add_u32 s27, s67, 0
 v_mfma_f32_16x16x32_bf16 v[184:187], a[56:59], a[12:15], v[184:187]
 ds_read_b128 a[44:47], v14 offset:14336
 buffer_load_dwordx4 v10, s[28:31], s27 offen lds
 v_mfma_f32_16x16x32_bf16 v[188:191], a[60:63], a[12:15], v[188:191]
 buffer_load_dwordx4 a[140:143], v43, s[4:7], s50 offen sc1
 s_waitcnt lgkmcnt(10)
 v_mfma_f32_16x16x32_bf16 v[192:195], a[48:51], a[16:19], v[192:195]
 ds_read_b64_tr_b16 a[0:1], v2 offset:32768
 v_mfma_f32_16x16x32_bf16 v[196:199], a[52:55], a[16:19], v[196:199]
 ds_read_b64_tr_b16 a[2:3], v2 offset:33792
 v_mfma_f32_16x16x32_bf16 v[200:203], a[56:59], a[16:19], v[200:203]
 v_mfma_f32_16x16x32_bf16 v[204:207], a[60:63], a[16:19], v[204:207]
 s_waitcnt lgkmcnt(9)
 v_mfma_f32_16x16x32_bf16 v[208:211], a[48:51], a[20:23], v[208:211]
 ds_read_b64_tr_b16 a[4:5], v3 offset:32768
 v_mfma_f32_16x16x32_bf16 v[212:215], a[52:55], a[20:23], v[212:215]
 ds_read_b64_tr_b16 a[6:7], v3 offset:33792
 v_mfma_f32_16x16x32_bf16 v[216:219], a[56:59], a[20:23], v[216:219]
 v_mfma_f32_16x16x32_bf16 v[220:223], a[60:63], a[20:23], v[220:223]
 s_waitcnt lgkmcnt(8)
 v_mfma_f32_16x16x32_bf16 v[224:227], a[48:51], a[24:27], v[224:227]
 ds_read_b64_tr_b16 a[8:9], v4 offset:32768
 v_mfma_f32_16x16x32_bf16 v[228:231], a[52:55], a[24:27], v[228:231]
 ds_read_b64_tr_b16 a[10:11], v4 offset:33792
 v_mfma_f32_16x16x32_bf16 v[232:235], a[56:59], a[24:27], v[232:235]
 v_mfma_f32_16x16x32_bf16 v[236:239], a[60:63], a[24:27], v[236:239]
 s_waitcnt lgkmcnt(7)
 v_mfma_f32_16x16x32_bf16 v[240:243], a[48:51], a[28:31], v[240:243]
 ds_read_b64_tr_b16 a[12:13], v5 offset:32768
 s_add_u32 m0, s59, 1024
 v_mfma_f32_16x16x32_bf16 v[244:247], a[52:55], a[28:31], v[244:247]
 ds_read_b64_tr_b16 a[14:15], v5 offset:33792
 s_add_u32 s27, s67, 0
 v_mfma_f32_16x16x32_bf16 v[248:251], a[56:59], a[28:31], v[248:251]
 buffer_load_dwordx4 v11, s[28:31], s27 offen lds
 v_mfma_f32_16x16x32_bf16 v[252:255], a[60:63], a[28:31], v[252:255]
 s_waitcnt lgkmcnt(6)
 v_mfma_f32_16x16x32_bf16 v[64:67], a[0:3], a[32:35], v[64:67]
 ds_read_b64_tr_b16 a[16:17], v6 offset:32768
 v_mfma_f32_16x16x32_bf16 v[68:71], a[0:3], a[36:39], v[68:71]
 ds_read_b64_tr_b16 a[18:19], v6 offset:33792
 v_mfma_f32_16x16x32_bf16 v[72:75], a[0:3], a[40:43], v[72:75]
 v_mfma_f32_16x16x32_bf16 v[76:79], a[0:3], a[44:47], v[76:79]
 s_waitcnt lgkmcnt(6)
 v_mfma_f32_16x16x32_bf16 v[80:83], a[4:7], a[32:35], v[80:83]
 ds_read_b64_tr_b16 a[20:21], v7 offset:32768
 v_mfma_f32_16x16x32_bf16 v[84:87], a[4:7], a[36:39], v[84:87]
 ds_read_b64_tr_b16 a[22:23], v7 offset:33792
 v_mfma_f32_16x16x32_bf16 v[88:91], a[4:7], a[40:43], v[88:91]
 v_mfma_f32_16x16x32_bf16 v[92:95], a[4:7], a[44:47], v[92:95]
 s_waitcnt lgkmcnt(6)
 v_mfma_f32_16x16x32_bf16 v[96:99], a[8:11], a[32:35], v[96:99]
 ds_read_b64_tr_b16 a[24:25], v8 offset:32768
 v_mfma_f32_16x16x32_bf16 v[100:103], a[8:11], a[36:39], v[100:103]
 ds_read_b64_tr_b16 a[26:27], v8 offset:33792
 v_mfma_f32_16x16x32_bf16 v[104:107], a[8:11], a[40:43], v[104:107]
 v_mfma_f32_16x16x32_bf16 v[108:111], a[8:11], a[44:47], v[108:111]
 s_waitcnt lgkmcnt(6)
 v_mfma_f32_16x16x32_bf16 v[112:115], a[12:15], a[32:35], v[112:115]
 ds_read_b64_tr_b16 a[28:29], v9 offset:32768
 s_add_u32 m0, s65, 8192
 v_mfma_f32_16x16x32_bf16 v[116:119], a[12:15], a[36:39], v[116:119]
 ds_read_b64_tr_b16 a[30:31], v9 offset:33792
 s_add_u32 s27, s68, 0
 s_mov_b32 s50, 1024
 v_mfma_f32_16x16x32_bf16 v[120:123], a[12:15], a[40:43], v[120:123]
 buffer_load_dwordx4 v37, s[32:35], s27 offen lds
 buffer_load_dwordx4 a[144:147], v40, s[4:7], s50 offen sc1
 v_mfma_f32_16x16x32_bf16 v[124:127], a[12:15], a[44:47], v[124:127]
 s_waitcnt lgkmcnt(6)
 v_mfma_f32_16x16x32_bf16 a[64:67], a[16:19], a[32:35], a[64:67]
 ds_read_b64_tr_b16 a[0:1], v2 offset:40960
 v_mfma_f32_16x16x32_bf16 a[68:71], a[16:19], a[36:39], a[68:71]
 ds_read_b64_tr_b16 a[2:3], v2 offset:41984
 v_mfma_f32_16x16x32_bf16 a[72:75], a[16:19], a[40:43], a[72:75]
 v_mfma_f32_16x16x32_bf16 a[76:79], a[16:19], a[44:47], a[76:79]
 s_waitcnt lgkmcnt(6)
 v_mfma_f32_16x16x32_bf16 a[80:83], a[20:23], a[32:35], a[80:83]
 ds_read_b64_tr_b16 a[4:5], v3 offset:40960
 v_mfma_f32_16x16x32_bf16 a[84:87], a[20:23], a[36:39], a[84:87]
 ds_read_b64_tr_b16 a[6:7], v3 offset:41984
 v_mfma_f32_16x16x32_bf16 a[88:91], a[20:23], a[40:43], a[88:91]
 v_mfma_f32_16x16x32_bf16 a[92:95], a[20:23], a[44:47], a[92:95]
 s_waitcnt lgkmcnt(6)
 v_mfma_f32_16x16x32_bf16 a[96:99], a[24:27], a[32:35], a[96:99]
 ds_read_b64_tr_b16 a[8:9], v4 offset:40960
 v_mfma_f32_16x16x32_bf16 a[100:103], a[24:27], a[36:39], a[100:103]
 ds_read_b64_tr_b16 a[10:11], v4 offset:41984
 buffer_load_dwordx4 a[148:151], v41, s[4:7], s50 offen sc1
 v_mfma_f32_16x16x32_bf16 a[104:107], a[24:27], a[40:43], a[104:107]
 v_mfma_f32_16x16x32_bf16 a[108:111], a[24:27], a[44:47], a[108:111]
 s_waitcnt lgkmcnt(6)
 v_mfma_f32_16x16x32_bf16 a[112:115], a[28:31], a[32:35], a[112:115]
 ds_read_b64_tr_b16 a[12:13], v5 offset:40960
 v_mfma_f32_16x16x32_bf16 a[116:119], a[28:31], a[36:39], a[116:119]
 ds_read_b64_tr_b16 a[14:15], v5 offset:41984
 v_mfma_f32_16x16x32_bf16 a[120:123], a[28:31], a[40:43], a[120:123]
 v_mfma_f32_16x16x32_bf16 a[124:127], a[28:31], a[44:47], a[124:127]
 s_waitcnt lgkmcnt(6)
 v_mfma_f32_16x16x32_bf16 v[128:131], a[32:35], a[0:3], v[128:131]
 ds_read_b64_tr_b16 a[16:17], v6 offset:40960
 v_mfma_f32_16x16x32_bf16 v[132:135], a[36:39], a[0:3], v[132:135]
 ds_read_b64_tr_b16 a[18:19], v6 offset:41984
 v_mfma_f32_16x16x32_bf16 v[136:139], a[40:43], a[0:3], v[136:139]
 ds_read_b128 a[48:51], v15 offset:8192
 v_mfma_f32_16x16x32_bf16 v[140:143], a[44:47], a[0:3], v[140:143]
 s_waitcnt lgkmcnt(7)
 v_mfma_f32_16x16x32_bf16 v[144:147], a[32:35], a[4:7], v[144:147]
 ds_read_b64_tr_b16 a[20:21], v7 offset:40960
 buffer_load_dwordx4 a[152:155], v42, s[4:7], s50 offen sc1
 v_mfma_f32_16x16x32_bf16 v[148:151], a[36:39], a[4:7], v[148:151]
 ds_read_b64_tr_b16 a[22:23], v7 offset:41984
 v_mfma_f32_16x16x32_bf16 v[152:155], a[40:43], a[4:7], v[152:155]
 ds_read_b128 a[52:55], v15 offset:10240
 v_mfma_f32_16x16x32_bf16 v[156:159], a[44:47], a[4:7], v[156:159]
 s_waitcnt lgkmcnt(8)
 v_mfma_f32_16x16x32_bf16 v[160:163], a[32:35], a[8:11], v[160:163]
 ds_read_b64_tr_b16 a[24:25], v8 offset:40960
 v_mfma_f32_16x16x32_bf16 v[164:167], a[36:39], a[8:11], v[164:167]
 ds_read_b64_tr_b16 a[26:27], v8 offset:41984
 v_mfma_f32_16x16x32_bf16 v[168:171], a[40:43], a[8:11], v[168:171]
 ds_read_b128 a[56:59], v15 offset:12288
 v_mfma_f32_16x16x32_bf16 v[172:175], a[44:47], a[8:11], v[172:175]
 s_waitcnt lgkmcnt(9)
 v_mfma_f32_16x16x32_bf16 v[176:179], a[32:35], a[12:15], v[176:179]
 s_waitcnt vmcnt(8)
 s_barrier
 ds_read_b64_tr_b16 a[28:29], v9 offset:40960
 s_add_u32 m0, s59, 16384
 v_mfma_f32_16x16x32_bf16 v[180:183], a[36:39], a[12:15], v[180:183]
 ds_read_b64_tr_b16 a[30:31], v9 offset:41984
 s_add_u32 s27, s67, 262144
 v_mfma_f32_16x16x32_bf16 v[184:187], a[40:43], a[12:15], v[184:187]
 ds_read_b128 a[60:63], v15 offset:14336
 buffer_load_dwordx4 v10, s[28:31], s27 offen lds
 v_mfma_f32_16x16x32_bf16 v[188:191], a[44:47], a[12:15], v[188:191]
 buffer_load_dwordx4 a[156:159], v43, s[4:7], s50 offen sc1
 s_waitcnt lgkmcnt(10)
 v_mfma_f32_16x16x32_bf16 v[192:195], a[32:35], a[16:19], v[192:195]
 ds_read_b64_tr_b16 a[0:1], v2 offset:49152
 v_mfma_f32_16x16x32_bf16 v[196:199], a[36:39], a[16:19], v[196:199]
 ds_read_b64_tr_b16 a[2:3], v2 offset:50176
 v_mfma_f32_16x16x32_bf16 v[200:203], a[40:43], a[16:19], v[200:203]
 v_mfma_f32_16x16x32_bf16 v[204:207], a[44:47], a[16:19], v[204:207]
 s_waitcnt lgkmcnt(9)
 v_mfma_f32_16x16x32_bf16 v[208:211], a[32:35], a[20:23], v[208:211]
 ds_read_b64_tr_b16 a[4:5], v3 offset:49152
 v_mfma_f32_16x16x32_bf16 v[212:215], a[36:39], a[20:23], v[212:215]
 ds_read_b64_tr_b16 a[6:7], v3 offset:50176
 v_mfma_f32_16x16x32_bf16 v[216:219], a[40:43], a[20:23], v[216:219]
 v_mfma_f32_16x16x32_bf16 v[220:223], a[44:47], a[20:23], v[220:223]
 s_waitcnt lgkmcnt(8)
 v_mfma_f32_16x16x32_bf16 v[224:227], a[32:35], a[24:27], v[224:227]
 ds_read_b64_tr_b16 a[8:9], v4 offset:49152
 v_mfma_f32_16x16x32_bf16 v[228:231], a[36:39], a[24:27], v[228:231]
 ds_read_b64_tr_b16 a[10:11], v4 offset:50176
 v_mfma_f32_16x16x32_bf16 v[232:235], a[40:43], a[24:27], v[232:235]
 v_mfma_f32_16x16x32_bf16 v[236:239], a[44:47], a[24:27], v[236:239]
 s_waitcnt lgkmcnt(7)
 v_mfma_f32_16x16x32_bf16 v[240:243], a[32:35], a[28:31], v[240:243]
 ds_read_b64_tr_b16 a[12:13], v5 offset:49152
 s_add_u32 m0, s59, 17408
 v_mfma_f32_16x16x32_bf16 v[244:247], a[36:39], a[28:31], v[244:247]
 ds_read_b64_tr_b16 a[14:15], v5 offset:50176
 s_add_u32 s27, s67, 262144
 v_mfma_f32_16x16x32_bf16 v[248:251], a[40:43], a[28:31], v[248:251]
 buffer_load_dwordx4 v11, s[28:31], s27 offen lds
 v_mfma_f32_16x16x32_bf16 v[252:255], a[44:47], a[28:31], v[252:255]
 s_waitcnt lgkmcnt(6)
 v_mfma_f32_16x16x32_bf16 v[64:67], a[0:3], a[48:51], v[64:67]
 ds_read_b64_tr_b16 a[16:17], v6 offset:49152
 v_mfma_f32_16x16x32_bf16 v[68:71], a[0:3], a[52:55], v[68:71]
 ds_read_b64_tr_b16 a[18:19], v6 offset:50176
 v_mfma_f32_16x16x32_bf16 v[72:75], a[0:3], a[56:59], v[72:75]
 v_mfma_f32_16x16x32_bf16 v[76:79], a[0:3], a[60:63], v[76:79]
 s_waitcnt lgkmcnt(6)
 v_mfma_f32_16x16x32_bf16 v[80:83], a[4:7], a[48:51], v[80:83]
 ds_read_b64_tr_b16 a[20:21], v7 offset:49152
 v_mfma_f32_16x16x32_bf16 v[84:87], a[4:7], a[52:55], v[84:87]
 ds_read_b64_tr_b16 a[22:23], v7 offset:50176
 v_mfma_f32_16x16x32_bf16 v[88:91], a[4:7], a[56:59], v[88:91]
 v_mfma_f32_16x16x32_bf16 v[92:95], a[4:7], a[60:63], v[92:95]
 s_waitcnt lgkmcnt(6)
 v_mfma_f32_16x16x32_bf16 v[96:99], a[8:11], a[48:51], v[96:99]
 ds_read_b64_tr_b16 a[24:25], v8 offset:49152
 v_mfma_f32_16x16x32_bf16 v[100:103], a[8:11], a[52:55], v[100:103]
 ds_read_b64_tr_b16 a[26:27], v8 offset:50176
 v_mfma_f32_16x16x32_bf16 v[104:107], a[8:11], a[56:59], v[104:107]
 v_cvt_pk_bf16_f32 v64, v64, v65
 v_cvt_pk_bf16_f32 v65, v66, v67
 v_cvt_pk_bf16_f32 v66, v80, v81
 v_mfma_f32_16x16x32_bf16 v[108:111], a[8:11], a[60:63], v[108:111]
 v_cvt_pk_bf16_f32 v67, v82, v83
 v_cvt_pk_bf16_f32 v68, v68, v69
 v_cvt_pk_bf16_f32 v69, v70, v71
 s_waitcnt lgkmcnt(6)
 v_mfma_f32_16x16x32_bf16 v[112:115], a[12:15], a[48:51], v[112:115]
 ds_read_b64_tr_b16 a[28:29], v9 offset:49152
 v_cvt_pk_bf16_f32 v70, v84, v85
 v_cvt_pk_bf16_f32 v71, v86, v87
 s_add_u32 m0, s65, 24576
 v_mfma_f32_16x16x32_bf16 v[116:119], a[12:15], a[52:55], v[116:119]
 ds_read_b64_tr_b16 a[30:31], v9 offset:50176
 v_cvt_pk_bf16_f32 v72, v72, v73
 s_add_u32 s27, s68, 110592
 s_mov_b32 s50, 2048
 v_mfma_f32_16x16x32_bf16 v[120:123], a[12:15], a[56:59], v[120:123]
 buffer_load_dwordx4 v37, s[32:35], s27 offen lds
 v_cvt_pk_bf16_f32 v73, v74, v75
 v_cvt_pk_bf16_f32 v74, v88, v89
 buffer_load_dwordx4 a[160:163], v40, s[4:7], s50 offen sc1
 v_mfma_f32_16x16x32_bf16 v[124:127], a[12:15], a[60:63], v[124:127]
 v_cvt_pk_bf16_f32 v75, v90, v91
 v_cvt_pk_bf16_f32 v76, v76, v77
 v_cvt_pk_bf16_f32 v77, v78, v79
 s_waitcnt lgkmcnt(6)
 v_mfma_f32_16x16x32_bf16 a[64:67], a[16:19], a[48:51], a[64:67]
 ds_read_b64_tr_b16 a[0:1], v2 offset:57344
 v_cvt_pk_bf16_f32 v78, v92, v93
 v_cvt_pk_bf16_f32 v79, v94, v95
 v_mfma_f32_16x16x32_bf16 a[68:71], a[16:19], a[52:55], a[68:71]
 ds_read_b64_tr_b16 a[2:3], v2 offset:58368
 v_mfma_f32_16x16x32_bf16 a[72:75], a[16:19], a[56:59], a[72:75]
 v_cvt_pk_bf16_f32 v96, v96, v97
 v_cvt_pk_bf16_f32 v97, v98, v99
 v_cvt_pk_bf16_f32 v98, v112, v113
 v_mfma_f32_16x16x32_bf16 a[76:79], a[16:19], a[60:63], a[76:79]
 v_cvt_pk_bf16_f32 v99, v114, v115
 v_cvt_pk_bf16_f32 v100, v100, v101
 v_cvt_pk_bf16_f32 v101, v102, v103
 s_waitcnt lgkmcnt(6)
 v_mfma_f32_16x16x32_bf16 a[80:83], a[20:23], a[48:51], a[80:83]
 ds_read_b64_tr_b16 a[4:5], v3 offset:57344
 v_cvt_pk_bf16_f32 v102, v116, v117
 v_cvt_pk_bf16_f32 v103, v118, v119
 v_cvt_pk_bf16_f32 v104, v104, v105
 v_mfma_f32_16x16x32_bf16 a[84:87], a[20:23], a[52:55], a[84:87]
 ds_read_b64_tr_b16 a[6:7], v3 offset:58368
 v_cvt_pk_bf16_f32 v105, v106, v107
 v_cvt_pk_bf16_f32 v106, v120, v121
 v_cvt_pk_bf16_f32 v107, v122, v123
 v_mfma_f32_16x16x32_bf16 a[88:91], a[20:23], a[56:59], a[88:91]
 v_cvt_pk_bf16_f32 v108, v108, v109
 v_cvt_pk_bf16_f32 v109, v110, v111
 v_cvt_pk_bf16_f32 v110, v124, v125
 v_mfma_f32_16x16x32_bf16 a[92:95], a[20:23], a[60:63], a[92:95]
 v_cvt_pk_bf16_f32 v111, v126, v127
 s_waitcnt lgkmcnt(6)
 v_mfma_f32_16x16x32_bf16 a[96:99], a[24:27], a[48:51], a[96:99]
 ds_read_b64_tr_b16 a[8:9], v4 offset:57344
 v_mfma_f32_16x16x32_bf16 a[100:103], a[24:27], a[52:55], a[100:103]
 ds_read_b64_tr_b16 a[10:11], v4 offset:58368
 buffer_load_dwordx4 a[164:167], v41, s[4:7], s50 offen sc1
 v_mfma_f32_16x16x32_bf16 a[104:107], a[24:27], a[56:59], a[104:107]
 v_accvgpr_read_b32 v52, a64
 v_accvgpr_read_b32 v53, a65
 v_accvgpr_read_b32 v54, a66
 v_mfma_f32_16x16x32_bf16 a[108:111], a[24:27], a[60:63], a[108:111]
 v_accvgpr_read_b32 v55, a67
 v_accvgpr_read_b32 v56, a80
 v_accvgpr_read_b32 v57, a81
 s_waitcnt lgkmcnt(6)
 v_mfma_f32_16x16x32_bf16 a[112:115], a[28:31], a[48:51], a[112:115]
 ds_read_b64_tr_b16 a[12:13], v5 offset:57344
 v_accvgpr_read_b32 v58, a82
 v_accvgpr_read_b32 v59, a83
 v_cvt_pk_bf16_f32 v80, v52, v53
 v_mfma_f32_16x16x32_bf16 a[116:119], a[28:31], a[52:55], a[116:119]
 ds_read_b64_tr_b16 a[14:15], v5 offset:58368
 v_cvt_pk_bf16_f32 v81, v54, v55
 v_cvt_pk_bf16_f32 v82, v56, v57
 v_cvt_pk_bf16_f32 v83, v58, v59
 v_mfma_f32_16x16x32_bf16 a[120:123], a[28:31], a[56:59], a[120:123]
 v_accvgpr_read_b32 v22, a68
 v_accvgpr_read_b32 v23, a69
 v_accvgpr_read_b32 v24, a70
 v_mfma_f32_16x16x32_bf16 a[124:127], a[28:31], a[60:63], a[124:127]
 v_accvgpr_read_b32 v25, a71
 v_accvgpr_read_b32 v26, a84
 v_accvgpr_read_b32 v27, a85
 s_waitcnt lgkmcnt(6)
 v_mfma_f32_16x16x32_bf16 v[128:131], a[48:51], a[0:3], v[128:131]
 ds_read_b64_tr_b16 a[16:17], v6 offset:57344
 v_accvgpr_read_b32 v28, a86
 v_accvgpr_read_b32 v29, a87
 v_cvt_pk_bf16_f32 v84, v22, v23
 v_mfma_f32_16x16x32_bf16 v[132:135], a[52:55], a[0:3], v[132:135]
 ds_read_b64_tr_b16 a[18:19], v6 offset:58368
 v_cvt_pk_bf16_f32 v85, v24, v25
 v_cvt_pk_bf16_f32 v86, v26, v27
 v_cvt_pk_bf16_f32 v87, v28, v29
 v_mfma_f32_16x16x32_bf16 v[136:139], a[56:59], a[0:3], v[136:139]
 v_accvgpr_read_b32 v52, a72
 v_accvgpr_read_b32 v53, a73
 v_accvgpr_read_b32 v54, a74
 v_mfma_f32_16x16x32_bf16 v[140:143], a[60:63], a[0:3], v[140:143]
 v_accvgpr_read_b32 v55, a75
 v_accvgpr_read_b32 v56, a88
 v_accvgpr_read_b32 v57, a89
 s_waitcnt lgkmcnt(6)
 v_mfma_f32_16x16x32_bf16 v[144:147], a[48:51], a[4:7], v[144:147]
 ds_read_b64_tr_b16 a[20:21], v7 offset:57344
 v_accvgpr_read_b32 v58, a90
 v_accvgpr_read_b32 v59, a91
 buffer_load_dwordx4 a[168:171], v42, s[4:7], s50 offen sc1
 v_mfma_f32_16x16x32_bf16 v[148:151], a[52:55], a[4:7], v[148:151]
 ds_read_b64_tr_b16 a[22:23], v7 offset:58368
 v_cvt_pk_bf16_f32 v88, v52, v53
 v_cvt_pk_bf16_f32 v89, v54, v55
 v_cvt_pk_bf16_f32 v90, v56, v57
 v_mfma_f32_16x16x32_bf16 v[152:155], a[56:59], a[4:7], v[152:155]
 v_cvt_pk_bf16_f32 v91, v58, v59
 v_accvgpr_read_b32 v22, a76
 v_accvgpr_read_b32 v23, a77
 v_mfma_f32_16x16x32_bf16 v[156:159], a[60:63], a[4:7], v[156:159]
 v_accvgpr_read_b32 v24, a78
 v_accvgpr_read_b32 v25, a79
 v_accvgpr_read_b32 v26, a92
 s_waitcnt lgkmcnt(6)
 v_mfma_f32_16x16x32_bf16 v[160:163], a[48:51], a[8:11], v[160:163]
 ds_read_b64_tr_b16 a[24:25], v8 offset:57344
 v_accvgpr_read_b32 v27, a93
 v_accvgpr_read_b32 v28, a94
 v_accvgpr_read_b32 v29, a95
 v_mfma_f32_16x16x32_bf16 v[164:167], a[52:55], a[8:11], v[164:167]
 ds_read_b64_tr_b16 a[26:27], v8 offset:58368
 v_cvt_pk_bf16_f32 v92, v22, v23
 v_cvt_pk_bf16_f32 v93, v24, v25
 v_cvt_pk_bf16_f32 v94, v26, v27
 v_mfma_f32_16x16x32_bf16 v[168:171], a[56:59], a[8:11], v[168:171]
 v_cvt_pk_bf16_f32 v95, v28, v29
 v_accvgpr_read_b32 v52, a96
 v_accvgpr_read_b32 v53, a97
 v_mfma_f32_16x16x32_bf16 v[172:175], a[60:63], a[8:11], v[172:175]
 v_accvgpr_read_b32 v54, a98
 v_accvgpr_read_b32 v55, a99
 v_accvgpr_read_b32 v56, a112
 s_waitcnt lgkmcnt(6)
 v_mfma_f32_16x16x32_bf16 v[176:179], a[48:51], a[12:15], v[176:179]
 s_waitcnt vmcnt(10)
 s_barrier
 v_accvgpr_read_b32 v57, a113
 ds_read_b64_tr_b16 a[28:29], v9 offset:57344
 s_add_u32 m0, s59, 32768
 v_mfma_f32_16x16x32_bf16 v[180:183], a[52:55], a[12:15], v[180:183]
 ds_read_b64_tr_b16 a[30:31], v9 offset:58368
 v_accvgpr_read_b32 v58, a114
 v_accvgpr_read_b32 v59, a115
 s_add_u32 s27, s67, 524288
 v_mfma_f32_16x16x32_bf16 v[184:187], a[56:59], a[12:15], v[184:187]
 buffer_load_dwordx4 v10, s[28:31], s27 offen lds
 v_cvt_pk_bf16_f32 v112, v52, v53
 v_cvt_pk_bf16_f32 v113, v54, v55
 v_cvt_pk_bf16_f32 v114, v56, v57
 v_mfma_f32_16x16x32_bf16 v[188:191], a[60:63], a[12:15], v[188:191]
 buffer_load_dwordx4 a[172:175], v43, s[4:7], s50 offen sc1
 v_cvt_pk_bf16_f32 v115, v58, v59
 v_accvgpr_read_b32 v22, a100
 v_accvgpr_read_b32 v23, a101
 s_waitcnt lgkmcnt(6)
 v_mfma_f32_16x16x32_bf16 v[192:195], a[48:51], a[16:19], v[192:195]
 ds_read_b64_tr_b16 a[0:1], v2
 v_accvgpr_read_b32 v24, a102
 v_accvgpr_read_b32 v25, a103
 v_accvgpr_read_b32 v26, a116
 v_mfma_f32_16x16x32_bf16 v[196:199], a[52:55], a[16:19], v[196:199]
 ds_read_b64_tr_b16 a[2:3], v2 offset:1024
 v_accvgpr_read_b32 v27, a117
 v_accvgpr_read_b32 v28, a118
 v_accvgpr_read_b32 v29, a119
 v_mfma_f32_16x16x32_bf16 v[200:203], a[56:59], a[16:19], v[200:203]
 v_cvt_pk_bf16_f32 v116, v22, v23
 v_cvt_pk_bf16_f32 v117, v24, v25
 v_cvt_pk_bf16_f32 v118, v26, v27
 v_mfma_f32_16x16x32_bf16 v[204:207], a[60:63], a[16:19], v[204:207]
 v_cvt_pk_bf16_f32 v119, v28, v29
 v_accvgpr_read_b32 v52, a104
 v_accvgpr_read_b32 v53, a105
 s_waitcnt lgkmcnt(6)
 v_mfma_f32_16x16x32_bf16 v[208:211], a[48:51], a[20:23], v[208:211]
 ds_read_b64_tr_b16 a[4:5], v3
 v_accvgpr_read_b32 v54, a106
 v_accvgpr_read_b32 v55, a107
 v_accvgpr_read_b32 v56, a120
 v_mfma_f32_16x16x32_bf16 v[212:215], a[52:55], a[20:23], v[212:215]
 ds_read_b64_tr_b16 a[6:7], v3 offset:1024
 v_accvgpr_read_b32 v57, a121
 v_accvgpr_read_b32 v58, a122
 v_accvgpr_read_b32 v59, a123
 v_mfma_f32_16x16x32_bf16 v[216:219], a[56:59], a[20:23], v[216:219]
 v_cvt_pk_bf16_f32 v120, v52, v53
 v_cvt_pk_bf16_f32 v121, v54, v55
 v_cvt_pk_bf16_f32 v122, v56, v57
 v_mfma_f32_16x16x32_bf16 v[220:223], a[60:63], a[20:23], v[220:223]
 v_cvt_pk_bf16_f32 v123, v58, v59
 v_accvgpr_read_b32 v22, a108
 v_accvgpr_read_b32 v23, a109
 s_waitcnt lgkmcnt(6)
 v_mfma_f32_16x16x32_bf16 v[224:227], a[48:51], a[24:27], v[224:227]
 ds_read_b64_tr_b16 a[8:9], v4
 v_accvgpr_read_b32 v24, a110
 v_accvgpr_read_b32 v25, a111
 v_accvgpr_read_b32 v26, a124
 v_mfma_f32_16x16x32_bf16 v[228:231], a[52:55], a[24:27], v[228:231]
 ds_read_b64_tr_b16 a[10:11], v4 offset:1024
 v_accvgpr_read_b32 v27, a125
 v_accvgpr_read_b32 v28, a126
 v_accvgpr_read_b32 v29, a127
 v_mfma_f32_16x16x32_bf16 v[232:235], a[56:59], a[24:27], v[232:235]
 v_cvt_pk_bf16_f32 v124, v22, v23
 v_cvt_pk_bf16_f32 v125, v24, v25
 v_cvt_pk_bf16_f32 v126, v26, v27
 v_mfma_f32_16x16x32_bf16 v[236:239], a[60:63], a[24:27], v[236:239]
 v_cvt_pk_bf16_f32 v127, v28, v29
 v_cvt_pk_bf16_f32 v128, v128, v129
 v_cvt_pk_bf16_f32 v129, v130, v131
 s_waitcnt lgkmcnt(6)
 v_mfma_f32_16x16x32_bf16 v[240:243], a[48:51], a[28:31], v[240:243]
 ds_read_b64_tr_b16 a[12:13], v5
 v_cvt_pk_bf16_f32 v130, v132, v133
 v_cvt_pk_bf16_f32 v131, v134, v135
 s_add_u32 m0, s59, 33792
 v_mfma_f32_16x16x32_bf16 v[244:247], a[52:55], a[28:31], v[244:247]
 ds_read_b64_tr_b16 a[14:15], v5 offset:1024
 v_cvt_pk_bf16_f32 v136, v136, v137
 v_cvt_pk_bf16_f32 v137, v138, v139
 s_add_u32 s27, s67, 524288
 v_mfma_f32_16x16x32_bf16 v[248:251], a[56:59], a[28:31], v[248:251]
 buffer_load_dwordx4 v11, s[28:31], s27 offen lds
 v_cvt_pk_bf16_f32 v138, v140, v141
 v_cvt_pk_bf16_f32 v139, v142, v143
 v_cvt_pk_bf16_f32 v144, v144, v145
 v_mfma_f32_16x16x32_bf16 v[252:255], a[60:63], a[28:31], v[252:255]
 v_cvt_pk_bf16_f32 v145, v146, v147
 v_cvt_pk_bf16_f32 v146, v148, v149
 v_cvt_pk_bf16_f32 v147, v150, v151
 s_waitcnt lgkmcnt(6)
 v_mfma_f32_16x16x32_bf16 a[192:195], a[0:3], a[128:131], 0
 ds_read_b64_tr_b16 a[16:17], v6
 v_cvt_pk_bf16_f32 v152, v152, v153
 v_cvt_pk_bf16_f32 v153, v154, v155
 v_cvt_pk_bf16_f32 v154, v156, v157
 v_mfma_f32_16x16x32_bf16 a[196:199], a[0:3], a[132:135], 0
 ds_read_b64_tr_b16 a[18:19], v6 offset:1024
 v_cvt_pk_bf16_f32 v155, v158, v159
 v_cvt_pk_bf16_f32 v160, v160, v161
 v_cvt_pk_bf16_f32 v161, v162, v163
 v_mfma_f32_16x16x32_bf16 a[200:203], a[0:3], a[136:139], 0
 v_cvt_pk_bf16_f32 v162, v164, v165
 v_cvt_pk_bf16_f32 v163, v166, v167
 v_cvt_pk_bf16_f32 v168, v168, v169
 v_mfma_f32_16x16x32_bf16 a[204:207], a[0:3], a[140:143], 0
 v_cvt_pk_bf16_f32 v169, v170, v171
 v_cvt_pk_bf16_f32 v170, v172, v173
 v_cvt_pk_bf16_f32 v171, v174, v175
 s_waitcnt lgkmcnt(6)
 v_mfma_f32_16x16x32_bf16 a[208:211], a[4:7], a[128:131], 0
 ds_read_b64_tr_b16 a[20:21], v7
 v_cvt_pk_bf16_f32 v176, v176, v177
 v_cvt_pk_bf16_f32 v177, v178, v179
 v_cvt_pk_bf16_f32 v178, v180, v181
 v_mfma_f32_16x16x32_bf16 a[212:215], a[4:7], a[132:135], 0
 ds_read_b64_tr_b16 a[22:23], v7 offset:1024
 v_cvt_pk_bf16_f32 v179, v182, v183
 v_cvt_pk_bf16_f32 v184, v184, v185
 s_mov_b32 s50, 3072
 v_mfma_f32_16x16x32_bf16 a[216:219], a[4:7], a[136:139], 0
 buffer_load_dwordx4 a[176:179], v40, s[4:7], s50 offen sc1
 v_cvt_pk_bf16_f32 v185, v186, v187
 v_cvt_pk_bf16_f32 v186, v188, v189
 v_cvt_pk_bf16_f32 v187, v190, v191
 v_mfma_f32_16x16x32_bf16 a[220:223], a[4:7], a[140:143], 0
 v_cvt_pk_bf16_f32 v192, v192, v193
 v_cvt_pk_bf16_f32 v193, v194, v195
 v_cvt_pk_bf16_f32 v194, v196, v197
 s_waitcnt lgkmcnt(6)
 v_mfma_f32_16x16x32_bf16 a[224:227], a[8:11], a[128:131], 0
 ds_read_b64_tr_b16 a[24:25], v8
 v_cvt_pk_bf16_f32 v195, v198, v199
 v_cvt_pk_bf16_f32 v200, v200, v201
 v_cvt_pk_bf16_f32 v201, v202, v203
 v_mfma_f32_16x16x32_bf16 a[228:231], a[8:11], a[132:135], 0
 ds_read_b64_tr_b16 a[26:27], v8 offset:1024
 v_cvt_pk_bf16_f32 v202, v204, v205
 v_cvt_pk_bf16_f32 v203, v206, v207
 v_cvt_pk_bf16_f32 v208, v208, v209
 v_mfma_f32_16x16x32_bf16 a[232:235], a[8:11], a[136:139], 0
 v_cvt_pk_bf16_f32 v209, v210, v211
 v_cvt_pk_bf16_f32 v210, v212, v213
 v_cvt_pk_bf16_f32 v211, v214, v215
 v_mfma_f32_16x16x32_bf16 a[236:239], a[8:11], a[140:143], 0
 v_cvt_pk_bf16_f32 v216, v216, v217
 v_cvt_pk_bf16_f32 v217, v218, v219
 v_cvt_pk_bf16_f32 v218, v220, v221
 s_waitcnt lgkmcnt(6)
 v_mfma_f32_16x16x32_bf16 a[240:243], a[12:15], a[128:131], 0
 ds_read_b64_tr_b16 a[28:29], v9
 v_cvt_pk_bf16_f32 v219, v222, v223
 v_cvt_pk_bf16_f32 v224, v224, v225
 s_add_u32 m0, s65, 40960
 v_mfma_f32_16x16x32_bf16 a[244:247], a[12:15], a[132:135], 0
 ds_read_b64_tr_b16 a[30:31], v9 offset:1024
 v_cvt_pk_bf16_f32 v225, v226, v227
 v_cvt_pk_bf16_f32 v226, v228, v229
 s_add_u32 s27, s68, 221184
 v_mfma_f32_16x16x32_bf16 a[248:251], a[12:15], a[136:139], 0
 buffer_load_dwordx4 v37, s[32:35], s27 offen lds
 v_cvt_pk_bf16_f32 v227, v230, v231
 v_cvt_pk_bf16_f32 v232, v232, v233
 v_cvt_pk_bf16_f32 v233, v234, v235
 v_mfma_f32_16x16x32_bf16 a[252:255], a[12:15], a[140:143], 0
 v_cvt_pk_bf16_f32 v234, v236, v237
 v_cvt_pk_bf16_f32 v235, v238, v239
 v_cvt_pk_bf16_f32 v240, v240, v241
 s_waitcnt lgkmcnt(6)
 v_mfma_f32_16x16x32_bf16 a[64:67], a[16:19], a[128:131], 0
 ds_read_b64_tr_b16 a[0:1], v32
 v_cvt_pk_bf16_f32 v241, v242, v243
 v_cvt_pk_bf16_f32 v242, v244, v245
 v_cvt_pk_bf16_f32 v243, v246, v247
 v_mfma_f32_16x16x32_bf16 a[68:71], a[16:19], a[132:135], 0
 ds_read_b64_tr_b16 a[2:3], v32 offset:512
 v_cvt_pk_bf16_f32 v248, v248, v249
 v_cvt_pk_bf16_f32 v249, v250, v251
 buffer_load_dwordx4 a[180:183], v41, s[4:7], s50 offen sc1
 v_mfma_f32_16x16x32_bf16 a[72:75], a[16:19], a[136:139], 0
 buffer_store_dwordx4 v[64:67], v16, s[4:7], s55 offen sc1
 v_cvt_pk_bf16_f32 v250, v252, v253
 v_cvt_pk_bf16_f32 v251, v254, v255
 v_mfma_f32_16x16x32_bf16 a[76:79], a[16:19], a[140:143], 0
 buffer_store_dwordx4 v[68:71], v16, s[4:7], s56 offen sc1
 s_waitcnt lgkmcnt(6)
 v_mfma_f32_16x16x32_bf16 a[80:83], a[20:23], a[128:131], 0
 ds_read_b64_tr_b16 a[4:5], v33
 buffer_store_dwordx4 v[72:75], v16, s[4:7], s57 offen sc1
 v_mfma_f32_16x16x32_bf16 a[84:87], a[20:23], a[132:135], 0
 ds_read_b64_tr_b16 a[6:7], v33 offset:512
 v_mfma_f32_16x16x32_bf16 a[88:91], a[20:23], a[136:139], 0
 v_mfma_f32_16x16x32_bf16 a[92:95], a[20:23], a[140:143], 0
 s_waitcnt lgkmcnt(6)
 v_mfma_f32_16x16x32_bf16 a[96:99], a[24:27], a[128:131], 0
 ds_read_b64_tr_b16 a[8:9], v34
 v_mfma_f32_16x16x32_bf16 a[100:103], a[24:27], a[132:135], 0
 ds_read_b64_tr_b16 a[10:11], v34 offset:512
 v_mfma_f32_16x16x32_bf16 a[104:107], a[24:27], a[136:139], 0
 v_mfma_f32_16x16x32_bf16 a[108:111], a[24:27], a[140:143], 0
 s_waitcnt lgkmcnt(6)
 v_mfma_f32_16x16x32_bf16 a[112:115], a[28:31], a[128:131], 0
 ds_read_b64_tr_b16 a[12:13], v35
 buffer_load_dwordx4 a[184:187], v42, s[4:7], s50 offen sc1
 v_mfma_f32_16x16x32_bf16 a[116:119], a[28:31], a[132:135], 0
 ds_read_b64_tr_b16 a[14:15], v35 offset:512
 v_mfma_f32_16x16x32_bf16 a[120:123], a[28:31], a[136:139], 0
 s_waitcnt vmcnt(13)
 s_barrier
 s_add_u32 m0, s59, 49152
 v_mfma_f32_16x16x32_bf16 a[124:127], a[28:31], a[140:143], 0
 s_add_u32 s27, s67, 786432
 s_waitcnt lgkmcnt(6)
 v_mfma_f32_16x16x32_bf16 v[132:135], a[0:3], a[128:131], 0
 ds_read_b64_tr_b16 a[16:17], v36
 buffer_load_dwordx4 v10, s[28:31], s27 offen lds
 v_mfma_f32_16x16x32_bf16 v[140:143], a[0:3], a[132:135], 0
 ds_read_b64_tr_b16 a[18:19], v36 offset:512
 v_mfma_f32_16x16x32_bf16 v[148:151], a[0:3], a[136:139], 0
 v_mfma_f32_16x16x32_bf16 v[156:159], a[0:3], a[140:143], 0
 s_waitcnt lgkmcnt(6)
 v_mfma_f32_16x16x32_bf16 v[164:167], a[4:7], a[128:131], 0
 ds_read_b64_tr_b16 a[20:21], v2 offset:16384
 v_mfma_f32_16x16x32_bf16 v[172:175], a[4:7], a[132:135], 0
 ds_read_b64_tr_b16 a[22:23], v2 offset:17408
 v_mfma_f32_16x16x32_bf16 v[180:183], a[4:7], a[136:139], 0
 v_mfma_f32_16x16x32_bf16 v[188:191], a[4:7], a[140:143], 0
 buffer_load_dwordx4 a[188:191], v43, s[4:7], s50 offen sc1
 buffer_store_dwordx4 v[76:79], v16, s[4:7], s58 offen sc1
 s_waitcnt lgkmcnt(6)
 v_mfma_f32_16x16x32_bf16 v[196:199], a[8:11], a[128:131], 0
 ds_read_b64_tr_b16 a[24:25], v3 offset:16384
 v_mfma_f32_16x16x32_bf16 v[204:207], a[8:11], a[132:135], 0
 ds_read_b64_tr_b16 a[26:27], v3 offset:17408
 v_mfma_f32_16x16x32_bf16 v[212:215], a[8:11], a[136:139], 0
 v_mfma_f32_16x16x32_bf16 v[220:223], a[8:11], a[140:143], 0
 s_waitcnt lgkmcnt(6)
 v_mfma_f32_16x16x32_bf16 v[228:231], a[12:15], a[128:131], 0
 ds_read_b64_tr_b16 a[28:29], v4 offset:16384
 s_add_u32 m0, s59, 50176
 v_mfma_f32_16x16x32_bf16 v[236:239], a[12:15], a[132:135], 0
 ds_read_b64_tr_b16 a[30:31], v4 offset:17408
 s_add_u32 s27, s67, 786432
 v_mfma_f32_16x16x32_bf16 v[244:247], a[12:15], a[136:139], 0
 buffer_load_dwordx4 v11, s[28:31], s27 offen lds
 v_mfma_f32_16x16x32_bf16 v[252:255], a[12:15], a[140:143], 0
 s_waitcnt lgkmcnt(6)
 v_mfma_f32_16x16x32_bf16 v[48:51], a[16:19], v[44:47], 0
 ds_read_b64_tr_b16 a[0:1], v5 offset:16384
 ds_read_b64_tr_b16 a[2:3], v5 offset:17408
 s_waitcnt lgkmcnt(6)
 v_mfma_f32_16x16x32_bf16 a[192:195], a[20:23], a[144:147], a[192:195]
 ds_read_b64_tr_b16 a[4:5], v6 offset:16384
 v_mfma_f32_16x16x32_bf16 a[196:199], a[20:23], a[148:151], a[196:199]
 ds_read_b64_tr_b16 a[6:7], v6 offset:17408
 v_mfma_f32_16x16x32_bf16 a[200:203], a[20:23], a[152:155], a[200:203]
 v_mfma_f32_16x16x32_bf16 a[204:207], a[20:23], a[156:159], a[204:207]
 s_waitcnt lgkmcnt(6)
 v_mfma_f32_16x16x32_bf16 a[208:211], a[24:27], a[144:147], a[208:211]
 ds_read_b64_tr_b16 a[8:9], v7 offset:16384
 v_mfma_f32_16x16x32_bf16 a[212:215], a[24:27], a[148:151], a[212:215]
 ds_read_b64_tr_b16 a[10:11], v7 offset:17408
 s_mov_b32 s50, 4096
 v_mfma_f32_16x16x32_bf16 a[216:219], a[24:27], a[152:155], a[216:219]
 buffer_load_dwordx4 a[32:35], v40, s[4:7], s50 offen sc1
 v_mfma_f32_16x16x32_bf16 a[220:223], a[24:27], a[156:159], a[220:223]
 s_waitcnt lgkmcnt(6)
 v_mfma_f32_16x16x32_bf16 a[224:227], a[28:31], a[144:147], a[224:227]
 ds_read_b64_tr_b16 a[12:13], v8 offset:16384
 v_mfma_f32_16x16x32_bf16 a[228:231], a[28:31], a[148:151], a[228:231]
 ds_read_b64_tr_b16 a[14:15], v8 offset:17408
 s_add_u32 m0, s65, 57344
 v_mfma_f32_16x16x32_bf16 a[232:235], a[28:31], a[152:155], a[232:235]
 s_add_u32 s27, s68, 331776
 v_mfma_f32_16x16x32_bf16 a[236:239], a[28:31], a[156:159], a[236:239]
 buffer_load_dwordx4 v37, s[32:35], s27 offen lds
 buffer_store_dwordx4 v[96:99], v16, s[4:7], s55 offen offset:1024 sc1
 s_waitcnt lgkmcnt(6)
 v_mfma_f32_16x16x32_bf16 a[240:243], a[0:3], a[144:147], a[240:243]
 ds_read_b64_tr_b16 a[16:17], v9 offset:16384
 v_mfma_f32_16x16x32_bf16 a[244:247], a[0:3], a[148:151], a[244:247]
 ds_read_b64_tr_b16 a[18:19], v9 offset:17408
 v_mfma_f32_16x16x32_bf16 a[248:251], a[0:3], a[152:155], a[248:251]
 v_mfma_f32_16x16x32_bf16 a[252:255], a[0:3], a[156:159], a[252:255]
 s_waitcnt lgkmcnt(6)
 v_mfma_f32_16x16x32_bf16 a[64:67], a[4:7], a[144:147], a[64:67]
 ds_read_b64_tr_b16 a[20:21], v32 offset:16384
 v_mfma_f32_16x16x32_bf16 a[68:71], a[4:7], a[148:151], a[68:71]
 ds_read_b64_tr_b16 a[22:23], v32 offset:16896
 buffer_load_dwordx4 a[36:39], v41, s[4:7], s50 offen sc1
 v_mfma_f32_16x16x32_bf16 a[72:75], a[4:7], a[152:155], a[72:75]
 v_mfma_f32_16x16x32_bf16 a[76:79], a[4:7], a[156:159], a[76:79]
 s_waitcnt lgkmcnt(6)
 v_mfma_f32_16x16x32_bf16 a[80:83], a[8:11], a[144:147], a[80:83]
 ds_read_b64_tr_b16 a[24:25], v33 offset:16384
 v_mfma_f32_16x16x32_bf16 a[84:87], a[8:11], a[148:151], a[84:87]
 ds_read_b64_tr_b16 a[26:27], v33 offset:16896
 v_mfma_f32_16x16x32_bf16 a[88:91], a[8:11], a[152:155], a[88:91]
 v_mfma_f32_16x16x32_bf16 a[92:95], a[8:11], a[156:159], a[92:95]
 s_waitcnt lgkmcnt(6)
 v_mfma_f32_16x16x32_bf16 a[96:99], a[12:15], a[144:147], a[96:99]
 ds_read_b64_tr_b16 a[28:29], v34 offset:16384
 v_mfma_f32_16x16x32_bf16 a[100:103], a[12:15], a[148:151], a[100:103]
 ds_read_b64_tr_b16 a[30:31], v34 offset:16896
 v_mfma_f32_16x16x32_bf16 a[104:107], a[12:15], a[152:155], a[104:107]
 v_mfma_f32_16x16x32_bf16 a[108:111], a[12:15], a[156:159], a[108:111]
 s_waitcnt lgkmcnt(6)
 v_mfma_f32_16x16x32_bf16 a[112:115], a[16:19], a[144:147], a[112:115]
 ds_read_b64_tr_b16 a[0:1], v35 offset:16384
 buffer_load_dwordx4 a[40:43], v42, s[4:7], s50 offen sc1
 v_mfma_f32_16x16x32_bf16 a[116:119], a[16:19], a[148:151], a[116:119]
 ds_read_b64_tr_b16 a[2:3], v35 offset:16896
 v_mfma_f32_16x16x32_bf16 a[120:123], a[16:19], a[152:155], a[120:123]
 s_waitcnt vmcnt(14)
 s_barrier
 s_add_u32 m0, s59, 0
 v_mfma_f32_16x16x32_bf16 a[124:127], a[16:19], a[156:159], a[124:127]
 s_add_u32 s27, s67, 1048576
 s_waitcnt lgkmcnt(6)
 v_mfma_f32_16x16x32_bf16 v[132:135], a[20:23], a[144:147], v[132:135]
 ds_read_b64_tr_b16 a[4:5], v36 offset:16384
 buffer_load_dwordx4 v10, s[28:31], s27 offen lds
 buffer_store_dwordx4 v[100:103], v16, s[4:7], s56 offen offset:1024 sc1
 v_mfma_f32_16x16x32_bf16 v[140:143], a[20:23], a[148:151], v[140:143]
 ds_read_b64_tr_b16 a[6:7], v36 offset:16896
 v_mfma_f32_16x16x32_bf16 v[148:151], a[20:23], a[152:155], v[148:151]
 v_mfma_f32_16x16x32_bf16 v[156:159], a[20:23], a[156:159], v[156:159]
 s_waitcnt lgkmcnt(6)
 v_mfma_f32_16x16x32_bf16 v[164:167], a[24:27], a[144:147], v[164:167]
 ds_read_b64_tr_b16 a[8:9], v2 offset:32768
 v_mfma_f32_16x16x32_bf16 v[172:175], a[24:27], a[148:151], v[172:175]
 ds_read_b64_tr_b16 a[10:11], v2 offset:33792
 v_mfma_f32_16x16x32_bf16 v[180:183], a[24:27], a[152:155], v[180:183]
 v_mfma_f32_16x16x32_bf16 v[188:191], a[24:27], a[156:159], v[188:191]
 buffer_load_dwordx4 a[44:47], v43, s[4:7], s50 offen sc1
 s_waitcnt lgkmcnt(6)
 v_mfma_f32_16x16x32_bf16 v[196:199], a[28:31], a[144:147], v[196:199]
 ds_read_b64_tr_b16 a[12:13], v3 offset:32768
 v_mfma_f32_16x16x32_bf16 v[204:207], a[28:31], a[148:151], v[204:207]
 ds_read_b64_tr_b16 a[14:15], v3 offset:33792
 v_mfma_f32_16x16x32_bf16 v[212:215], a[28:31], a[152:155], v[212:215]
 v_mfma_f32_16x16x32_bf16 v[220:223], a[28:31], a[156:159], v[220:223]
 s_waitcnt lgkmcnt(6)
 v_mfma_f32_16x16x32_bf16 v[228:231], a[0:3], a[144:147], v[228:231]
 ds_read_b64_tr_b16 a[16:17], v4 offset:32768
 s_add_u32 m0, s59, 1024
 v_mfma_f32_16x16x32_bf16 v[236:239], a[0:3], a[148:151], v[236:239]
 ds_read_b64_tr_b16 a[18:19], v4 offset:33792
 s_add_u32 s27, s67, 1048576
 v_mfma_f32_16x16x32_bf16 v[244:247], a[0:3], a[152:155], v[244:247]
 buffer_load_dwordx4 v11, s[28:31], s27 offen lds
 v_mfma_f32_16x16x32_bf16 v[252:255], a[0:3], a[156:159], v[252:255]
 s_waitcnt lgkmcnt(6)
 v_mfma_f32_16x16x32_bf16 v[48:51], a[4:7], v[44:47], v[48:51]
 ds_read_b64_tr_b16 a[20:21], v5 offset:32768
 ds_read_b64_tr_b16 a[22:23], v5 offset:33792
 s_waitcnt lgkmcnt(6)
 v_mfma_f32_16x16x32_bf16 a[192:195], a[8:11], a[160:163], a[192:195]
 ds_read_b64_tr_b16 a[24:25], v6 offset:32768
 v_mfma_f32_16x16x32_bf16 a[196:199], a[8:11], a[164:167], a[196:199]
 ds_read_b64_tr_b16 a[26:27], v6 offset:33792
 v_mfma_f32_16x16x32_bf16 a[200:203], a[8:11], a[168:171], a[200:203]
 v_mfma_f32_16x16x32_bf16 a[204:207], a[8:11], a[172:175], a[204:207]
 s_waitcnt lgkmcnt(6)
 v_mfma_f32_16x16x32_bf16 a[208:211], a[12:15], a[160:163], a[208:211]
 ds_read_b64_tr_b16 a[28:29], v7 offset:32768
 buffer_store_dwordx4 v[104:107], v16, s[4:7], s57 offen offset:1024 sc1
 v_mfma_f32_16x16x32_bf16 a[212:215], a[12:15], a[164:167], a[212:215]
 ds_read_b64_tr_b16 a[30:31], v7 offset:33792
 s_mov_b32 s50, 5120
 v_mfma_f32_16x16x32_bf16 a[216:219], a[12:15], a[168:171], a[216:219]
 buffer_load_dwordx4 a[48:51], v40, s[4:7], s50 offen sc1
 v_mfma_f32_16x16x32_bf16 a[220:223], a[12:15], a[172:175], a[220:223]
 s_waitcnt lgkmcnt(6)
 v_mfma_f32_16x16x32_bf16 a[224:227], a[16:19], a[160:163], a[224:227]
 ds_read_b64_tr_b16 a[0:1], v8 offset:32768
 v_mfma_f32_16x16x32_bf16 a[228:231], a[16:19], a[164:167], a[228:231]
 ds_read_b64_tr_b16 a[2:3], v8 offset:33792
 s_add_u32 m0, s65, 8192
 v_mfma_f32_16x16x32_bf16 a[232:235], a[16:19], a[168:171], a[232:235]
 s_add_u32 s27, s68, 442368
 v_mfma_f32_16x16x32_bf16 a[236:239], a[16:19], a[172:175], a[236:239]
 buffer_load_dwordx4 v37, s[32:35], s27 offen lds
 buffer_load_dwordx4 a[52:55], v41, s[4:7], s50 offen sc1
 s_waitcnt lgkmcnt(6)
 v_mfma_f32_16x16x32_bf16 a[240:243], a[20:23], a[160:163], a[240:243]
 ds_read_b64_tr_b16 a[4:5], v9 offset:32768
 v_mfma_f32_16x16x32_bf16 a[244:247], a[20:23], a[164:167], a[244:247]
 ds_read_b64_tr_b16 a[6:7], v9 offset:33792
 v_mfma_f32_16x16x32_bf16 a[248:251], a[20:23], a[168:171], a[248:251]
 v_mfma_f32_16x16x32_bf16 a[252:255], a[20:23], a[172:175], a[252:255]
 s_waitcnt lgkmcnt(6)
 v_mfma_f32_16x16x32_bf16 a[64:67], a[24:27], a[160:163], a[64:67]
 ds_read_b64_tr_b16 a[8:9], v32 offset:32768
 buffer_load_dwordx4 a[56:59], v42, s[4:7], s50 offen sc1
 v_mfma_f32_16x16x32_bf16 a[68:71], a[24:27], a[164:167], a[68:71]
 ds_read_b64_tr_b16 a[10:11], v32 offset:33280
 v_mfma_f32_16x16x32_bf16 a[72:75], a[24:27], a[168:171], a[72:75]
 v_mfma_f32_16x16x32_bf16 a[76:79], a[24:27], a[172:175], a[76:79]
 s_waitcnt lgkmcnt(6)
 v_mfma_f32_16x16x32_bf16 a[80:83], a[28:31], a[160:163], a[80:83]
 ds_read_b64_tr_b16 a[12:13], v33 offset:32768
 v_mfma_f32_16x16x32_bf16 a[84:87], a[28:31], a[164:167], a[84:87]
 ds_read_b64_tr_b16 a[14:15], v33 offset:33280
 buffer_load_dwordx4 a[60:63], v43, s[4:7], s50 offen sc1
 v_mfma_f32_16x16x32_bf16 a[88:91], a[28:31], a[168:171], a[88:91]
 v_mfma_f32_16x16x32_bf16 a[92:95], a[28:31], a[172:175], a[92:95]
 s_waitcnt lgkmcnt(6)
 v_mfma_f32_16x16x32_bf16 a[96:99], a[0:3], a[160:163], a[96:99]
 ds_read_b64_tr_b16 a[16:17], v34 offset:32768
 v_mfma_f32_16x16x32_bf16 a[100:103], a[0:3], a[164:167], a[100:103]
 ds_read_b64_tr_b16 a[18:19], v34 offset:33280
 buffer_store_dwordx4 v[108:111], v16, s[4:7], s58 offen offset:1024 sc1
 v_mfma_f32_16x16x32_bf16 a[104:107], a[0:3], a[168:171], a[104:107]
 v_mfma_f32_16x16x32_bf16 a[108:111], a[0:3], a[172:175], a[108:111]
 s_mov_b32 s50, 6144
 s_waitcnt lgkmcnt(6)
 v_mfma_f32_16x16x32_bf16 a[112:115], a[4:7], a[160:163], a[112:115]
 ds_read_b64_tr_b16 a[20:21], v35 offset:32768
 buffer_load_dwordx4 a[128:131], v40, s[4:7], s50 offen sc1
 v_mfma_f32_16x16x32_bf16 a[116:119], a[4:7], a[164:167], a[116:119]
 ds_read_b64_tr_b16 a[22:23], v35 offset:33280
 v_mfma_f32_16x16x32_bf16 a[120:123], a[4:7], a[168:171], a[120:123]
 s_waitcnt vmcnt(15)
 s_barrier
 s_add_u32 m0, s59, 16384
 v_mfma_f32_16x16x32_bf16 a[124:127], a[4:7], a[172:175], a[124:127]
 s_add_u32 s27, s67, 1310720
 s_waitcnt lgkmcnt(6)
 v_mfma_f32_16x16x32_bf16 v[132:135], a[8:11], a[160:163], v[132:135]
 ds_read_b64_tr_b16 a[24:25], v36 offset:32768
 buffer_load_dwordx4 v10, s[28:31], s27 offen lds
 v_mfma_f32_16x16x32_bf16 v[140:143], a[8:11], a[164:167], v[140:143]
 ds_read_b64_tr_b16 a[26:27], v36 offset:33280
 buffer_load_dwordx4 a[132:135], v41, s[4:7], s50 offen sc1
 v_mfma_f32_16x16x32_bf16 v[148:151], a[8:11], a[168:171], v[148:151]
 v_mfma_f32_16x16x32_bf16 v[156:159], a[8:11], a[172:175], v[156:159]
 s_waitcnt lgkmcnt(6)
 v_mfma_f32_16x16x32_bf16 v[164:167], a[12:15], a[160:163], v[164:167]
 ds_read_b64_tr_b16 a[28:29], v2 offset:49152
 v_mfma_f32_16x16x32_bf16 v[172:175], a[12:15], a[164:167], v[172:175]
 ds_read_b64_tr_b16 a[30:31], v2 offset:50176
 v_mfma_f32_16x16x32_bf16 v[180:183], a[12:15], a[168:171], v[180:183]
 buffer_load_dwordx4 a[136:139], v42, s[4:7], s50 offen sc1
 v_mfma_f32_16x16x32_bf16 v[188:191], a[12:15], a[172:175], v[188:191]
 s_waitcnt lgkmcnt(6)
 v_mfma_f32_16x16x32_bf16 v[196:199], a[16:19], a[160:163], v[196:199]
 ds_read_b64_tr_b16 a[0:1], v3 offset:49152
 v_mfma_f32_16x16x32_bf16 v[204:207], a[16:19], a[164:167], v[204:207]
 ds_read_b64_tr_b16 a[2:3], v3 offset:50176
 v_mfma_f32_16x16x32_bf16 v[212:215], a[16:19], a[168:171], v[212:215]
 v_mfma_f32_16x16x32_bf16 v[220:223], a[16:19], a[172:175], v[220:223]
 buffer_load_dwordx4 a[140:143], v43, s[4:7], s50 offen sc1
 s_waitcnt lgkmcnt(6)
 v_mfma_f32_16x16x32_bf16 v[228:231], a[20:23], a[160:163], v[228:231]
 ds_read_b64_tr_b16 a[4:5], v4 offset:49152
 s_add_u32 m0, s59, 17408
 v_mfma_f32_16x16x32_bf16 v[236:239], a[20:23], a[164:167], v[236:239]
 ds_read_b64_tr_b16 a[6:7], v4 offset:50176
 s_add_u32 s27, s67, 1310720
 v_mfma_f32_16x16x32_bf16 v[244:247], a[20:23], a[168:171], v[244:247]
 buffer_load_dwordx4 v11, s[28:31], s27 offen lds
 buffer_store_dwordx4 v[80:83], v16, s[4:7], s55 offen offset:2048 sc1
 v_mfma_f32_16x16x32_bf16 v[252:255], a[20:23], a[172:175], v[252:255]
 s_waitcnt lgkmcnt(6)
 v_mfma_f32_16x16x32_bf16 v[48:51], a[24:27], v[44:47], v[48:51]
 ds_read_b64_tr_b16 a[8:9], v5 offset:49152
 ds_read_b64_tr_b16 a[10:11], v5 offset:50176
 s_waitcnt lgkmcnt(6)
 v_mfma_f32_16x16x32_bf16 a[192:195], a[28:31], a[176:179], a[192:195]
 ds_read_b64_tr_b16 a[12:13], v6 offset:49152
 v_mfma_f32_16x16x32_bf16 a[196:199], a[28:31], a[180:183], a[196:199]
 ds_read_b64_tr_b16 a[14:15], v6 offset:50176
 v_mfma_f32_16x16x32_bf16 a[200:203], a[28:31], a[184:187], a[200:203]
 v_mfma_f32_16x16x32_bf16 a[204:207], a[28:31], a[188:191], a[204:207]
 s_waitcnt lgkmcnt(6)
 v_mfma_f32_16x16x32_bf16 a[208:211], a[0:3], a[176:179], a[208:211]
 ds_read_b64_tr_b16 a[16:17], v7 offset:49152
 v_mfma_f32_16x16x32_bf16 a[212:215], a[0:3], a[180:183], a[212:215]
 ds_read_b64_tr_b16 a[18:19], v7 offset:50176
 s_mov_b32 s50, 7168
 v_mfma_f32_16x16x32_bf16 a[216:219], a[0:3], a[184:187], a[216:219]
 buffer_load_dwordx4 a[144:147], v40, s[4:7], s50 offen sc1
 v_mfma_f32_16x16x32_bf16 a[220:223], a[0:3], a[188:191], a[220:223]
 s_waitcnt lgkmcnt(6)
 v_mfma_f32_16x16x32_bf16 a[224:227], a[4:7], a[176:179], a[224:227]
 ds_read_b64_tr_b16 a[20:21], v8 offset:49152
 v_mfma_f32_16x16x32_bf16 a[228:231], a[4:7], a[180:183], a[228:231]
 ds_read_b64_tr_b16 a[22:23], v8 offset:50176
 s_add_u32 m0, s65, 24576
 v_mfma_f32_16x16x32_bf16 a[232:235], a[4:7], a[184:187], a[232:235]
 s_add_u32 s27, s68, 552960
 v_mfma_f32_16x16x32_bf16 a[236:239], a[4:7], a[188:191], a[236:239]
 buffer_load_dwordx4 v37, s[32:35], s27 offen lds
 s_waitcnt lgkmcnt(6)
 v_mfma_f32_16x16x32_bf16 a[240:243], a[8:11], a[176:179], a[240:243]
 ds_read_b64_tr_b16 a[24:25], v9 offset:49152
 v_mfma_f32_16x16x32_bf16 a[244:247], a[8:11], a[180:183], a[244:247]
 ds_read_b64_tr_b16 a[26:27], v9 offset:50176
 v_mfma_f32_16x16x32_bf16 a[248:251], a[8:11], a[184:187], a[248:251]
 v_mfma_f32_16x16x32_bf16 a[252:255], a[8:11], a[188:191], a[252:255]
 s_waitcnt lgkmcnt(6)
 v_mfma_f32_16x16x32_bf16 a[64:67], a[12:15], a[176:179], a[64:67]
 ds_read_b64_tr_b16 a[28:29], v32 offset:49152
 v_mfma_f32_16x16x32_bf16 a[68:71], a[12:15], a[180:183], a[68:71]
 ds_read_b64_tr_b16 a[30:31], v32 offset:49664
 buffer_load_dwordx4 a[148:151], v41, s[4:7], s50 offen sc1
 v_mfma_f32_16x16x32_bf16 a[72:75], a[12:15], a[184:187], a[72:75]
 buffer_store_dwordx4 v[84:87], v16, s[4:7], s56 offen offset:2048 sc1
 v_mfma_f32_16x16x32_bf16 a[76:79], a[12:15], a[188:191], a[76:79]
 s_waitcnt lgkmcnt(6)
 v_mfma_f32_16x16x32_bf16 a[80:83], a[16:19], a[176:179], a[80:83]
 ds_read_b64_tr_b16 a[0:1], v33 offset:49152
 v_mfma_f32_16x16x32_bf16 a[84:87], a[16:19], a[180:183], a[84:87]
 ds_read_b64_tr_b16 a[2:3], v33 offset:49664
 v_mfma_f32_16x16x32_bf16 a[88:91], a[16:19], a[184:187], a[88:91]
 v_mfma_f32_16x16x32_bf16 a[92:95], a[16:19], a[188:191], a[92:95]
 s_waitcnt lgkmcnt(6)
 v_mfma_f32_16x16x32_bf16 a[96:99], a[20:23], a[176:179], a[96:99]
 ds_read_b64_tr_b16 a[4:5], v34 offset:49152
 v_mfma_f32_16x16x32_bf16 a[100:103], a[20:23], a[180:183], a[100:103]
 ds_read_b64_tr_b16 a[6:7], v34 offset:49664
 v_mfma_f32_16x16x32_bf16 a[104:107], a[20:23], a[184:187], a[104:107]
 v_mfma_f32_16x16x32_bf16 a[108:111], a[20:23], a[188:191], a[108:111]
 s_waitcnt lgkmcnt(6)
 v_mfma_f32_16x16x32_bf16 a[112:115], a[24:27], a[176:179], a[112:115]
 ds_read_b64_tr_b16 a[8:9], v35 offset:49152
 buffer_load_dwordx4 a[152:155], v42, s[4:7], s50 offen sc1
 v_mfma_f32_16x16x32_bf16 a[116:119], a[24:27], a[180:183], a[116:119]
 ds_read_b64_tr_b16 a[10:11], v35 offset:49664
 v_mfma_f32_16x16x32_bf16 a[120:123], a[24:27], a[184:187], a[120:123]
 s_waitcnt vmcnt(16)
 s_barrier
 s_add_u32 m0, s59, 32768
 v_mfma_f32_16x16x32_bf16 a[124:127], a[24:27], a[188:191], a[124:127]
 s_add_u32 s27, s67, 1572864
 s_waitcnt lgkmcnt(6)
 v_mfma_f32_16x16x32_bf16 v[132:135], a[28:31], a[176:179], v[132:135]
 ds_read_b64_tr_b16 a[12:13], v36 offset:49152
 buffer_load_dwordx4 v10, s[28:31], s27 offen lds
 v_mfma_f32_16x16x32_bf16 v[140:143], a[28:31], a[180:183], v[140:143]
 ds_read_b64_tr_b16 a[14:15], v36 offset:49664
 v_mfma_f32_16x16x32_bf16 v[148:151], a[28:31], a[184:187], v[148:151]
 v_mfma_f32_16x16x32_bf16 v[156:159], a[28:31], a[188:191], v[156:159]
 s_waitcnt lgkmcnt(6)
 v_mfma_f32_16x16x32_bf16 v[164:167], a[0:3], a[176:179], v[164:167]
 ds_read_b64_tr_b16 a[16:17], v2
 v_mfma_f32_16x16x32_bf16 v[172:175], a[0:3], a[180:183], v[172:175]
 ds_read_b64_tr_b16 a[18:19], v2 offset:1024
 v_mfma_f32_16x16x32_bf16 v[180:183], a[0:3], a[184:187], v[180:183]
 v_mfma_f32_16x16x32_bf16 v[188:191], a[0:3], a[188:191], v[188:191]
 buffer_load_dwordx4 a[156:159], v43, s[4:7], s50 offen sc1
 buffer_store_dwordx4 v[88:91], v16, s[4:7], s57 offen offset:2048 sc1
 s_waitcnt lgkmcnt(6)
 v_mfma_f32_16x16x32_bf16 v[196:199], a[4:7], a[176:179], v[196:199]
 ds_read_b64_tr_b16 a[20:21], v3
 v_mfma_f32_16x16x32_bf16 v[204:207], a[4:7], a[180:183], v[204:207]
 ds_read_b64_tr_b16 a[22:23], v3 offset:1024
 v_mfma_f32_16x16x32_bf16 v[212:215], a[4:7], a[184:187], v[212:215]
 v_mfma_f32_16x16x32_bf16 v[220:223], a[4:7], a[188:191], v[220:223]
 s_waitcnt lgkmcnt(6)
 v_mfma_f32_16x16x32_bf16 v[228:231], a[8:11], a[176:179], v[228:231]
 ds_read_b64_tr_b16 a[24:25], v4
 s_add_u32 m0, s59, 33792
 v_mfma_f32_16x16x32_bf16 v[236:239], a[8:11], a[180:183], v[236:239]
 ds_read_b64_tr_b16 a[26:27], v4 offset:1024
 s_add_u32 s27, s67, 1572864
 v_mfma_f32_16x16x32_bf16 v[244:247], a[8:11], a[184:187], v[244:247]
 buffer_load_dwordx4 v11, s[28:31], s27 offen lds
 v_mfma_f32_16x16x32_bf16 v[252:255], a[8:11], a[188:191], v[252:255]
 s_waitcnt lgkmcnt(6)
 v_mfma_f32_16x16x32_bf16 v[48:51], a[12:15], v[44:47], v[48:51]
 ds_read_b64_tr_b16 a[28:29], v5
 ds_read_b64_tr_b16 a[30:31], v5 offset:1024
 s_waitcnt lgkmcnt(6)
 v_mfma_f32_16x16x32_bf16 a[192:195], a[16:19], a[32:35], a[192:195]
 ds_read_b64_tr_b16 a[0:1], v6
 v_mfma_f32_16x16x32_bf16 a[196:199], a[16:19], a[36:39], a[196:199]
 ds_read_b64_tr_b16 a[2:3], v6 offset:1024
 v_mfma_f32_16x16x32_bf16 a[200:203], a[16:19], a[40:43], a[200:203]
 v_mfma_f32_16x16x32_bf16 a[204:207], a[16:19], a[44:47], a[204:207]
 s_waitcnt lgkmcnt(6)
 v_mfma_f32_16x16x32_bf16 a[208:211], a[20:23], a[32:35], a[208:211]
 ds_read_b64_tr_b16 a[4:5], v7
 v_mfma_f32_16x16x32_bf16 a[212:215], a[20:23], a[36:39], a[212:215]
 ds_read_b64_tr_b16 a[6:7], v7 offset:1024
 s_mov_b32 s50, 8192
 v_mfma_f32_16x16x32_bf16 a[216:219], a[20:23], a[40:43], a[216:219]
 buffer_load_dwordx4 a[160:163], v40, s[4:7], s50 offen sc1
 v_mfma_f32_16x16x32_bf16 a[220:223], a[20:23], a[44:47], a[220:223]
 s_waitcnt lgkmcnt(6)
 v_mfma_f32_16x16x32_bf16 a[224:227], a[24:27], a[32:35], a[224:227]
 ds_read_b64_tr_b16 a[8:9], v8
 v_mfma_f32_16x16x32_bf16 a[228:231], a[24:27], a[36:39], a[228:231]
 ds_read_b64_tr_b16 a[10:11], v8 offset:1024
 s_add_u32 m0, s65, 40960
 v_mfma_f32_16x16x32_bf16 a[232:235], a[24:27], a[40:43], a[232:235]
 s_add_u32 s27, s68, 663552
 v_mfma_f32_16x16x32_bf16 a[236:239], a[24:27], a[44:47], a[236:239]
 buffer_load_dwordx4 v37, s[32:35], s27 offen lds
 buffer_store_dwordx4 v[92:95], v16, s[4:7], s58 offen offset:2048 sc1
 s_waitcnt lgkmcnt(6)
 v_mfma_f32_16x16x32_bf16 a[240:243], a[28:31], a[32:35], a[240:243]
 ds_read_b64_tr_b16 a[12:13], v9
 v_mfma_f32_16x16x32_bf16 a[244:247], a[28:31], a[36:39], a[244:247]
 ds_read_b64_tr_b16 a[14:15], v9 offset:1024
 v_mfma_f32_16x16x32_bf16 a[248:251], a[28:31], a[40:43], a[248:251]
 v_mfma_f32_16x16x32_bf16 a[252:255], a[28:31], a[44:47], a[252:255]
 s_waitcnt lgkmcnt(6)
 v_mfma_f32_16x16x32_bf16 a[64:67], a[0:3], a[32:35], a[64:67]
 ds_read_b64_tr_b16 a[16:17], v32
 v_mfma_f32_16x16x32_bf16 a[68:71], a[0:3], a[36:39], a[68:71]
 ds_read_b64_tr_b16 a[18:19], v32 offset:512
 buffer_load_dwordx4 a[164:167], v41, s[4:7], s50 offen sc1
 v_mfma_f32_16x16x32_bf16 a[72:75], a[0:3], a[40:43], a[72:75]
 v_mfma_f32_16x16x32_bf16 a[76:79], a[0:3], a[44:47], a[76:79]
 s_waitcnt lgkmcnt(6)
 v_mfma_f32_16x16x32_bf16 a[80:83], a[4:7], a[32:35], a[80:83]
 ds_read_b64_tr_b16 a[20:21], v33
 v_mfma_f32_16x16x32_bf16 a[84:87], a[4:7], a[36:39], a[84:87]
 ds_read_b64_tr_b16 a[22:23], v33 offset:512
 v_mfma_f32_16x16x32_bf16 a[88:91], a[4:7], a[40:43], a[88:91]
 v_mfma_f32_16x16x32_bf16 a[92:95], a[4:7], a[44:47], a[92:95]
 s_waitcnt lgkmcnt(6)
 v_mfma_f32_16x16x32_bf16 a[96:99], a[8:11], a[32:35], a[96:99]
 ds_read_b64_tr_b16 a[24:25], v34
 v_mfma_f32_16x16x32_bf16 a[100:103], a[8:11], a[36:39], a[100:103]
 ds_read_b64_tr_b16 a[26:27], v34 offset:512
 v_mfma_f32_16x16x32_bf16 a[104:107], a[8:11], a[40:43], a[104:107]
 v_mfma_f32_16x16x32_bf16 a[108:111], a[8:11], a[44:47], a[108:111]
 s_waitcnt lgkmcnt(6)
 v_mfma_f32_16x16x32_bf16 a[112:115], a[12:15], a[32:35], a[112:115]
 ds_read_b64_tr_b16 a[28:29], v35
 buffer_load_dwordx4 a[168:171], v42, s[4:7], s50 offen sc1
 v_mfma_f32_16x16x32_bf16 a[116:119], a[12:15], a[36:39], a[116:119]
 ds_read_b64_tr_b16 a[30:31], v35 offset:512
 v_mfma_f32_16x16x32_bf16 a[120:123], a[12:15], a[40:43], a[120:123]
 s_waitcnt vmcnt(12)
 s_barrier
 s_add_u32 m0, s59, 49152
 v_mfma_f32_16x16x32_bf16 a[124:127], a[12:15], a[44:47], a[124:127]
 s_add_u32 s27, s67, 1835008
 s_waitcnt lgkmcnt(6)
 v_mfma_f32_16x16x32_bf16 v[132:135], a[16:19], a[32:35], v[132:135]
 ds_read_b64_tr_b16 a[0:1], v36
 buffer_load_dwordx4 v10, s[28:31], s27 offen lds
 buffer_store_dwordx4 v[112:115], v16, s[4:7], s55 offen offset:3072 sc1
 v_mfma_f32_16x16x32_bf16 v[140:143], a[16:19], a[36:39], v[140:143]
 ds_read_b64_tr_b16 a[2:3], v36 offset:512
 v_mfma_f32_16x16x32_bf16 v[148:151], a[16:19], a[40:43], v[148:151]
 v_mfma_f32_16x16x32_bf16 v[156:159], a[16:19], a[44:47], v[156:159]
 s_waitcnt lgkmcnt(6)
 v_mfma_f32_16x16x32_bf16 v[164:167], a[20:23], a[32:35], v[164:167]
 ds_read_b64_tr_b16 a[4:5], v2 offset:16384
 v_mfma_f32_16x16x32_bf16 v[172:175], a[20:23], a[36:39], v[172:175]
 ds_read_b64_tr_b16 a[6:7], v2 offset:17408
 v_mfma_f32_16x16x32_bf16 v[180:183], a[20:23], a[40:43], v[180:183]
 v_mfma_f32_16x16x32_bf16 v[188:191], a[20:23], a[44:47], v[188:191]
 buffer_load_dwordx4 a[172:175], v43, s[4:7], s50 offen sc1
 s_waitcnt lgkmcnt(6)
 v_mfma_f32_16x16x32_bf16 v[196:199], a[24:27], a[32:35], v[196:199]
 ds_read_b64_tr_b16 a[8:9], v3 offset:16384
 v_mfma_f32_16x16x32_bf16 v[204:207], a[24:27], a[36:39], v[204:207]
 ds_read_b64_tr_b16 a[10:11], v3 offset:17408
 v_mfma_f32_16x16x32_bf16 v[212:215], a[24:27], a[40:43], v[212:215]
 v_mfma_f32_16x16x32_bf16 v[220:223], a[24:27], a[44:47], v[220:223]
 s_waitcnt lgkmcnt(6)
 v_mfma_f32_16x16x32_bf16 v[228:231], a[28:31], a[32:35], v[228:231]
 ds_read_b64_tr_b16 a[12:13], v4 offset:16384
 s_add_u32 m0, s59, 50176
 v_mfma_f32_16x16x32_bf16 v[236:239], a[28:31], a[36:39], v[236:239]
 ds_read_b64_tr_b16 a[14:15], v4 offset:17408
 s_add_u32 s27, s67, 1835008
 v_mfma_f32_16x16x32_bf16 v[244:247], a[28:31], a[40:43], v[244:247]
 buffer_load_dwordx4 v11, s[28:31], s27 offen lds
 v_mfma_f32_16x16x32_bf16 v[252:255], a[28:31], a[44:47], v[252:255]
 s_waitcnt lgkmcnt(6)
 v_mfma_f32_16x16x32_bf16 v[48:51], a[0:3], v[44:47], v[48:51]
 ds_read_b64_tr_b16 a[16:17], v5 offset:16384
 ds_read_b64_tr_b16 a[18:19], v5 offset:17408
 s_waitcnt lgkmcnt(6)
 v_mfma_f32_16x16x32_bf16 a[192:195], a[4:7], a[48:51], a[192:195]
 ds_read_b64_tr_b16 a[20:21], v6 offset:16384
 v_mfma_f32_16x16x32_bf16 a[196:199], a[4:7], a[52:55], a[196:199]
 ds_read_b64_tr_b16 a[22:23], v6 offset:17408
 v_mfma_f32_16x16x32_bf16 a[200:203], a[4:7], a[56:59], a[200:203]
 v_mfma_f32_16x16x32_bf16 a[204:207], a[4:7], a[60:63], a[204:207]
 s_waitcnt lgkmcnt(6)
 v_mfma_f32_16x16x32_bf16 a[208:211], a[8:11], a[48:51], a[208:211]
 ds_read_b64_tr_b16 a[24:25], v7 offset:16384
 buffer_store_dwordx4 v[116:119], v16, s[4:7], s56 offen offset:3072 sc1
 v_mfma_f32_16x16x32_bf16 a[212:215], a[8:11], a[52:55], a[212:215]
 ds_read_b64_tr_b16 a[26:27], v7 offset:17408
 s_mov_b32 s50, 9216
 v_mfma_f32_16x16x32_bf16 a[216:219], a[8:11], a[56:59], a[216:219]
 buffer_load_dwordx4 a[176:179], v40, s[4:7], s50 offen sc1
 v_mfma_f32_16x16x32_bf16 a[220:223], a[8:11], a[60:63], a[220:223]
 s_waitcnt lgkmcnt(6)
 v_mfma_f32_16x16x32_bf16 a[224:227], a[12:15], a[48:51], a[224:227]
 ds_read_b64_tr_b16 a[28:29], v8 offset:16384
 v_mfma_f32_16x16x32_bf16 a[228:231], a[12:15], a[52:55], a[228:231]
 ds_read_b64_tr_b16 a[30:31], v8 offset:17408
 s_add_u32 m0, s65, 57344
 v_mfma_f32_16x16x32_bf16 a[232:235], a[12:15], a[56:59], a[232:235]
 s_add_u32 s27, s68, 774144
 v_mfma_f32_16x16x32_bf16 a[236:239], a[12:15], a[60:63], a[236:239]
 buffer_load_dwordx4 v37, s[32:35], s27 offen lds
 s_waitcnt lgkmcnt(6)
 v_mfma_f32_16x16x32_bf16 a[240:243], a[16:19], a[48:51], a[240:243]
 ds_read_b64_tr_b16 a[0:1], v9 offset:16384
 v_mfma_f32_16x16x32_bf16 a[244:247], a[16:19], a[52:55], a[244:247]
 ds_read_b64_tr_b16 a[2:3], v9 offset:17408
 v_mfma_f32_16x16x32_bf16 a[248:251], a[16:19], a[56:59], a[248:251]
 v_mfma_f32_16x16x32_bf16 a[252:255], a[16:19], a[60:63], a[252:255]
 s_waitcnt lgkmcnt(6)
 v_mfma_f32_16x16x32_bf16 a[64:67], a[20:23], a[48:51], a[64:67]
 ds_read_b64_tr_b16 a[4:5], v32 offset:16384
 v_mfma_f32_16x16x32_bf16 a[68:71], a[20:23], a[52:55], a[68:71]
 ds_read_b64_tr_b16 a[6:7], v32 offset:16896
 buffer_load_dwordx4 a[180:183], v41, s[4:7], s50 offen sc1
 v_mfma_f32_16x16x32_bf16 a[72:75], a[20:23], a[56:59], a[72:75]
 v_mfma_f32_16x16x32_bf16 a[76:79], a[20:23], a[60:63], a[76:79]
 s_waitcnt lgkmcnt(6)
 v_mfma_f32_16x16x32_bf16 a[80:83], a[24:27], a[48:51], a[80:83]
 ds_read_b64_tr_b16 a[8:9], v33 offset:16384
 v_mfma_f32_16x16x32_bf16 a[84:87], a[24:27], a[52:55], a[84:87]
 ds_read_b64_tr_b16 a[10:11], v33 offset:16896
 v_mfma_f32_16x16x32_bf16 a[88:91], a[24:27], a[56:59], a[88:91]
 v_mfma_f32_16x16x32_bf16 a[92:95], a[24:27], a[60:63], a[92:95]
 s_waitcnt lgkmcnt(6)
 v_mfma_f32_16x16x32_bf16 a[96:99], a[28:31], a[48:51], a[96:99]
 ds_read_b64_tr_b16 a[12:13], v34 offset:16384
 v_mfma_f32_16x16x32_bf16 a[100:103], a[28:31], a[52:55], a[100:103]
 ds_read_b64_tr_b16 a[14:15], v34 offset:16896
 buffer_store_dwordx4 v[120:123], v16, s[4:7], s57 offen offset:3072 sc1
 v_mfma_f32_16x16x32_bf16 a[104:107], a[28:31], a[56:59], a[104:107]
 v_mfma_f32_16x16x32_bf16 a[108:111], a[28:31], a[60:63], a[108:111]
 s_waitcnt lgkmcnt(6)
 v_mfma_f32_16x16x32_bf16 a[112:115], a[0:3], a[48:51], a[112:115]
 ds_read_b64_tr_b16 a[16:17], v35 offset:16384
 buffer_load_dwordx4 a[184:187], v42, s[4:7], s50 offen sc1
 v_mfma_f32_16x16x32_bf16 a[116:119], a[0:3], a[52:55], a[116:119]
 ds_read_b64_tr_b16 a[18:19], v35 offset:16896
 v_mfma_f32_16x16x32_bf16 a[120:123], a[0:3], a[56:59], a[120:123]
 s_waitcnt vmcnt(13)
 s_barrier
 s_add_u32 m0, s59, 0
 v_mfma_f32_16x16x32_bf16 a[124:127], a[0:3], a[60:63], a[124:127]
 s_add_u32 s27, s67, 2097152
 s_waitcnt lgkmcnt(6)
 v_mfma_f32_16x16x32_bf16 v[132:135], a[4:7], a[48:51], v[132:135]
 ds_read_b64_tr_b16 a[20:21], v36 offset:16384
 buffer_load_dwordx4 v10, s[28:31], s27 offen lds
 v_mfma_f32_16x16x32_bf16 v[140:143], a[4:7], a[52:55], v[140:143]
 ds_read_b64_tr_b16 a[22:23], v36 offset:16896
 v_mfma_f32_16x16x32_bf16 v[148:151], a[4:7], a[56:59], v[148:151]
 v_mfma_f32_16x16x32_bf16 v[156:159], a[4:7], a[60:63], v[156:159]
 s_waitcnt lgkmcnt(6)
 v_mfma_f32_16x16x32_bf16 v[164:167], a[8:11], a[48:51], v[164:167]
 ds_read_b64_tr_b16 a[24:25], v2 offset:32768
 v_mfma_f32_16x16x32_bf16 v[172:175], a[8:11], a[52:55], v[172:175]
 ds_read_b64_tr_b16 a[26:27], v2 offset:33792
 v_mfma_f32_16x16x32_bf16 v[180:183], a[8:11], a[56:59], v[180:183]
 v_mfma_f32_16x16x32_bf16 v[188:191], a[8:11], a[60:63], v[188:191]
 buffer_load_dwordx4 a[188:191], v43, s[4:7], s50 offen sc1
 s_waitcnt lgkmcnt(6)
 v_mfma_f32_16x16x32_bf16 v[196:199], a[12:15], a[48:51], v[196:199]
 ds_read_b64_tr_b16 a[28:29], v3 offset:32768
 v_mfma_f32_16x16x32_bf16 v[204:207], a[12:15], a[52:55], v[204:207]
 ds_read_b64_tr_b16 a[30:31], v3 offset:33792
 v_mfma_f32_16x16x32_bf16 v[212:215], a[12:15], a[56:59], v[212:215]
 v_mfma_f32_16x16x32_bf16 v[220:223], a[12:15], a[60:63], v[220:223]
 s_waitcnt lgkmcnt(6)
 v_mfma_f32_16x16x32_bf16 v[228:231], a[16:19], a[48:51], v[228:231]
 ds_read_b64_tr_b16 a[0:1], v4 offset:32768
 s_add_u32 m0, s59, 1024
 v_mfma_f32_16x16x32_bf16 v[236:239], a[16:19], a[52:55], v[236:239]
 ds_read_b64_tr_b16 a[2:3], v4 offset:33792
 s_add_u32 s27, s67, 2097152
 v_mfma_f32_16x16x32_bf16 v[244:247], a[16:19], a[56:59], v[244:247]
 buffer_load_dwordx4 v11, s[28:31], s27 offen lds
 buffer_store_dwordx4 v[124:127], v16, s[4:7], s58 offen offset:3072 sc1
 v_mfma_f32_16x16x32_bf16 v[252:255], a[16:19], a[60:63], v[252:255]
 s_waitcnt lgkmcnt(6)
 v_mfma_f32_16x16x32_bf16 v[48:51], a[20:23], v[44:47], v[48:51]
 ds_read_b64_tr_b16 a[4:5], v5 offset:32768
 ds_read_b64_tr_b16 a[6:7], v5 offset:33792
 s_waitcnt lgkmcnt(6)
 v_mfma_f32_16x16x32_bf16 a[192:195], a[24:27], a[128:131], a[192:195]
 ds_read_b64_tr_b16 a[8:9], v6 offset:32768
 v_mfma_f32_16x16x32_bf16 a[196:199], a[24:27], a[132:135], a[196:199]
 ds_read_b64_tr_b16 a[10:11], v6 offset:33792
 v_mfma_f32_16x16x32_bf16 a[200:203], a[24:27], a[136:139], a[200:203]
 v_mfma_f32_16x16x32_bf16 a[204:207], a[24:27], a[140:143], a[204:207]
 s_waitcnt lgkmcnt(6)
 v_mfma_f32_16x16x32_bf16 a[208:211], a[28:31], a[128:131], a[208:211]
 ds_read_b64_tr_b16 a[12:13], v7 offset:32768
 v_mfma_f32_16x16x32_bf16 a[212:215], a[28:31], a[132:135], a[212:215]
 ds_read_b64_tr_b16 a[14:15], v7 offset:33792
 s_mov_b32 s50, 10240
 v_mfma_f32_16x16x32_bf16 a[216:219], a[28:31], a[136:139], a[216:219]
 buffer_load_dwordx4 a[32:35], v40, s[4:7], s50 offen sc1
 v_mfma_f32_16x16x32_bf16 a[220:223], a[28:31], a[140:143], a[220:223]
 s_waitcnt lgkmcnt(6)
 v_mfma_f32_16x16x32_bf16 a[224:227], a[0:3], a[128:131], a[224:227]
 ds_read_b64_tr_b16 a[16:17], v8 offset:32768
 v_mfma_f32_16x16x32_bf16 a[228:231], a[0:3], a[132:135], a[228:231]
 ds_read_b64_tr_b16 a[18:19], v8 offset:33792
 s_add_u32 m0, s65, 8192
 v_mfma_f32_16x16x32_bf16 a[232:235], a[0:3], a[136:139], a[232:235]
 s_add_u32 s27, s68, 884736
 v_mfma_f32_16x16x32_bf16 a[236:239], a[0:3], a[140:143], a[236:239]
 buffer_load_dwordx4 v37, s[32:35], s27 offen lds
 s_waitcnt lgkmcnt(6)
 v_mfma_f32_16x16x32_bf16 a[240:243], a[4:7], a[128:131], a[240:243]
 ds_read_b64_tr_b16 a[20:21], v9 offset:32768
 v_mfma_f32_16x16x32_bf16 a[244:247], a[4:7], a[132:135], a[244:247]
 ds_read_b64_tr_b16 a[22:23], v9 offset:33792
 v_mfma_f32_16x16x32_bf16 a[248:251], a[4:7], a[136:139], a[248:251]
 v_mfma_f32_16x16x32_bf16 a[252:255], a[4:7], a[140:143], a[252:255]
 s_waitcnt lgkmcnt(6)
 v_mfma_f32_16x16x32_bf16 a[64:67], a[8:11], a[128:131], a[64:67]
 ds_read_b64_tr_b16 a[24:25], v32 offset:32768
 v_mfma_f32_16x16x32_bf16 a[68:71], a[8:11], a[132:135], a[68:71]
 ds_read_b64_tr_b16 a[26:27], v32 offset:33280
 buffer_load_dwordx4 a[36:39], v41, s[4:7], s50 offen sc1
 v_mfma_f32_16x16x32_bf16 a[72:75], a[8:11], a[136:139], a[72:75]
 buffer_store_dwordx4 v[128:131], v17, s[4:7], s55 offen sc1
 v_mfma_f32_16x16x32_bf16 a[76:79], a[8:11], a[140:143], a[76:79]
 s_waitcnt lgkmcnt(6)
 v_mfma_f32_16x16x32_bf16 a[80:83], a[12:15], a[128:131], a[80:83]
 ds_read_b64_tr_b16 a[28:29], v33 offset:32768
 v_mfma_f32_16x16x32_bf16 a[84:87], a[12:15], a[132:135], a[84:87]
 ds_read_b64_tr_b16 a[30:31], v33 offset:33280
 v_mfma_f32_16x16x32_bf16 a[88:91], a[12:15], a[136:139], a[88:91]
 v_mfma_f32_16x16x32_bf16 a[92:95], a[12:15], a[140:143], a[92:95]
 s_waitcnt lgkmcnt(6)
 v_mfma_f32_16x16x32_bf16 a[96:99], a[16:19], a[128:131], a[96:99]
 ds_read_b64_tr_b16 a[0:1], v34 offset:32768
 v_mfma_f32_16x16x32_bf16 a[100:103], a[16:19], a[132:135], a[100:103]
 ds_read_b64_tr_b16 a[2:3], v34 offset:33280
 v_mfma_f32_16x16x32_bf16 a[104:107], a[16:19], a[136:139], a[104:107]
 v_mfma_f32_16x16x32_bf16 a[108:111], a[16:19], a[140:143], a[108:111]
 s_waitcnt lgkmcnt(6)
 v_mfma_f32_16x16x32_bf16 a[112:115], a[20:23], a[128:131], a[112:115]
 ds_read_b64_tr_b16 a[4:5], v35 offset:32768
 buffer_load_dwordx4 a[40:43], v42, s[4:7], s50 offen sc1
 v_mfma_f32_16x16x32_bf16 a[116:119], a[20:23], a[132:135], a[116:119]
 ds_read_b64_tr_b16 a[6:7], v35 offset:33280
 v_mfma_f32_16x16x32_bf16 a[120:123], a[20:23], a[136:139], a[120:123]
 s_waitcnt vmcnt(12)
 s_barrier
 s_add_u32 m0, s59, 16384
 v_mfma_f32_16x16x32_bf16 a[124:127], a[20:23], a[140:143], a[124:127]
 s_add_u32 s27, s67, 2359296
 s_waitcnt lgkmcnt(6)
 v_mfma_f32_16x16x32_bf16 v[132:135], a[24:27], a[128:131], v[132:135]
 ds_read_b64_tr_b16 a[8:9], v36 offset:32768
 buffer_load_dwordx4 v10, s[28:31], s27 offen lds
 v_mfma_f32_16x16x32_bf16 v[140:143], a[24:27], a[132:135], v[140:143]
 ds_read_b64_tr_b16 a[10:11], v36 offset:33280
 v_mfma_f32_16x16x32_bf16 v[148:151], a[24:27], a[136:139], v[148:151]
 v_mfma_f32_16x16x32_bf16 v[156:159], a[24:27], a[140:143], v[156:159]
 s_waitcnt lgkmcnt(6)
 v_mfma_f32_16x16x32_bf16 v[164:167], a[28:31], a[128:131], v[164:167]
 ds_read_b64_tr_b16 a[12:13], v2 offset:49152
 v_mfma_f32_16x16x32_bf16 v[172:175], a[28:31], a[132:135], v[172:175]
 ds_read_b64_tr_b16 a[14:15], v2 offset:50176
 v_mfma_f32_16x16x32_bf16 v[180:183], a[28:31], a[136:139], v[180:183]
 v_mfma_f32_16x16x32_bf16 v[188:191], a[28:31], a[140:143], v[188:191]
 buffer_load_dwordx4 a[44:47], v43, s[4:7], s50 offen sc1
 buffer_store_dwordx4 v[136:139], v17, s[4:7], s57 offen sc1
 s_waitcnt lgkmcnt(6)
 v_mfma_f32_16x16x32_bf16 v[196:199], a[0:3], a[128:131], v[196:199]
 ds_read_b64_tr_b16 a[16:17], v3 offset:49152
 v_mfma_f32_16x16x32_bf16 v[204:207], a[0:3], a[132:135], v[204:207]
 ds_read_b64_tr_b16 a[18:19], v3 offset:50176
 v_mfma_f32_16x16x32_bf16 v[212:215], a[0:3], a[136:139], v[212:215]
 v_mfma_f32_16x16x32_bf16 v[220:223], a[0:3], a[140:143], v[220:223]
 s_waitcnt lgkmcnt(6)
 v_mfma_f32_16x16x32_bf16 v[228:231], a[4:7], a[128:131], v[228:231]
 ds_read_b64_tr_b16 a[20:21], v4 offset:49152
 s_add_u32 m0, s59, 17408
 v_mfma_f32_16x16x32_bf16 v[236:239], a[4:7], a[132:135], v[236:239]
 ds_read_b64_tr_b16 a[22:23], v4 offset:50176
 s_add_u32 s27, s67, 2359296
 v_mfma_f32_16x16x32_bf16 v[244:247], a[4:7], a[136:139], v[244:247]
 buffer_load_dwordx4 v11, s[28:31], s27 offen lds
 v_mfma_f32_16x16x32_bf16 v[252:255], a[4:7], a[140:143], v[252:255]
 s_waitcnt lgkmcnt(6)
 v_mfma_f32_16x16x32_bf16 v[48:51], a[8:11], v[44:47], v[48:51]
 ds_read_b64_tr_b16 a[24:25], v5 offset:49152
 ds_read_b64_tr_b16 a[26:27], v5 offset:50176
 s_waitcnt lgkmcnt(6)
 v_mfma_f32_16x16x32_bf16 a[192:195], a[12:15], a[144:147], a[192:195]
 ds_read_b64_tr_b16 a[28:29], v6 offset:49152
 v_mfma_f32_16x16x32_bf16 a[196:199], a[12:15], a[148:151], a[196:199]
 ds_read_b64_tr_b16 a[30:31], v6 offset:50176
 v_mfma_f32_16x16x32_bf16 a[200:203], a[12:15], a[152:155], a[200:203]
 v_mfma_f32_16x16x32_bf16 a[204:207], a[12:15], a[156:159], a[204:207]
 s_waitcnt lgkmcnt(6)
 v_mfma_f32_16x16x32_bf16 a[208:211], a[16:19], a[144:147], a[208:211]
 ds_read_b64_tr_b16 a[0:1], v7 offset:49152
 v_mfma_f32_16x16x32_bf16 a[212:215], a[16:19], a[148:151], a[212:215]
 ds_read_b64_tr_b16 a[2:3], v7 offset:50176
 s_mov_b32 s50, 11264
 v_mfma_f32_16x16x32_bf16 a[216:219], a[16:19], a[152:155], a[216:219]
 buffer_load_dwordx4 a[48:51], v40, s[4:7], s50 offen sc1
 v_mfma_f32_16x16x32_bf16 a[220:223], a[16:19], a[156:159], a[220:223]
 s_waitcnt lgkmcnt(6)
 v_mfma_f32_16x16x32_bf16 a[224:227], a[20:23], a[144:147], a[224:227]
 ds_read_b64_tr_b16 a[4:5], v8 offset:49152
 v_mfma_f32_16x16x32_bf16 a[228:231], a[20:23], a[148:151], a[228:231]
 ds_read_b64_tr_b16 a[6:7], v8 offset:50176
 s_add_u32 m0, s65, 24576
 v_mfma_f32_16x16x32_bf16 a[232:235], a[20:23], a[152:155], a[232:235]
 s_add_u32 s27, s68, 995328
 v_mfma_f32_16x16x32_bf16 a[236:239], a[20:23], a[156:159], a[236:239]
 buffer_load_dwordx4 v37, s[32:35], s27 offen lds
 buffer_store_dwordx4 v[144:147], v17, s[4:7], s55 offen offset:1024 sc1
 s_waitcnt lgkmcnt(6)
 v_mfma_f32_16x16x32_bf16 a[240:243], a[24:27], a[144:147], a[240:243]
 ds_read_b64_tr_b16 a[8:9], v9 offset:49152
 v_mfma_f32_16x16x32_bf16 a[244:247], a[24:27], a[148:151], a[244:247]
 ds_read_b64_tr_b16 a[10:11], v9 offset:50176
 v_mfma_f32_16x16x32_bf16 a[248:251], a[24:27], a[152:155], a[248:251]
 v_mfma_f32_16x16x32_bf16 a[252:255], a[24:27], a[156:159], a[252:255]
 s_waitcnt lgkmcnt(6)
 v_mfma_f32_16x16x32_bf16 a[64:67], a[28:31], a[144:147], a[64:67]
 ds_read_b64_tr_b16 a[12:13], v32 offset:49152
 v_mfma_f32_16x16x32_bf16 a[68:71], a[28:31], a[148:151], a[68:71]
 ds_read_b64_tr_b16 a[14:15], v32 offset:49664
 buffer_load_dwordx4 a[52:55], v41, s[4:7], s50 offen sc1
 v_mfma_f32_16x16x32_bf16 a[72:75], a[28:31], a[152:155], a[72:75]
 v_mfma_f32_16x16x32_bf16 a[76:79], a[28:31], a[156:159], a[76:79]
 s_waitcnt lgkmcnt(6)
 v_mfma_f32_16x16x32_bf16 a[80:83], a[0:3], a[144:147], a[80:83]
 ds_read_b64_tr_b16 a[16:17], v33 offset:49152
 v_mfma_f32_16x16x32_bf16 a[84:87], a[0:3], a[148:151], a[84:87]
 ds_read_b64_tr_b16 a[18:19], v33 offset:49664
 v_mfma_f32_16x16x32_bf16 a[88:91], a[0:3], a[152:155], a[88:91]
 v_mfma_f32_16x16x32_bf16 a[92:95], a[0:3], a[156:159], a[92:95]
 s_waitcnt lgkmcnt(6)
 v_mfma_f32_16x16x32_bf16 a[96:99], a[4:7], a[144:147], a[96:99]
 ds_read_b64_tr_b16 a[20:21], v34 offset:49152
 v_mfma_f32_16x16x32_bf16 a[100:103], a[4:7], a[148:151], a[100:103]
 ds_read_b64_tr_b16 a[22:23], v34 offset:49664
 v_mfma_f32_16x16x32_bf16 a[104:107], a[4:7], a[152:155], a[104:107]
 v_mfma_f32_16x16x32_bf16 a[108:111], a[4:7], a[156:159], a[108:111]
 s_waitcnt lgkmcnt(6)
 v_mfma_f32_16x16x32_bf16 a[112:115], a[8:11], a[144:147], a[112:115]
 ds_read_b64_tr_b16 a[24:25], v35 offset:49152
 buffer_load_dwordx4 a[56:59], v42, s[4:7], s50 offen sc1
 v_mfma_f32_16x16x32_bf16 a[116:119], a[8:11], a[148:151], a[116:119]
 ds_read_b64_tr_b16 a[26:27], v35 offset:49664
 v_mfma_f32_16x16x32_bf16 a[120:123], a[8:11], a[152:155], a[120:123]
 s_waitcnt vmcnt(12)
 s_barrier
 s_add_u32 m0, s59, 32768
 v_mfma_f32_16x16x32_bf16 a[124:127], a[8:11], a[156:159], a[124:127]
 s_add_u32 s27, s67, 2621440
 s_waitcnt lgkmcnt(6)
 v_mfma_f32_16x16x32_bf16 v[132:135], a[12:15], a[144:147], v[132:135]
 ds_read_b64_tr_b16 a[28:29], v36 offset:49152
 buffer_load_dwordx4 v10, s[28:31], s27 offen lds
 buffer_store_dwordx4 v[152:155], v17, s[4:7], s57 offen offset:1024 sc1
 v_mfma_f32_16x16x32_bf16 v[140:143], a[12:15], a[148:151], v[140:143]
 ds_read_b64_tr_b16 a[30:31], v36 offset:49664
 v_mfma_f32_16x16x32_bf16 v[148:151], a[12:15], a[152:155], v[148:151]
 v_mfma_f32_16x16x32_bf16 v[156:159], a[12:15], a[156:159], v[156:159]
 s_waitcnt lgkmcnt(6)
 v_mfma_f32_16x16x32_bf16 v[164:167], a[16:19], a[144:147], v[164:167]
 ds_read_b64_tr_b16 a[0:1], v2
 v_mfma_f32_16x16x32_bf16 v[172:175], a[16:19], a[148:151], v[172:175]
 ds_read_b64_tr_b16 a[2:3], v2 offset:1024
 v_mfma_f32_16x16x32_bf16 v[180:183], a[16:19], a[152:155], v[180:183]
 v_mfma_f32_16x16x32_bf16 v[188:191], a[16:19], a[156:159], v[188:191]
 buffer_load_dwordx4 a[60:63], v43, s[4:7], s50 offen sc1
 s_waitcnt lgkmcnt(6)
 v_mfma_f32_16x16x32_bf16 v[196:199], a[20:23], a[144:147], v[196:199]
 ds_read_b64_tr_b16 a[4:5], v3
 v_mfma_f32_16x16x32_bf16 v[204:207], a[20:23], a[148:151], v[204:207]
 ds_read_b64_tr_b16 a[6:7], v3 offset:1024
 v_mfma_f32_16x16x32_bf16 v[212:215], a[20:23], a[152:155], v[212:215]
 v_mfma_f32_16x16x32_bf16 v[220:223], a[20:23], a[156:159], v[220:223]
 s_waitcnt lgkmcnt(6)
 v_mfma_f32_16x16x32_bf16 v[228:231], a[24:27], a[144:147], v[228:231]
 ds_read_b64_tr_b16 a[8:9], v4
 s_add_u32 m0, s59, 33792
 v_mfma_f32_16x16x32_bf16 v[236:239], a[24:27], a[148:151], v[236:239]
 ds_read_b64_tr_b16 a[10:11], v4 offset:1024
 s_add_u32 s27, s67, 2621440
 v_mfma_f32_16x16x32_bf16 v[244:247], a[24:27], a[152:155], v[244:247]
 buffer_load_dwordx4 v11, s[28:31], s27 offen lds
 v_mfma_f32_16x16x32_bf16 v[252:255], a[24:27], a[156:159], v[252:255]
 s_waitcnt lgkmcnt(6)
 v_mfma_f32_16x16x32_bf16 v[48:51], a[28:31], v[44:47], v[48:51]
 ds_read_b64_tr_b16 a[12:13], v5
 ds_read_b64_tr_b16 a[14:15], v5 offset:1024
 s_waitcnt lgkmcnt(6)
 v_mfma_f32_16x16x32_bf16 a[192:195], a[0:3], a[160:163], a[192:195]
 ds_read_b64_tr_b16 a[16:17], v6
 v_mfma_f32_16x16x32_bf16 a[196:199], a[0:3], a[164:167], a[196:199]
 ds_read_b64_tr_b16 a[18:19], v6 offset:1024
 v_mfma_f32_16x16x32_bf16 a[200:203], a[0:3], a[168:171], a[200:203]
 v_mfma_f32_16x16x32_bf16 a[204:207], a[0:3], a[172:175], a[204:207]
 s_waitcnt lgkmcnt(6)
 v_mfma_f32_16x16x32_bf16 a[208:211], a[4:7], a[160:163], a[208:211]
 ds_read_b64_tr_b16 a[20:21], v7
 buffer_store_dwordx4 v[160:163], v17, s[4:7], s55 offen offset:2048 sc1
 v_mfma_f32_16x16x32_bf16 a[212:215], a[4:7], a[164:167], a[212:215]
 ds_read_b64_tr_b16 a[22:23], v7 offset:1024
 s_mov_b32 s50, 12288
 v_mfma_f32_16x16x32_bf16 a[216:219], a[4:7], a[168:171], a[216:219]
 buffer_load_dwordx4 a[128:131], v40, s[4:7], s50 offen sc1
 v_mfma_f32_16x16x32_bf16 a[220:223], a[4:7], a[172:175], a[220:223]
 s_waitcnt lgkmcnt(6)
 v_mfma_f32_16x16x32_bf16 a[224:227], a[8:11], a[160:163], a[224:227]
 ds_read_b64_tr_b16 a[24:25], v8
 v_mfma_f32_16x16x32_bf16 a[228:231], a[8:11], a[164:167], a[228:231]
 ds_read_b64_tr_b16 a[26:27], v8 offset:1024
 s_add_u32 m0, s65, 40960
 v_mfma_f32_16x16x32_bf16 a[232:235], a[8:11], a[168:171], a[232:235]
 s_add_u32 s27, s68, 1105920
 v_mfma_f32_16x16x32_bf16 a[236:239], a[8:11], a[172:175], a[236:239]
 buffer_load_dwordx4 v37, s[32:35], s27 offen lds
 s_waitcnt lgkmcnt(6)
 v_mfma_f32_16x16x32_bf16 a[240:243], a[12:15], a[160:163], a[240:243]
 ds_read_b64_tr_b16 a[28:29], v9
 v_mfma_f32_16x16x32_bf16 a[244:247], a[12:15], a[164:167], a[244:247]
 ds_read_b64_tr_b16 a[30:31], v9 offset:1024
 v_mfma_f32_16x16x32_bf16 a[248:251], a[12:15], a[168:171], a[248:251]
 v_mfma_f32_16x16x32_bf16 a[252:255], a[12:15], a[172:175], a[252:255]
 s_waitcnt lgkmcnt(6)
 v_mfma_f32_16x16x32_bf16 a[64:67], a[16:19], a[160:163], a[64:67]
 ds_read_b64_tr_b16 a[0:1], v32
 v_mfma_f32_16x16x32_bf16 a[68:71], a[16:19], a[164:167], a[68:71]
 ds_read_b64_tr_b16 a[2:3], v32 offset:512
 buffer_load_dwordx4 a[132:135], v41, s[4:7], s50 offen sc1
 v_mfma_f32_16x16x32_bf16 a[72:75], a[16:19], a[168:171], a[72:75]
 v_mfma_f32_16x16x32_bf16 a[76:79], a[16:19], a[172:175], a[76:79]
 s_waitcnt lgkmcnt(6)
 v_mfma_f32_16x16x32_bf16 a[80:83], a[20:23], a[160:163], a[80:83]
 ds_read_b64_tr_b16 a[4:5], v33
 v_mfma_f32_16x16x32_bf16 a[84:87], a[20:23], a[164:167], a[84:87]
 ds_read_b64_tr_b16 a[6:7], v33 offset:512
 v_mfma_f32_16x16x32_bf16 a[88:91], a[20:23], a[168:171], a[88:91]
 v_mfma_f32_16x16x32_bf16 a[92:95], a[20:23], a[172:175], a[92:95]
 s_waitcnt lgkmcnt(6)
 v_mfma_f32_16x16x32_bf16 a[96:99], a[24:27], a[160:163], a[96:99]
 ds_read_b64_tr_b16 a[8:9], v34
 v_mfma_f32_16x16x32_bf16 a[100:103], a[24:27], a[164:167], a[100:103]
 ds_read_b64_tr_b16 a[10:11], v34 offset:512
 buffer_store_dwordx4 v[168:171], v17, s[4:7], s57 offen offset:2048 sc1
 v_mfma_f32_16x16x32_bf16 a[104:107], a[24:27], a[168:171], a[104:107]
 v_mfma_f32_16x16x32_bf16 a[108:111], a[24:27], a[172:175], a[108:111]
 s_waitcnt lgkmcnt(6)
 v_mfma_f32_16x16x32_bf16 a[112:115], a[28:31], a[160:163], a[112:115]
 ds_read_b64_tr_b16 a[12:13], v35
 buffer_load_dwordx4 a[136:139], v42, s[4:7], s50 offen sc1
 v_mfma_f32_16x16x32_bf16 a[116:119], a[28:31], a[164:167], a[116:119]
 ds_read_b64_tr_b16 a[14:15], v35 offset:512
 v_mfma_f32_16x16x32_bf16 a[120:123], a[28:31], a[168:171], a[120:123]
 s_waitcnt vmcnt(13)
 s_barrier
 s_add_u32 m0, s59, 49152
 v_mfma_f32_16x16x32_bf16 a[124:127], a[28:31], a[172:175], a[124:127]
 s_add_u32 s27, s67, 2883584
 s_waitcnt lgkmcnt(6)
 v_mfma_f32_16x16x32_bf16 v[132:135], a[0:3], a[160:163], v[132:135]
 ds_read_b64_tr_b16 a[16:17], v36
 buffer_load_dwordx4 v10, s[28:31], s27 offen lds
 v_mfma_f32_16x16x32_bf16 v[140:143], a[0:3], a[164:167], v[140:143]
 ds_read_b64_tr_b16 a[18:19], v36 offset:512
 v_mfma_f32_16x16x32_bf16 v[148:151], a[0:3], a[168:171], v[148:151]
 v_mfma_f32_16x16x32_bf16 v[156:159], a[0:3], a[172:175], v[156:159]
 s_waitcnt lgkmcnt(6)
 v_mfma_f32_16x16x32_bf16 v[164:167], a[4:7], a[160:163], v[164:167]
 ds_read_b64_tr_b16 a[20:21], v2 offset:16384
 v_mfma_f32_16x16x32_bf16 v[172:175], a[4:7], a[164:167], v[172:175]
 ds_read_b64_tr_b16 a[22:23], v2 offset:17408
 v_mfma_f32_16x16x32_bf16 v[180:183], a[4:7], a[168:171], v[180:183]
 v_mfma_f32_16x16x32_bf16 v[188:191], a[4:7], a[172:175], v[188:191]
 buffer_load_dwordx4 a[140:143], v43, s[4:7], s50 offen sc1
 s_waitcnt lgkmcnt(6)
 v_mfma_f32_16x16x32_bf16 v[196:199], a[8:11], a[160:163], v[196:199]
 ds_read_b64_tr_b16 a[24:25], v3 offset:16384
 v_mfma_f32_16x16x32_bf16 v[204:207], a[8:11], a[164:167], v[204:207]
 ds_read_b64_tr_b16 a[26:27], v3 offset:17408
 v_mfma_f32_16x16x32_bf16 v[212:215], a[8:11], a[168:171], v[212:215]
 v_mfma_f32_16x16x32_bf16 v[220:223], a[8:11], a[172:175], v[220:223]
 s_waitcnt lgkmcnt(6)
 v_mfma_f32_16x16x32_bf16 v[228:231], a[12:15], a[160:163], v[228:231]
 ds_read_b64_tr_b16 a[28:29], v4 offset:16384
 s_add_u32 m0, s59, 50176
 v_mfma_f32_16x16x32_bf16 v[236:239], a[12:15], a[164:167], v[236:239]
 ds_read_b64_tr_b16 a[30:31], v4 offset:17408
 s_add_u32 s27, s67, 2883584
 v_mfma_f32_16x16x32_bf16 v[244:247], a[12:15], a[168:171], v[244:247]
 buffer_load_dwordx4 v11, s[28:31], s27 offen lds
 buffer_store_dwordx4 v[176:179], v17, s[4:7], s55 offen offset:3072 sc1
 v_mfma_f32_16x16x32_bf16 v[252:255], a[12:15], a[172:175], v[252:255]
 s_waitcnt lgkmcnt(6)
 v_mfma_f32_16x16x32_bf16 v[48:51], a[16:19], v[44:47], v[48:51]
 ds_read_b64_tr_b16 a[0:1], v5 offset:16384
 ds_read_b64_tr_b16 a[2:3], v5 offset:17408
 s_waitcnt lgkmcnt(6)
 v_mfma_f32_16x16x32_bf16 a[192:195], a[20:23], a[176:179], a[192:195]
 ds_read_b64_tr_b16 a[4:5], v6 offset:16384
 v_mfma_f32_16x16x32_bf16 a[196:199], a[20:23], a[180:183], a[196:199]
 ds_read_b64_tr_b16 a[6:7], v6 offset:17408
 v_mfma_f32_16x16x32_bf16 a[200:203], a[20:23], a[184:187], a[200:203]
 v_mfma_f32_16x16x32_bf16 a[204:207], a[20:23], a[188:191], a[204:207]
 s_waitcnt lgkmcnt(6)
 v_mfma_f32_16x16x32_bf16 a[208:211], a[24:27], a[176:179], a[208:211]
 ds_read_b64_tr_b16 a[8:9], v7 offset:16384
 v_mfma_f32_16x16x32_bf16 a[212:215], a[24:27], a[180:183], a[212:215]
 ds_read_b64_tr_b16 a[10:11], v7 offset:17408
 s_mov_b32 s50, 13312
 v_mfma_f32_16x16x32_bf16 a[216:219], a[24:27], a[184:187], a[216:219]
 buffer_load_dwordx4 a[144:147], v40, s[4:7], s50 offen sc1
 v_mfma_f32_16x16x32_bf16 a[220:223], a[24:27], a[188:191], a[220:223]
 s_waitcnt lgkmcnt(6)
 v_mfma_f32_16x16x32_bf16 a[224:227], a[28:31], a[176:179], a[224:227]
 ds_read_b64_tr_b16 a[12:13], v8 offset:16384
 v_mfma_f32_16x16x32_bf16 a[228:231], a[28:31], a[180:183], a[228:231]
 ds_read_b64_tr_b16 a[14:15], v8 offset:17408
 s_add_u32 m0, s65, 57344
 v_mfma_f32_16x16x32_bf16 a[232:235], a[28:31], a[184:187], a[232:235]
 s_add_u32 s27, s68, 1216512
 v_mfma_f32_16x16x32_bf16 a[236:239], a[28:31], a[188:191], a[236:239]
 buffer_load_dwordx4 v37, s[32:35], s27 offen lds
 s_waitcnt lgkmcnt(6)
 v_mfma_f32_16x16x32_bf16 a[240:243], a[0:3], a[176:179], a[240:243]
 ds_read_b64_tr_b16 a[16:17], v9 offset:16384
 v_mfma_f32_16x16x32_bf16 a[244:247], a[0:3], a[180:183], a[244:247]
 ds_read_b64_tr_b16 a[18:19], v9 offset:17408
 v_mfma_f32_16x16x32_bf16 a[248:251], a[0:3], a[184:187], a[248:251]
 v_mfma_f32_16x16x32_bf16 a[252:255], a[0:3], a[188:191], a[252:255]
 s_waitcnt lgkmcnt(6)
 v_mfma_f32_16x16x32_bf16 a[64:67], a[4:7], a[176:179], a[64:67]
 ds_read_b64_tr_b16 a[20:21], v32 offset:16384
 v_mfma_f32_16x16x32_bf16 a[68:71], a[4:7], a[180:183], a[68:71]
 ds_read_b64_tr_b16 a[22:23], v32 offset:16896
 buffer_load_dwordx4 a[148:151], v41, s[4:7], s50 offen sc1
 v_mfma_f32_16x16x32_bf16 a[72:75], a[4:7], a[184:187], a[72:75]
 buffer_store_dwordx4 v[184:187], v17, s[4:7], s57 offen offset:3072 sc1
 v_mfma_f32_16x16x32_bf16 a[76:79], a[4:7], a[188:191], a[76:79]
 s_waitcnt lgkmcnt(6)
 v_mfma_f32_16x16x32_bf16 a[80:83], a[8:11], a[176:179], a[80:83]
 ds_read_b64_tr_b16 a[24:25], v33 offset:16384
 v_mfma_f32_16x16x32_bf16 a[84:87], a[8:11], a[180:183], a[84:87]
 ds_read_b64_tr_b16 a[26:27], v33 offset:16896
 v_mfma_f32_16x16x32_bf16 a[88:91], a[8:11], a[184:187], a[88:91]
 v_mfma_f32_16x16x32_bf16 a[92:95], a[8:11], a[188:191], a[92:95]
 s_waitcnt lgkmcnt(6)
 v_mfma_f32_16x16x32_bf16 a[96:99], a[12:15], a[176:179], a[96:99]
 ds_read_b64_tr_b16 a[28:29], v34 offset:16384
 v_mfma_f32_16x16x32_bf16 a[100:103], a[12:15], a[180:183], a[100:103]
 ds_read_b64_tr_b16 a[30:31], v34 offset:16896
 v_mfma_f32_16x16x32_bf16 a[104:107], a[12:15], a[184:187], a[104:107]
 v_mfma_f32_16x16x32_bf16 a[108:111], a[12:15], a[188:191], a[108:111]
 s_waitcnt lgkmcnt(6)
 v_mfma_f32_16x16x32_bf16 a[112:115], a[16:19], a[176:179], a[112:115]
 ds_read_b64_tr_b16 a[0:1], v35 offset:16384
 buffer_load_dwordx4 a[152:155], v42, s[4:7], s50 offen sc1
 v_mfma_f32_16x16x32_bf16 a[116:119], a[16:19], a[180:183], a[116:119]
 ds_read_b64_tr_b16 a[2:3], v35 offset:16896
 v_mfma_f32_16x16x32_bf16 a[120:123], a[16:19], a[184:187], a[120:123]
 s_waitcnt vmcnt(12)
 s_barrier
 s_add_u32 m0, s59, 0
 v_mfma_f32_16x16x32_bf16 a[124:127], a[16:19], a[188:191], a[124:127]
 s_add_u32 s27, s67, 3145728
 s_waitcnt lgkmcnt(6)
 v_mfma_f32_16x16x32_bf16 v[132:135], a[20:23], a[176:179], v[132:135]
 ds_read_b64_tr_b16 a[4:5], v36 offset:16384
 buffer_load_dwordx4 v10, s[28:31], s27 offen lds
 v_mfma_f32_16x16x32_bf16 v[140:143], a[20:23], a[180:183], v[140:143]
 ds_read_b64_tr_b16 a[6:7], v36 offset:16896
 v_mfma_f32_16x16x32_bf16 v[148:151], a[20:23], a[184:187], v[148:151]
 v_mfma_f32_16x16x32_bf16 v[156:159], a[20:23], a[188:191], v[156:159]
 s_waitcnt lgkmcnt(6)
 v_mfma_f32_16x16x32_bf16 v[164:167], a[24:27], a[176:179], v[164:167]
 ds_read_b64_tr_b16 a[8:9], v2 offset:32768
 v_mfma_f32_16x16x32_bf16 v[172:175], a[24:27], a[180:183], v[172:175]
 ds_read_b64_tr_b16 a[10:11], v2 offset:33792
 v_mfma_f32_16x16x32_bf16 v[180:183], a[24:27], a[184:187], v[180:183]
 v_mfma_f32_16x16x32_bf16 v[188:191], a[24:27], a[188:191], v[188:191]
 buffer_load_dwordx4 a[156:159], v43, s[4:7], s50 offen sc1
 buffer_store_dwordx4 v[192:195], v17, s[4:7], s56 offen sc1
 s_waitcnt lgkmcnt(6)
 v_mfma_f32_16x16x32_bf16 v[196:199], a[28:31], a[176:179], v[196:199]
 ds_read_b64_tr_b16 a[12:13], v3 offset:32768
 v_mfma_f32_16x16x32_bf16 v[204:207], a[28:31], a[180:183], v[204:207]
 ds_read_b64_tr_b16 a[14:15], v3 offset:33792
 v_mfma_f32_16x16x32_bf16 v[212:215], a[28:31], a[184:187], v[212:215]
 v_mfma_f32_16x16x32_bf16 v[220:223], a[28:31], a[188:191], v[220:223]
 s_waitcnt lgkmcnt(6)
 v_mfma_f32_16x16x32_bf16 v[228:231], a[0:3], a[176:179], v[228:231]
 ds_read_b64_tr_b16 a[16:17], v4 offset:32768
 s_add_u32 m0, s59, 1024
 v_mfma_f32_16x16x32_bf16 v[236:239], a[0:3], a[180:183], v[236:239]
 ds_read_b64_tr_b16 a[18:19], v4 offset:33792
 s_add_u32 s27, s67, 3145728
 v_mfma_f32_16x16x32_bf16 v[244:247], a[0:3], a[184:187], v[244:247]
 buffer_load_dwordx4 v11, s[28:31], s27 offen lds
 v_mfma_f32_16x16x32_bf16 v[252:255], a[0:3], a[188:191], v[252:255]
 s_waitcnt lgkmcnt(6)
 v_mfma_f32_16x16x32_bf16 v[48:51], a[4:7], v[44:47], v[48:51]
 ds_read_b64_tr_b16 a[20:21], v5 offset:32768
 ds_read_b64_tr_b16 a[22:23], v5 offset:33792
 s_waitcnt lgkmcnt(6)
 v_mfma_f32_16x16x32_bf16 a[192:195], a[8:11], a[32:35], a[192:195]
 ds_read_b64_tr_b16 a[24:25], v6 offset:32768
 v_mfma_f32_16x16x32_bf16 a[196:199], a[8:11], a[36:39], a[196:199]
 ds_read_b64_tr_b16 a[26:27], v6 offset:33792
 v_mfma_f32_16x16x32_bf16 a[200:203], a[8:11], a[40:43], a[200:203]
 v_mfma_f32_16x16x32_bf16 a[204:207], a[8:11], a[44:47], a[204:207]
 s_waitcnt lgkmcnt(6)
 v_mfma_f32_16x16x32_bf16 a[208:211], a[12:15], a[32:35], a[208:211]
 ds_read_b64_tr_b16 a[28:29], v7 offset:32768
 v_mfma_f32_16x16x32_bf16 a[212:215], a[12:15], a[36:39], a[212:215]
 ds_read_b64_tr_b16 a[30:31], v7 offset:33792
 s_mov_b32 s50, 14336
 v_mfma_f32_16x16x32_bf16 a[216:219], a[12:15], a[40:43], a[216:219]
 buffer_load_dwordx4 a[160:163], v40, s[4:7], s50 offen sc1
 v_mfma_f32_16x16x32_bf16 a[220:223], a[12:15], a[44:47], a[220:223]
 s_waitcnt lgkmcnt(6)
 v_mfma_f32_16x16x32_bf16 a[224:227], a[16:19], a[32:35], a[224:227]
 ds_read_b64_tr_b16 a[0:1], v8 offset:32768
 v_mfma_f32_16x16x32_bf16 a[228:231], a[16:19], a[36:39], a[228:231]
 ds_read_b64_tr_b16 a[2:3], v8 offset:33792
 s_add_u32 m0, s65, 8192
 v_mfma_f32_16x16x32_bf16 a[232:235], a[16:19], a[40:43], a[232:235]
 s_add_u32 s27, s68, 1327104
 v_mfma_f32_16x16x32_bf16 a[236:239], a[16:19], a[44:47], a[236:239]
 buffer_load_dwordx4 v37, s[32:35], s27 offen lds
 buffer_store_dwordx4 v[200:203], v17, s[4:7], s58 offen sc1
 s_waitcnt lgkmcnt(6)
 v_mfma_f32_16x16x32_bf16 a[240:243], a[20:23], a[32:35], a[240:243]
 ds_read_b64_tr_b16 a[4:5], v9 offset:32768
 v_mfma_f32_16x16x32_bf16 a[244:247], a[20:23], a[36:39], a[244:247]
 ds_read_b64_tr_b16 a[6:7], v9 offset:33792
 v_mfma_f32_16x16x32_bf16 a[248:251], a[20:23], a[40:43], a[248:251]
 v_mfma_f32_16x16x32_bf16 a[252:255], a[20:23], a[44:47], a[252:255]
 s_waitcnt lgkmcnt(6)
 v_mfma_f32_16x16x32_bf16 a[64:67], a[24:27], a[32:35], a[64:67]
 ds_read_b64_tr_b16 a[8:9], v32 offset:32768
 v_mfma_f32_16x16x32_bf16 a[68:71], a[24:27], a[36:39], a[68:71]
 ds_read_b64_tr_b16 a[10:11], v32 offset:33280
 buffer_load_dwordx4 a[164:167], v41, s[4:7], s50 offen sc1
 v_mfma_f32_16x16x32_bf16 a[72:75], a[24:27], a[40:43], a[72:75]
 v_mfma_f32_16x16x32_bf16 a[76:79], a[24:27], a[44:47], a[76:79]
 s_waitcnt lgkmcnt(6)
 v_mfma_f32_16x16x32_bf16 a[80:83], a[28:31], a[32:35], a[80:83]
 ds_read_b64_tr_b16 a[12:13], v33 offset:32768
 v_mfma_f32_16x16x32_bf16 a[84:87], a[28:31], a[36:39], a[84:87]
 ds_read_b64_tr_b16 a[14:15], v33 offset:33280
 v_mfma_f32_16x16x32_bf16 a[88:91], a[28:31], a[40:43], a[88:91]
 v_mfma_f32_16x16x32_bf16 a[92:95], a[28:31], a[44:47], a[92:95]
 s_waitcnt lgkmcnt(6)
 v_mfma_f32_16x16x32_bf16 a[96:99], a[0:3], a[32:35], a[96:99]
 ds_read_b64_tr_b16 a[16:17], v34 offset:32768
 v_mfma_f32_16x16x32_bf16 a[100:103], a[0:3], a[36:39], a[100:103]
 ds_read_b64_tr_b16 a[18:19], v34 offset:33280
 v_mfma_f32_16x16x32_bf16 a[104:107], a[0:3], a[40:43], a[104:107]
 v_mfma_f32_16x16x32_bf16 a[108:111], a[0:3], a[44:47], a[108:111]
 s_waitcnt lgkmcnt(6)
 v_mfma_f32_16x16x32_bf16 a[112:115], a[4:7], a[32:35], a[112:115]
 ds_read_b64_tr_b16 a[20:21], v35 offset:32768
 buffer_load_dwordx4 a[168:171], v42, s[4:7], s50 offen sc1
 v_mfma_f32_16x16x32_bf16 a[116:119], a[4:7], a[36:39], a[116:119]
 ds_read_b64_tr_b16 a[22:23], v35 offset:33280
 v_mfma_f32_16x16x32_bf16 a[120:123], a[4:7], a[40:43], a[120:123]
 s_waitcnt vmcnt(12)
 s_barrier
 s_add_u32 m0, s59, 16384
 v_mfma_f32_16x16x32_bf16 a[124:127], a[4:7], a[44:47], a[124:127]
 s_add_u32 s27, s67, 3407872
 s_waitcnt lgkmcnt(6)
 v_mfma_f32_16x16x32_bf16 v[132:135], a[8:11], a[32:35], v[132:135]
 ds_read_b64_tr_b16 a[24:25], v36 offset:32768
 buffer_load_dwordx4 v10, s[28:31], s27 offen lds
 buffer_store_dwordx4 v[208:211], v17, s[4:7], s56 offen offset:1024 sc1
 v_mfma_f32_16x16x32_bf16 v[140:143], a[8:11], a[36:39], v[140:143]
 ds_read_b64_tr_b16 a[26:27], v36 offset:33280
 v_mfma_f32_16x16x32_bf16 v[148:151], a[8:11], a[40:43], v[148:151]
 v_mfma_f32_16x16x32_bf16 v[156:159], a[8:11], a[44:47], v[156:159]
 s_waitcnt lgkmcnt(6)
 v_mfma_f32_16x16x32_bf16 v[164:167], a[12:15], a[32:35], v[164:167]
 ds_read_b64_tr_b16 a[28:29], v2 offset:49152
 v_mfma_f32_16x16x32_bf16 v[172:175], a[12:15], a[36:39], v[172:175]
 ds_read_b64_tr_b16 a[30:31], v2 offset:50176
 v_mfma_f32_16x16x32_bf16 v[180:183], a[12:15], a[40:43], v[180:183]
 v_mfma_f32_16x16x32_bf16 v[188:191], a[12:15], a[44:47], v[188:191]
 buffer_load_dwordx4 a[172:175], v43, s[4:7], s50 offen sc1
 s_waitcnt lgkmcnt(6)
 v_mfma_f32_16x16x32_bf16 v[196:199], a[16:19], a[32:35], v[196:199]
 ds_read_b64_tr_b16 a[0:1], v3 offset:49152
 v_mfma_f32_16x16x32_bf16 v[204:207], a[16:19], a[36:39], v[204:207]
 ds_read_b64_tr_b16 a[2:3], v3 offset:50176
 v_mfma_f32_16x16x32_bf16 v[212:215], a[16:19], a[40:43], v[212:215]
 v_mfma_f32_16x16x32_bf16 v[220:223], a[16:19], a[44:47], v[220:223]
 s_waitcnt lgkmcnt(6)
 v_mfma_f32_16x16x32_bf16 v[228:231], a[20:23], a[32:35], v[228:231]
 ds_read_b64_tr_b16 a[4:5], v4 offset:49152
 s_add_u32 m0, s59, 17408
 v_mfma_f32_16x16x32_bf16 v[236:239], a[20:23], a[36:39], v[236:239]
 ds_read_b64_tr_b16 a[6:7], v4 offset:50176
 s_add_u32 s27, s67, 3407872
 v_mfma_f32_16x16x32_bf16 v[244:247], a[20:23], a[40:43], v[244:247]
 buffer_load_dwordx4 v11, s[28:31], s27 offen lds
 v_mfma_f32_16x16x32_bf16 v[252:255], a[20:23], a[44:47], v[252:255]
 s_waitcnt lgkmcnt(6)
 v_mfma_f32_16x16x32_bf16 v[48:51], a[24:27], v[44:47], v[48:51]
 ds_read_b64_tr_b16 a[8:9], v5 offset:49152
 ds_read_b64_tr_b16 a[10:11], v5 offset:50176
 s_waitcnt lgkmcnt(6)
 v_mfma_f32_16x16x32_bf16 a[192:195], a[28:31], a[48:51], a[192:195]
 ds_read_b64_tr_b16 a[12:13], v6 offset:49152
 v_mfma_f32_16x16x32_bf16 a[196:199], a[28:31], a[52:55], a[196:199]
 ds_read_b64_tr_b16 a[14:15], v6 offset:50176
 v_mfma_f32_16x16x32_bf16 a[200:203], a[28:31], a[56:59], a[200:203]
 v_mfma_f32_16x16x32_bf16 a[204:207], a[28:31], a[60:63], a[204:207]
 s_waitcnt lgkmcnt(6)
 v_mfma_f32_16x16x32_bf16 a[208:211], a[0:3], a[48:51], a[208:211]
 ds_read_b64_tr_b16 a[16:17], v7 offset:49152
 buffer_store_dwordx4 v[216:219], v17, s[4:7], s58 offen offset:1024 sc1
 v_mfma_f32_16x16x32_bf16 a[212:215], a[0:3], a[52:55], a[212:215]
 ds_read_b64_tr_b16 a[18:19], v7 offset:50176
 s_mov_b32 s50, 15360
 v_mfma_f32_16x16x32_bf16 a[216:219], a[0:3], a[56:59], a[216:219]
 buffer_load_dwordx4 a[176:179], v40, s[4:7], s50 offen sc1
 v_mfma_f32_16x16x32_bf16 a[220:223], a[0:3], a[60:63], a[220:223]
 s_waitcnt lgkmcnt(6)
 v_mfma_f32_16x16x32_bf16 a[224:227], a[4:7], a[48:51], a[224:227]
 ds_read_b64_tr_b16 a[20:21], v8 offset:49152
 v_mfma_f32_16x16x32_bf16 a[228:231], a[4:7], a[52:55], a[228:231]
 ds_read_b64_tr_b16 a[22:23], v8 offset:50176
 s_add_u32 m0, s65, 24576
 v_mfma_f32_16x16x32_bf16 a[232:235], a[4:7], a[56:59], a[232:235]
 s_add_u32 s27, s68, 1437696
 v_mfma_f32_16x16x32_bf16 a[236:239], a[4:7], a[60:63], a[236:239]
 buffer_load_dwordx4 v37, s[32:35], s27 offen lds
 s_waitcnt lgkmcnt(6)
 v_mfma_f32_16x16x32_bf16 a[240:243], a[8:11], a[48:51], a[240:243]
 ds_read_b64_tr_b16 a[24:25], v9 offset:49152
 v_mfma_f32_16x16x32_bf16 a[244:247], a[8:11], a[52:55], a[244:247]
 ds_read_b64_tr_b16 a[26:27], v9 offset:50176
 v_mfma_f32_16x16x32_bf16 a[248:251], a[8:11], a[56:59], a[248:251]
 v_mfma_f32_16x16x32_bf16 a[252:255], a[8:11], a[60:63], a[252:255]
 s_waitcnt lgkmcnt(6)
 v_mfma_f32_16x16x32_bf16 a[64:67], a[12:15], a[48:51], a[64:67]
 ds_read_b64_tr_b16 a[28:29], v32 offset:49152
 v_mfma_f32_16x16x32_bf16 a[68:71], a[12:15], a[52:55], a[68:71]
 ds_read_b64_tr_b16 a[30:31], v32 offset:49664
 buffer_load_dwordx4 a[180:183], v41, s[4:7], s50 offen sc1
 v_mfma_f32_16x16x32_bf16 a[72:75], a[12:15], a[56:59], a[72:75]
 v_mfma_f32_16x16x32_bf16 a[76:79], a[12:15], a[60:63], a[76:79]
 s_waitcnt lgkmcnt(6)
 v_mfma_f32_16x16x32_bf16 a[80:83], a[16:19], a[48:51], a[80:83]
 ds_read_b64_tr_b16 a[0:1], v33 offset:49152
 v_mfma_f32_16x16x32_bf16 a[84:87], a[16:19], a[52:55], a[84:87]
 ds_read_b64_tr_b16 a[2:3], v33 offset:49664
 v_mfma_f32_16x16x32_bf16 a[88:91], a[16:19], a[56:59], a[88:91]
 v_mfma_f32_16x16x32_bf16 a[92:95], a[16:19], a[60:63], a[92:95]
 s_waitcnt lgkmcnt(6)
 v_mfma_f32_16x16x32_bf16 a[96:99], a[20:23], a[48:51], a[96:99]
 ds_read_b64_tr_b16 a[4:5], v34 offset:49152
 v_mfma_f32_16x16x32_bf16 a[100:103], a[20:23], a[52:55], a[100:103]
 ds_read_b64_tr_b16 a[6:7], v34 offset:49664
 buffer_store_dwordx4 v[224:227], v17, s[4:7], s56 offen offset:2048 sc1
 v_mfma_f32_16x16x32_bf16 a[104:107], a[20:23], a[56:59], a[104:107]
 v_mfma_f32_16x16x32_bf16 a[108:111], a[20:23], a[60:63], a[108:111]
 s_waitcnt lgkmcnt(6)
 v_mfma_f32_16x16x32_bf16 a[112:115], a[24:27], a[48:51], a[112:115]
 ds_read_b64_tr_b16 a[8:9], v35 offset:49152
 buffer_load_dwordx4 a[184:187], v42, s[4:7], s50 offen sc1
 v_mfma_f32_16x16x32_bf16 a[116:119], a[24:27], a[52:55], a[116:119]
 ds_read_b64_tr_b16 a[10:11], v35 offset:49664
 v_mfma_f32_16x16x32_bf16 a[120:123], a[24:27], a[56:59], a[120:123]
 s_waitcnt vmcnt(13)
 s_barrier
 s_add_u32 m0, s59, 32768
 v_mfma_f32_16x16x32_bf16 a[124:127], a[24:27], a[60:63], a[124:127]
 s_add_u32 s27, s67, 3670016
 s_waitcnt lgkmcnt(6)
 v_mfma_f32_16x16x32_bf16 v[132:135], a[28:31], a[48:51], v[132:135]
 ds_read_b64_tr_b16 a[12:13], v36 offset:49152
 buffer_load_dwordx4 v10, s[28:31], s27 offen lds
 v_mfma_f32_16x16x32_bf16 v[140:143], a[28:31], a[52:55], v[140:143]
 ds_read_b64_tr_b16 a[14:15], v36 offset:49664
 v_mfma_f32_16x16x32_bf16 v[148:151], a[28:31], a[56:59], v[148:151]
 v_mfma_f32_16x16x32_bf16 v[156:159], a[28:31], a[60:63], v[156:159]
 s_waitcnt lgkmcnt(6)
 v_mfma_f32_16x16x32_bf16 v[164:167], a[0:3], a[48:51], v[164:167]
 ds_read_b64_tr_b16 a[16:17], v2
 v_mfma_f32_16x16x32_bf16 v[172:175], a[0:3], a[52:55], v[172:175]
 ds_read_b64_tr_b16 a[18:19], v2 offset:1024
 v_mfma_f32_16x16x32_bf16 v[180:183], a[0:3], a[56:59], v[180:183]
 v_mfma_f32_16x16x32_bf16 v[188:191], a[0:3], a[60:63], v[188:191]
 buffer_load_dwordx4 a[188:191], v43, s[4:7], s50 offen sc1
 s_waitcnt lgkmcnt(6)
 v_mfma_f32_16x16x32_bf16 v[196:199], a[4:7], a[48:51], v[196:199]
 ds_read_b64_tr_b16 a[20:21], v3
 v_mfma_f32_16x16x32_bf16 v[204:207], a[4:7], a[52:55], v[204:207]
 ds_read_b64_tr_b16 a[22:23], v3 offset:1024
 v_mfma_f32_16x16x32_bf16 v[212:215], a[4:7], a[56:59], v[212:215]
 v_mfma_f32_16x16x32_bf16 v[220:223], a[4:7], a[60:63], v[220:223]
 s_waitcnt lgkmcnt(6)
 v_mfma_f32_16x16x32_bf16 v[228:231], a[8:11], a[48:51], v[228:231]
 ds_read_b64_tr_b16 a[24:25], v4
 s_add_u32 m0, s59, 33792
 v_mfma_f32_16x16x32_bf16 v[236:239], a[8:11], a[52:55], v[236:239]
 ds_read_b64_tr_b16 a[26:27], v4 offset:1024
 s_add_u32 s27, s67, 3670016
 v_mfma_f32_16x16x32_bf16 v[244:247], a[8:11], a[56:59], v[244:247]
 buffer_load_dwordx4 v11, s[28:31], s27 offen lds
 buffer_store_dwordx4 v[232:235], v17, s[4:7], s58 offen offset:2048 sc1
 v_mfma_f32_16x16x32_bf16 v[252:255], a[8:11], a[60:63], v[252:255]
 s_waitcnt lgkmcnt(6)
 v_mfma_f32_16x16x32_bf16 v[48:51], a[12:15], v[44:47], v[48:51]
 ds_read_b64_tr_b16 a[28:29], v5
 ds_read_b64_tr_b16 a[30:31], v5 offset:1024
 s_waitcnt lgkmcnt(6)
 v_mfma_f32_16x16x32_bf16 a[192:195], a[16:19], a[128:131], a[192:195]
 ds_read_b64_tr_b16 a[0:1], v6
 v_mfma_f32_16x16x32_bf16 a[196:199], a[16:19], a[132:135], a[196:199]
 ds_read_b64_tr_b16 a[2:3], v6 offset:1024
 v_mfma_f32_16x16x32_bf16 a[200:203], a[16:19], a[136:139], a[200:203]
 v_mfma_f32_16x16x32_bf16 a[204:207], a[16:19], a[140:143], a[204:207]
 s_waitcnt lgkmcnt(6)
 v_mfma_f32_16x16x32_bf16 a[208:211], a[20:23], a[128:131], a[208:211]
 ds_read_b64_tr_b16 a[4:5], v7
 v_mfma_f32_16x16x32_bf16 a[212:215], a[20:23], a[132:135], a[212:215]
 ds_read_b64_tr_b16 a[6:7], v7 offset:1024
 s_mov_b32 s50, 16384
 v_mfma_f32_16x16x32_bf16 a[216:219], a[20:23], a[136:139], a[216:219]
 buffer_load_dwordx4 a[32:35], v40, s[4:7], s50 offen sc1
 v_mfma_f32_16x16x32_bf16 a[220:223], a[20:23], a[140:143], a[220:223]
 s_waitcnt lgkmcnt(6)
 v_mfma_f32_16x16x32_bf16 a[224:227], a[24:27], a[128:131], a[224:227]
 ds_read_b64_tr_b16 a[8:9], v8
 v_mfma_f32_16x16x32_bf16 a[228:231], a[24:27], a[132:135], a[228:231]
 ds_read_b64_tr_b16 a[10:11], v8 offset:1024
 s_add_u32 m0, s65, 40960
 v_mfma_f32_16x16x32_bf16 a[232:235], a[24:27], a[136:139], a[232:235]
 s_add_u32 s27, s68, 1548288
 v_mfma_f32_16x16x32_bf16 a[236:239], a[24:27], a[140:143], a[236:239]
 buffer_load_dwordx4 v37, s[32:35], s27 offen lds
 s_waitcnt lgkmcnt(6)
 v_mfma_f32_16x16x32_bf16 a[240:243], a[28:31], a[128:131], a[240:243]
 ds_read_b64_tr_b16 a[12:13], v9
 v_mfma_f32_16x16x32_bf16 a[244:247], a[28:31], a[132:135], a[244:247]
 ds_read_b64_tr_b16 a[14:15], v9 offset:1024
 v_mfma_f32_16x16x32_bf16 a[248:251], a[28:31], a[136:139], a[248:251]
 v_mfma_f32_16x16x32_bf16 a[252:255], a[28:31], a[140:143], a[252:255]
 s_waitcnt lgkmcnt(6)
 v_mfma_f32_16x16x32_bf16 a[64:67], a[0:3], a[128:131], a[64:67]
 ds_read_b64_tr_b16 a[16:17], v32
 v_mfma_f32_16x16x32_bf16 a[68:71], a[0:3], a[132:135], a[68:71]
 ds_read_b64_tr_b16 a[18:19], v32 offset:512
 buffer_load_dwordx4 a[36:39], v41, s[4:7], s50 offen sc1
 v_mfma_f32_16x16x32_bf16 a[72:75], a[0:3], a[136:139], a[72:75]
 buffer_store_dwordx4 v[240:243], v17, s[4:7], s56 offen offset:3072 sc1
 v_mfma_f32_16x16x32_bf16 a[76:79], a[0:3], a[140:143], a[76:79]
 s_waitcnt lgkmcnt(6)
 v_mfma_f32_16x16x32_bf16 a[80:83], a[4:7], a[128:131], a[80:83]
 ds_read_b64_tr_b16 a[20:21], v33
 v_mfma_f32_16x16x32_bf16 a[84:87], a[4:7], a[132:135], a[84:87]
 ds_read_b64_tr_b16 a[22:23], v33 offset:512
 v_mfma_f32_16x16x32_bf16 a[88:91], a[4:7], a[136:139], a[88:91]
 v_mfma_f32_16x16x32_bf16 a[92:95], a[4:7], a[140:143], a[92:95]
 s_waitcnt lgkmcnt(6)
 v_mfma_f32_16x16x32_bf16 a[96:99], a[8:11], a[128:131], a[96:99]
 ds_read_b64_tr_b16 a[24:25], v34
 v_mfma_f32_16x16x32_bf16 a[100:103], a[8:11], a[132:135], a[100:103]
 ds_read_b64_tr_b16 a[26:27], v34 offset:512
 v_mfma_f32_16x16x32_bf16 a[104:107], a[8:11], a[136:139], a[104:107]
 v_mfma_f32_16x16x32_bf16 a[108:111], a[8:11], a[140:143], a[108:111]
 s_waitcnt lgkmcnt(6)
 v_mfma_f32_16x16x32_bf16 a[112:115], a[12:15], a[128:131], a[112:115]
 ds_read_b64_tr_b16 a[28:29], v35
 buffer_load_dwordx4 a[40:43], v42, s[4:7], s50 offen sc1
 v_mfma_f32_16x16x32_bf16 a[116:119], a[12:15], a[132:135], a[116:119]
 ds_read_b64_tr_b16 a[30:31], v35 offset:512
 v_mfma_f32_16x16x32_bf16 a[120:123], a[12:15], a[136:139], a[120:123]
 s_waitcnt vmcnt(12)
 s_barrier
 s_add_u32 m0, s59, 49152
 v_mfma_f32_16x16x32_bf16 a[124:127], a[12:15], a[140:143], a[124:127]
 s_add_u32 s27, s67, 3932160
 s_waitcnt lgkmcnt(6)
 v_mfma_f32_16x16x32_bf16 v[132:135], a[16:19], a[128:131], v[132:135]
 ds_read_b64_tr_b16 a[0:1], v36
 buffer_load_dwordx4 v10, s[28:31], s27 offen lds
 v_mfma_f32_16x16x32_bf16 v[140:143], a[16:19], a[132:135], v[140:143]
 ds_read_b64_tr_b16 a[2:3], v36 offset:512
 v_mfma_f32_16x16x32_bf16 v[148:151], a[16:19], a[136:139], v[148:151]
 v_mfma_f32_16x16x32_bf16 v[156:159], a[16:19], a[140:143], v[156:159]
 s_waitcnt lgkmcnt(6)
 v_mfma_f32_16x16x32_bf16 v[164:167], a[20:23], a[128:131], v[164:167]
 ds_read_b64_tr_b16 a[4:5], v2 offset:16384
 v_mfma_f32_16x16x32_bf16 v[172:175], a[20:23], a[132:135], v[172:175]
 ds_read_b64_tr_b16 a[6:7], v2 offset:17408
 v_mfma_f32_16x16x32_bf16 v[180:183], a[20:23], a[136:139], v[180:183]
 v_mfma_f32_16x16x32_bf16 v[188:191], a[20:23], a[140:143], v[188:191]
 buffer_load_dwordx4 a[44:47], v43, s[4:7], s50 offen sc1
 s_waitcnt lgkmcnt(6)
 v_mfma_f32_16x16x32_bf16 v[196:199], a[24:27], a[128:131], v[196:199]
 ds_read_b64_tr_b16 a[8:9], v3 offset:16384
 buffer_store_dwordx4 v[248:251], v17, s[4:7], s58 offen offset:3072 sc1
 v_mfma_f32_16x16x32_bf16 v[204:207], a[24:27], a[132:135], v[204:207]
 ds_read_b64_tr_b16 a[10:11], v3 offset:17408
 v_mfma_f32_16x16x32_bf16 v[212:215], a[24:27], a[136:139], v[212:215]
 v_mfma_f32_16x16x32_bf16 v[220:223], a[24:27], a[140:143], v[220:223]
 s_waitcnt lgkmcnt(6)
 v_mfma_f32_16x16x32_bf16 v[228:231], a[28:31], a[128:131], v[228:231]
 ds_read_b64_tr_b16 a[12:13], v4 offset:16384
 s_add_u32 m0, s59, 50176
 v_mfma_f32_16x16x32_bf16 v[236:239], a[28:31], a[132:135], v[236:239]
 ds_read_b64_tr_b16 a[14:15], v4 offset:17408
 s_add_u32 s27, s67, 3932160
 v_mfma_f32_16x16x32_bf16 v[244:247], a[28:31], a[136:139], v[244:247]
 buffer_load_dwordx4 v11, s[28:31], s27 offen lds
 v_mfma_f32_16x16x32_bf16 v[252:255], a[28:31], a[140:143], v[252:255]
 s_waitcnt lgkmcnt(6)
 v_mfma_f32_16x16x32_bf16 v[48:51], a[0:3], v[44:47], v[48:51]
 ds_read_b64_tr_b16 a[16:17], v5 offset:16384
 ds_read_b64_tr_b16 a[18:19], v5 offset:17408
 s_waitcnt lgkmcnt(6)
 v_mfma_f32_16x16x32_bf16 a[192:195], a[4:7], a[144:147], a[192:195]
 ds_read_b64_tr_b16 a[20:21], v6 offset:16384
 v_mfma_f32_16x16x32_bf16 a[196:199], a[4:7], a[148:151], a[196:199]
 ds_read_b64_tr_b16 a[22:23], v6 offset:17408
 v_mfma_f32_16x16x32_bf16 a[200:203], a[4:7], a[152:155], a[200:203]
 v_mfma_f32_16x16x32_bf16 a[204:207], a[4:7], a[156:159], a[204:207]
 s_waitcnt lgkmcnt(6)
 v_mfma_f32_16x16x32_bf16 a[208:211], a[8:11], a[144:147], a[208:211]
 ds_read_b64_tr_b16 a[24:25], v7 offset:16384
 v_lshlrev_b32 v30, 3, v20
 v_mfma_f32_16x16x32_bf16 a[212:215], a[8:11], a[148:151], a[212:215]
 ds_read_b64_tr_b16 a[26:27], v7 offset:17408
 s_mov_b32 s50, 17408
 v_mfma_f32_16x16x32_bf16 a[216:219], a[8:11], a[152:155], a[216:219]
 s_lshl_b32 s53, s66, 7
 s_add_u32 s53, s53, 3145728
 buffer_load_dwordx4 a[48:51], v40, s[4:7], s50 offen sc1
 v_mfma_f32_16x16x32_bf16 a[220:223], a[8:11], a[156:159], a[220:223]
 s_waitcnt lgkmcnt(6)
 v_mfma_f32_16x16x32_bf16 a[224:227], a[12:15], a[144:147], a[224:227]
 ds_read_b64_tr_b16 a[28:29], v8 offset:16384
 buffer_load_dwordx2 v[22:23], v30, s[4:7], s53 offen sc1
 v_mfma_f32_16x16x32_bf16 a[228:231], a[12:15], a[148:151], a[228:231]
 ds_read_b64_tr_b16 a[30:31], v8 offset:17408
 s_add_u32 m0, s65, 57344
 v_mfma_f32_16x16x32_bf16 a[232:235], a[12:15], a[152:155], a[232:235]
 s_add_u32 s27, s68, 1658880
 v_mfma_f32_16x16x32_bf16 a[236:239], a[12:15], a[156:159], a[236:239]
 buffer_load_dwordx4 v37, s[32:35], s27 offen lds
 s_waitcnt lgkmcnt(6)
 v_mfma_f32_16x16x32_bf16 a[240:243], a[16:19], a[144:147], a[240:243]
 ds_read_b64_tr_b16 a[0:1], v9 offset:16384
 v_mfma_f32_16x16x32_bf16 a[244:247], a[16:19], a[148:151], a[244:247]
 ds_read_b64_tr_b16 a[2:3], v9 offset:17408
 v_mfma_f32_16x16x32_bf16 a[248:251], a[16:19], a[152:155], a[248:251]
 v_mfma_f32_16x16x32_bf16 a[252:255], a[16:19], a[156:159], a[252:255]
 s_waitcnt lgkmcnt(6)
 v_mfma_f32_16x16x32_bf16 a[64:67], a[20:23], a[144:147], a[64:67]
 ds_read_b64_tr_b16 a[4:5], v32 offset:16384
 buffer_load_dwordx2 v[24:25], v30, s[4:7], s53 offen offset:512 sc1
 v_mfma_f32_16x16x32_bf16 a[68:71], a[20:23], a[148:151], a[68:71]
 ds_read_b64_tr_b16 a[6:7], v32 offset:16896
 buffer_load_dwordx4 a[52:55], v41, s[4:7], s50 offen sc1
 v_mfma_f32_16x16x32_bf16 a[72:75], a[20:23], a[152:155], a[72:75]
 v_mfma_f32_16x16x32_bf16 a[76:79], a[20:23], a[156:159], a[76:79]
 s_waitcnt lgkmcnt(6)
 v_mfma_f32_16x16x32_bf16 a[80:83], a[24:27], a[144:147], a[80:83]
 ds_read_b64_tr_b16 a[8:9], v33 offset:16384
 v_mfma_f32_16x16x32_bf16 a[84:87], a[24:27], a[148:151], a[84:87]
 ds_read_b64_tr_b16 a[10:11], v33 offset:16896
 v_mfma_f32_16x16x32_bf16 a[88:91], a[24:27], a[152:155], a[88:91]
 s_lshl_b32 s53, s54, 7
 s_add_u32 s53, s53, 3145728
 v_mfma_f32_16x16x32_bf16 a[92:95], a[24:27], a[156:159], a[92:95]
 s_waitcnt lgkmcnt(6)
 v_mfma_f32_16x16x32_bf16 a[96:99], a[28:31], a[144:147], a[96:99]
 ds_read_b64_tr_b16 a[12:13], v34 offset:16384
 buffer_load_dwordx2 v[26:27], v30, s[4:7], s53 offen sc1
 v_mfma_f32_16x16x32_bf16 a[100:103], a[28:31], a[148:151], a[100:103]
 ds_read_b64_tr_b16 a[14:15], v34 offset:16896
 v_mfma_f32_16x16x32_bf16 a[104:107], a[28:31], a[152:155], a[104:107]
 v_mfma_f32_16x16x32_bf16 a[108:111], a[28:31], a[156:159], a[108:111]
 s_waitcnt lgkmcnt(6)
 v_mfma_f32_16x16x32_bf16 a[112:115], a[0:3], a[144:147], a[112:115]
 ds_read_b64_tr_b16 a[16:17], v35 offset:16384
 buffer_load_dwordx4 a[56:59], v42, s[4:7], s50 offen sc1
 v_mfma_f32_16x16x32_bf16 a[116:119], a[0:3], a[148:151], a[116:119]
 ds_read_b64_tr_b16 a[18:19], v35 offset:16896
 v_mfma_f32_16x16x32_bf16 a[120:123], a[0:3], a[152:155], a[120:123]
 s_waitcnt vmcnt(14)
 s_barrier
 s_add_u32 m0, s59, 0
 v_mfma_f32_16x16x32_bf16 a[124:127], a[0:3], a[156:159], a[124:127]
 s_add_u32 s27, s67, 4194304
 s_waitcnt lgkmcnt(6)
 v_mfma_f32_16x16x32_bf16 v[132:135], a[4:7], a[144:147], v[132:135]
 ds_read_b64_tr_b16 a[20:21], v36 offset:16384
 buffer_load_dwordx4 v10, s[28:31], s27 offen lds
 buffer_load_dwordx2 v[28:29], v30, s[4:7], s53 offen offset:512 sc1
 v_mfma_f32_16x16x32_bf16 v[140:143], a[4:7], a[148:151], v[140:143]
 ds_read_b64_tr_b16 a[22:23], v36 offset:16896
 v_mfma_f32_16x16x32_bf16 v[148:151], a[4:7], a[152:155], v[148:151]
 v_lshlrev_b32 v31, 3, v21
 s_lshl_b32 s53, s64, 7
 v_mfma_f32_16x16x32_bf16 v[156:159], a[4:7], a[156:159], v[156:159]
 s_waitcnt lgkmcnt(6)
 v_mfma_f32_16x16x32_bf16 v[164:167], a[8:11], a[144:147], v[164:167]
 ds_read_b64_tr_b16 a[24:25], v2 offset:32768
 v_mfma_f32_16x16x32_bf16 v[172:175], a[8:11], a[148:151], v[172:175]
 ds_read_b64_tr_b16 a[26:27], v2 offset:33792
 v_mfma_f32_16x16x32_bf16 v[180:183], a[8:11], a[152:155], v[180:183]
 s_add_u32 m0, s59, 1024
 v_mfma_f32_16x16x32_bf16 v[188:191], a[8:11], a[156:159], v[188:191]
 s_add_u32 s27, s67, 4194304
 buffer_load_dwordx4 a[60:63], v43, s[4:7], s50 offen sc1
 s_waitcnt lgkmcnt(6)
 v_mfma_f32_16x16x32_bf16 v[196:199], a[12:15], a[144:147], v[196:199]
 ds_read_b64_tr_b16 a[28:29], v3 offset:32768
 buffer_load_dwordx4 v11, s[28:31], s27 offen lds
 buffer_load_dwordx2 v[52:53], v31, s[36:39], s53 offen
 v_mfma_f32_16x16x32_bf16 v[204:207], a[12:15], a[148:151], v[204:207]
 ds_read_b64_tr_b16 a[30:31], v3 offset:33792
 v_mfma_f32_16x16x32_bf16 v[212:215], a[12:15], a[152:155], v[212:215]
 v_mfma_f32_16x16x32_bf16 v[220:223], a[12:15], a[156:159], v[220:223]
 s_waitcnt lgkmcnt(6)
 v_mfma_f32_16x16x32_bf16 v[228:231], a[16:19], a[144:147], v[228:231]
 ds_read_b64_tr_b16 a[0:1], v4 offset:32768
 v_mfma_f32_16x16x32_bf16 v[236:239], a[16:19], a[148:151], v[236:239]
 ds_read_b64_tr_b16 a[2:3], v4 offset:33792
 v_mfma_f32_16x16x32_bf16 v[244:247], a[16:19], a[152:155], v[244:247]
 s_add_u32 m0, s65, 8192
 v_mfma_f32_16x16x32_bf16 v[252:255], a[16:19], a[156:159], v[252:255]
 s_add_u32 s27, s68, 1769472
 s_waitcnt lgkmcnt(6)
 v_mfma_f32_16x16x32_bf16 v[48:51], a[20:23], v[44:47], v[48:51]
 ds_read_b64_tr_b16 a[4:5], v5 offset:32768
 ds_read_b64_tr_b16 a[6:7], v5 offset:33792
 buffer_load_dwordx4 v37, s[32:35], s27 offen lds
 buffer_load_dwordx2 v[54:55], v31, s[36:39], s53 offen offset:32
 s_waitcnt lgkmcnt(6)
 v_mfma_f32_16x16x32_bf16 a[192:195], a[24:27], a[160:163], a[192:195]
 ds_read_b64_tr_b16 a[8:9], v6 offset:32768
 v_mfma_f32_16x16x32_bf16 a[196:199], a[24:27], a[164:167], a[196:199]
 ds_read_b64_tr_b16 a[10:11], v6 offset:33792
 v_mfma_f32_16x16x32_bf16 a[200:203], a[24:27], a[168:171], a[200:203]
 v_mfma_f32_16x16x32_bf16 a[204:207], a[24:27], a[172:175], a[204:207]
 s_waitcnt lgkmcnt(6)
 v_mfma_f32_16x16x32_bf16 a[208:211], a[28:31], a[160:163], a[208:211]
 ds_read_b64_tr_b16 a[12:13], v7 offset:32768
 v_mfma_f32_16x16x32_bf16 a[212:215], a[28:31], a[164:167], a[212:215]
 ds_read_b64_tr_b16 a[14:15], v7 offset:33792
 s_add_u32 m0, s59, 65536
 s_mov_b32 s50, 18432
 v_mfma_f32_16x16x32_bf16 a[216:219], a[28:31], a[168:171], a[216:219]
 s_add_u32 s27, s67, 4456448
 buffer_load_dwordx4 a[128:131], v40, s[4:7], s50 offen sc1
 v_mfma_f32_16x16x32_bf16 a[220:223], a[28:31], a[172:175], a[220:223]
 buffer_load_dwordx4 v10, s[28:31], s27 offen lds
 buffer_load_dwordx2 v[56:57], v31, s[36:39], s53 offen offset:64
 s_waitcnt lgkmcnt(6)
 v_mfma_f32_16x16x32_bf16 a[224:227], a[0:3], a[160:163], a[224:227]
 ds_read_b64_tr_b16 a[16:17], v8 offset:32768
 v_mfma_f32_16x16x32_bf16 a[228:231], a[0:3], a[164:167], a[228:231]
 ds_read_b64_tr_b16 a[18:19], v8 offset:33792
 v_mfma_f32_16x16x32_bf16 a[232:235], a[0:3], a[168:171], a[232:235]
 v_mfma_f32_16x16x32_bf16 a[236:239], a[0:3], a[172:175], a[236:239]
 s_waitcnt lgkmcnt(6)
 v_mfma_f32_16x16x32_bf16 a[240:243], a[4:7], a[160:163], a[240:243]
 ds_read_b64_tr_b16 a[20:21], v9 offset:32768
 v_mfma_f32_16x16x32_bf16 a[244:247], a[4:7], a[164:167], a[244:247]
 ds_read_b64_tr_b16 a[22:23], v9 offset:33792
 s_add_u32 m0, s59, 66560
 v_mfma_f32_16x16x32_bf16 a[248:251], a[4:7], a[168:171], a[248:251]
 s_add_u32 s27, s67, 4456448
 v_mfma_f32_16x16x32_bf16 a[252:255], a[4:7], a[172:175], a[252:255]
 buffer_load_dwordx4 v11, s[28:31], s27 offen lds
 buffer_load_dwordx2 v[58:59], v31, s[36:39], s53 offen offset:96
 s_waitcnt lgkmcnt(6)
 v_mfma_f32_16x16x32_bf16 a[64:67], a[8:11], a[160:163], a[64:67]
 ds_read_b64_tr_b16 a[24:25], v32 offset:32768
 v_mfma_f32_16x16x32_bf16 a[68:71], a[8:11], a[164:167], a[68:71]
 ds_read_b64_tr_b16 a[26:27], v32 offset:33280
 buffer_load_dwordx4 a[132:135], v41, s[4:7], s50 offen sc1
 v_mfma_f32_16x16x32_bf16 a[72:75], a[8:11], a[168:171], a[72:75]
 v_mfma_f32_16x16x32_bf16 a[76:79], a[8:11], a[172:175], a[76:79]
 v_add_u32 v12, 0x2000, v1
 s_waitcnt lgkmcnt(6)
 v_mfma_f32_16x16x32_bf16 a[80:83], a[12:15], a[160:163], a[80:83]
 ds_read_b64_tr_b16 a[28:29], v33 offset:32768
 v_add_u32 v13, 16777216, v1
 v_mfma_f32_16x16x32_bf16 a[84:87], a[12:15], a[164:167], a[84:87]
 ds_read_b64_tr_b16 a[30:31], v33 offset:33280
 v_add_u32 v14, 16785408, v1
 s_add_u32 m0, s65, 73728
 v_mfma_f32_16x16x32_bf16 a[88:91], a[12:15], a[168:171], a[88:91]
 s_add_u32 s27, s68, 1880064
 s_lshl_b32 s52, s47, 19
 v_mfma_f32_16x16x32_bf16 a[92:95], a[12:15], a[172:175], a[92:95]
 buffer_load_dwordx4 v37, s[32:35], s27 offen lds
 s_lshl_b32 s58, s44, 11
 s_waitcnt lgkmcnt(6)
 v_mfma_f32_16x16x32_bf16 a[96:99], a[16:19], a[160:163], a[96:99]
 ds_read_b64_tr_b16 a[0:1], v34 offset:32768
 s_add_u32 s52, s52, s58
 v_mfma_f32_16x16x32_bf16 a[100:103], a[16:19], a[164:167], a[100:103]
 ds_read_b64_tr_b16 a[2:3], v34 offset:33280
 s_add_u32 s52, s52, 16777216
 v_mfma_f32_16x16x32_bf16 a[104:107], a[16:19], a[168:171], a[104:107]
 s_or_b32 s57, s58, 131072
 v_mfma_f32_16x16x32_bf16 a[108:111], a[16:19], a[172:175], a[108:111]
 s_mul_i32 s66, s66, 186368
 s_waitcnt lgkmcnt(6)
 v_mfma_f32_16x16x32_bf16 a[112:115], a[20:23], a[160:163], a[112:115]
 ds_read_b64_tr_b16 a[4:5], v35 offset:32768
 buffer_load_dwordx4 a[136:139], v42, s[4:7], s50 offen sc1
 s_mul_i32 s54, s54, 186368
 v_mfma_f32_16x16x32_bf16 a[116:119], a[20:23], a[164:167], a[116:119]
 ds_read_b64_tr_b16 a[6:7], v35 offset:33280
 s_add_u32 m0, s59, 77824
 s_lshl_b32 s53, s47, 12
 v_mfma_f32_16x16x32_bf16 a[120:123], a[20:23], a[168:171], a[120:123]
 s_waitcnt vmcnt(19)
 s_barrier
 s_add_u32 s27, s67, 4718592
 s_add_u32 s53, s53, 50331648
 v_mfma_f32_16x16x32_bf16 a[124:127], a[20:23], a[172:175], a[124:127]
 buffer_load_dwordx4 v10, s[28:31], s27 offen lds
 s_add_u32 s62, s66, s53
 s_waitcnt lgkmcnt(6)
 v_mfma_f32_16x16x32_bf16 v[132:135], a[24:27], a[160:163], v[132:135]
 ds_read_b64_tr_b16 a[8:9], v36 offset:32768
 s_add_u32 s63, s54, s53
 v_mfma_f32_16x16x32_bf16 v[140:143], a[24:27], a[164:167], v[140:143]
 ds_read_b64_tr_b16 a[10:11], v36 offset:33280
 s_lshl_b32 s53, s64, 11
 v_mfma_f32_16x16x32_bf16 v[148:151], a[24:27], a[168:171], v[148:151]
 s_add_u32 s53, s53, 50462720
 v_mfma_f32_16x16x32_bf16 v[156:159], a[24:27], a[172:175], v[156:159]
 s_add_u32 s66, s66, s53
 s_waitcnt lgkmcnt(6)
 v_mfma_f32_16x16x32_bf16 v[164:167], a[28:31], a[160:163], v[164:167]
 ds_read_b64_tr_b16 a[12:13], v2 offset:49152
 s_add_u32 s54, s54, s53
 v_mfma_f32_16x16x32_bf16 v[172:175], a[28:31], a[164:167], v[172:175]
 ds_read_b64_tr_b16 a[14:15], v2 offset:50176
 s_add_u32 m0, s59, 78848
 s_mov_b32 s69, 0x3e0293ee
 v_mfma_f32_16x16x32_bf16 v[180:183], a[28:31], a[168:171], v[180:183]
 s_add_u32 s27, s67, 4718592
 v_lshlrev_b32 v19, 2, v0
 v_mfma_f32_16x16x32_bf16 v[188:191], a[28:31], a[172:175], v[188:191]
 buffer_load_dwordx4 v11, s[28:31], s27 offen lds
 buffer_load_dwordx4 a[140:143], v43, s[4:7], s50 offen sc1
 s_lshl_b32 s70, s47, 7
 s_waitcnt lgkmcnt(6)
 v_mfma_f32_16x16x32_bf16 v[196:199], a[0:3], a[160:163], v[196:199]
 ds_read_b64_tr_b16 a[16:17], v3 offset:49152
 s_add_u32 s70, s70, 3211264
 v_mfma_f32_16x16x32_bf16 v[204:207], a[0:3], a[164:167], v[204:207]
 ds_read_b64_tr_b16 a[18:19], v3 offset:50176
 v_mfma_f32_16x16x32_bf16 v[212:215], a[0:3], a[168:171], v[212:215]
 v_mfma_f32_16x16x32_bf16 v[220:223], a[0:3], a[172:175], v[220:223]
 s_waitcnt lgkmcnt(6)
 v_mfma_f32_16x16x32_bf16 v[228:231], a[4:7], a[160:163], v[228:231]
 ds_read_b64_tr_b16 a[20:21], v4 offset:49152
 v_mfma_f32_16x16x32_bf16 v[236:239], a[4:7], a[164:167], v[236:239]
 ds_read_b64_tr_b16 a[22:23], v4 offset:50176
 s_add_u32 m0, s65, 86016
 v_mfma_f32_16x16x32_bf16 v[244:247], a[4:7], a[168:171], v[244:247]
 s_add_u32 s27, s68, 1990656
 v_mfma_f32_16x16x32_bf16 v[252:255], a[4:7], a[172:175], v[252:255]
 buffer_load_dwordx4 v37, s[32:35], s27 offen lds
 s_waitcnt lgkmcnt(6)
 v_mfma_f32_16x16x32_bf16 v[48:51], a[8:11], v[44:47], v[48:51]
 ds_read_b64_tr_b16 a[24:25], v5 offset:49152
 ds_read_b64_tr_b16 a[26:27], v5 offset:50176
 s_waitcnt lgkmcnt(6)
 v_mfma_f32_16x16x32_bf16 a[192:195], a[12:15], a[176:179], a[192:195]
 ds_read_b64_tr_b16 a[28:29], v6 offset:49152
 v_mfma_f32_16x16x32_bf16 a[196:199], a[12:15], a[180:183], a[196:199]
 ds_read_b64_tr_b16 a[30:31], v6 offset:50176
 v_mfma_f32_16x16x32_bf16 a[200:203], a[12:15], a[184:187], a[200:203]
 v_mfma_f32_16x16x32_bf16 a[204:207], a[12:15], a[188:191], a[204:207]
 s_waitcnt lgkmcnt(6)
 v_mfma_f32_16x16x32_bf16 a[208:211], a[16:19], a[176:179], a[208:211]
 ds_read_b64_tr_b16 a[0:1], v7 offset:49152
 s_add_u32 m0, s59, 90112
 v_mfma_f32_16x16x32_bf16 a[212:215], a[16:19], a[180:183], a[212:215]
 ds_read_b64_tr_b16 a[2:3], v7 offset:50176
 s_add_u32 s27, s67, 4980736
 s_mov_b32 s50, 19456
 v_mfma_f32_16x16x32_bf16 a[216:219], a[16:19], a[184:187], a[216:219]
 buffer_load_dwordx4 v10, s[28:31], s27 offen lds
 buffer_load_dwordx4 a[144:147], v40, s[4:7], s50 offen sc1
 v_mfma_f32_16x16x32_bf16 a[220:223], a[16:19], a[188:191], a[220:223]
 s_waitcnt lgkmcnt(6)
 v_mfma_f32_16x16x32_bf16 a[224:227], a[20:23], a[176:179], a[224:227]
 ds_read_b64_tr_b16 a[4:5], v8 offset:49152
 v_mfma_f32_16x16x32_bf16 a[228:231], a[20:23], a[180:183], a[228:231]
 ds_read_b64_tr_b16 a[6:7], v8 offset:50176
 v_mfma_f32_16x16x32_bf16 a[232:235], a[20:23], a[184:187], a[232:235]
 v_mfma_f32_16x16x32_bf16 a[236:239], a[20:23], a[188:191], a[236:239]
 s_waitcnt lgkmcnt(6)
 v_mfma_f32_16x16x32_bf16 a[240:243], a[24:27], a[176:179], a[240:243]
 ds_read_b64_tr_b16 a[8:9], v9 offset:49152
 s_add_u32 m0, s59, 91136
 v_mfma_f32_16x16x32_bf16 a[244:247], a[24:27], a[180:183], a[244:247]
 ds_read_b64_tr_b16 a[10:11], v9 offset:50176
 s_add_u32 s27, s67, 4980736
 v_mfma_f32_16x16x32_bf16 a[248:251], a[24:27], a[184:187], a[248:251]
 buffer_load_dwordx4 v11, s[28:31], s27 offen lds
 v_mfma_f32_16x16x32_bf16 a[252:255], a[24:27], a[188:191], a[252:255]
 s_waitcnt lgkmcnt(6)
 v_mfma_f32_16x16x32_bf16 a[64:67], a[28:31], a[176:179], a[64:67]
 ds_read_b64_tr_b16 a[12:13], v32 offset:49152
 v_mfma_f32_16x16x32_bf16 a[68:71], a[28:31], a[180:183], a[68:71]
 ds_read_b64_tr_b16 a[14:15], v32 offset:49664
 buffer_load_dwordx4 a[148:151], v41, s[4:7], s50 offen sc1
 v_mfma_f32_16x16x32_bf16 a[72:75], a[28:31], a[184:187], a[72:75]
 v_mfma_f32_16x16x32_bf16 a[76:79], a[28:31], a[188:191], a[76:79]
 s_waitcnt lgkmcnt(6)
 v_mfma_f32_16x16x32_bf16 a[80:83], a[0:3], a[176:179], a[80:83]
 ds_read_b64_tr_b16 a[16:17], v33 offset:49152
 s_add_u32 m0, s65, 98304
 v_mfma_f32_16x16x32_bf16 a[84:87], a[0:3], a[180:183], a[84:87]
 ds_read_b64_tr_b16 a[18:19], v33 offset:49664
 s_add_u32 s27, s68, 2101248
 v_mfma_f32_16x16x32_bf16 a[88:91], a[0:3], a[184:187], a[88:91]
 buffer_load_dwordx4 v37, s[32:35], s27 offen lds
 v_mfma_f32_16x16x32_bf16 a[92:95], a[0:3], a[188:191], a[92:95]
 s_waitcnt lgkmcnt(6)
 v_mfma_f32_16x16x32_bf16 a[96:99], a[4:7], a[176:179], a[96:99]
 ds_read_b64_tr_b16 a[20:21], v34 offset:49152
 v_mfma_f32_16x16x32_bf16 a[100:103], a[4:7], a[180:183], a[100:103]
 ds_read_b64_tr_b16 a[22:23], v34 offset:49664
 v_mfma_f32_16x16x32_bf16 a[104:107], a[4:7], a[184:187], a[104:107]
 v_mfma_f32_16x16x32_bf16 a[108:111], a[4:7], a[188:191], a[108:111]
 s_waitcnt lgkmcnt(6)
 v_mfma_f32_16x16x32_bf16 a[112:115], a[8:11], a[176:179], a[112:115]
 ds_read_b64_tr_b16 a[24:25], v35 offset:49152
 buffer_load_dwordx4 a[152:155], v42, s[4:7], s50 offen sc1
 v_mfma_f32_16x16x32_bf16 a[116:119], a[8:11], a[180:183], a[116:119]
 ds_read_b64_tr_b16 a[26:27], v35 offset:49664
 v_mfma_f32_16x16x32_bf16 a[120:123], a[8:11], a[184:187], a[120:123]
 s_waitcnt vmcnt(19)
 s_barrier
 v_mfma_f32_16x16x32_bf16 a[124:127], a[8:11], a[188:191], a[124:127]
 s_waitcnt lgkmcnt(6)
 v_mfma_f32_16x16x32_bf16 v[132:135], a[12:15], a[176:179], v[132:135]
 buffer_store_dword v61, v18, s[4:7], s60 offen sc1
 ds_read_b64_tr_b16 a[28:29], v36 offset:49152
 v_mfma_f32_16x16x32_bf16 v[140:143], a[12:15], a[180:183], v[140:143]
 ds_read_b64_tr_b16 a[30:31], v36 offset:49664
 v_mfma_f32_16x16x32_bf16 v[148:151], a[12:15], a[184:187], v[148:151]
 v_mfma_f32_16x16x32_bf16 v[156:159], a[12:15], a[188:191], v[156:159]
 s_waitcnt lgkmcnt(6)
 v_mfma_f32_16x16x32_bf16 v[164:167], a[16:19], a[176:179], v[164:167]
 ds_read_b64_tr_b16 a[0:1], v2
 v_mfma_f32_16x16x32_bf16 v[172:175], a[16:19], a[180:183], v[172:175]
 ds_read_b64_tr_b16 a[2:3], v2 offset:1024
 v_mfma_f32_16x16x32_bf16 v[180:183], a[16:19], a[184:187], v[180:183]
 v_mfma_f32_16x16x32_bf16 v[188:191], a[16:19], a[188:191], v[188:191]
 buffer_load_dwordx4 a[156:159], v43, s[4:7], s50 offen sc1
 s_waitcnt lgkmcnt(6)
 v_mfma_f32_16x16x32_bf16 v[196:199], a[20:23], a[176:179], v[196:199]
 ds_read_b64_tr_b16 a[4:5], v3
 v_mfma_f32_16x16x32_bf16 v[204:207], a[20:23], a[180:183], v[204:207]
 ds_read_b64_tr_b16 a[6:7], v3 offset:1024
 v_mfma_f32_16x16x32_bf16 v[212:215], a[20:23], a[184:187], v[212:215]
 v_mfma_f32_16x16x32_bf16 v[220:223], a[20:23], a[188:191], v[220:223]
 s_waitcnt lgkmcnt(6)
 v_mfma_f32_16x16x32_bf16 v[228:231], a[24:27], a[176:179], v[228:231]
 ds_read_b64_tr_b16 a[8:9], v4
 v_mfma_f32_16x16x32_bf16 v[236:239], a[24:27], a[180:183], v[236:239]
 ds_read_b64_tr_b16 a[10:11], v4 offset:1024
 v_mfma_f32_16x16x32_bf16 v[244:247], a[24:27], a[184:187], v[244:247]
 v_mfma_f32_16x16x32_bf16 v[252:255], a[24:27], a[188:191], v[252:255]
 s_waitcnt lgkmcnt(6)
 v_mfma_f32_16x16x32_bf16 v[48:51], a[28:31], v[44:47], v[48:51]
 ds_read_b64_tr_b16 a[12:13], v5
 ds_read_b64_tr_b16 a[14:15], v5 offset:1024
 s_waitcnt lgkmcnt(6)
 v_mfma_f32_16x16x32_bf16 a[192:195], a[0:3], a[32:35], a[192:195]
 ds_read_b64_tr_b16 a[16:17], v6
 v_mfma_f32_16x16x32_bf16 a[196:199], a[0:3], a[36:39], a[196:199]
 ds_read_b64_tr_b16 a[18:19], v6 offset:1024
 v_mfma_f32_16x16x32_bf16 a[200:203], a[0:3], a[40:43], a[200:203]
 v_mfma_f32_16x16x32_bf16 a[204:207], a[0:3], a[44:47], a[204:207]
 s_waitcnt lgkmcnt(6)
 v_mfma_f32_16x16x32_bf16 a[208:211], a[4:7], a[32:35], a[208:211]
 ds_read_b64_tr_b16 a[20:21], v7
 v_mfma_f32_16x16x32_bf16 a[212:215], a[4:7], a[36:39], a[212:215]
 ds_read_b64_tr_b16 a[22:23], v7 offset:1024
 v_mfma_f32_16x16x32_bf16 a[216:219], a[4:7], a[40:43], a[216:219]
 v_mfma_f32_16x16x32_bf16 a[220:223], a[4:7], a[44:47], a[220:223]
 s_waitcnt lgkmcnt(6)
 v_mfma_f32_16x16x32_bf16 a[224:227], a[8:11], a[32:35], a[224:227]
 ds_read_b64_tr_b16 a[24:25], v8
 v_mfma_f32_16x16x32_bf16 a[228:231], a[8:11], a[36:39], a[228:231]
 ds_read_b64_tr_b16 a[26:27], v8 offset:1024
 v_mfma_f32_16x16x32_bf16 a[232:235], a[8:11], a[40:43], a[232:235]
 v_mfma_f32_16x16x32_bf16 a[236:239], a[8:11], a[44:47], a[236:239]
 s_waitcnt lgkmcnt(6)
 v_mfma_f32_16x16x32_bf16 a[240:243], a[12:15], a[32:35], a[240:243]
 ds_read_b64_tr_b16 a[28:29], v9
 v_mfma_f32_16x16x32_bf16 a[244:247], a[12:15], a[36:39], a[244:247]
 ds_read_b64_tr_b16 a[30:31], v9 offset:1024
 v_mfma_f32_16x16x32_bf16 a[248:251], a[12:15], a[40:43], a[248:251]
 v_mfma_f32_16x16x32_bf16 a[252:255], a[12:15], a[44:47], a[252:255]
 s_waitcnt lgkmcnt(6)
 v_mfma_f32_16x16x32_bf16 a[64:67], a[16:19], a[32:35], a[64:67]
 ds_read_b64_tr_b16 a[0:1], v32
 v_mfma_f32_16x16x32_bf16 a[68:71], a[16:19], a[36:39], a[68:71]
 ds_read_b64_tr_b16 a[2:3], v32 offset:512
 v_mfma_f32_16x16x32_bf16 a[72:75], a[16:19], a[40:43], a[72:75]
 v_mfma_f32_16x16x32_bf16 a[76:79], a[16:19], a[44:47], a[76:79]
 s_waitcnt lgkmcnt(6)
 v_mfma_f32_16x16x32_bf16 a[80:83], a[20:23], a[32:35], a[80:83]
 ds_read_b64_tr_b16 a[4:5], v33
 v_mfma_f32_16x16x32_bf16 a[84:87], a[20:23], a[36:39], a[84:87]
 ds_read_b64_tr_b16 a[6:7], v33 offset:512
 v_mfma_f32_16x16x32_bf16 a[88:91], a[20:23], a[40:43], a[88:91]
 v_mfma_f32_16x16x32_bf16 a[92:95], a[20:23], a[44:47], a[92:95]
 s_waitcnt lgkmcnt(6)
 v_mfma_f32_16x16x32_bf16 a[96:99], a[24:27], a[32:35], a[96:99]
 ds_read_b64_tr_b16 a[8:9], v34
 v_mfma_f32_16x16x32_bf16 a[100:103], a[24:27], a[36:39], a[100:103]
 ds_read_b64_tr_b16 a[10:11], v34 offset:512
 v_mfma_f32_16x16x32_bf16 a[104:107], a[24:27], a[40:43], a[104:107]
 v_mfma_f32_16x16x32_bf16 a[108:111], a[24:27], a[44:47], a[108:111]
 s_waitcnt lgkmcnt(6)
 v_mfma_f32_16x16x32_bf16 a[112:115], a[28:31], a[32:35], a[112:115]
 ds_read_b64_tr_b16 a[12:13], v35
 v_mfma_f32_16x16x32_bf16 a[116:119], a[28:31], a[36:39], a[116:119]
 ds_read_b64_tr_b16 a[14:15], v35 offset:512
 v_mfma_f32_16x16x32_bf16 a[120:123], a[28:31], a[40:43], a[120:123]
 s_waitcnt vmcnt(3)
 s_barrier
 v_mfma_f32_16x16x32_bf16 a[124:127], a[28:31], a[44:47], a[124:127]
 s_waitcnt lgkmcnt(6)
 v_mfma_f32_16x16x32_bf16 v[132:135], a[0:3], a[32:35], v[132:135]
 ds_read_b64_tr_b16 a[16:17], v36
 v_mfma_f32_16x16x32_bf16 v[140:143], a[0:3], a[36:39], v[140:143]
 ds_read_b64_tr_b16 a[18:19], v36 offset:512
 v_mfma_f32_16x16x32_bf16 v[148:151], a[0:3], a[40:43], v[148:151]
 v_mfma_f32_16x16x32_bf16 v[156:159], a[0:3], a[44:47], v[156:159]
 s_waitcnt lgkmcnt(6)
 v_mfma_f32_16x16x32_bf16 v[164:167], a[4:7], a[32:35], v[164:167]
 v_add_u32 v2, 65536, v2
 ds_read_b64_tr_b16 a[20:21], v2
 v_mfma_f32_16x16x32_bf16 v[172:175], a[4:7], a[36:39], v[172:175]
 ds_read_b64_tr_b16 a[22:23], v2 offset:1024
 v_mfma_f32_16x16x32_bf16 v[180:183], a[4:7], a[40:43], v[180:183]
 v_mfma_f32_16x16x32_bf16 v[188:191], a[4:7], a[44:47], v[188:191]
 s_waitcnt lgkmcnt(6)
 v_mfma_f32_16x16x32_bf16 v[196:199], a[8:11], a[32:35], v[196:199]
 ds_read_b64_tr_b16 a[24:25], v2 offset:12288
 v_mfma_f32_16x16x32_bf16 v[204:207], a[8:11], a[36:39], v[204:207]
 ds_read_b64_tr_b16 a[26:27], v2 offset:13312
 v_mfma_f32_16x16x32_bf16 v[212:215], a[8:11], a[40:43], v[212:215]
 v_mfma_f32_16x16x32_bf16 v[220:223], a[8:11], a[44:47], v[220:223]
 s_waitcnt lgkmcnt(6)
 v_mfma_f32_16x16x32_bf16 v[228:231], a[12:15], a[32:35], v[228:231]
 ds_read_b64_tr_b16 a[28:29], v2 offset:24576
 v_mfma_f32_16x16x32_bf16 v[236:239], a[12:15], a[36:39], v[236:239]
 ds_read_b64_tr_b16 a[30:31], v2 offset:25600
 v_mfma_f32_16x16x32_bf16 v[244:247], a[12:15], a[40:43], v[244:247]
 v_mfma_f32_16x16x32_bf16 v[252:255], a[12:15], a[44:47], v[252:255]
 s_waitcnt lgkmcnt(6)
 v_mfma_f32_16x16x32_bf16 v[48:51], a[16:19], v[44:47], v[48:51]
 v_add_u32 v3, 65536, v3
 ds_read_b64_tr_b16 a[0:1], v3
 ds_read_b64_tr_b16 a[2:3], v3 offset:1024
 s_waitcnt lgkmcnt(6)
 v_mfma_f32_16x16x32_bf16 a[192:195], a[20:23], a[48:51], a[192:195]
 ds_read_b64_tr_b16 a[4:5], v3 offset:12288
 v_mfma_f32_16x16x32_bf16 a[196:199], a[20:23], a[52:55], a[196:199]
 ds_read_b64_tr_b16 a[6:7], v3 offset:13312
 v_mfma_f32_16x16x32_bf16 a[200:203], a[20:23], a[56:59], a[200:203]
 s_barrier
 v_mfma_f32_16x16x32_bf16 a[204:207], a[20:23], a[60:63], a[204:207]
 s_waitcnt lgkmcnt(6)
 v_mfma_f32_16x16x32_bf16 a[192:195], a[24:27], a[128:131], a[192:195]
 ds_read_b64_tr_b16 a[8:9], v3 offset:24576
 v_mfma_f32_16x16x32_bf16 a[196:199], a[24:27], a[132:135], a[196:199]
 ds_read_b64_tr_b16 a[10:11], v3 offset:25600
 v_mfma_f32_16x16x32_bf16 a[200:203], a[24:27], a[136:139], a[200:203]
 v_mfma_f32_16x16x32_bf16 a[204:207], a[24:27], a[140:143], a[204:207]
 s_waitcnt lgkmcnt(6)
 v_mfma_f32_16x16x32_bf16 a[192:195], a[28:31], a[144:147], a[192:195]
 v_add_u32 v4, 65536, v4
 ds_read_b64_tr_b16 a[12:13], v4
 v_mfma_f32_16x16x32_bf16 a[196:199], a[28:31], a[148:151], a[196:199]
 ds_read_b64_tr_b16 a[14:15], v4 offset:1024
 s_waitcnt vmcnt(2)
 v_mfma_f32_16x16x32_bf16 a[200:203], a[28:31], a[152:155], a[200:203]
 s_waitcnt vmcnt(0)
 v_mfma_f32_16x16x32_bf16 a[204:207], a[28:31], a[156:159], a[204:207]
 s_waitcnt lgkmcnt(6)
 v_mfma_f32_16x16x32_bf16 a[208:211], a[0:3], a[48:51], a[208:211]
 ds_read_b64_tr_b16 a[16:17], v4 offset:12288
 v_mfma_f32_16x16x32_bf16 a[212:215], a[0:3], a[52:55], a[212:215]
 ds_read_b64_tr_b16 a[18:19], v4 offset:13312
 v_mfma_f32_16x16x32_bf16 a[216:219], a[0:3], a[56:59], a[216:219]
 v_accvgpr_read_b32 v128, a192
 v_accvgpr_read_b32 v129, a193
 v_mfma_f32_16x16x32_bf16 a[220:223], a[0:3], a[60:63], a[220:223]
 v_accvgpr_read_b32 v130, a194
 v_accvgpr_read_b32 v131, a195
 s_waitcnt lgkmcnt(6)
 v_mfma_f32_16x16x32_bf16 a[208:211], a[4:7], a[128:131], a[208:211]
 ds_read_b64_tr_b16 a[20:21], v4 offset:24576
 v_mul_f32 v128, s69, v128
 v_mul_f32 v129, s69, v129
 v_mfma_f32_16x16x32_bf16 a[212:215], a[4:7], a[132:135], a[212:215]
 ds_read_b64_tr_b16 a[22:23], v4 offset:25600
 v_mul_f32 v130, s69, v130
 v_mul_f32 v131, s69, v131
 v_mfma_f32_16x16x32_bf16 a[216:219], a[4:7], a[136:139], a[216:219]
 v_mfma_f32_16x16x32_bf16 a[220:223], a[4:7], a[140:143], a[220:223]
 s_waitcnt lgkmcnt(6)
 v_mfma_f32_16x16x32_bf16 a[208:211], a[8:11], a[144:147], a[208:211]
 v_add_u32 v5, 65536, v5
 ds_read_b64_tr_b16 a[24:25], v5
 v_mfma_f32_16x16x32_bf16 a[212:215], a[8:11], a[148:151], a[212:215]
 ds_read_b64_tr_b16 a[26:27], v5 offset:1024
 v_mfma_f32_16x16x32_bf16 a[216:219], a[8:11], a[152:155], a[216:219]
 v_mfma_f32_16x16x32_bf16 a[220:223], a[8:11], a[156:159], a[220:223]
 s_waitcnt lgkmcnt(6)
 v_mfma_f32_16x16x32_bf16 a[224:227], a[12:15], a[48:51], a[224:227]
 ds_read_b64_tr_b16 a[28:29], v5 offset:12288
 v_mfma_f32_16x16x32_bf16 a[228:231], a[12:15], a[52:55], a[228:231]
 ds_read_b64_tr_b16 a[30:31], v5 offset:13312
 v_mfma_f32_16x16x32_bf16 a[232:235], a[12:15], a[56:59], a[232:235]
 v_accvgpr_read_b32 v136, a208
 v_accvgpr_read_b32 v137, a209
 v_mfma_f32_16x16x32_bf16 a[236:239], a[12:15], a[60:63], a[236:239]
 v_accvgpr_read_b32 v138, a210
 v_accvgpr_read_b32 v139, a211
 s_waitcnt lgkmcnt(6)
 v_mfma_f32_16x16x32_bf16 a[224:227], a[16:19], a[128:131], a[224:227]
 ds_read_b64_tr_b16 a[0:1], v5 offset:24576
 v_mul_f32 v136, s69, v136
 v_mul_f32 v137, s69, v137
 v_mfma_f32_16x16x32_bf16 a[228:231], a[16:19], a[132:135], a[228:231]
 ds_read_b64_tr_b16 a[2:3], v5 offset:25600
 v_mul_f32 v138, s69, v138
 v_mul_f32 v139, s69, v139
 v_mfma_f32_16x16x32_bf16 a[232:235], a[16:19], a[136:139], a[232:235]
 buffer_load_dword v62, v19, s[4:7], s70 offen sc1
 v_cvt_pk_bf16_f32 v64, v128, v129
 v_cvt_pk_bf16_f32 v65, v130, v131
 v_mfma_f32_16x16x32_bf16 a[236:239], a[16:19], a[140:143], a[236:239]
 v_cvt_pk_bf16_f32 v66, v136, v137
 v_cvt_pk_bf16_f32 v67, v138, v139
 s_waitcnt lgkmcnt(6)
 v_mfma_f32_16x16x32_bf16 a[224:227], a[20:23], a[144:147], a[224:227]
 v_add_u32 v6, 65536, v6
 ds_read_b64_tr_b16 a[4:5], v6
 v_accvgpr_read_b32 v144, a196
 v_mfma_f32_16x16x32_bf16 a[228:231], a[20:23], a[148:151], a[228:231]
 ds_read_b64_tr_b16 a[6:7], v6 offset:1024
 v_accvgpr_read_b32 v145, a197
 v_accvgpr_read_b32 v146, a198
 v_mfma_f32_16x16x32_bf16 a[232:235], a[20:23], a[152:155], a[232:235]
 v_accvgpr_read_b32 v147, a199
 v_mul_f32 v144, s69, v144
 v_mfma_f32_16x16x32_bf16 a[236:239], a[20:23], a[156:159], a[236:239]
 v_mul_f32 v145, s69, v145
 v_mul_f32 v146, s69, v146
 s_waitcnt lgkmcnt(6)
 v_mfma_f32_16x16x32_bf16 a[240:243], a[24:27], a[48:51], a[240:243]
 ds_read_b64_tr_b16 a[8:9], v6 offset:12288
 v_mul_f32 v147, s69, v147
 v_accvgpr_read_b32 v152, a212
 v_mfma_f32_16x16x32_bf16 a[244:247], a[24:27], a[52:55], a[244:247]
 ds_read_b64_tr_b16 a[10:11], v6 offset:13312
 v_accvgpr_read_b32 v153, a213
 v_accvgpr_read_b32 v154, a214
 v_mfma_f32_16x16x32_bf16 a[248:251], a[24:27], a[56:59], a[248:251]
 v_accvgpr_read_b32 v155, a215
 v_mul_f32 v152, s69, v152
 v_mfma_f32_16x16x32_bf16 a[252:255], a[24:27], a[60:63], a[252:255]
 v_mul_f32 v153, s69, v153
 v_mul_f32 v154, s69, v154
 s_waitcnt lgkmcnt(6)
 v_mfma_f32_16x16x32_bf16 a[240:243], a[28:31], a[128:131], a[240:243]
 ds_read_b64_tr_b16 a[12:13], v6 offset:24576
 v_mul_f32 v155, s69, v155
 v_cvt_pk_bf16_f32 v80, v144, v145
 v_mfma_f32_16x16x32_bf16 a[244:247], a[28:31], a[132:135], a[244:247]
 ds_read_b64_tr_b16 a[14:15], v6 offset:25600
 v_cvt_pk_bf16_f32 v81, v146, v147
 v_cvt_pk_bf16_f32 v82, v152, v153
 v_mfma_f32_16x16x32_bf16 a[248:251], a[28:31], a[136:139], a[248:251]
 v_cvt_pk_bf16_f32 v83, v154, v155
 v_accvgpr_read_b32 v160, a200
 v_mfma_f32_16x16x32_bf16 a[252:255], a[28:31], a[140:143], a[252:255]
 v_accvgpr_read_b32 v161, a201
 v_accvgpr_read_b32 v162, a202
 s_waitcnt lgkmcnt(6)
 v_mfma_f32_16x16x32_bf16 a[240:243], a[0:3], a[144:147], a[240:243]
 v_add_u32 v7, 65536, v7
 ds_read_b64_tr_b16 a[16:17], v7
 v_accvgpr_read_b32 v163, a203
 v_mfma_f32_16x16x32_bf16 a[244:247], a[0:3], a[148:151], a[244:247]
 ds_read_b64_tr_b16 a[18:19], v7 offset:1024
 v_mul_f32 v160, s69, v160
 v_mul_f32 v161, s69, v161
 v_mfma_f32_16x16x32_bf16 a[248:251], a[0:3], a[152:155], a[248:251]
 v_mul_f32 v162, s69, v162
 v_mul_f32 v163, s69, v163
 v_mfma_f32_16x16x32_bf16 a[252:255], a[0:3], a[156:159], a[252:255]
 v_accvgpr_read_b32 v168, a216
 v_accvgpr_read_b32 v169, a217
 s_waitcnt lgkmcnt(6)
 v_mfma_f32_16x16x32_bf16 a[64:67], a[4:7], a[48:51], a[64:67]
 ds_read_b64_tr_b16 a[20:21], v7 offset:12288
 v_accvgpr_read_b32 v170, a218
 v_accvgpr_read_b32 v171, a219
 v_mfma_f32_16x16x32_bf16 a[68:71], a[4:7], a[52:55], a[68:71]
 ds_read_b64_tr_b16 a[22:23], v7 offset:13312
 v_mul_f32 v168, s69, v168
 v_mul_f32 v169, s69, v169
 v_mfma_f32_16x16x32_bf16 a[72:75], a[4:7], a[56:59], a[72:75]
 v_mul_f32 v170, s69, v170
 v_mul_f32 v171, s69, v171
 v_mfma_f32_16x16x32_bf16 a[76:79], a[4:7], a[60:63], a[76:79]
 v_cvt_pk_bf16_f32 v96, v160, v161
 v_cvt_pk_bf16_f32 v97, v162, v163
 s_waitcnt lgkmcnt(6)
 v_mfma_f32_16x16x32_bf16 a[64:67], a[8:11], a[128:131], a[64:67]
 ds_read_b64_tr_b16 a[24:25], v7 offset:24576
 v_cvt_pk_bf16_f32 v98, v168, v169
 v_cvt_pk_bf16_f32 v99, v170, v171
 v_mfma_f32_16x16x32_bf16 a[68:71], a[8:11], a[132:135], a[68:71]
 ds_read_b64_tr_b16 a[26:27], v7 offset:25600
 v_accvgpr_read_b32 v176, a204
 v_accvgpr_read_b32 v177, a205
 v_mfma_f32_16x16x32_bf16 a[72:75], a[8:11], a[136:139], a[72:75]
 v_accvgpr_read_b32 v178, a206
 v_accvgpr_read_b32 v179, a207
 v_mfma_f32_16x16x32_bf16 a[76:79], a[8:11], a[140:143], a[76:79]
 v_mul_f32 v176, s69, v176
 v_mul_f32 v177, s69, v177
 s_waitcnt lgkmcnt(6)
 v_mfma_f32_16x16x32_bf16 a[64:67], a[12:15], a[144:147], a[64:67]
 v_add_u32 v8, 65536, v8
 ds_read_b64_tr_b16 a[28:29], v8
 v_mul_f32 v178, s69, v178
 v_mfma_f32_16x16x32_bf16 a[68:71], a[12:15], a[148:151], a[68:71]
 ds_read_b64_tr_b16 a[30:31], v8 offset:1024
 v_mul_f32 v179, s69, v179
 v_accvgpr_read_b32 v184, a220
 v_mfma_f32_16x16x32_bf16 a[72:75], a[12:15], a[152:155], a[72:75]
 v_accvgpr_read_b32 v185, a221
 v_accvgpr_read_b32 v186, a222
 v_mfma_f32_16x16x32_bf16 a[76:79], a[12:15], a[156:159], a[76:79]
 v_accvgpr_read_b32 v187, a223
 v_mul_f32 v184, s69, v184
 s_waitcnt lgkmcnt(6)
 v_mfma_f32_16x16x32_bf16 a[80:83], a[16:19], a[48:51], a[80:83]
 ds_read_b64_tr_b16 a[0:1], v8 offset:12288
 v_mul_f32 v185, s69, v185
 v_mul_f32 v186, s69, v186
 v_mfma_f32_16x16x32_bf16 a[84:87], a[16:19], a[52:55], a[84:87]
 ds_read_b64_tr_b16 a[2:3], v8 offset:13312
 v_mul_f32 v187, s69, v187
 v_cvt_pk_bf16_f32 v112, v176, v177
 v_mfma_f32_16x16x32_bf16 a[88:91], a[16:19], a[56:59], a[88:91]
 v_cvt_pk_bf16_f32 v113, v178, v179
 v_cvt_pk_bf16_f32 v114, v184, v185
 v_mfma_f32_16x16x32_bf16 a[92:95], a[16:19], a[60:63], a[92:95]
 v_cvt_pk_bf16_f32 v115, v186, v187
 v_accvgpr_read_b32 v192, a224
 s_waitcnt lgkmcnt(6)
 v_mfma_f32_16x16x32_bf16 a[80:83], a[20:23], a[128:131], a[80:83]
 ds_read_b64_tr_b16 a[4:5], v8 offset:24576
 v_accvgpr_read_b32 v193, a225
 v_accvgpr_read_b32 v194, a226
 v_mfma_f32_16x16x32_bf16 a[84:87], a[20:23], a[132:135], a[84:87]
 ds_read_b64_tr_b16 a[6:7], v8 offset:25600
 v_accvgpr_read_b32 v195, a227
 v_mul_f32 v192, s69, v192
 v_mfma_f32_16x16x32_bf16 a[88:91], a[20:23], a[136:139], a[88:91]
 s_waitcnt vmcnt(0)
 v_cmp_eq_u32 vcc, s100, v62
 s_nop 1
 s_and_b32 s71, vcc_lo, 255
 s_cmp_eq_u32 s71, 255
 s_cbranch_scc0 L_slow_kv
L_back_kv:
 v_mfma_f32_16x16x32_bf16 a[92:95], a[20:23], a[140:143], a[92:95]
 s_cmp_eq_u32 s2, 0
 s_cselect_b32 s49, 3211136, s51
 buffer_store_dword v61, v18, s[4:7], s49 offen sc1
 s_waitcnt lgkmcnt(6)
 v_mfma_f32_16x16x32_bf16 a[80:83], a[24:27], a[144:147], a[80:83]
 v_add_u32 v9, 65536, v9
 ds_read_b64_tr_b16 a[8:9], v9
 v_mul_f32 v193, s69, v193
 v_mfma_f32_16x16x32_bf16 a[84:87], a[24:27], a[148:151], a[84:87]
 ds_read_b64_tr_b16 a[10:11], v9 offset:1024
 v_mul_f32 v194, s69, v194
 s_add_u32 m0, s57, 0
 v_mfma_f32_16x16x32_bf16 a[88:91], a[24:27], a[152:155], a[88:91]
 v_mul_f32 v195, s69, v195
 v_accvgpr_read_b32 v200, a240
 v_mfma_f32_16x16x32_bf16 a[92:95], a[24:27], a[156:159], a[92:95]
 buffer_load_dwordx4 v1, s[4:7], s52 offen sc1 lds
 v_accvgpr_read_b32 v201, a241
 v_accvgpr_read_b32 v202, a242
 s_waitcnt lgkmcnt(6)
 v_mfma_f32_16x16x32_bf16 a[96:99], a[28:31], a[48:51], a[96:99]
 ds_read_b64_tr_b16 a[12:13], v9 offset:12288
 v_accvgpr_read_b32 v203, a243
 v_mul_f32 v200, s69, v200
 v_mfma_f32_16x16x32_bf16 a[100:103], a[28:31], a[52:55], a[100:103]
 ds_read_b64_tr_b16 a[14:15], v9 offset:13312
 v_mul_f32 v201, s69, v201
 buffer_load_dwordx4 v1, s[4:7], s52 offen offset:1024 sc1 lds
 v_mfma_f32_16x16x32_bf16 a[104:107], a[28:31], a[56:59], a[104:107]
 v_mul_f32 v202, s69, v202
 v_mul_f32 v203, s69, v203
 v_mfma_f32_16x16x32_bf16 a[108:111], a[28:31], a[60:63], a[108:111]
 s_add_u32 m0, s58, 0
 v_cvt_pk_bf16_f32 v68, v192, v193
 v_cvt_pk_bf16_f32 v69, v194, v195
 s_waitcnt lgkmcnt(6)
 v_mfma_f32_16x16x32_bf16 a[96:99], a[0:3], a[128:131], a[96:99]
 ds_read_b64_tr_b16 a[16:17], v9 offset:24576
 v_cvt_pk_bf16_f32 v70, v200, v201
 v_cvt_pk_bf16_f32 v71, v202, v203
 v_mfma_f32_16x16x32_bf16 a[100:103], a[0:3], a[132:135], a[100:103]
 ds_read_b64_tr_b16 a[18:19], v9 offset:25600
 v_accvgpr_read_b32 v208, a228
 buffer_load_dwordx4 v13, s[4:7], s52 offen sc1 lds
 v_mfma_f32_16x16x32_bf16 a[104:107], a[0:3], a[136:139], a[104:107]
 v_accvgpr_read_b32 v209, a229
 v_accvgpr_read_b32 v210, a230
 v_mfma_f32_16x16x32_bf16 a[108:111], a[0:3], a[140:143], a[108:111]
 buffer_load_dwordx4 v13, s[4:7], s52 offen offset:1024 sc1 lds
 v_accvgpr_read_b32 v211, a231
 v_mul_f32 v208, s69, v208
 s_waitcnt lgkmcnt(6)
 v_mfma_f32_16x16x32_bf16 a[96:99], a[4:7], a[144:147], a[96:99]
 v_add_u32 v36, 65536, v36
 ds_read_b64_tr_b16 a[20:21], v36
 v_mul_f32 v209, s69, v209
 v_mfma_f32_16x16x32_bf16 a[100:103], a[4:7], a[148:151], a[100:103]
 ds_read_b64_tr_b16 a[22:23], v36 offset:512
 v_mul_f32 v210, s69, v210
 s_add_u32 m0, s57, 8192
 v_mfma_f32_16x16x32_bf16 a[104:107], a[4:7], a[152:155], a[104:107]
 v_mul_f32 v211, s69, v211
 v_accvgpr_read_b32 v216, a244
 v_mfma_f32_16x16x32_bf16 a[108:111], a[4:7], a[156:159], a[108:111]
 buffer_load_dwordx4 v12, s[4:7], s52 offen sc1 lds
 v_accvgpr_read_b32 v217, a245
 v_accvgpr_read_b32 v218, a246
 s_waitcnt lgkmcnt(6)
 v_mfma_f32_16x16x32_bf16 a[112:115], a[8:11], a[48:51], a[112:115]
 ds_read_b64_tr_b16 a[24:25], v36 offset:12288
 v_accvgpr_read_b32 v219, a247
 v_mul_f32 v216, s69, v216
 v_mfma_f32_16x16x32_bf16 a[116:119], a[8:11], a[52:55], a[116:119]
 ds_read_b64_tr_b16 a[26:27], v36 offset:12800
 v_mul_f32 v217, s69, v217
 buffer_load_dwordx4 v12, s[4:7], s52 offen offset:1024 sc1 lds
 v_mfma_f32_16x16x32_bf16 a[120:123], a[8:11], a[56:59], a[120:123]
 v_mul_f32 v218, s69, v218
 v_mul_f32 v219, s69, v219
 v_mfma_f32_16x16x32_bf16 a[124:127], a[8:11], a[60:63], a[124:127]
 s_add_u32 m0, s58, 8192
 v_cvt_pk_bf16_f32 v84, v208, v209
 v_cvt_pk_bf16_f32 v85, v210, v211
 s_waitcnt lgkmcnt(6)
 v_mfma_f32_16x16x32_bf16 a[112:115], a[12:15], a[128:131], a[112:115]
 ds_read_b64_tr_b16 a[28:29], v36 offset:24576
 v_cvt_pk_bf16_f32 v86, v216, v217
 v_cvt_pk_bf16_f32 v87, v218, v219
 v_mfma_f32_16x16x32_bf16 a[116:119], a[12:15], a[132:135], a[116:119]
 ds_read_b64_tr_b16 a[30:31], v36 offset:25088
 v_accvgpr_read_b32 v224, a232
 buffer_load_dwordx4 v14, s[4:7], s52 offen sc1 lds
 v_mfma_f32_16x16x32_bf16 a[120:123], a[12:15], a[136:139], a[120:123]
 v_accvgpr_read_b32 v225, a233
 v_accvgpr_read_b32 v226, a234
 v_mfma_f32_16x16x32_bf16 a[124:127], a[12:15], a[140:143], a[124:127]
 buffer_load_dwordx4 v14, s[4:7], s52 offen offset:1024 sc1 lds
 v_accvgpr_read_b32 v227, a235
 v_mul_f32 v224, s69, v224
 s_waitcnt lgkmcnt(6)
 v_mfma_f32_16x16x32_bf16 a[112:115], a[16:19], a[144:147], a[112:115]
 v_add_u32 v32, 65536, v32
 ds_read_b64_tr_b16 a[0:1], v32
 v_mul_f32 v225, s69, v225
 v_mfma_f32_16x16x32_bf16 a[116:119], a[16:19], a[148:151], a[116:119]
 ds_read_b64_tr_b16 a[2:3], v32 offset:512
 v_mul_f32 v226, s69, v226
 s_xor_b32 s57, s57, 0x4000
 v_mfma_f32_16x16x32_bf16 a[120:123], a[16:19], a[152:155], a[120:123]
 v_mul_f32 v227, s69, v227
 v_accvgpr_read_b32 v232, a248
 v_mfma_f32_16x16x32_bf16 a[124:127], a[16:19], a[156:159], a[124:127]
 s_add_u32 s58, s58, 0x4000
 v_accvgpr_read_b32 v233, a249
 v_accvgpr_read_b32 v234, a250
 s_waitcnt lgkmcnt(6)
 v_mfma_f32_16x16x32_bf16 v[48:51], a[20:23], v[44:47], v[48:51]
 ds_read_b64_tr_b16 a[4:5], v32 offset:12288
 v_accvgpr_read_b32 v235, a251
 ds_read_b64_tr_b16 a[6:7], v32 offset:12800
 s_waitcnt lgkmcnt(6)
 v_mfma_f32_16x16x32_bf16 v[48:51], a[24:27], v[44:47], v[48:51]
 ds_read_b64_tr_b16 a[8:9], v32 offset:24576
 ds_read_b64_tr_b16 a[10:11], v32 offset:25088
 s_and_b32 s58, s58, 0xffff
 s_waitcnt lgkmcnt(6)
 v_mfma_f32_16x16x32_bf16 v[48:51], a[28:31], v[44:47], v[48:51]
 v_add_u32 v33, 65536, v33
 ds_read_b64_tr_b16 a[12:13], v33
 ds_read_b64_tr_b16 a[14:15], v33 offset:512
 s_waitcnt lgkmcnt(6)
 v_mfma_f32_16x16x32_bf16 v[132:135], a[0:3], a[48:51], v[132:135]
 ds_read_b64_tr_b16 a[16:17], v33 offset:12288
 v_mul_f32 v232, s69, v232
 s_add_u32 s52, s52, 0x4000
 v_mfma_f32_16x16x32_bf16 v[140:143], a[0:3], a[52:55], v[140:143]
 ds_read_b64_tr_b16 a[18:19], v33 offset:12800
 v_mul_f32 v233, s69, v233
 v_mul_f32 v234, s69, v234
 v_mfma_f32_16x16x32_bf16 v[148:151], a[0:3], a[56:59], v[148:151]
 s_add_u32 m0, s57, 0
 v_mul_f32 v235, s69, v235
 v_cvt_pk_bf16_f32 v100, v224, v225
 v_mfma_f32_16x16x32_bf16 v[156:159], a[0:3], a[60:63], v[156:159]
 v_cvt_pk_bf16_f32 v101, v226, v227
 v_cvt_pk_bf16_f32 v102, v232, v233
 s_waitcnt lgkmcnt(6)
 v_mfma_f32_16x16x32_bf16 v[132:135], a[4:7], a[128:131], v[132:135]
 ds_read_b64_tr_b16 a[20:21], v33 offset:24576
 v_cvt_pk_bf16_f32 v103, v234, v235
 buffer_load_dwordx4 v1, s[4:7], s52 offen sc1 lds
 v_mfma_f32_16x16x32_bf16 v[140:143], a[4:7], a[132:135], v[140:143]
 ds_read_b64_tr_b16 a[22:23], v33 offset:25088
 v_accvgpr_read_b32 v240, a236
 v_accvgpr_read_b32 v241, a237
 v_mfma_f32_16x16x32_bf16 v[148:151], a[4:7], a[136:139], v[148:151]
 buffer_load_dwordx4 v1, s[4:7], s52 offen offset:1024 sc1 lds
 v_accvgpr_read_b32 v242, a238
 v_accvgpr_read_b32 v243, a239
 v_mfma_f32_16x16x32_bf16 v[156:159], a[4:7], a[140:143], v[156:159]
 v_mul_f32 v240, s69, v240
 v_mul_f32 v241, s69, v241
 s_waitcnt lgkmcnt(6)
 v_mfma_f32_16x16x32_bf16 v[132:135], a[8:11], a[144:147], v[132:135]
 v_add_u32 v34, 65536, v34
 ds_read_b64_tr_b16 a[24:25], v34
 s_add_u32 m0, s58, 0
 v_mfma_f32_16x16x32_bf16 v[140:143], a[8:11], a[148:151], v[140:143]
 ds_read_b64_tr_b16 a[26:27], v34 offset:512
 v_mul_f32 v242, s69, v242
 v_mul_f32 v243, s69, v243
 v_mfma_f32_16x16x32_bf16 v[148:151], a[8:11], a[152:155], v[148:151]
 buffer_load_dwordx4 v13, s[4:7], s52 offen sc1 lds
 v_accvgpr_read_b32 v248, a252
 v_accvgpr_read_b32 v249, a253
 v_mfma_f32_16x16x32_bf16 v[156:159], a[8:11], a[156:159], v[156:159]
 v_accvgpr_read_b32 v250, a254
 v_accvgpr_read_b32 v251, a255
 s_waitcnt lgkmcnt(6)
 v_mfma_f32_16x16x32_bf16 v[164:167], a[12:15], a[48:51], v[164:167]
 ds_read_b64_tr_b16 a[28:29], v34 offset:12288
 v_mul_f32 v248, s69, v248
 buffer_load_dwordx4 v13, s[4:7], s52 offen offset:1024 sc1 lds
 v_mfma_f32_16x16x32_bf16 v[172:175], a[12:15], a[52:55], v[172:175]
 ds_read_b64_tr_b16 a[30:31], v34 offset:12800
 v_mul_f32 v249, s69, v249
 v_mul_f32 v250, s69, v250
 v_mfma_f32_16x16x32_bf16 v[180:183], a[12:15], a[56:59], v[180:183]
 s_add_u32 m0, s57, 8192
 v_mul_f32 v251, s69, v251
 v_cvt_pk_bf16_f32 v116, v240, v241
 v_mfma_f32_16x16x32_bf16 v[188:191], a[12:15], a[60:63], v[188:191]
 v_cvt_pk_bf16_f32 v117, v242, v243
 v_cvt_pk_bf16_f32 v118, v248, v249
 s_waitcnt lgkmcnt(6)
 v_mfma_f32_16x16x32_bf16 v[164:167], a[16:19], a[128:131], v[164:167]
 ds_read_b64_tr_b16 a[0:1], v34 offset:24576
 v_cvt_pk_bf16_f32 v119, v250, v251
 buffer_load_dwordx4 v12, s[4:7], s52 offen sc1 lds
 v_mfma_f32_16x16x32_bf16 v[172:175], a[16:19], a[132:135], v[172:175]
 ds_read_b64_tr_b16 a[2:3], v34 offset:25088
 v_accvgpr_read_b32 v128, a64
 v_accvgpr_read_b32 v129, a65
 v_mfma_f32_16x16x32_bf16 v[180:183], a[16:19], a[136:139], v[180:183]
 buffer_load_dwordx4 v12, s[4:7], s52 offen offset:1024 sc1 lds
 v_accvgpr_read_b32 v130, a66
 v_accvgpr_read_b32 v131, a67
 v_mfma_f32_16x16x32_bf16 v[188:191], a[16:19], a[140:143], v[188:191]
 v_mul_f32 v128, s69, v128
 v_mul_f32 v129, s69, v129
 s_waitcnt lgkmcnt(6)
 v_mfma_f32_16x16x32_bf16 v[164:167], a[20:23], a[144:147], v[164:167]
 v_add_u32 v35, 65536, v35
 ds_read_b64_tr_b16 a[4:5], v35
 s_add_u32 m0, s58, 8192
 v_mfma_f32_16x16x32_bf16 v[172:175], a[20:23], a[148:151], v[172:175]
 ds_read_b64_tr_b16 a[6:7], v35 offset:512
 v_mul_f32 v130, s69, v130
 v_mul_f32 v131, s69, v131
 v_mfma_f32_16x16x32_bf16 v[180:183], a[20:23], a[152:155], v[180:183]
 buffer_load_dwordx4 v14, s[4:7], s52 offen sc1 lds
 v_accvgpr_read_b32 v136, a80
 v_accvgpr_read_b32 v137, a81
 v_mfma_f32_16x16x32_bf16 v[188:191], a[20:23], a[156:159], v[188:191]
 v_accvgpr_read_b32 v138, a82
 v_accvgpr_read_b32 v139, a83
 s_waitcnt lgkmcnt(6)
 v_mfma_f32_16x16x32_bf16 v[196:199], a[24:27], a[48:51], v[196:199]
 ds_read_b64_tr_b16 a[8:9], v35 offset:12288
 v_mul_f32 v136, s69, v136
 buffer_load_dwordx4 v14, s[4:7], s52 offen offset:1024 sc1 lds
 v_mfma_f32_16x16x32_bf16 v[204:207], a[24:27], a[52:55], v[204:207]
 ds_read_b64_tr_b16 a[10:11], v35 offset:12800
 v_mul_f32 v137, s69, v137
 v_mul_f32 v138, s69, v138
 v_mfma_f32_16x16x32_bf16 v[212:215], a[24:27], a[56:59], v[212:215]
 s_xor_b32 s57, s57, 0x4000
 v_mul_f32 v139, s69, v139
 v_cvt_pk_bf16_f32 v72, v128, v129
 v_mfma_f32_16x16x32_bf16 v[220:223], a[24:27], a[60:63], v[220:223]
 v_cvt_pk_bf16_f32 v73, v130, v131
 v_cvt_pk_bf16_f32 v74, v136, v137
 s_waitcnt lgkmcnt(6)
 v_mfma_f32_16x16x32_bf16 v[196:199], a[28:31], a[128:131], v[196:199]
 ds_read_b64_tr_b16 a[12:13], v35 offset:24576
 v_cvt_pk_bf16_f32 v75, v138, v139
 s_add_u32 s58, s58, 0x4000
 v_mfma_f32_16x16x32_bf16 v[204:207], a[28:31], a[132:135], v[204:207]
 ds_read_b64_tr_b16 a[14:15], v35 offset:25088
 v_accvgpr_read_b32 v144, a68
 v_accvgpr_read_b32 v145, a69
 v_mfma_f32_16x16x32_bf16 v[212:215], a[28:31], a[136:139], v[212:215]
 s_and_b32 s58, s58, 0xffff
 v_accvgpr_read_b32 v146, a70
 v_accvgpr_read_b32 v147, a71
 v_mfma_f32_16x16x32_bf16 v[220:223], a[28:31], a[140:143], v[220:223]
 v_mul_f32 v144, s69, v144
 v_mul_f32 v145, s69, v145
 s_waitcnt lgkmcnt(6)
 v_mfma_f32_16x16x32_bf16 v[196:199], a[0:3], a[144:147], v[196:199]
 s_add_u32 s52, s52, 0x4000
 v_mul_f32 v146, s69, v146
 v_mul_f32 v147, s69, v147
 v_mfma_f32_16x16x32_bf16 v[204:207], a[0:3], a[148:151], v[204:207]
 v_accvgpr_read_b32 v152, a84
 v_accvgpr_read_b32 v153, a85
 v_mfma_f32_16x16x32_bf16 v[212:215], a[0:3], a[152:155], v[212:215]
 v_accvgpr_read_b32 v154, a86
 v_accvgpr_read_b32 v155, a87
 v_mfma_f32_16x16x32_bf16 v[220:223], a[0:3], a[156:159], v[220:223]
 v_mul_f32 v152, s69, v152
 v_mul_f32 v153, s69, v153
 s_waitcnt lgkmcnt(4)
 v_mfma_f32_16x16x32_bf16 v[228:231], a[4:7], a[48:51], v[228:231]
 v_mul_f32 v154, s69, v154
 v_mul_f32 v155, s69, v155
 v_mfma_f32_16x16x32_bf16 v[236:239], a[4:7], a[52:55], v[236:239]
 v_cvt_pk_bf16_f32 v88, v144, v145
 v_cvt_pk_bf16_f32 v89, v146, v147
 v_mfma_f32_16x16x32_bf16 v[244:247], a[4:7], a[56:59], v[244:247]
 v_cvt_pk_bf16_f32 v90, v152, v153
 v_cvt_pk_bf16_f32 v91, v154, v155
 v_mfma_f32_16x16x32_bf16 v[252:255], a[4:7], a[60:63], v[252:255]
 v_accvgpr_read_b32 v160, a72
 v_accvgpr_read_b32 v161, a73
 s_waitcnt lgkmcnt(2)
 v_mfma_f32_16x16x32_bf16 v[228:231], a[8:11], a[128:131], v[228:231]
 v_accvgpr_read_b32 v162, a74
 v_accvgpr_read_b32 v163, a75
 v_mfma_f32_16x16x32_bf16 v[236:239], a[8:11], a[132:135], v[236:239]
 v_mul_f32 v160, s69, v160
 v_mul_f32 v161, s69, v161
 v_mfma_f32_16x16x32_bf16 v[244:247], a[8:11], a[136:139], v[244:247]
 v_mul_f32 v162, s69, v162
 v_mul_f32 v163, s69, v163
 v_mfma_f32_16x16x32_bf16 v[252:255], a[8:11], a[140:143], v[252:255]
 v_accvgpr_read_b32 v168, a88
 v_accvgpr_read_b32 v169, a89
 s_waitcnt lgkmcnt(0)
 v_mfma_f32_16x16x32_bf16 v[228:231], a[12:15], a[144:147], v[228:231]
 v_accvgpr_read_b32 v170, a90
 v_accvgpr_read_b32 v171, a91
 v_mfma_f32_16x16x32_bf16 v[236:239], a[12:15], a[148:151], v[236:239]
 v_mul_f32 v168, s69, v168
 v_mul_f32 v169, s69, v169
 v_mfma_f32_16x16x32_bf16 v[244:247], a[12:15], a[152:155], v[244:247]
 v_mul_f32 v170, s69, v170
 v_mul_f32 v171, s69, v171
 v_mfma_f32_16x16x32_bf16 v[252:255], a[12:15], a[156:159], v[252:255]
 v_add_u32 v30, s65, v1
 v_add_u32 v30, 65536, v30
 ds_write_b128 v30, v[48:51] offset:0xf000
 v_cvt_pk_bf16_f32 v104, v160, v161
 v_cvt_pk_bf16_f32 v105, v162, v163
 v_cvt_pk_bf16_f32 v106, v168, v169
 v_cvt_pk_bf16_f32 v107, v170, v171
 v_accvgpr_read_b32 v176, a76
 v_accvgpr_read_b32 v177, a77
 v_accvgpr_read_b32 v178, a78
 v_accvgpr_read_b32 v179, a79
 v_mul_f32 v176, s69, v176
 v_mul_f32 v177, s69, v177
 v_mul_f32 v178, s69, v178
 v_mul_f32 v179, s69, v179
 v_accvgpr_read_b32 v184, a92
 v_accvgpr_read_b32 v185, a93
 v_accvgpr_read_b32 v186, a94
 v_accvgpr_read_b32 v187, a95
 v_mul_f32 v184, s69, v184
 v_mul_f32 v185, s69, v185
 v_mul_f32 v186, s69, v186
 v_mul_f32 v187, s69, v187
 v_cvt_pk_bf16_f32 v120, v176, v177
 v_cvt_pk_bf16_f32 v121, v178, v179
 v_cvt_pk_bf16_f32 v122, v184, v185
 v_cvt_pk_bf16_f32 v123, v186, v187
 v_accvgpr_read_b32 v192, a96
 v_accvgpr_read_b32 v193, a97
 v_accvgpr_read_b32 v194, a98
 v_accvgpr_read_b32 v195, a99
 v_mul_f32 v192, s69, v192
 v_mul_f32 v193, s69, v193
 v_mul_f32 v194, s69, v194
 v_mul_f32 v195, s69, v195
 v_accvgpr_read_b32 v200, a112
 v_accvgpr_read_b32 v201, a113
 v_accvgpr_read_b32 v202, a114
 v_accvgpr_read_b32 v203, a115
 v_mul_f32 v200, s69, v200
 v_mul_f32 v201, s69, v201
 v_mul_f32 v202, s69, v202
 v_mul_f32 v203, s69, v203
 v_cvt_pk_bf16_f32 v76, v192, v193
 v_cvt_pk_bf16_f32 v77, v194, v195
 v_cvt_pk_bf16_f32 v78, v200, v201
 v_cvt_pk_bf16_f32 v79, v202, v203
 v_accvgpr_read_b32 v208, a100
 v_accvgpr_read_b32 v209, a101
 v_accvgpr_read_b32 v210, a102
 v_accvgpr_read_b32 v211, a103
 v_mul_f32 v208, s69, v208
 v_mul_f32 v209, s69, v209
 v_mul_f32 v210, s69, v210
 v_mul_f32 v211, s69, v211
 v_accvgpr_read_b32 v216, a116
 v_accvgpr_read_b32 v217, a117
 v_accvgpr_read_b32 v218, a118
 v_accvgpr_read_b32 v219, a119
 v_mul_f32 v216, s69, v216
 v_mul_f32 v217, s69, v217
 v_mul_f32 v218, s69, v218
 v_mul_f32 v219, s69, v219
 v_cvt_pk_bf16_f32 v92, v208, v209
 v_cvt_pk_bf16_f32 v93, v210, v211
 v_cvt_pk_bf16_f32 v94, v216, v217
 v_cvt_pk_bf16_f32 v95, v218, v219
 v_accvgpr_read_b32 v224, a104
 v_accvgpr_read_b32 v225, a105
 v_accvgpr_read_b32 v226, a106
 v_accvgpr_read_b32 v227, a107
 v_mul_f32 v224, s69, v224
 v_mul_f32 v225, s69, v225
 v_mul_f32 v226, s69, v226
 v_mul_f32 v227, s69, v227
 v_accvgpr_read_b32 v232, a120
 v_accvgpr_read_b32 v233, a121
 v_accvgpr_read_b32 v234, a122
 v_accvgpr_read_b32 v235, a123
 v_mul_f32 v232, s69, v232
 v_mul_f32 v233, s69, v233
 v_mul_f32 v234, s69, v234
 v_mul_f32 v235, s69, v235
 v_cvt_pk_bf16_f32 v108, v224, v225
 v_cvt_pk_bf16_f32 v109, v226, v227
 v_cvt_pk_bf16_f32 v110, v232, v233
 v_cvt_pk_bf16_f32 v111, v234, v235
 v_accvgpr_read_b32 v240, a108
 v_accvgpr_read_b32 v241, a109
 v_accvgpr_read_b32 v242, a110
 v_accvgpr_read_b32 v243, a111
 v_mul_f32 v240, s69, v240
 v_mul_f32 v241, s69, v241
 v_mul_f32 v242, s69, v242
 v_mul_f32 v243, s69, v243
 v_accvgpr_read_b32 v248, a124
 v_accvgpr_read_b32 v249, a125
 v_accvgpr_read_b32 v250, a126
 v_accvgpr_read_b32 v251, a127
 v_mul_f32 v248, s69, v248
 v_mul_f32 v249, s69, v249
 v_mul_f32 v250, s69, v250
 v_mul_f32 v251, s69, v251
 v_cvt_pk_bf16_f32 v124, v240, v241
 v_cvt_pk_bf16_f32 v125, v242, v243
 v_cvt_pk_bf16_f32 v126, v248, v249
 v_cvt_pk_bf16_f32 v127, v250, v251
 v_lshlrev_b32 v32, 16, v52
 v_and_b32 v33, 0xffff0000, v52
 v_lshlrev_b32 v34, 16, v53
 v_and_b32 v35, 0xffff0000, v53
 v_lshlrev_b32 v36, 16, v54
 v_and_b32 v37, 0xffff0000, v54
 v_lshlrev_b32 v38, 16, v55
 v_and_b32 v39, 0xffff0000, v55
 v_lshlrev_b32 v40, 16, v56
 v_and_b32 v41, 0xffff0000, v56
 v_lshlrev_b32 v42, 16, v57
 v_and_b32 v43, 0xffff0000, v57
 v_lshlrev_b32 v44, 16, v58
 v_and_b32 v45, 0xffff0000, v58
 v_lshlrev_b32 v46, 16, v59
 v_and_b32 v47, 0xffff0000, v59
 s_load_dwordx2 s[8:9], s[0:1], 40
 s_load_dwordx2 s[12:13], s[0:1], 72
 s_load_dwordx2 s[94:95], s[0:1], 80
 s_load_dwordx2 s[24:25], s[0:1], 88
 s_mov_b32 s10, 5242880
 s_mov_b32 s14, 2211840
 v_mov_b32 v4, v18
 v_add_u32 v30, 65536, v1
 s_waitcnt lgkmcnt(0)
 s_barrier
 v_mov_b32 v128, 0xc0135761
 v_mov_b32 v129, 0xbdd2d3e8
 v_mov_b32 v130, 1.0
 ds_read_b128 v[48:51], v30 offset:61440
 ds_read_b128 v[52:55], v30 offset:62464
 ds_read_b128 v[56:59], v30 offset:63488
 ds_read_b128 v[60:63], v30 offset:64512
 s_cmp_ge_u32 s64, 27
 s_cselect_b32 s66, s51, s66
 s_cselect_b32 s54, s51, s54
 s_cbranch_scc1 L_nogelu
 s_waitcnt lgkmcnt(0)
 v_pk_fma_f32 v[132:133], v[48:49], v[22:23], v[132:133] op_sel_hi:[1,0,1] neg_lo:[0,1,0] neg_hi:[0,1,0]
 v_pk_fma_f32 v[134:135], v[50:51], v[22:23], v[134:135] op_sel_hi:[1,0,1] neg_lo:[0,1,0] neg_hi:[0,1,0]
 v_pk_fma_f32 v[164:165], v[52:53], v[22:23], v[164:165] op_sel_hi:[1,0,1] neg_lo:[0,1,0] neg_hi:[0,1,0]
 v_pk_fma_f32 v[166:167], v[54:55], v[22:23], v[166:167] op_sel_hi:[1,0,1] neg_lo:[0,1,0] neg_hi:[0,1,0]
 v_pk_fma_f32 v[132:133], v[132:133], v[22:23], v[32:33] op_sel:[0,1,0] op_sel_hi:[1,1,1]
 v_pk_fma_f32 v[134:135], v[134:135], v[22:23], v[34:35] op_sel:[0,1,0] op_sel_hi:[1,1,1]
 v_pk_fma_f32 v[164:165], v[164:165], v[22:23], v[36:37] op_sel:[0,1,0] op_sel_hi:[1,1,1]
 v_pk_fma_f32 v[166:167], v[166:167], v[22:23], v[38:39] op_sel:[0,1,0] op_sel_hi:[1,1,1]
 v_pk_mul_f32 v[136:137], v[132:133], v[132:133]
 v_pk_mul_f32 v[138:139], v[134:135], v[134:135]
 v_pk_mul_f32 v[144:145], v[164:165], v[164:165]
 v_pk_mul_f32 v[146:147], v[166:167], v[166:167]
 v_pk_fma_f32 v[136:137], v[136:137], v[128:129], v[128:129] op_sel:[0,1,0] op_sel_hi:[1,1,0]
 v_pk_fma_f32 v[138:139], v[138:139], v[128:129], v[128:129] op_sel:[0,1,0] op_sel_hi:[1,1,0]
 v_pk_fma_f32 v[144:145], v[144:145], v[128:129], v[128:129] op_sel:[0,1,0] op_sel_hi:[1,1,0]
 v_pk_fma_f32 v[146:147], v[146:147], v[128:129], v[128:129] op_sel:[0,1,0] op_sel_hi:[1,1,0]
 v_pk_mul_f32 v[136:137], v[136:137], v[132:133]
 v_pk_mul_f32 v[138:139], v[138:139], v[134:135]
 v_pk_mul_f32 v[144:145], v[144:145], v[164:165]
 v_pk_mul_f32 v[146:147], v[146:147], v[166:167]
 v_exp_f32 v136, v136
 v_exp_f32 v137, v137
 v_exp_f32 v138, v138
 v_exp_f32 v139, v139
 v_exp_f32 v144, v144
 v_exp_f32 v145, v145
 v_exp_f32 v146, v146
 v_exp_f32 v147, v147
 v_pk_add_f32 v[136:137], v[136:137], v[130:131] op_sel_hi:[1,0]
 v_pk_add_f32 v[138:139], v[138:139], v[130:131] op_sel_hi:[1,0]
 v_pk_add_f32 v[144:145], v[144:145], v[130:131] op_sel_hi:[1,0]
 v_pk_add_f32 v[146:147], v[146:147], v[130:131] op_sel_hi:[1,0]
 v_rcp_f32 v136, v136
 v_rcp_f32 v137, v137
 v_rcp_f32 v138, v138
 v_rcp_f32 v139, v139
 v_rcp_f32 v144, v144
 v_rcp_f32 v145, v145
 v_rcp_f32 v146, v146
 v_rcp_f32 v147, v147
 v_pk_mul_f32 v[136:137], v[136:137], v[132:133]
 v_pk_mul_f32 v[138:139], v[138:139], v[134:135]
 v_pk_mul_f32 v[144:145], v[144:145], v[164:165]
 v_pk_mul_f32 v[146:147], v[146:147], v[166:167]
 v_cvt_pk_bf16_f32 v132, v136, v137
 v_cvt_pk_bf16_f32 v133, v138, v139
 v_cvt_pk_bf16_f32 v134, v144, v145
 v_cvt_pk_bf16_f32 v135, v146, v147
 s_add_u32 s49, s66, 0
 buffer_store_dwordx4 v[132:135], v1, s[4:7], s49 offen sc1
 v_pk_fma_f32 v[196:197], v[56:57], v[22:23], v[196:197] op_sel_hi:[1,0,1] neg_lo:[0,1,0] neg_hi:[0,1,0]
 v_pk_fma_f32 v[198:199], v[58:59], v[22:23], v[198:199] op_sel_hi:[1,0,1] neg_lo:[0,1,0] neg_hi:[0,1,0]
 v_pk_fma_f32 v[228:229], v[60:61], v[22:23], v[228:229] op_sel_hi:[1,0,1] neg_lo:[0,1,0] neg_hi:[0,1,0]
 v_pk_fma_f32 v[230:231], v[62:63], v[22:23], v[230:231] op_sel_hi:[1,0,1] neg_lo:[0,1,0] neg_hi:[0,1,0]
 v_pk_fma_f32 v[196:197], v[196:197], v[22:23], v[40:41] op_sel:[0,1,0] op_sel_hi:[1,1,1]
 v_pk_fma_f32 v[198:199], v[198:199], v[22:23], v[42:43] op_sel:[0,1,0] op_sel_hi:[1,1,1]
 v_pk_fma_f32 v[228:229], v[228:229], v[22:23], v[44:45] op_sel:[0,1,0] op_sel_hi:[1,1,1]
 v_pk_fma_f32 v[230:231], v[230:231], v[22:23], v[46:47] op_sel:[0,1,0] op_sel_hi:[1,1,1]
 v_pk_mul_f32 v[136:137], v[196:197], v[196:197]
 v_pk_mul_f32 v[138:139], v[198:199], v[198:199]
 v_pk_mul_f32 v[144:145], v[228:229], v[228:229]
 v_pk_mul_f32 v[146:147], v[230:231], v[230:231]
 v_pk_fma_f32 v[136:137], v[136:137], v[128:129], v[128:129] op_sel:[0,1,0] op_sel_hi:[1,1,0]
 v_pk_fma_f32 v[138:139], v[138:139], v[128:129], v[128:129] op_sel:[0,1,0] op_sel_hi:[1,1,0]
 v_pk_fma_f32 v[144:145], v[144:145], v[128:129], v[128:129] op_sel:[0,1,0] op_sel_hi:[1,1,0]
 v_pk_fma_f32 v[146:147], v[146:147], v[128:129], v[128:129] op_sel:[0,1,0] op_sel_hi:[1,1,0]
 v_pk_mul_f32 v[136:137], v[136:137], v[196:197]
 v_pk_mul_f32 v[138:139], v[138:139], v[198:199]
 v_pk_mul_f32 v[144:145], v[144:145], v[228:229]
 v_pk_mul_f32 v[146:147], v[146:147], v[230:231]
 v_exp_f32 v136, v136
 v_exp_f32 v137, v137
 v_exp_f32 v138, v138
 v_exp_f32 v139, v139
 v_exp_f32 v144, v144
 v_exp_f32 v145, v145
 v_exp_f32 v146, v146
 v_exp_f32 v147, v147
 v_pk_add_f32 v[136:137], v[136:137], v[130:131] op_sel_hi:[1,0]
 v_pk_add_f32 v[138:139], v[138:139], v[130:131] op_sel_hi:[1,0]
 v_pk_add_f32 v[144:145], v[144:145], v[130:131] op_sel_hi:[1,0]
 v_pk_add_f32 v[146:147], v[146:147], v[130:131] op_sel_hi:[1,0]
 v_rcp_f32 v136, v136
 v_rcp_f32 v137, v137
 v_rcp_f32 v138, v138
 v_rcp_f32 v139, v139
 v_rcp_f32 v144, v144
 v_rcp_f32 v145, v145
 v_rcp_f32 v146, v146
 v_rcp_f32 v147, v147
 v_pk_mul_f32 v[136:137], v[136:137], v[196:197]
 v_pk_mul_f32 v[138:139], v[138:139], v[198:199]
 v_pk_mul_f32 v[144:145], v[144:145], v[228:229]
 v_pk_mul_f32 v[146:147], v[146:147], v[230:231]
 v_cvt_pk_bf16_f32 v196, v136, v137
 v_cvt_pk_bf16_f32 v197, v138, v139
 v_cvt_pk_bf16_f32 v198, v144, v145
 v_cvt_pk_bf16_f32 v199, v146, v147
 s_add_u32 s49, s66, 1024
 buffer_store_dwordx4 v[196:199], v1, s[4:7], s49 offen sc1
 v_pk_fma_f32 v[140:141], v[48:49], v[24:25], v[140:141] op_sel_hi:[1,0,1] neg_lo:[0,1,0] neg_hi:[0,1,0]
 v_pk_fma_f32 v[142:143], v[50:51], v[24:25], v[142:143] op_sel_hi:[1,0,1] neg_lo:[0,1,0] neg_hi:[0,1,0]
 v_pk_fma_f32 v[172:173], v[52:53], v[24:25], v[172:173] op_sel_hi:[1,0,1] neg_lo:[0,1,0] neg_hi:[0,1,0]
 v_pk_fma_f32 v[174:175], v[54:55], v[24:25], v[174:175] op_sel_hi:[1,0,1] neg_lo:[0,1,0] neg_hi:[0,1,0]
 v_pk_fma_f32 v[140:141], v[140:141], v[24:25], v[32:33] op_sel:[0,1,0] op_sel_hi:[1,1,1]
 v_pk_fma_f32 v[142:143], v[142:143], v[24:25], v[34:35] op_sel:[0,1,0] op_sel_hi:[1,1,1]
 v_pk_fma_f32 v[172:173], v[172:173], v[24:25], v[36:37] op_sel:[0,1,0] op_sel_hi:[1,1,1]
 v_pk_fma_f32 v[174:175], v[174:175], v[24:25], v[38:39] op_sel:[0,1,0] op_sel_hi:[1,1,1]
 v_pk_mul_f32 v[136:137], v[140:141], v[140:141]
 v_pk_mul_f32 v[138:139], v[142:143], v[142:143]
 v_pk_mul_f32 v[144:145], v[172:173], v[172:173]
 v_pk_mul_f32 v[146:147], v[174:175], v[174:175]
 v_pk_fma_f32 v[136:137], v[136:137], v[128:129], v[128:129] op_sel:[0,1,0] op_sel_hi:[1,1,0]
 v_pk_fma_f32 v[138:139], v[138:139], v[128:129], v[128:129] op_sel:[0,1,0] op_sel_hi:[1,1,0]
 v_pk_fma_f32 v[144:145], v[144:145], v[128:129], v[128:129] op_sel:[0,1,0] op_sel_hi:[1,1,0]
 v_pk_fma_f32 v[146:147], v[146:147], v[128:129], v[128:129] op_sel:[0,1,0] op_sel_hi:[1,1,0]
 v_pk_mul_f32 v[136:137], v[136:137], v[140:141]
 v_pk_mul_f32 v[138:139], v[138:139], v[142:143]
 v_pk_mul_f32 v[144:145], v[144:145], v[172:173]
 v_pk_mul_f32 v[146:147], v[146:147], v[174:175]
 v_exp_f32 v136, v136
 v_exp_f32 v137, v137
 v_exp_f32 v138, v138
 v_exp_f32 v139, v139
 v_exp_f32 v144, v144
 v_exp_f32 v145, v145
 v_exp_f32 v146, v146
 v_exp_f32 v147, v147
 v_pk_add_f32 v[136:137], v[136:137], v[130:131] op_sel_hi:[1,0]
 v_pk_add_f32 v[138:139], v[138:139], v[130:131] op_sel_hi:[1,0]
 v_pk_add_f32 v[144:145], v[144:145], v[130:131] op_sel_hi:[1,0]
 v_pk_add_f32 v[146:147], v[146:147], v[130:131] op_sel_hi:[1,0]
 v_rcp_f32 v136, v136
 v_rcp_f32 v137, v137
 v_rcp_f32 v138, v138
 v_rcp_f32 v139, v139
 v_rcp_f32 v144, v144
 v_rcp_f32 v145, v145
 v_rcp_f32 v146, v146
 v_rcp_f32 v147, v147
 v_pk_mul_f32 v[136:137], v[136:137], v[140:141]
 v_pk_mul_f32 v[138:139], v[138:139], v[142:143]
 v_pk_mul_f32 v[144:145], v[144:145], v[172:173]
 v_pk_mul_f32 v[146:147], v[146:147], v[174:175]
 v_cvt_pk_bf16_f32 v140, v136, v137
 v_cvt_pk_bf16_f32 v141, v138, v139
 v_cvt_pk_bf16_f32 v142, v144, v145
 v_cvt_pk_bf16_f32 v143, v146, v147
 s_add_u32 s49, s66, 745472
 buffer_store_dwordx4 v[140:143], v1, s[4:7], s49 offen sc1
 v_pk_fma_f32 v[204:205], v[56:57], v[24:25], v[204:205] op_sel_hi:[1,0,1] neg_lo:[0,1,0] neg_hi:[0,1,0]
 v_pk_fma_f32 v[206:207], v[58:59], v[24:25], v[206:207] op_sel_hi:[1,0,1] neg_lo:[0,1,0] neg_hi:[0,1,0]
 v_pk_fma_f32 v[236:237], v[60:61], v[24:25], v[236:237] op_sel_hi:[1,0,1] neg_lo:[0,1,0] neg_hi:[0,1,0]
 v_pk_fma_f32 v[238:239], v[62:63], v[24:25], v[238:239] op_sel_hi:[1,0,1] neg_lo:[0,1,0] neg_hi:[0,1,0]
 v_pk_fma_f32 v[204:205], v[204:205], v[24:25], v[40:41] op_sel:[0,1,0] op_sel_hi:[1,1,1]
 v_pk_fma_f32 v[206:207], v[206:207], v[24:25], v[42:43] op_sel:[0,1,0] op_sel_hi:[1,1,1]
 v_pk_fma_f32 v[236:237], v[236:237], v[24:25], v[44:45] op_sel:[0,1,0] op_sel_hi:[1,1,1]
 v_pk_fma_f32 v[238:239], v[238:239], v[24:25], v[46:47] op_sel:[0,1,0] op_sel_hi:[1,1,1]
 v_pk_mul_f32 v[136:137], v[204:205], v[204:205]
 v_pk_mul_f32 v[138:139], v[206:207], v[206:207]
 v_pk_mul_f32 v[144:145], v[236:237], v[236:237]
 v_pk_mul_f32 v[146:147], v[238:239], v[238:239]
 v_pk_fma_f32 v[136:137], v[136:137], v[128:129], v[128:129] op_sel:[0,1,0] op_sel_hi:[1,1,0]
 v_pk_fma_f32 v[138:139], v[138:139], v[128:129], v[128:129] op_sel:[0,1,0] op_sel_hi:[1,1,0]
 v_pk_fma_f32 v[144:145], v[144:145], v[128:129], v[128:129] op_sel:[0,1,0] op_sel_hi:[1,1,0]
 v_pk_fma_f32 v[146:147], v[146:147], v[128:129], v[128:129] op_sel:[0,1,0] op_sel_hi:[1,1,0]
 v_pk_mul_f32 v[136:137], v[136:137], v[204:205]
 v_pk_mul_f32 v[138:139], v[138:139], v[206:207]
 v_pk_mul_f32 v[144:145], v[144:145], v[236:237]
 v_pk_mul_f32 v[146:147], v[146:147], v[238:239]
 v_exp_f32 v136, v136
 v_exp_f32 v137, v137
 v_exp_f32 v138, v138
 v_exp_f32 v139, v139
 v_exp_f32 v144, v144
 v_exp_f32 v145, v145
 v_exp_f32 v146, v146
 v_exp_f32 v147, v147
 v_pk_add_f32 v[136:137], v[136:137], v[130:131] op_sel_hi:[1,0]
 v_pk_add_f32 v[138:139], v[138:139], v[130:131] op_sel_hi:[1,0]
 v_pk_add_f32 v[144:145], v[144:145], v[130:131] op_sel_hi:[1,0]
 v_pk_add_f32 v[146:147], v[146:147], v[130:131] op_sel_hi:[1,0]
 v_rcp_f32 v136, v136
 v_rcp_f32 v137, v137
 v_rcp_f32 v138, v138
 v_rcp_f32 v139, v139
 v_rcp_f32 v144, v144
 v_rcp_f32 v145, v145
 v_rcp_f32 v146, v146
 v_rcp_f32 v147, v147
 v_pk_mul_f32 v[136:137], v[136:137], v[204:205]
 v_pk_mul_f32 v[138:139], v[138:139], v[206:207]
 v_pk_mul_f32 v[144:145], v[144:145], v[236:237]
 v_pk_mul_f32 v[146:147], v[146:147], v[238:239]
 v_cvt_pk_bf16_f32 v204, v136, v137
 v_cvt_pk_bf16_f32 v205, v138, v139
 v_cvt_pk_bf16_f32 v206, v144, v145
 v_cvt_pk_bf16_f32 v207, v146, v147
 s_add_u32 s49, s66, 746496
 buffer_store_dwordx4 v[204:207], v1, s[4:7], s49 offen sc1
 v_pk_fma_f32 v[148:149], v[48:49], v[26:27], v[148:149] op_sel_hi:[1,0,1] neg_lo:[0,1,0] neg_hi:[0,1,0]
 v_pk_fma_f32 v[150:151], v[50:51], v[26:27], v[150:151] op_sel_hi:[1,0,1] neg_lo:[0,1,0] neg_hi:[0,1,0]
 v_pk_fma_f32 v[180:181], v[52:53], v[26:27], v[180:181] op_sel_hi:[1,0,1] neg_lo:[0,1,0] neg_hi:[0,1,0]
 v_pk_fma_f32 v[182:183], v[54:55], v[26:27], v[182:183] op_sel_hi:[1,0,1] neg_lo:[0,1,0] neg_hi:[0,1,0]
 v_pk_fma_f32 v[148:149], v[148:149], v[26:27], v[32:33] op_sel:[0,1,0] op_sel_hi:[1,1,1]
 v_pk_fma_f32 v[150:151], v[150:151], v[26:27], v[34:35] op_sel:[0,1,0] op_sel_hi:[1,1,1]
 v_pk_fma_f32 v[180:181], v[180:181], v[26:27], v[36:37] op_sel:[0,1,0] op_sel_hi:[1,1,1]
 v_pk_fma_f32 v[182:183], v[182:183], v[26:27], v[38:39] op_sel:[0,1,0] op_sel_hi:[1,1,1]
 v_pk_mul_f32 v[136:137], v[148:149], v[148:149]
 v_pk_mul_f32 v[138:139], v[150:151], v[150:151]
 v_pk_mul_f32 v[144:145], v[180:181], v[180:181]
 v_pk_mul_f32 v[146:147], v[182:183], v[182:183]
 v_pk_fma_f32 v[136:137], v[136:137], v[128:129], v[128:129] op_sel:[0,1,0] op_sel_hi:[1,1,0]
 v_pk_fma_f32 v[138:139], v[138:139], v[128:129], v[128:129] op_sel:[0,1,0] op_sel_hi:[1,1,0]
 v_pk_fma_f32 v[144:145], v[144:145], v[128:129], v[128:129] op_sel:[0,1,0] op_sel_hi:[1,1,0]
 v_pk_fma_f32 v[146:147], v[146:147], v[128:129], v[128:129] op_sel:[0,1,0] op_sel_hi:[1,1,0]
 v_pk_mul_f32 v[136:137], v[136:137], v[148:149]
 v_pk_mul_f32 v[138:139], v[138:139], v[150:151]
 v_pk_mul_f32 v[144:145], v[144:145], v[180:181]
 v_pk_mul_f32 v[146:147], v[146:147], v[182:183]
 v_exp_f32 v136, v136
 v_exp_f32 v137, v137
 v_exp_f32 v138, v138
 v_exp_f32 v139, v139
 v_exp_f32 v144, v144
 v_exp_f32 v145, v145
 v_exp_f32 v146, v146
 v_exp_f32 v147, v147
 v_pk_add_f32 v[136:137], v[136:137], v[130:131] op_sel_hi:[1,0]
 v_pk_add_f32 v[138:139], v[138:139], v[130:131] op_sel_hi:[1,0]
 v_pk_add_f32 v[144:145], v[144:145], v[130:131] op_sel_hi:[1,0]
 v_pk_add_f32 v[146:147], v[146:147], v[130:131] op_sel_hi:[1,0]
 v_rcp_f32 v136, v136
 v_rcp_f32 v137, v137
 v_rcp_f32 v138, v138
 v_rcp_f32 v139, v139
 v_rcp_f32 v144, v144
 v_rcp_f32 v145, v145
 v_rcp_f32 v146, v146
 v_rcp_f32 v147, v147
 v_pk_mul_f32 v[136:137], v[136:137], v[148:149]
 v_pk_mul_f32 v[138:139], v[138:139], v[150:151]
 v_pk_mul_f32 v[144:145], v[144:145], v[180:181]
 v_pk_mul_f32 v[146:147], v[146:147], v[182:183]
 v_cvt_pk_bf16_f32 v148, v136, v137
 v_cvt_pk_bf16_f32 v149, v138, v139
 v_cvt_pk_bf16_f32 v150, v144, v145
 v_cvt_pk_bf16_f32 v151, v146, v147
 s_add_u32 s49, s54, 0
 buffer_store_dwordx4 v[148:151], v1, s[4:7], s49 offen sc1
 v_pk_fma_f32 v[212:213], v[56:57], v[26:27], v[212:213] op_sel_hi:[1,0,1] neg_lo:[0,1,0] neg_hi:[0,1,0]
 v_pk_fma_f32 v[214:215], v[58:59], v[26:27], v[214:215] op_sel_hi:[1,0,1] neg_lo:[0,1,0] neg_hi:[0,1,0]
 v_pk_fma_f32 v[244:245], v[60:61], v[26:27], v[244:245] op_sel_hi:[1,0,1] neg_lo:[0,1,0] neg_hi:[0,1,0]
 v_pk_fma_f32 v[246:247], v[62:63], v[26:27], v[246:247] op_sel_hi:[1,0,1] neg_lo:[0,1,0] neg_hi:[0,1,0]
 v_pk_fma_f32 v[212:213], v[212:213], v[26:27], v[40:41] op_sel:[0,1,0] op_sel_hi:[1,1,1]
 v_pk_fma_f32 v[214:215], v[214:215], v[26:27], v[42:43] op_sel:[0,1,0] op_sel_hi:[1,1,1]
 v_pk_fma_f32 v[244:245], v[244:245], v[26:27], v[44:45] op_sel:[0,1,0] op_sel_hi:[1,1,1]
 v_pk_fma_f32 v[246:247], v[246:247], v[26:27], v[46:47] op_sel:[0,1,0] op_sel_hi:[1,1,1]
 v_pk_mul_f32 v[136:137], v[212:213], v[212:213]
 v_pk_mul_f32 v[138:139], v[214:215], v[214:215]
 v_pk_mul_f32 v[144:145], v[244:245], v[244:245]
 v_pk_mul_f32 v[146:147], v[246:247], v[246:247]
 v_pk_fma_f32 v[136:137], v[136:137], v[128:129], v[128:129] op_sel:[0,1,0] op_sel_hi:[1,1,0]
 v_pk_fma_f32 v[138:139], v[138:139], v[128:129], v[128:129] op_sel:[0,1,0] op_sel_hi:[1,1,0]
 v_pk_fma_f32 v[144:145], v[144:145], v[128:129], v[128:129] op_sel:[0,1,0] op_sel_hi:[1,1,0]
 v_pk_fma_f32 v[146:147], v[146:147], v[128:129], v[128:129] op_sel:[0,1,0] op_sel_hi:[1,1,0]
 v_pk_mul_f32 v[136:137], v[136:137], v[212:213]
 v_pk_mul_f32 v[138:139], v[138:139], v[214:215]
 v_pk_mul_f32 v[144:145], v[144:145], v[244:245]
 v_pk_mul_f32 v[146:147], v[146:147], v[246:247]
 v_exp_f32 v136, v136
 v_exp_f32 v137, v137
 v_exp_f32 v138, v138
 v_exp_f32 v139, v139
 v_exp_f32 v144, v144
 v_exp_f32 v145, v145
 v_exp_f32 v146, v146
 v_exp_f32 v147, v147
 v_pk_add_f32 v[136:137], v[136:137], v[130:131] op_sel_hi:[1,0]
 v_pk_add_f32 v[138:139], v[138:139], v[130:131] op_sel_hi:[1,0]
 v_pk_add_f32 v[144:145], v[144:145], v[130:131] op_sel_hi:[1,0]
 v_pk_add_f32 v[146:147], v[146:147], v[130:131] op_sel_hi:[1,0]
 v_rcp_f32 v136, v136
 v_rcp_f32 v137, v137
 v_rcp_f32 v138, v138
 v_rcp_f32 v139, v139
 v_rcp_f32 v144, v144
 v_rcp_f32 v145, v145
 v_rcp_f32 v146, v146
 v_rcp_f32 v147, v147
 v_pk_mul_f32 v[136:137], v[136:137], v[212:213]
 v_pk_mul_f32 v[138:139], v[138:139], v[214:215]
 v_pk_mul_f32 v[144:145], v[144:145], v[244:245]
 v_pk_mul_f32 v[146:147], v[146:147], v[246:247]
 v_cvt_pk_bf16_f32 v212, v136, v137
 v_cvt_pk_bf16_f32 v213, v138, v139
 v_cvt_pk_bf16_f32 v214, v144, v145
 v_cvt_pk_bf16_f32 v215, v146, v147
 s_add_u32 s49, s54, 1024
 buffer_store_dwordx4 v[212:215], v1, s[4:7], s49 offen sc1
 v_pk_fma_f32 v[156:157], v[48:49], v[28:29], v[156:157] op_sel_hi:[1,0,1] neg_lo:[0,1,0] neg_hi:[0,1,0]
 v_pk_fma_f32 v[158:159], v[50:51], v[28:29], v[158:159] op_sel_hi:[1,0,1] neg_lo:[0,1,0] neg_hi:[0,1,0]
 v_pk_fma_f32 v[188:189], v[52:53], v[28:29], v[188:189] op_sel_hi:[1,0,1] neg_lo:[0,1,0] neg_hi:[0,1,0]
 v_pk_fma_f32 v[190:191], v[54:55], v[28:29], v[190:191] op_sel_hi:[1,0,1] neg_lo:[0,1,0] neg_hi:[0,1,0]
 v_pk_fma_f32 v[156:157], v[156:157], v[28:29], v[32:33] op_sel:[0,1,0] op_sel_hi:[1,1,1]
 v_pk_fma_f32 v[158:159], v[158:159], v[28:29], v[34:35] op_sel:[0,1,0] op_sel_hi:[1,1,1]
 v_pk_fma_f32 v[188:189], v[188:189], v[28:29], v[36:37] op_sel:[0,1,0] op_sel_hi:[1,1,1]
 v_pk_fma_f32 v[190:191], v[190:191], v[28:29], v[38:39] op_sel:[0,1,0] op_sel_hi:[1,1,1]
 v_pk_mul_f32 v[136:137], v[156:157], v[156:157]
 v_pk_mul_f32 v[138:139], v[158:159], v[158:159]
 v_pk_mul_f32 v[144:145], v[188:189], v[188:189]
 v_pk_mul_f32 v[146:147], v[190:191], v[190:191]
 v_pk_fma_f32 v[136:137], v[136:137], v[128:129], v[128:129] op_sel:[0,1,0] op_sel_hi:[1,1,0]
 v_pk_fma_f32 v[138:139], v[138:139], v[128:129], v[128:129] op_sel:[0,1,0] op_sel_hi:[1,1,0]
 v_pk_fma_f32 v[144:145], v[144:145], v[128:129], v[128:129] op_sel:[0,1,0] op_sel_hi:[1,1,0]
 v_pk_fma_f32 v[146:147], v[146:147], v[128:129], v[128:129] op_sel:[0,1,0] op_sel_hi:[1,1,0]
 v_pk_mul_f32 v[136:137], v[136:137], v[156:157]
 v_pk_mul_f32 v[138:139], v[138:139], v[158:159]
 v_pk_mul_f32 v[144:145], v[144:145], v[188:189]
 v_pk_mul_f32 v[146:147], v[146:147], v[190:191]
 v_exp_f32 v136, v136
 v_exp_f32 v137, v137
 v_exp_f32 v138, v138
 v_exp_f32 v139, v139
 v_exp_f32 v144, v144
 v_exp_f32 v145, v145
 v_exp_f32 v146, v146
 v_exp_f32 v147, v147
 v_pk_add_f32 v[136:137], v[136:137], v[130:131] op_sel_hi:[1,0]
 v_pk_add_f32 v[138:139], v[138:139], v[130:131] op_sel_hi:[1,0]
 v_pk_add_f32 v[144:145], v[144:145], v[130:131] op_sel_hi:[1,0]
 v_pk_add_f32 v[146:147], v[146:147], v[130:131] op_sel_hi:[1,0]
 v_rcp_f32 v136, v136
 v_rcp_f32 v137, v137
 v_rcp_f32 v138, v138
 v_rcp_f32 v139, v139
 v_rcp_f32 v144, v144
 v_rcp_f32 v145, v145
 v_rcp_f32 v146, v146
 v_rcp_f32 v147, v147
 v_pk_mul_f32 v[136:137], v[136:137], v[156:157]
 v_pk_mul_f32 v[138:139], v[138:139], v[158:159]
 v_pk_mul_f32 v[144:145], v[144:145], v[188:189]
 v_pk_mul_f32 v[146:147], v[146:147], v[190:191]
 v_cvt_pk_bf16_f32 v156, v136, v137
 v_cvt_pk_bf16_f32 v157, v138, v139
 v_cvt_pk_bf16_f32 v158, v144, v145
 v_cvt_pk_bf16_f32 v159, v146, v147
 s_add_u32 s49, s54, 745472
 buffer_store_dwordx4 v[156:159], v1, s[4:7], s49 offen sc1
 v_pk_fma_f32 v[220:221], v[56:57], v[28:29], v[220:221] op_sel_hi:[1,0,1] neg_lo:[0,1,0] neg_hi:[0,1,0]
 v_pk_fma_f32 v[222:223], v[58:59], v[28:29], v[222:223] op_sel_hi:[1,0,1] neg_lo:[0,1,0] neg_hi:[0,1,0]
 v_pk_fma_f32 v[252:253], v[60:61], v[28:29], v[252:253] op_sel_hi:[1,0,1] neg_lo:[0,1,0] neg_hi:[0,1,0]
 v_pk_fma_f32 v[254:255], v[62:63], v[28:29], v[254:255] op_sel_hi:[1,0,1] neg_lo:[0,1,0] neg_hi:[0,1,0]
 v_pk_fma_f32 v[220:221], v[220:221], v[28:29], v[40:41] op_sel:[0,1,0] op_sel_hi:[1,1,1]
 v_pk_fma_f32 v[222:223], v[222:223], v[28:29], v[42:43] op_sel:[0,1,0] op_sel_hi:[1,1,1]
 v_pk_fma_f32 v[252:253], v[252:253], v[28:29], v[44:45] op_sel:[0,1,0] op_sel_hi:[1,1,1]
 v_pk_fma_f32 v[254:255], v[254:255], v[28:29], v[46:47] op_sel:[0,1,0] op_sel_hi:[1,1,1]
 v_pk_mul_f32 v[136:137], v[220:221], v[220:221]
 v_pk_mul_f32 v[138:139], v[222:223], v[222:223]
 v_pk_mul_f32 v[144:145], v[252:253], v[252:253]
 v_pk_mul_f32 v[146:147], v[254:255], v[254:255]
 v_pk_fma_f32 v[136:137], v[136:137], v[128:129], v[128:129] op_sel:[0,1,0] op_sel_hi:[1,1,0]
 v_pk_fma_f32 v[138:139], v[138:139], v[128:129], v[128:129] op_sel:[0,1,0] op_sel_hi:[1,1,0]
 v_pk_fma_f32 v[144:145], v[144:145], v[128:129], v[128:129] op_sel:[0,1,0] op_sel_hi:[1,1,0]
 v_pk_fma_f32 v[146:147], v[146:147], v[128:129], v[128:129] op_sel:[0,1,0] op_sel_hi:[1,1,0]
 v_pk_mul_f32 v[136:137], v[136:137], v[220:221]
 v_pk_mul_f32 v[138:139], v[138:139], v[222:223]
 v_pk_mul_f32 v[144:145], v[144:145], v[252:253]
 v_pk_mul_f32 v[146:147], v[146:147], v[254:255]
 v_exp_f32 v136, v136
 v_exp_f32 v137, v137
 v_exp_f32 v138, v138
 v_exp_f32 v139, v139
 v_exp_f32 v144, v144
 v_exp_f32 v145, v145
 v_exp_f32 v146, v146
 v_exp_f32 v147, v147
 v_pk_add_f32 v[136:137], v[136:137], v[130:131] op_sel_hi:[1,0]
 v_pk_add_f32 v[138:139], v[138:139], v[130:131] op_sel_hi:[1,0]
 v_pk_add_f32 v[144:145], v[144:145], v[130:131] op_sel_hi:[1,0]
 v_pk_add_f32 v[146:147], v[146:147], v[130:131] op_sel_hi:[1,0]
 v_rcp_f32 v136, v136
 v_rcp_f32 v137, v137
 v_rcp_f32 v138, v138
 v_rcp_f32 v139, v139
 v_rcp_f32 v144, v144
 v_rcp_f32 v145, v145
 v_rcp_f32 v146, v146
 v_rcp_f32 v147, v147
 v_pk_mul_f32 v[136:137], v[136:137], v[220:221]
 v_pk_mul_f32 v[138:139], v[138:139], v[222:223]
 v_pk_mul_f32 v[144:145], v[144:145], v[252:253]
 v_pk_mul_f32 v[146:147], v[146:147], v[254:255]
 v_cvt_pk_bf16_f32 v220, v136, v137
 v_cvt_pk_bf16_f32 v221, v138, v139
 v_cvt_pk_bf16_f32 v222, v144, v145
 v_cvt_pk_bf16_f32 v223, v146, v147
 s_add_u32 s49, s54, 746496
 buffer_store_dwordx4 v[220:223], v1, s[4:7], s49 offen sc1
 s_branch L_hdone
L_nogelu:
 s_add_u32 s49, s66, 0
 buffer_store_dwordx4 v[132:135], v1, s[4:7], s49 offen sc1
 s_add_u32 s49, s66, 1024
 buffer_store_dwordx4 v[196:199], v1, s[4:7], s49 offen sc1
 s_add_u32 s49, s66, 745472
 buffer_store_dwordx4 v[140:143], v1, s[4:7], s49 offen sc1
 s_add_u32 s49, s66, 746496
 buffer_store_dwordx4 v[204:207], v1, s[4:7], s49 offen sc1
 s_add_u32 s49, s54, 0
 buffer_store_dwordx4 v[148:151], v1, s[4:7], s49 offen sc1
 s_add_u32 s49, s54, 1024
 buffer_store_dwordx4 v[212:215], v1, s[4:7], s49 offen sc1
 s_add_u32 s49, s54, 745472
 buffer_store_dwordx4 v[156:159], v1, s[4:7], s49 offen sc1
 s_add_u32 s49, s54, 746496
 buffer_store_dwordx4 v[220:223], v1, s[4:7], s49 offen sc1
L_hdone:
 s_mov_b32 s39, 0
 s_mov_b32 s26, s51
 s_mov_b32 s64, s3
L_pro:
 v_add_u32 v5, 131072, v1
 v_add_u32 v6, 0xc000, v1
 s_mov_b32 s61, 0
 s_waitcnt vmcnt(18)
 s_barrier
 ds_read_b128 a[128:131], v5
 ds_read_b128 a[132:135], v5 offset:1024
 ds_read_b128 a[136:139], v5 offset:2048
 ds_read_b128 a[140:143], v5 offset:3072
 ds_read_b128 a[144:147], v5 offset:4096
 ds_read_b128 a[148:151], v5 offset:5120
 ds_read_b128 a[152:155], v5 offset:6144
 ds_read_b128 a[156:159], v5 offset:7168
 v_and_b32 v20, 15, v0
 v_lshrrev_b32 v21, 4, v0
 v_lshlrev_b32 v21, 2, v21
 v_sub_u32 v20, v20, v21
 s_lshl_b32 s49, s44, 4
 v_add_u32 v20, s49, v20
 v_mov_b32 v21, 0xff800000
 v_mov_b32 v240, 0
 v_mov_b32 v241, 0
 v_mov_b32 v242, 0
 v_mov_b32 v243, 0
 v_mov_b32 v244, 0xf149f2ca
 v_mov_b32 v9, s100
 v_mov_b32 v8, 0x5d800000
 v_mov_b32 v16, 0x3f803f80
 v_mov_b32 v17, 0x3f803f80
 v_mov_b32 v18, 0x3f803f80
 v_mov_b32 v19, 0x3f803f80
 v_cmp_gt_i32 s[16:17], 0, v20
 v_cmp_gt_i32 s[18:19], 1, v20
 v_cmp_gt_i32 vcc, 2, v20
 v_cndmask_b32 v224, 0, v21, s[16:17]
 v_cndmask_b32 v225, 0, v21, s[18:19]
 v_cndmask_b32 v226, 0, v21, vcc
 v_cmp_gt_i32 s[16:17], 3, v20
 v_cmp_gt_i32 s[18:19], 16, v20
 v_cmp_gt_i32 vcc, 17, v20
 v_cndmask_b32 v227, 0, v21, s[16:17]
 s_waitcnt lgkmcnt(7)
 v_mfma_f32_16x16x32_bf16 v[128:131], a[128:131], v[64:67], 0
 v_cndmask_b32 v228, 0, v21, s[18:19]
 v_cndmask_b32 v229, 0, v21, vcc
 s_waitcnt lgkmcnt(6)
 v_mfma_f32_16x16x32_bf16 v[128:131], a[132:135], v[68:71], v[128:131]
 ds_read_b128 a[160:163], v5 offset:8192
 v_cmp_gt_i32 s[16:17], 18, v20
 s_waitcnt lgkmcnt(6)
 v_mfma_f32_16x16x32_bf16 v[128:131], a[136:139], v[72:75], v[128:131]
 v_cmp_gt_i32 s[18:19], 19, v20
 v_cmp_gt_i32 vcc, 32, v20
 s_waitcnt lgkmcnt(5)
 v_mfma_f32_16x16x32_bf16 v[128:131], a[140:143], v[76:79], v[128:131]
 v_cndmask_b32 v230, 0, v21, s[16:17]
 v_mfma_f32_16x16x32_bf16 v[136:139], a[128:131], v[80:83], 0
 ds_read_b128 a[164:167], v5 offset:9216
 v_cndmask_b32 v231, 0, v21, s[18:19]
 v_mfma_f32_16x16x32_bf16 v[136:139], a[132:135], v[84:87], v[136:139]
 v_cndmask_b32 v232, 0, v21, vcc
 v_cmp_gt_i32 s[16:17], 33, v20
 v_mfma_f32_16x16x32_bf16 v[136:139], a[136:139], v[88:91], v[136:139]
 v_cmp_gt_i32 s[18:19], 34, v20
 v_mfma_f32_16x16x32_bf16 v[136:139], a[140:143], v[92:95], v[136:139]
 ds_read_b128 a[168:171], v5 offset:10240
 v_cmp_gt_i32 vcc, 35, v20
 v_mfma_f32_16x16x32_bf16 v[144:147], a[128:131], v[96:99], 0
 v_cndmask_b32 v233, 0, v21, s[16:17]
 v_cndmask_b32 v234, 0, v21, s[18:19]
 v_mfma_f32_16x16x32_bf16 v[144:147], a[132:135], v[100:103], v[144:147]
 v_cndmask_b32 v235, 0, v21, vcc
 v_mfma_f32_16x16x32_bf16 v[144:147], a[136:139], v[104:107], v[144:147]
 ds_read_b128 a[172:175], v5 offset:11264
 v_cmp_gt_i32 s[16:17], 48, v20
 v_mfma_f32_16x16x32_bf16 v[144:147], a[140:143], v[108:111], v[144:147]
 v_cmp_gt_i32 s[18:19], 49, v20
 v_cmp_gt_i32 vcc, 50, v20
 v_mfma_f32_16x16x32_bf16 v[152:155], a[128:131], v[112:115], 0
 v_cndmask_b32 v236, 0, v21, s[16:17]
 v_mfma_f32_16x16x32_bf16 v[152:155], a[132:135], v[116:119], v[152:155]
 ds_read_b128 a[176:179], v5 offset:12288
 v_cndmask_b32 v237, 0, v21, s[18:19]
 v_mfma_f32_16x16x32_bf16 v[152:155], a[136:139], v[120:123], v[152:155]
 v_cndmask_b32 v238, 0, v21, vcc
 v_cmp_gt_i32 s[16:17], 51, v20
 v_mfma_f32_16x16x32_bf16 v[152:155], a[140:143], v[124:127], v[152:155]
 s_nop 0
 v_cndmask_b32 v239, 0, v21, s[16:17]
 s_waitcnt lgkmcnt(8)
 v_mfma_f32_16x16x32_bf16 v[132:135], a[144:147], v[64:67], 0
 ds_read_b128 a[180:183], v5 offset:13312
 s_lshl_b32 s49, s47, 2
 s_add_u32 s49, s49, s44
 s_waitcnt lgkmcnt(8)
 v_mfma_f32_16x16x32_bf16 v[132:135], a[148:151], v[68:71], v[132:135]
 s_sub_u32 s50, s49, 82
 s_waitcnt lgkmcnt(7)
 v_mfma_f32_16x16x32_bf16 v[132:135], a[152:155], v[72:75], v[132:135]
 s_cmp_lt_u32 s49, 82
 s_waitcnt lgkmcnt(6)
 v_mfma_f32_16x16x32_bf16 v[132:135], a[156:159], v[76:79], v[132:135]
 ds_read_b128 a[184:187], v5 offset:14336
 s_cselect_b32 s40, s8, s12
 s_cselect_b32 s41, s9, s13
 v_mfma_f32_16x16x32_bf16 v[140:143], a[144:147], v[80:83], 0
 s_cselect_b32 s42, s10, s14
 v_mfma_f32_16x16x32_bf16 v[140:143], a[148:151], v[84:87], v[140:143]
 s_cselect_b32 s49, s49, s50
 v_mfma_f32_16x16x32_bf16 v[140:143], a[152:155], v[88:91], v[140:143]
 ds_read_b128 a[188:191], v5 offset:15360
 s_mov_b32 s43, 0x20000
 s_mul_i32 s37, s49, 56
 v_mfma_f32_16x16x32_bf16 v[140:143], a[156:159], v[92:95], v[140:143]
 s_mul_i32 s49, s48, s48
 v_mfma_f32_16x16x32_bf16 v[148:151], a[144:147], v[96:99], 0
 s_sub_u32 s49, s49, s48
 v_mfma_f32_16x16x32_bf16 v[148:151], a[148:151], v[100:103], v[148:151]
 s_add_u32 s37, s37, s49
 s_mul_i32 s37, s37, 1152
 v_mfma_f32_16x16x32_bf16 v[148:151], a[152:155], v[104:107], v[148:151]
 v_min_u32 v15, 8, v0
 v_mfma_f32_16x16x32_bf16 v[148:151], a[156:159], v[108:111], v[148:151]
 v_lshlrev_b32 v15, 7, v15
 v_mfma_f32_16x16x32_bf16 v[156:159], a[144:147], v[112:115], 0
 v_mfma_f32_16x16x32_bf16 v[156:159], a[148:151], v[116:119], v[156:159]
 v_mfma_f32_16x16x32_bf16 v[156:159], a[152:155], v[120:123], v[156:159]
 v_mfma_f32_16x16x32_bf16 v[156:159], a[156:159], v[124:127], v[156:159]
 s_nop 7
 v_max_f32 v20, v148, v156
 s_cmp_lg_u32 s48, 0
 s_cbranch_scc1 L_nopat
 v_add_f32 v144, v144, v224
 v_add_f32 v145, v145, v225
 v_add_f32 v146, v146, v226
 v_add_f32 v147, v147, v227
 v_add_f32 v148, v148, v228
 v_add_f32 v149, v149, v229
 v_add_f32 v150, v150, v230
 v_add_f32 v151, v151, v231
L_nopat:
 s_cmp_lg_u32 s39, 0
 s_cbranch_scc1 L_A
 v_max3_f32 v2, v244, v128, v129
 v_max3_f32 v3, v244, v136, v137
 v_max3_f32 v10, v244, v144, v145
 v_max3_f32 v11, v244, v152, v153
 v_max3_f32 v2, v2, v130, v131
 v_max3_f32 v3, v3, v138, v139
 v_max3_f32 v10, v10, v146, v147
 v_max3_f32 v11, v11, v154, v155
 v_max3_f32 v2, v2, v132, v133
 v_max3_f32 v3, v3, v140, v141
 v_max3_f32 v10, v10, v148, v149
 v_max3_f32 v11, v11, v156, v157
 v_max3_f32 v2, v2, v134, v135
 v_max3_f32 v3, v3, v142, v143
 v_max3_f32 v10, v10, v150, v151
 v_max3_f32 v11, v11, v158, v159
 v_mov_b32 v20, v2
 v_mov_b32 v21, v3
 v_mov_b32 v22, v10
 v_mov_b32 v23, v11
 v_permlane16_swap_b32 v20, v2
 v_permlane16_swap_b32 v21, v3
 v_permlane16_swap_b32 v22, v10
 v_permlane16_swap_b32 v23, v11
 v_max_f32 v2, v2, v20
 v_max_f32 v3, v3, v21
 v_max_f32 v10, v10, v22
 v_max_f32 v11, v11, v23
 v_mov_b32 v20, v2
 v_mov_b32 v21, v3
 v_mov_b32 v22, v10
 v_mov_b32 v23, v11
 v_permlane32_swap_b32 v20, v2
 v_permlane32_swap_b32 v21, v3
 v_permlane32_swap_b32 v22, v10
 v_permlane32_swap_b32 v23, v11
 v_max_f32 v2, v2, v20
 v_max_f32 v3, v3, v21
 v_max_f32 v10, v10, v22
 v_max_f32 v11, v11, v23
 v_sub_f32 v32, 0, v2
 v_sub_f32 v33, 0, v2
 v_sub_f32 v34, 0, v2
 v_sub_f32 v35, 0, v2
 v_sub_f32 v36, 0, v3
 v_sub_f32 v37, 0, v3
 v_sub_f32 v38, 0, v3
 v_sub_f32 v39, 0, v3
 v_sub_f32 v40, 0, v10
 v_sub_f32 v41, 0, v10
 v_sub_f32 v42, 0, v10
 v_sub_f32 v43, 0, v10
 v_sub_f32 v44, 0, v11
 v_sub_f32 v45, 0, v11
 v_sub_f32 v46, 0, v11
 v_sub_f32 v47, 0, v11
L_A:
 s_waitcnt lgkmcnt(7)
 v_mfma_f32_16x16x32_bf16 v[160:163], a[160:163], v[64:67], v[32:35]
 s_waitcnt lgkmcnt(3)
 s_waitcnt vmcnt(10)
 s_barrier
 v_mfma_f32_16x16x32_bf16 v[160:163], a[164:167], v[68:71], v[160:163]
 v_add_u32 v6, 0x4000, v6
 v_and_b32 v6, 0xffff, v6
 ds_read_b128 a[128:131], v6
 v_sub_f32 v128, v128, v2
 v_mfma_f32_16x16x32_bf16 v[160:163], a[168:171], v[72:75], v[160:163]
 s_add_u32 m0, s57, 0
 v_exp_f32 v128, v128
 v_sub_f32 v129, v129, v2
 v_mfma_f32_16x16x32_bf16 v[160:163], a[172:175], v[76:79], v[160:163]
 v_exp_f32 v129, v129
 v_sub_f32 v130, v130, v2
 v_mfma_f32_16x16x32_bf16 v[168:171], a[160:163], v[80:83], v[36:39]
 v_exp_f32 v130, v130
 v_sub_f32 v131, v131, v2
 v_cvt_pk_bf16_f32 v192, v128, v129
 v_mfma_f32_16x16x32_bf16 v[168:171], a[164:167], v[84:87], v[168:171]
 ds_read_b128 a[132:135], v6 offset:1024
 v_exp_f32 v131, v131
 v_sub_f32 v132, v132, v2
 v_mfma_f32_16x16x32_bf16 v[168:171], a[168:171], v[88:91], v[168:171]
 v_exp_f32 v132, v132
 v_sub_f32 v133, v133, v2
 v_cvt_pk_bf16_f32 v193, v130, v131
 v_mfma_f32_16x16x32_bf16 v[168:171], a[172:175], v[92:95], v[168:171]
 buffer_load_dwordx4 v1, s[4:7], s52 offen sc1 lds
 v_exp_f32 v133, v133
 v_mfma_f32_16x16x32_bf16 v[176:179], a[160:163], v[96:99], v[40:43]
 v_sub_f32 v134, v134, v2
 v_exp_f32 v134, v134
 v_sub_f32 v135, v135, v2
 v_mfma_f32_16x16x32_bf16 v[176:179], a[164:167], v[100:103], v[176:179]
 v_cvt_pk_bf16_f32 v194, v132, v133
 v_exp_f32 v135, v135
 v_mfma_f32_16x16x32_bf16 v[176:179], a[168:171], v[104:107], v[176:179]
 ds_read_b128 a[136:139], v6 offset:2048
 v_sub_f32 v136, v136, v3
 v_exp_f32 v136, v136
 v_mfma_f32_16x16x32_bf16 v[176:179], a[172:175], v[108:111], v[176:179]
 v_sub_f32 v137, v137, v3
 v_cvt_pk_bf16_f32 v195, v134, v135
 v_mfma_f32_16x16x32_bf16 v[184:187], a[160:163], v[112:115], v[44:47]
 v_exp_f32 v137, v137
 v_sub_f32 v138, v138, v3
 v_mfma_f32_16x16x32_bf16 v[184:187], a[164:167], v[116:119], v[184:187]
 v_exp_f32 v138, v138
 v_sub_f32 v139, v139, v3
 v_mfma_f32_16x16x32_bf16 v[184:187], a[168:171], v[120:123], v[184:187]
 buffer_load_dwordx4 v1, s[4:7], s52 offen offset:1024 sc1 lds
 v_cvt_pk_bf16_f32 v196, v136, v137
 v_mfma_f32_16x16x32_bf16 v[184:187], a[172:175], v[124:127], v[184:187]
 ds_read_b128 a[140:143], v6 offset:3072
 v_exp_f32 v139, v139
 v_sub_f32 v140, v140, v3
 v_mfma_f32_16x16x32_bf16 v[164:167], a[176:179], v[64:67], v[32:35]
 s_waitcnt lgkmcnt(3)
 v_exp_f32 v140, v140
 v_sub_f32 v141, v141, v3
 v_cvt_pk_bf16_f32 v197, v138, v139
 v_mfma_f32_16x16x32_bf16 v[164:167], a[180:183], v[68:71], v[164:167]
 v_exp_f32 v141, v141
 v_sub_f32 v142, v142, v3
 v_mfma_f32_16x16x32_bf16 v[164:167], a[184:187], v[72:75], v[164:167]
 v_exp_f32 v142, v142
 v_sub_f32 v143, v143, v3
 v_mfma_f32_16x16x32_bf16 v[164:167], a[188:191], v[76:79], v[164:167]
 v_cvt_pk_bf16_f32 v198, v140, v141
 v_exp_f32 v143, v143
 v_mfma_f32_16x16x32_bf16 v[172:175], a[176:179], v[80:83], v[36:39]
 ds_read_b128 a[144:147], v6 offset:4096
 v_sub_f32 v144, v144, v10
 v_exp_f32 v144, v144
 s_add_u32 m0, s58, 0
 v_sub_f32 v145, v145, v10
 v_mfma_f32_16x16x32_bf16 v[172:175], a[180:183], v[84:87], v[172:175]
 v_cvt_pk_bf16_f32 v199, v142, v143
 v_exp_f32 v145, v145
 v_mfma_f32_16x16x32_bf16 v[172:175], a[184:187], v[88:91], v[172:175]
 v_sub_f32 v146, v146, v10
 v_exp_f32 v146, v146
 v_mfma_f32_16x16x32_bf16 v[172:175], a[188:191], v[92:95], v[172:175]
 v_sub_f32 v147, v147, v10
 v_cvt_pk_bf16_f32 v200, v144, v145
 v_mfma_f32_16x16x32_bf16 v[180:183], a[176:179], v[96:99], v[40:43]
 v_exp_f32 v147, v147
 v_sub_f32 v148, v148, v10
 v_mfma_f32_16x16x32_bf16 v[180:183], a[180:183], v[100:103], v[180:183]
 ds_read_b128 a[148:151], v6 offset:5120
 v_exp_f32 v148, v148
 v_sub_f32 v149, v149, v10
 v_mfma_f32_16x16x32_bf16 v[180:183], a[184:187], v[104:107], v[180:183]
 v_cvt_pk_bf16_f32 v201, v146, v147
 v_exp_f32 v149, v149
 v_mfma_f32_16x16x32_bf16 v[180:183], a[188:191], v[108:111], v[180:183]
 buffer_load_dwordx4 v13, s[4:7], s52 offen sc1 lds
 v_sub_f32 v150, v150, v10
 v_mfma_f32_16x16x32_bf16 v[188:191], a[176:179], v[112:115], v[44:47]
 v_exp_f32 v150, v150
 v_sub_f32 v151, v151, v10
 v_cvt_pk_bf16_f32 v202, v148, v149
 v_mfma_f32_16x16x32_bf16 v[188:191], a[180:183], v[116:119], v[188:191]
 v_exp_f32 v151, v151
 v_sub_f32 v152, v152, v11
 v_mfma_f32_16x16x32_bf16 v[188:191], a[184:187], v[120:123], v[188:191]
 ds_read_b128 a[152:155], v6 offset:6144
 v_exp_f32 v152, v152
 v_sub_f32 v153, v153, v11
 v_mfma_f32_16x16x32_bf16 v[188:191], a[188:191], v[124:127], v[188:191]
 v_cvt_pk_bf16_f32 v203, v150, v151
 v_exp_f32 v153, v153
 v_mfma_f32_32x32x16_bf16 v[48:63], v[240:243], v[240:243], 0
 v_sub_f32 v154, v154, v11
 v_exp_f32 v154, v154
 v_mfma_f32_32x32x16_bf16 a[0:15], v[240:243], v[240:243], 0
 buffer_load_dwordx4 v13, s[4:7], s52 offen offset:1024 sc1 lds
 v_sub_f32 v155, v155, v11
 v_cvt_pk_bf16_f32 v204, v152, v153
 v_mfma_f32_32x32x16_bf16 a[16:31], v[240:243], v[240:243], 0
 v_exp_f32 v155, v155
 v_sub_f32 v156, v156, v11
 v_mfma_f32_32x32x16_bf16 a[32:47], v[240:243], v[240:243], 0
 ds_read_b128 a[156:159], v6 offset:7168
 v_exp_f32 v156, v156
 v_sub_f32 v157, v157, v11
 v_mfma_f32_32x32x16_bf16 a[48:63], v[240:243], v[240:243], 0
 v_cvt_pk_bf16_f32 v205, v154, v155
 v_exp_f32 v157, v157
 v_mfma_f32_32x32x16_bf16 a[64:79], v[240:243], v[240:243], 0
 v_sub_f32 v158, v158, v11
 v_exp_f32 v158, v158
 v_mfma_f32_32x32x16_bf16 a[80:95], v[240:243], v[240:243], 0
 v_sub_f32 v159, v159, v11
 v_cvt_pk_bf16_f32 v206, v156, v157
 v_mfma_f32_32x32x16_bf16 a[96:111], v[240:243], v[240:243], 0
 v_exp_f32 v159, v159
 s_nop 0
 v_cvt_pk_bf16_f32 v207, v158, v159
 v_mfma_f32_32x32x16_bf16 a[112:127], v[240:243], v[240:243], 0
 s_lshl_b32 s59, s48, 1
 s_sub_u32 s59, s59, 1
 s_cbranch_scc1 L_M1
 .p2align 6
L_D1:
 v_mfma_f32_16x16x32_bf16 v[48:51], v[16:19], v[192:195], v[48:51]
 s_waitcnt vmcnt(10)
 s_barrier
 v_mfma_f32_16x16x32_bf16 v[52:55], v[16:19], v[196:199], v[52:55]
 v_xor_b32 v5, 0x4000, v5
 ds_read_b128 a[160:163], v5
 v_mfma_f32_16x16x32_bf16 v[56:59], v[16:19], v[200:203], v[56:59]
 buffer_load_dword v255, v15, s[40:43], s37 offen
 v_mfma_f32_16x16x32_bf16 v[60:63], v[16:19], v[204:207], v[60:63]
 s_waitcnt lgkmcnt(7)
 v_exp_f32 v160, v160
 v_mfma_f32_16x16x32_bf16 a[0:3], a[128:131], v[192:195], a[0:3]
 v_exp_f32 v161, v161
 v_mfma_f32_16x16x32_bf16 a[32:35], a[128:131], v[196:199], a[32:35]
 ds_read_b128 a[164:167], v5 offset:1024
 v_mfma_f32_16x16x32_bf16 a[64:67], a[128:131], v[200:203], a[64:67]
 s_add_u32 s37, s37, 1152
 v_exp_f32 v162, v162
 v_mfma_f32_16x16x32_bf16 a[96:99], a[128:131], v[204:207], a[96:99]
 v_cvt_pk_bf16_f32 v208, v160, v161
 v_mfma_f32_16x16x32_bf16 a[4:7], a[132:135], v[192:195], a[4:7]
 v_exp_f32 v163, v163
 v_mfma_f32_16x16x32_bf16 a[36:39], a[132:135], v[196:199], a[36:39]
 ds_read_b128 a[168:171], v5 offset:2048
 v_mfma_f32_16x16x32_bf16 a[68:71], a[132:135], v[200:203], a[68:71]
 v_exp_f32 v164, v164
 v_mfma_f32_16x16x32_bf16 a[100:103], a[132:135], v[204:207], a[100:103]
 s_waitcnt lgkmcnt(7)
 v_cvt_pk_bf16_f32 v209, v162, v163
 v_mfma_f32_16x16x32_bf16 a[8:11], a[136:139], v[192:195], a[8:11]
 s_add_u32 m0, s57, 8192
 v_exp_f32 v165, v165
 v_mfma_f32_16x16x32_bf16 a[40:43], a[136:139], v[196:199], a[40:43]
 ds_read_b128 a[172:175], v5 offset:3072
 v_mfma_f32_16x16x32_bf16 a[72:75], a[136:139], v[200:203], a[72:75]
 v_exp_f32 v166, v166
 v_mfma_f32_16x16x32_bf16 a[104:107], a[136:139], v[204:207], a[104:107]
 v_cvt_pk_bf16_f32 v210, v164, v165
 v_mfma_f32_16x16x32_bf16 a[12:15], a[140:143], v[192:195], a[12:15]
 v_exp_f32 v167, v167
 v_mfma_f32_16x16x32_bf16 a[44:47], a[140:143], v[196:199], a[44:47]
 ds_read_b128 a[176:179], v5 offset:4096
 v_mfma_f32_16x16x32_bf16 a[76:79], a[140:143], v[200:203], a[76:79]
 buffer_load_dwordx4 v12, s[4:7], s52 offen sc1 lds
 v_mfma_f32_16x16x32_bf16 a[108:111], a[140:143], v[204:207], a[108:111]
 s_waitcnt lgkmcnt(7)
 v_exp_f32 v168, v168
 v_mfma_f32_16x16x32_bf16 a[16:19], a[144:147], v[192:195], a[16:19]
 v_cvt_pk_bf16_f32 v211, v166, v167
 v_mfma_f32_16x16x32_bf16 a[48:51], a[144:147], v[196:199], a[48:51]
 ds_read_b128 a[180:183], v5 offset:5120
 v_mfma_f32_16x16x32_bf16 a[80:83], a[144:147], v[200:203], a[80:83]
 v_exp_f32 v169, v169
 v_mfma_f32_16x16x32_bf16 a[112:115], a[144:147], v[204:207], a[112:115]
 buffer_load_dwordx4 v12, s[4:7], s52 offen offset:1024 sc1 lds
 v_mfma_f32_16x16x32_bf16 a[20:23], a[148:151], v[192:195], a[20:23]
 v_exp_f32 v170, v170
 v_mfma_f32_16x16x32_bf16 a[52:55], a[148:151], v[196:199], a[52:55]
 ds_read_b128 a[184:187], v5 offset:6144
 v_cvt_pk_bf16_f32 v212, v168, v169
 v_mfma_f32_16x16x32_bf16 a[84:87], a[148:151], v[200:203], a[84:87]
 v_exp_f32 v171, v171
 v_mfma_f32_16x16x32_bf16 a[116:119], a[148:151], v[204:207], a[116:119]
 s_waitcnt lgkmcnt(7)
 v_exp_f32 v172, v172
 v_mfma_f32_16x16x32_bf16 a[24:27], a[152:155], v[192:195], a[24:27]
 s_add_u32 m0, s58, 8192
 v_cvt_pk_bf16_f32 v213, v170, v171
 v_mfma_f32_16x16x32_bf16 a[56:59], a[152:155], v[196:199], a[56:59]
 ds_read_b128 a[188:191], v5 offset:7168
 v_mfma_f32_16x16x32_bf16 a[88:91], a[152:155], v[200:203], a[88:91]
 v_exp_f32 v173, v173
 v_mfma_f32_16x16x32_bf16 a[120:123], a[152:155], v[204:207], a[120:123]
 v_exp_f32 v174, v174
 v_mfma_f32_16x16x32_bf16 a[28:31], a[156:159], v[192:195], a[28:31]
 v_cvt_pk_bf16_f32 v214, v172, v173
 v_mfma_f32_16x16x32_bf16 a[60:63], a[156:159], v[196:199], a[60:63]
 v_exp_f32 v175, v175
 v_mfma_f32_16x16x32_bf16 a[92:95], a[156:159], v[200:203], a[92:95]
 ds_read_b128 a[128:131], v6 offset:8192
 v_mfma_f32_16x16x32_bf16 a[124:127], a[156:159], v[204:207], a[124:127]
 s_waitcnt lgkmcnt(5)
 buffer_load_dwordx4 v14, s[4:7], s52 offen sc1 lds
 v_mfma_f32_16x16x32_bf16 v[128:131], a[160:163], v[64:67], v[32:35]
 v_exp_f32 v176, v176
 v_mfma_f32_16x16x32_bf16 v[128:131], a[164:167], v[68:71], v[128:131]
 v_cvt_pk_bf16_f32 v215, v174, v175
 v_mfma_f32_16x16x32_bf16 v[128:131], a[168:171], v[72:75], v[128:131]
 ds_read_b128 a[132:135], v6 offset:9216
 v_mfma_f32_16x16x32_bf16 v[128:131], a[172:175], v[76:79], v[128:131]
 buffer_load_dwordx4 v14, s[4:7], s52 offen offset:1024 sc1 lds
 v_mfma_f32_16x16x32_bf16 v[136:139], a[160:163], v[80:83], v[36:39]
 v_exp_f32 v177, v177
 v_mfma_f32_16x16x32_bf16 v[136:139], a[164:167], v[84:87], v[136:139]
 v_exp_f32 v178, v178
 v_mfma_f32_16x16x32_bf16 v[136:139], a[168:171], v[88:91], v[136:139]
 ds_read_b128 a[136:139], v6 offset:10240
 v_cvt_pk_bf16_f32 v216, v176, v177
 v_mfma_f32_16x16x32_bf16 v[136:139], a[172:175], v[92:95], v[136:139]
 v_exp_f32 v179, v179
 v_mfma_f32_16x16x32_bf16 v[144:147], a[160:163], v[96:99], v[40:43]
 v_exp_f32 v180, v180
 v_mfma_f32_16x16x32_bf16 v[144:147], a[164:167], v[100:103], v[144:147]
 s_xor_b32 s57, s57, 0x4000
 v_cvt_pk_bf16_f32 v217, v178, v179
 v_mfma_f32_16x16x32_bf16 v[144:147], a[168:171], v[104:107], v[144:147]
 ds_read_b128 a[140:143], v6 offset:11264
 v_mfma_f32_16x16x32_bf16 v[144:147], a[172:175], v[108:111], v[144:147]
 v_exp_f32 v181, v181
 v_mfma_f32_16x16x32_bf16 v[152:155], a[160:163], v[112:115], v[44:47]
 v_exp_f32 v182, v182
 v_mfma_f32_16x16x32_bf16 v[152:155], a[164:167], v[116:119], v[152:155]
 v_cvt_pk_bf16_f32 v218, v180, v181
 v_mfma_f32_16x16x32_bf16 v[152:155], a[168:171], v[120:123], v[152:155]
 ds_read_b128 a[144:147], v6 offset:12288
 s_add_u32 s58, s58, 0x4000
 v_mfma_f32_16x16x32_bf16 v[152:155], a[172:175], v[124:127], v[152:155]
 s_waitcnt lgkmcnt(5)
 v_exp_f32 v183, v183
 v_mfma_f32_16x16x32_bf16 v[132:135], a[176:179], v[64:67], v[32:35]
 v_exp_f32 v184, v184
 v_mfma_f32_16x16x32_bf16 v[132:135], a[180:183], v[68:71], v[132:135]
 v_cvt_pk_bf16_f32 v219, v182, v183
 v_mfma_f32_16x16x32_bf16 v[132:135], a[184:187], v[72:75], v[132:135]
 ds_read_b128 a[148:151], v6 offset:13312
 v_mfma_f32_16x16x32_bf16 v[132:135], a[188:191], v[76:79], v[132:135]
 v_exp_f32 v185, v185
 v_mfma_f32_16x16x32_bf16 v[140:143], a[176:179], v[80:83], v[36:39]
 s_and_b32 s58, s58, 0xffff
 v_exp_f32 v186, v186
 v_mfma_f32_16x16x32_bf16 v[140:143], a[180:183], v[84:87], v[140:143]
 v_cvt_pk_bf16_f32 v220, v184, v185
 v_mfma_f32_16x16x32_bf16 v[140:143], a[184:187], v[88:91], v[140:143]
 ds_read_b128 a[152:155], v6 offset:14336
 v_mfma_f32_16x16x32_bf16 v[140:143], a[188:191], v[92:95], v[140:143]
 v_exp_f32 v187, v187
 v_mfma_f32_16x16x32_bf16 v[148:151], a[176:179], v[96:99], v[40:43]
 v_exp_f32 v188, v188
 v_mfma_f32_16x16x32_bf16 v[148:151], a[180:183], v[100:103], v[148:151]
 s_add_u32 s52, s52, 0x4000
 v_cvt_pk_bf16_f32 v221, v186, v187
 v_mfma_f32_16x16x32_bf16 v[148:151], a[184:187], v[104:107], v[148:151]
 ds_read_b128 a[156:159], v6 offset:15360
 v_mfma_f32_16x16x32_bf16 v[148:151], a[188:191], v[108:111], v[148:151]
 v_exp_f32 v189, v189
 v_mfma_f32_16x16x32_bf16 v[156:159], a[176:179], v[112:115], v[44:47]
 v_exp_f32 v190, v190
 v_mfma_f32_16x16x32_bf16 v[156:159], a[180:183], v[116:119], v[156:159]
 v_cvt_pk_bf16_f32 v222, v188, v189
 v_mfma_f32_16x16x32_bf16 v[156:159], a[184:187], v[120:123], v[156:159]
 v_exp_f32 v191, v191
 v_mfma_f32_16x16x32_bf16 v[156:159], a[188:191], v[124:127], v[156:159]
 v_cvt_pk_bf16_f32 v223, v190, v191
 s_sub_u32 s59, s59, 1
 s_cbranch_scc1 L_M0
 v_mfma_f32_16x16x32_bf16 v[48:51], v[16:19], v[208:211], v[48:51]
 s_waitcnt vmcnt(10)
 s_barrier
 v_mfma_f32_16x16x32_bf16 v[52:55], v[16:19], v[212:215], v[52:55]
 ds_read_b128 a[160:163], v5 offset:8192
 v_mfma_f32_16x16x32_bf16 v[56:59], v[16:19], v[216:219], v[56:59]
 buffer_store_dword v9, v4, s[4:7], s26 offen sc1
 v_mfma_f32_16x16x32_bf16 v[60:63], v[16:19], v[220:223], v[60:63]
 s_waitcnt lgkmcnt(7)
 v_exp_f32 v128, v128
 v_mfma_f32_16x16x32_bf16 a[0:3], a[128:131], v[208:211], a[0:3]
 v_exp_f32 v129, v129
 v_mfma_f32_16x16x32_bf16 a[32:35], a[128:131], v[212:215], a[32:35]
 ds_read_b128 a[164:167], v5 offset:9216
 v_mfma_f32_16x16x32_bf16 a[64:67], a[128:131], v[216:219], a[64:67]
 v_exp_f32 v130, v130
 v_mfma_f32_16x16x32_bf16 a[96:99], a[128:131], v[220:223], a[96:99]
 v_cvt_pk_bf16_f32 v192, v128, v129
 v_mfma_f32_16x16x32_bf16 a[4:7], a[132:135], v[208:211], a[4:7]
 s_mov_b32 s26, s64
 v_exp_f32 v131, v131
 v_mfma_f32_16x16x32_bf16 a[36:39], a[132:135], v[212:215], a[36:39]
 ds_read_b128 a[168:171], v5 offset:10240
 v_mfma_f32_16x16x32_bf16 a[68:71], a[132:135], v[216:219], a[68:71]
 v_exp_f32 v132, v132
 v_mfma_f32_16x16x32_bf16 a[100:103], a[132:135], v[220:223], a[100:103]
 s_waitcnt lgkmcnt(7)
 v_cvt_pk_bf16_f32 v193, v130, v131
 v_mfma_f32_16x16x32_bf16 a[8:11], a[136:139], v[208:211], a[8:11]
 v_exp_f32 v133, v133
 v_mfma_f32_16x16x32_bf16 a[40:43], a[136:139], v[212:215], a[40:43]
 ds_read_b128 a[172:175], v5 offset:11264
 v_mfma_f32_16x16x32_bf16 a[72:75], a[136:139], v[216:219], a[72:75]
 v_exp_f32 v134, v134
 v_mfma_f32_16x16x32_bf16 a[104:107], a[136:139], v[220:223], a[104:107]
 s_mov_b32 s64, s51
 v_cvt_pk_bf16_f32 v194, v132, v133
 v_mfma_f32_16x16x32_bf16 a[12:15], a[140:143], v[208:211], a[12:15]
 v_exp_f32 v135, v135
 v_mfma_f32_16x16x32_bf16 a[44:47], a[140:143], v[212:215], a[44:47]
 ds_read_b128 a[176:179], v5 offset:12288
 v_mfma_f32_16x16x32_bf16 a[76:79], a[140:143], v[216:219], a[76:79]
 v_exp_f32 v136, v136
 v_mfma_f32_16x16x32_bf16 a[108:111], a[140:143], v[220:223], a[108:111]
 s_waitcnt lgkmcnt(7)
 v_cvt_pk_bf16_f32 v195, v134, v135
 v_mfma_f32_16x16x32_bf16 a[16:19], a[144:147], v[208:211], a[16:19]
 v_exp_f32 v137, v137
 v_mfma_f32_16x16x32_bf16 a[48:51], a[144:147], v[212:215], a[48:51]
 ds_read_b128 a[180:183], v5 offset:13312
 v_mfma_f32_16x16x32_bf16 a[80:83], a[144:147], v[216:219], a[80:83]
 v_exp_f32 v138, v138
 v_mfma_f32_16x16x32_bf16 a[112:115], a[144:147], v[220:223], a[112:115]
 s_add_u32 m0, s57, 0
 v_cvt_pk_bf16_f32 v196, v136, v137
 v_mfma_f32_16x16x32_bf16 a[20:23], a[148:151], v[208:211], a[20:23]
 v_exp_f32 v139, v139
 v_mfma_f32_16x16x32_bf16 a[52:55], a[148:151], v[212:215], a[52:55]
 ds_read_b128 a[184:187], v5 offset:14336
 v_mfma_f32_16x16x32_bf16 a[84:87], a[148:151], v[216:219], a[84:87]
 v_exp_f32 v140, v140
 v_mfma_f32_16x16x32_bf16 a[116:119], a[148:151], v[220:223], a[116:119]
 s_waitcnt lgkmcnt(7)
 v_cvt_pk_bf16_f32 v197, v138, v139
 v_mfma_f32_16x16x32_bf16 a[24:27], a[152:155], v[208:211], a[24:27]
 v_exp_f32 v141, v141
 v_mfma_f32_16x16x32_bf16 a[56:59], a[152:155], v[212:215], a[56:59]
 ds_read_b128 a[188:191], v5 offset:15360
 v_mfma_f32_16x16x32_bf16 a[88:91], a[152:155], v[216:219], a[88:91]
 buffer_load_dwordx4 v1, s[4:7], s52 offen sc1 lds
 v_mfma_f32_16x16x32_bf16 a[120:123], a[152:155], v[220:223], a[120:123]
 v_exp_f32 v142, v142
 v_mfma_f32_16x16x32_bf16 a[28:31], a[156:159], v[208:211], a[28:31]
 v_cvt_pk_bf16_f32 v198, v140, v141
 v_mfma_f32_16x16x32_bf16 a[60:63], a[156:159], v[212:215], a[60:63]
 v_exp_f32 v143, v143
 v_mfma_f32_16x16x32_bf16 a[92:95], a[156:159], v[216:219], a[92:95]
 v_add_u32 v6, 0x4000, v6
 v_and_b32 v6, 0xffff, v6
 ds_read_b128 a[128:131], v6
 v_mfma_f32_16x16x32_bf16 a[124:127], a[156:159], v[220:223], a[124:127]
 s_waitcnt lgkmcnt(5)
 v_exp_f32 v144, v144
 v_mfma_f32_16x16x32_bf16 v[160:163], a[160:163], v[64:67], v[32:35]
 v_cvt_pk_bf16_f32 v199, v142, v143
 v_mfma_f32_16x16x32_bf16 v[160:163], a[164:167], v[68:71], v[160:163]
 buffer_load_dwordx4 v1, s[4:7], s52 offen offset:1024 sc1 lds
 v_mfma_f32_16x16x32_bf16 v[160:163], a[168:171], v[72:75], v[160:163]
 ds_read_b128 a[132:135], v6 offset:1024
 v_mfma_f32_16x16x32_bf16 v[160:163], a[172:175], v[76:79], v[160:163]
 v_exp_f32 v145, v145
 v_mfma_f32_16x16x32_bf16 v[168:171], a[160:163], v[80:83], v[36:39]
 v_exp_f32 v146, v146
 v_mfma_f32_16x16x32_bf16 v[168:171], a[164:167], v[84:87], v[168:171]
 v_cvt_pk_bf16_f32 v200, v144, v145
 v_mfma_f32_16x16x32_bf16 v[168:171], a[168:171], v[88:91], v[168:171]
 ds_read_b128 a[136:139], v6 offset:2048
 v_mfma_f32_16x16x32_bf16 v[168:171], a[172:175], v[92:95], v[168:171]
 v_exp_f32 v147, v147
 v_mfma_f32_16x16x32_bf16 v[176:179], a[160:163], v[96:99], v[40:43]
 v_exp_f32 v148, v148
 v_mfma_f32_16x16x32_bf16 v[176:179], a[164:167], v[100:103], v[176:179]
 s_add_u32 m0, s58, 0
 v_cvt_pk_bf16_f32 v201, v146, v147
 v_mfma_f32_16x16x32_bf16 v[176:179], a[168:171], v[104:107], v[176:179]
 ds_read_b128 a[140:143], v6 offset:3072
 v_mfma_f32_16x16x32_bf16 v[176:179], a[172:175], v[108:111], v[176:179]
 v_exp_f32 v149, v149
 v_mfma_f32_16x16x32_bf16 v[184:187], a[160:163], v[112:115], v[44:47]
 v_exp_f32 v150, v150
 v_mfma_f32_16x16x32_bf16 v[184:187], a[164:167], v[116:119], v[184:187]
 v_cvt_pk_bf16_f32 v202, v148, v149
 v_mfma_f32_16x16x32_bf16 v[184:187], a[168:171], v[120:123], v[184:187]
 ds_read_b128 a[144:147], v6 offset:4096
 v_mfma_f32_16x16x32_bf16 v[184:187], a[172:175], v[124:127], v[184:187]
 s_waitcnt lgkmcnt(5)
 v_exp_f32 v151, v151
 v_mfma_f32_16x16x32_bf16 v[164:167], a[176:179], v[64:67], v[32:35]
 buffer_load_dwordx4 v13, s[4:7], s52 offen sc1 lds
 v_mfma_f32_16x16x32_bf16 v[164:167], a[180:183], v[68:71], v[164:167]
 v_exp_f32 v152, v152
 v_mfma_f32_16x16x32_bf16 v[164:167], a[184:187], v[72:75], v[164:167]
 ds_read_b128 a[148:151], v6 offset:5120
 v_cvt_pk_bf16_f32 v203, v150, v151
 v_mfma_f32_16x16x32_bf16 v[164:167], a[188:191], v[76:79], v[164:167]
 v_exp_f32 v153, v153
 v_mfma_f32_16x16x32_bf16 v[172:175], a[176:179], v[80:83], v[36:39]
 v_exp_f32 v154, v154
 v_mfma_f32_16x16x32_bf16 v[172:175], a[180:183], v[84:87], v[172:175]
 v_cvt_pk_bf16_f32 v204, v152, v153
 v_mfma_f32_16x16x32_bf16 v[172:175], a[184:187], v[88:91], v[172:175]
 ds_read_b128 a[152:155], v6 offset:6144
 v_mfma_f32_16x16x32_bf16 v[172:175], a[188:191], v[92:95], v[172:175]
 buffer_load_dwordx4 v13, s[4:7], s52 offen offset:1024 sc1 lds
 v_mfma_f32_16x16x32_bf16 v[180:183], a[176:179], v[96:99], v[40:43]
 v_exp_f32 v155, v155
 v_mfma_f32_16x16x32_bf16 v[180:183], a[180:183], v[100:103], v[180:183]
 v_exp_f32 v156, v156
 v_mfma_f32_16x16x32_bf16 v[180:183], a[184:187], v[104:107], v[180:183]
 ds_read_b128 a[156:159], v6 offset:7168
 v_cvt_pk_bf16_f32 v205, v154, v155
 v_mfma_f32_16x16x32_bf16 v[180:183], a[188:191], v[108:111], v[180:183]
 v_exp_f32 v157, v157
 v_mfma_f32_16x16x32_bf16 v[188:191], a[176:179], v[112:115], v[44:47]
 v_exp_f32 v158, v158
 v_mfma_f32_16x16x32_bf16 v[188:191], a[180:183], v[116:119], v[188:191]
 v_cvt_pk_bf16_f32 v206, v156, v157
 v_mfma_f32_16x16x32_bf16 v[188:191], a[184:187], v[120:123], v[188:191]
 v_exp_f32 v159, v159
 v_mfma_f32_16x16x32_bf16 v[188:191], a[188:191], v[124:127], v[188:191]
 v_cvt_pk_bf16_f32 v207, v158, v159
 s_branch L_D1
L_M0:
 v_mfma_f32_16x16x32_bf16 v[48:51], v[16:19], v[208:211], v[48:51]
 s_waitcnt vmcnt(10)
 s_barrier
 v_mfma_f32_16x16x32_bf16 v[52:55], v[16:19], v[212:215], v[52:55]
 ds_read_b128 a[160:163], v5 offset:8192
 v_exp_f32 v128, v128
 s_add_u32 m0, s57, 0
 v_mfma_f32_16x16x32_bf16 v[56:59], v[16:19], v[216:219], v[56:59]
 v_exp_f32 v129, v129
 v_mfma_f32_16x16x32_bf16 v[60:63], v[16:19], v[220:223], v[60:63]
 s_waitcnt lgkmcnt(7)
 v_exp_f32 v130, v130
 v_mfma_f32_16x16x32_bf16 a[0:3], a[128:131], v[208:211], a[0:3]
 v_cvt_pk_bf16_f32 v192, v128, v129
 v_mfma_f32_16x16x32_bf16 a[32:35], a[128:131], v[212:215], a[32:35]
 ds_read_b128 a[164:167], v5 offset:9216
 v_exp_f32 v131, v131
 v_mfma_f32_16x16x32_bf16 a[64:67], a[128:131], v[216:219], a[64:67]
 v_exp_f32 v132, v132
 v_mfma_f32_16x16x32_bf16 a[96:99], a[128:131], v[220:223], a[96:99]
 v_mfma_f32_16x16x32_bf16 a[4:7], a[132:135], v[208:211], a[4:7]
 v_cvt_pk_bf16_f32 v193, v130, v131
 v_mfma_f32_16x16x32_bf16 a[36:39], a[132:135], v[212:215], a[36:39]
 ds_read_b128 a[168:171], v5 offset:10240
 v_exp_f32 v133, v133
 v_mfma_f32_16x16x32_bf16 a[68:71], a[132:135], v[216:219], a[68:71]
 v_exp_f32 v134, v134
 v_mfma_f32_16x16x32_bf16 a[100:103], a[132:135], v[220:223], a[100:103]
 s_waitcnt lgkmcnt(7)
 v_cvt_pk_bf16_f32 v194, v132, v133
 v_mfma_f32_16x16x32_bf16 a[8:11], a[136:139], v[208:211], a[8:11]
 buffer_load_dwordx4 v1, s[4:7], s52 offen sc1 lds
 v_mfma_f32_16x16x32_bf16 a[40:43], a[136:139], v[212:215], a[40:43]
 ds_read_b128 a[172:175], v5 offset:11264
 v_exp_f32 v135, v135
 v_mfma_f32_16x16x32_bf16 a[72:75], a[136:139], v[216:219], a[72:75]
 v_exp_f32 v136, v136
 v_mfma_f32_16x16x32_bf16 a[104:107], a[136:139], v[220:223], a[104:107]
 v_cvt_pk_bf16_f32 v195, v134, v135
 v_mfma_f32_16x16x32_bf16 a[12:15], a[140:143], v[208:211], a[12:15]
 v_exp_f32 v137, v137
 v_mfma_f32_16x16x32_bf16 a[44:47], a[140:143], v[212:215], a[44:47]
 ds_read_b128 a[176:179], v5 offset:12288
 v_exp_f32 v138, v138
 v_mfma_f32_16x16x32_bf16 a[76:79], a[140:143], v[216:219], a[76:79]
 v_cvt_pk_bf16_f32 v196, v136, v137
 v_mfma_f32_16x16x32_bf16 a[108:111], a[140:143], v[220:223], a[108:111]
 s_waitcnt lgkmcnt(7)
 v_exp_f32 v139, v139
 v_mfma_f32_16x16x32_bf16 a[16:19], a[144:147], v[208:211], a[16:19]
 v_mfma_f32_16x16x32_bf16 a[48:51], a[144:147], v[212:215], a[48:51]
 ds_read_b128 a[180:183], v5 offset:13312
 v_exp_f32 v140, v140
 v_mfma_f32_16x16x32_bf16 a[80:83], a[144:147], v[216:219], a[80:83]
 v_cvt_pk_bf16_f32 v197, v138, v139
 v_mfma_f32_16x16x32_bf16 a[112:115], a[144:147], v[220:223], a[112:115]
 buffer_load_dwordx4 v1, s[4:7], s52 offen offset:1024 sc1 lds
 v_mfma_f32_16x16x32_bf16 a[20:23], a[148:151], v[208:211], a[20:23]
 v_exp_f32 v141, v141
 v_mfma_f32_16x16x32_bf16 a[52:55], a[148:151], v[212:215], a[52:55]
 ds_read_b128 a[184:187], v5 offset:14336
 v_exp_f32 v142, v142
 v_mfma_f32_16x16x32_bf16 a[84:87], a[148:151], v[216:219], a[84:87]
 v_cvt_pk_bf16_f32 v198, v140, v141
 v_exp_f32 v143, v143
 v_mfma_f32_16x16x32_bf16 a[116:119], a[148:151], v[220:223], a[116:119]
 s_waitcnt lgkmcnt(7)
 v_mfma_f32_16x16x32_bf16 a[24:27], a[152:155], v[208:211], a[24:27]
 v_add_f32 v144, v144, v224
 v_mfma_f32_16x16x32_bf16 a[56:59], a[152:155], v[212:215], a[56:59]
 ds_read_b128 a[188:191], v5 offset:15360
 v_exp_f32 v144, v144
 v_mfma_f32_16x16x32_bf16 a[88:91], a[152:155], v[216:219], a[88:91]
 v_add_f32 v145, v145, v225
 v_mfma_f32_16x16x32_bf16 a[120:123], a[152:155], v[220:223], a[120:123]
 v_cvt_pk_bf16_f32 v199, v142, v143
 v_mfma_f32_16x16x32_bf16 a[28:31], a[156:159], v[208:211], a[28:31]
 v_exp_f32 v145, v145
 v_mfma_f32_16x16x32_bf16 a[60:63], a[156:159], v[212:215], a[60:63]
 v_mfma_f32_16x16x32_bf16 a[92:95], a[156:159], v[216:219], a[92:95]
 v_add_u32 v6, 0x4000, v6
 v_and_b32 v6, 0xffff, v6
 ds_read_b128 a[128:131], v6
 v_mfma_f32_16x16x32_bf16 a[124:127], a[156:159], v[220:223], a[124:127]
 s_waitcnt lgkmcnt(5)
 s_add_u32 m0, s58, 0
 v_add_f32 v146, v146, v226
 v_exp_f32 v146, v146
 v_mfma_f32_16x16x32_bf16 v[160:163], a[160:163], v[64:67], v[32:35]
 v_add_f32 v147, v147, v227
 v_mfma_f32_16x16x32_bf16 v[160:163], a[164:167], v[68:71], v[160:163]
 v_cvt_pk_bf16_f32 v200, v144, v145
 v_mfma_f32_16x16x32_bf16 v[160:163], a[168:171], v[72:75], v[160:163]
 ds_read_b128 a[132:135], v6 offset:1024
 v_exp_f32 v147, v147
 v_mfma_f32_16x16x32_bf16 v[160:163], a[172:175], v[76:79], v[160:163]
 v_add_f32 v148, v148, v228
 v_mfma_f32_16x16x32_bf16 v[168:171], a[160:163], v[80:83], v[36:39]
 v_mfma_f32_16x16x32_bf16 v[168:171], a[164:167], v[84:87], v[168:171]
 v_exp_f32 v148, v148
 v_mfma_f32_16x16x32_bf16 v[168:171], a[168:171], v[88:91], v[168:171]
 ds_read_b128 a[136:139], v6 offset:2048
 v_add_f32 v149, v149, v229
 v_mfma_f32_16x16x32_bf16 v[168:171], a[172:175], v[92:95], v[168:171]
 v_cvt_pk_bf16_f32 v201, v146, v147
 v_mfma_f32_16x16x32_bf16 v[176:179], a[160:163], v[96:99], v[40:43]
 v_exp_f32 v149, v149
 v_mfma_f32_16x16x32_bf16 v[176:179], a[164:167], v[100:103], v[176:179]
 buffer_load_dwordx4 v13, s[4:7], s52 offen sc1 lds
 v_add_f32 v150, v150, v230
 v_mfma_f32_16x16x32_bf16 v[176:179], a[168:171], v[104:107], v[176:179]
 ds_read_b128 a[140:143], v6 offset:3072
 v_exp_f32 v150, v150
 v_mfma_f32_16x16x32_bf16 v[176:179], a[172:175], v[108:111], v[176:179]
 v_mfma_f32_16x16x32_bf16 v[184:187], a[160:163], v[112:115], v[44:47]
 v_add_f32 v151, v151, v231
 v_mfma_f32_16x16x32_bf16 v[184:187], a[164:167], v[116:119], v[184:187]
 v_cvt_pk_bf16_f32 v202, v148, v149
 v_mfma_f32_16x16x32_bf16 v[184:187], a[168:171], v[120:123], v[184:187]
 ds_read_b128 a[144:147], v6 offset:4096
 v_exp_f32 v151, v151
 v_mfma_f32_16x16x32_bf16 v[184:187], a[172:175], v[124:127], v[184:187]
 s_waitcnt lgkmcnt(5)
 v_exp_f32 v152, v152
 v_mfma_f32_16x16x32_bf16 v[164:167], a[176:179], v[64:67], v[32:35]
 v_cvt_pk_bf16_f32 v203, v150, v151
 v_mfma_f32_16x16x32_bf16 v[164:167], a[180:183], v[68:71], v[164:167]
 v_mfma_f32_16x16x32_bf16 v[164:167], a[184:187], v[72:75], v[164:167]
 ds_read_b128 a[148:151], v6 offset:5120
 v_exp_f32 v153, v153
 v_mfma_f32_16x16x32_bf16 v[164:167], a[188:191], v[76:79], v[164:167]
 v_exp_f32 v154, v154
 v_mfma_f32_16x16x32_bf16 v[172:175], a[176:179], v[80:83], v[36:39]
 buffer_load_dwordx4 v13, s[4:7], s52 offen offset:1024 sc1 lds
 v_cvt_pk_bf16_f32 v204, v152, v153
 v_mfma_f32_16x16x32_bf16 v[172:175], a[180:183], v[84:87], v[172:175]
 v_exp_f32 v155, v155
 v_mfma_f32_16x16x32_bf16 v[172:175], a[184:187], v[88:91], v[172:175]
 ds_read_b128 a[152:155], v6 offset:6144
 v_exp_f32 v156, v156
 v_mfma_f32_16x16x32_bf16 v[172:175], a[188:191], v[92:95], v[172:175]
 v_cvt_pk_bf16_f32 v205, v154, v155
 v_mfma_f32_16x16x32_bf16 v[180:183], a[176:179], v[96:99], v[40:43]
 v_mfma_f32_16x16x32_bf16 v[180:183], a[180:183], v[100:103], v[180:183]
 v_exp_f32 v157, v157
 v_mfma_f32_16x16x32_bf16 v[180:183], a[184:187], v[104:107], v[180:183]
 ds_read_b128 a[156:159], v6 offset:7168
 v_exp_f32 v158, v158
 v_mfma_f32_16x16x32_bf16 v[180:183], a[188:191], v[108:111], v[180:183]
 v_cvt_pk_bf16_f32 v206, v156, v157
 v_mfma_f32_16x16x32_bf16 v[188:191], a[176:179], v[112:115], v[44:47]
 v_exp_f32 v159, v159
 v_mfma_f32_16x16x32_bf16 v[188:191], a[180:183], v[116:119], v[188:191]
 v_cvt_pk_bf16_f32 v207, v158, v159
 v_mfma_f32_16x16x32_bf16 v[188:191], a[184:187], v[120:123], v[188:191]
 v_mfma_f32_16x16x32_bf16 v[188:191], a[188:191], v[124:127], v[188:191]
L_M1:
 v_mfma_f32_16x16x32_bf16 v[48:51], v[16:19], v[192:195], v[48:51]
 s_waitcnt vmcnt(10)
 s_barrier
 v_mfma_f32_16x16x32_bf16 v[52:55], v[16:19], v[196:199], v[52:55]
 v_xor_b32 v5, 0x4000, v5
 ds_read_b128 a[160:163], v5
 v_exp_f32 v160, v160
 s_add_u32 m0, s57, 8192
 v_mfma_f32_16x16x32_bf16 v[56:59], v[16:19], v[200:203], v[56:59]
 v_exp_f32 v161, v161
 v_and_b32 v22, 15, v0
 v_mfma_f32_16x16x32_bf16 v[60:63], v[16:19], v[204:207], v[60:63]
 s_waitcnt lgkmcnt(7)
 v_exp_f32 v162, v162
 v_lshrrev_b32 v23, 4, v0
 v_mfma_f32_16x16x32_bf16 a[0:3], a[128:131], v[192:195], a[0:3]
 ds_read_b128 a[164:167], v5 offset:1024
 v_cvt_pk_bf16_f32 v208, v160, v161
 v_lshlrev_b32 v24, 2, v23
 v_and_b32 v25, 1, v23
 v_mfma_f32_16x16x32_bf16 a[32:35], a[128:131], v[196:199], a[32:35]
 v_exp_f32 v163, v163
 v_lshrrev_b32 v26, 2, v22
 v_mfma_f32_16x16x32_bf16 a[64:67], a[128:131], v[200:203], a[64:67]
 buffer_load_dwordx4 v12, s[4:7], s52 offen sc1 lds
 v_add_u32 v24, v24, v26
 v_mfma_f32_16x16x32_bf16 a[96:99], a[128:131], v[204:207], a[96:99]
 v_exp_f32 v164, v164
 v_cvt_pk_bf16_f32 v209, v162, v163
 v_mfma_f32_16x16x32_bf16 a[4:7], a[132:135], v[192:195], a[4:7]
 ds_read_b128 a[168:171], v5 offset:2048
 v_exp_f32 v165, v165
 v_mul_u32_u24 v24, 320, v24
 v_mfma_f32_16x16x32_bf16 a[36:39], a[132:135], v[196:199], a[36:39]
 v_exp_f32 v166, v166
 v_and_b32 v26, 3, v22
 v_mfma_f32_16x16x32_bf16 a[68:71], a[132:135], v[200:203], a[68:71]
 v_cvt_pk_bf16_f32 v210, v164, v165
 v_lshl_add_u32 v24, v26, 3, v24
 v_add_u32 v24, 0x10000, v24
 v_mfma_f32_16x16x32_bf16 a[100:103], a[132:135], v[204:207], a[100:103]
 s_waitcnt lgkmcnt(7)
 ds_read_b128 a[172:175], v5 offset:3072
 v_exp_f32 v167, v167
 v_lshl_add_u32 v245, v25, 5, v24
 v_mfma_f32_16x16x32_bf16 a[8:11], a[136:139], v[192:195], a[8:11]
 buffer_load_dwordx4 v12, s[4:7], s52 offen offset:1024 sc1 lds
 v_xor_b32 v25, 1, v25
 v_mfma_f32_16x16x32_bf16 a[40:43], a[136:139], v[196:199], a[40:43]
 v_exp_f32 v168, v168
 v_cvt_pk_bf16_f32 v211, v166, v167
 v_mfma_f32_16x16x32_bf16 a[72:75], a[136:139], v[200:203], a[72:75]
 s_mul_i32 s49, s44, 320
 v_exp_f32 v169, v169
 s_mov_b32 s50, 52429
 v_lshl_add_u32 v246, v25, 5, v24
 v_mfma_f32_16x16x32_bf16 a[104:107], a[136:139], v[204:207], a[104:107]
 ds_read_b128 a[176:179], v5 offset:4096
 v_exp_f32 v170, v170
 s_mul_i32 s38, s44, 5120
 v_add_u32 v24, s49, v0
 v_mfma_f32_16x16x32_bf16 a[12:15], a[140:143], v[192:195], a[12:15]
 v_cvt_pk_bf16_f32 v212, v168, v169
 v_add_u32 v24, 0, v24
 v_mul_lo_u32 v25, v24, s50
 v_mfma_f32_16x16x32_bf16 a[44:47], a[140:143], v[196:199], a[44:47]
 v_exp_f32 v171, v171
 v_lshrrev_b32 v25, 20, v25
 v_mfma_f32_16x16x32_bf16 a[76:79], a[140:143], v[200:203], a[76:79]
 s_add_u32 m0, s58, 8192
 v_exp_f32 v172, v172
 v_mul_u32_u24 v26, 20, v25
 v_mfma_f32_16x16x32_bf16 a[108:111], a[140:143], v[204:207], a[108:111]
 s_waitcnt lgkmcnt(7)
 ds_read_b128 a[180:183], v5 offset:5120
 v_cvt_pk_bf16_f32 v213, v170, v171
 v_sub_u32 v26, v24, v26
 v_bfe_u32 v27, v25, 2, 1
 v_mfma_f32_16x16x32_bf16 a[16:19], a[144:147], v[192:195], a[16:19]
 v_exp_f32 v173, v173
 v_lshlrev_b32 v27, 1, v27
 v_mfma_f32_16x16x32_bf16 a[48:51], a[144:147], v[196:199], a[48:51]
 v_exp_f32 v174, v174
 v_xor_b32 v26, v26, v27
 v_mfma_f32_16x16x32_bf16 a[80:83], a[144:147], v[200:203], a[80:83]
 ds_read_b128 a[184:187], v5 offset:6144
 v_cvt_pk_bf16_f32 v214, v172, v173
 v_mul_u32_u24 v25, 1280, v25
 v_lshl_add_u32 v247, v26, 4, v25
 v_mfma_f32_16x16x32_bf16 a[112:115], a[144:147], v[204:207], a[112:115]
 v_exp_f32 v175, v175
 v_add_u32 v24, s49, v0
 v_mfma_f32_16x16x32_bf16 a[20:23], a[148:151], v[192:195], a[20:23]
 buffer_load_dwordx4 v14, s[4:7], s52 offen sc1 lds
 v_add_f32 v176, v176, v232
 v_mfma_f32_16x16x32_bf16 a[52:55], a[148:151], v[196:199], a[52:55]
 v_exp_f32 v176, v176
 v_add_u32 v24, 64, v24
 v_mfma_f32_16x16x32_bf16 a[84:87], a[148:151], v[200:203], a[84:87]
 ds_read_b128 a[188:191], v5 offset:7168
 v_add_f32 v177, v177, v233
 v_mul_lo_u32 v25, v24, s50
 v_lshrrev_b32 v25, 20, v25
 v_mfma_f32_16x16x32_bf16 a[116:119], a[148:151], v[204:207], a[116:119]
 s_waitcnt lgkmcnt(8)
 v_cvt_pk_bf16_f32 v215, v174, v175
 v_mul_u32_u24 v26, 20, v25
 v_sub_u32 v26, v24, v26
 v_mfma_f32_16x16x32_bf16 a[24:27], a[152:155], v[192:195], a[24:27]
 v_exp_f32 v177, v177
 v_bfe_u32 v27, v25, 2, 1
 v_mfma_f32_16x16x32_bf16 a[56:59], a[152:155], v[196:199], a[56:59]
 v_lshlrev_b32 v27, 1, v27
 v_xor_b32 v26, v26, v27
 v_mul_u32_u24 v25, 1280, v25
 v_mfma_f32_16x16x32_bf16 a[88:91], a[152:155], v[200:203], a[88:91]
 ds_read_b128 a[128:131], v6 offset:8192
 v_add_f32 v178, v178, v234
 v_lshl_add_u32 v248, v26, 4, v25
 v_add_u32 v24, s49, v0
 v_mfma_f32_16x16x32_bf16 a[120:123], a[152:155], v[204:207], a[120:123]
 buffer_load_dwordx4 v14, s[4:7], s52 offen offset:1024 sc1 lds
 v_add_u32 v24, 128, v24
 v_mfma_f32_16x16x32_bf16 a[28:31], a[156:159], v[192:195], a[28:31]
 v_exp_f32 v178, v178
 v_add_f32 v179, v179, v235
 v_mfma_f32_16x16x32_bf16 a[60:63], a[156:159], v[196:199], a[60:63]
 ds_read_b128 a[132:135], v6 offset:9216
 v_cvt_pk_bf16_f32 v216, v176, v177
 v_mul_lo_u32 v25, v24, s50
 v_lshrrev_b32 v25, 20, v25
 v_mfma_f32_16x16x32_bf16 a[92:95], a[156:159], v[200:203], a[92:95]
 v_exp_f32 v179, v179
 v_mul_u32_u24 v26, 20, v25
 v_mfma_f32_16x16x32_bf16 a[124:127], a[156:159], v[204:207], a[124:127]
 s_waitcnt lgkmcnt(6)
 s_xor_b32 s57, s57, 0x4000
 v_add_f32 v180, v180, v236
 v_sub_u32 v26, v24, v26
 v_bfe_u32 v27, v25, 2, 1
 v_mfma_f32_16x16x32_bf16 v[152:155], a[160:163], v[112:115], v[44:47]
 v_exp_f32 v180, v180
 v_lshlrev_b32 v27, 1, v27
 v_mfma_f32_16x16x32_bf16 v[152:155], a[164:167], v[116:119], v[152:155]
 ds_read_b128 a[136:139], v6 offset:10240
 v_add_f32 v181, v181, v237
 v_xor_b32 v26, v26, v27
 v_mul_u32_u24 v25, 1280, v25
 v_mfma_f32_16x16x32_bf16 v[152:155], a[168:171], v[120:123], v[152:155]
 v_cvt_pk_bf16_f32 v217, v178, v179
 v_lshl_add_u32 v249, v26, 4, v25
 v_add_u32 v24, s49, v0
 v_mfma_f32_16x16x32_bf16 v[152:155], a[172:175], v[124:127], v[152:155]
 v_exp_f32 v181, v181
 v_add_u32 v24, 192, v24
 v_mfma_f32_16x16x32_bf16 v[128:131], a[160:163], v[64:67], v[32:35]
 ds_read_b128 a[140:143], v6 offset:11264
 v_add_f32 v182, v182, v238
 v_mul_lo_u32 v25, v24, s50
 v_mfma_f32_16x16x32_bf16 v[128:131], a[164:167], v[68:71], v[128:131]
 s_add_u32 s58, s58, 0x4000
 v_exp_f32 v182, v182
 v_lshrrev_b32 v25, 20, v25
 v_mfma_f32_16x16x32_bf16 v[128:131], a[168:171], v[72:75], v[128:131]
 v_add_f32 v183, v183, v239
 v_mul_u32_u24 v26, 20, v25
 v_sub_u32 v26, v24, v26
 v_mfma_f32_16x16x32_bf16 v[128:131], a[172:175], v[76:79], v[128:131]
 v_cvt_pk_bf16_f32 v218, v180, v181
 v_bfe_u32 v27, v25, 2, 1
 v_mfma_f32_16x16x32_bf16 v[136:139], a[160:163], v[80:83], v[36:39]
 ds_read_b128 a[144:147], v6 offset:12288
 v_exp_f32 v183, v183
 v_lshlrev_b32 v27, 1, v27
 v_mfma_f32_16x16x32_bf16 v[136:139], a[164:167], v[84:87], v[136:139]
 v_exp_f32 v184, v184
 v_xor_b32 v26, v26, v27
 v_mfma_f32_16x16x32_bf16 v[136:139], a[168:171], v[88:91], v[136:139]
 v_cvt_pk_bf16_f32 v219, v182, v183
 v_mul_u32_u24 v25, 1280, v25
 v_lshl_add_u32 v250, v26, 4, v25
 v_mfma_f32_16x16x32_bf16 v[136:139], a[172:175], v[92:95], v[136:139]
 s_waitcnt lgkmcnt(5)
 s_and_b32 s58, s58, 0xffff
 v_exp_f32 v185, v185
 v_add_u32 v24, s49, v0
 v_mfma_f32_16x16x32_bf16 v[156:159], a[176:179], v[112:115], v[44:47]
 ds_read_b128 a[148:151], v6 offset:13312
 v_exp_f32 v186, v186
 v_add_u32 v24, 256, v24
 v_mfma_f32_16x16x32_bf16 v[156:159], a[180:183], v[116:119], v[156:159]
 v_cvt_pk_bf16_f32 v220, v184, v185
 v_mul_lo_u32 v25, v24, s50
 v_lshrrev_b32 v25, 20, v25
 v_mfma_f32_16x16x32_bf16 v[156:159], a[184:187], v[120:123], v[156:159]
 v_exp_f32 v187, v187
 v_mul_u32_u24 v26, 20, v25
 v_mfma_f32_16x16x32_bf16 v[156:159], a[188:191], v[124:127], v[156:159]
 ds_read_b128 a[152:155], v6 offset:14336
 v_exp_f32 v188, v188
 v_sub_u32 v26, v24, v26
 v_mfma_f32_16x16x32_bf16 v[132:135], a[176:179], v[64:67], v[32:35]
 v_cvt_pk_bf16_f32 v221, v186, v187
 v_bfe_u32 v27, v25, 2, 1
 v_lshlrev_b32 v27, 1, v27
 v_mfma_f32_16x16x32_bf16 v[132:135], a[180:183], v[68:71], v[132:135]
 s_add_u32 s52, s52, 0x4000
 v_exp_f32 v189, v189
 v_xor_b32 v26, v26, v27
 v_mfma_f32_16x16x32_bf16 v[132:135], a[184:187], v[72:75], v[132:135]
 v_exp_f32 v190, v190
 v_mul_u32_u24 v25, 1280, v25
 v_mfma_f32_16x16x32_bf16 v[132:135], a[188:191], v[76:79], v[132:135]
 ds_read_b128 a[156:159], v6 offset:15360
 v_cvt_pk_bf16_f32 v222, v188, v189
 v_lshl_add_u32 v251, v26, 4, v25
 v_mfma_f32_16x16x32_bf16 v[140:143], a[176:179], v[80:83], v[36:39]
 v_exp_f32 v191, v191
 v_mfma_f32_16x16x32_bf16 v[140:143], a[180:183], v[84:87], v[140:143]
 v_cvt_pk_bf16_f32 v223, v190, v191
 v_mfma_f32_16x16x32_bf16 v[140:143], a[184:187], v[88:91], v[140:143]
 v_mfma_f32_16x16x32_bf16 v[140:143], a[188:191], v[92:95], v[140:143]
L_M2:
 v_mfma_f32_16x16x32_bf16 v[48:51], v[16:19], v[208:211], v[48:51]
 s_waitcnt vmcnt(10)
 s_barrier
 v_mfma_f32_16x16x32_bf16 v[52:55], v[16:19], v[212:215], v[52:55]
 ds_read_b128 a[160:163], v5 offset:8192
 v_add_f32 v152, v152, v224
 s_add_u32 m0, s57, 0
 s_sub_u32 s49, 15, s48
 v_mfma_f32_16x16x32_bf16 v[56:59], v[16:19], v[216:219], v[56:59]
 v_exp_f32 v152, v152
 v_mfma_f32_16x16x32_bf16 v[60:63], v[16:19], v[220:223], v[60:63]
 s_waitcnt lgkmcnt(7)
 v_add_f32 v153, v153, v225
 v_mfma_f32_16x16x32_bf16 a[0:3], a[128:131], v[208:211], a[0:3]
 ds_read_b128 a[164:167], v5 offset:9216
 v_exp_f32 v153, v153
 v_mfma_f32_16x16x32_bf16 a[32:35], a[128:131], v[212:215], a[32:35]
 s_bitcmp1_b32 s47, 2
 s_cselect_b32 s49, s48, s49
 s_cselect_b32 s36, 2, 1
 s_cselect_b32 s34, 32, 0
 v_mfma_f32_16x16x32_bf16 a[64:67], a[128:131], v[216:219], a[64:67]
 s_lshl_b32 s36, s36, 7
 v_add_f32 v154, v154, v226
 s_lshl_b32 s49, s49, 3
 s_lshl_b32 s50, s44, 1
 v_mfma_f32_16x16x32_bf16 a[96:99], a[128:131], v[220:223], a[96:99]
 s_add_u32 s49, s49, s50
 v_exp_f32 v154, v154
 s_mul_i32 s49, s49, 186368
 v_mfma_f32_16x16x32_bf16 a[4:7], a[132:135], v[208:211], a[4:7]
 ds_read_b128 a[168:171], v5 offset:10240
 v_add_f32 v155, v155, v227
 v_add_u32 v252, s49, v1
 v_mfma_f32_16x16x32_bf16 a[36:39], a[132:135], v[212:215], a[36:39]
 v_add_u32 v253, 186368, v252
 v_mfma_f32_16x16x32_bf16 a[68:71], a[132:135], v[216:219], a[68:71]
 buffer_load_dwordx4 v1, s[4:7], s52 offen sc1 lds
 v_cvt_pk_bf16_f32 v204, v152, v153
 v_mfma_f32_16x16x32_bf16 a[100:103], a[132:135], v[220:223], a[100:103]
 s_waitcnt lgkmcnt(7)
 ds_read_b128 a[172:175], v5 offset:11264
 v_exp_f32 v155, v155
 s_lshr_b32 s49, s47, 3
 v_mfma_f32_16x16x32_bf16 a[8:11], a[136:139], v[208:211], a[8:11]
 s_and_b32 s50, s47, 3
 v_add_f32 v156, v156, v228
 v_mfma_f32_16x16x32_bf16 a[40:43], a[136:139], v[212:215], a[40:43]
 s_lshl_b32 s30, s49, 15
 v_mfma_f32_16x16x32_bf16 a[72:75], a[136:139], v[216:219], a[72:75]
 s_add_u32 s30, s30, 50331648
 v_exp_f32 v156, v156
 v_mfma_f32_16x16x32_bf16 a[104:107], a[136:139], v[220:223], a[104:107]
 ds_read_b128 a[176:179], v5 offset:12288
 v_add_f32 v157, v157, v229
 s_mul_i32 s71, s50, 320
 v_mfma_f32_16x16x32_bf16 a[12:15], a[140:143], v[208:211], a[12:15]
 s_mul_i32 s28, s49, 1310720
 v_cvt_pk_bf16_f32 v205, v154, v155
 v_mfma_f32_16x16x32_bf16 a[44:47], a[140:143], v[212:215], a[44:47]
 s_add_u32 s28, s28, s71
 v_mfma_f32_16x16x32_bf16 a[76:79], a[140:143], v[216:219], a[76:79]
 s_mul_i32 s31, s49, 14
 v_exp_f32 v157, v157
 v_mfma_f32_16x16x32_bf16 a[108:111], a[140:143], v[220:223], a[108:111]
 s_waitcnt lgkmcnt(7)
 ds_read_b128 a[180:183], v5 offset:13312
 v_add_f32 v158, v158, v230
 v_mfma_f32_16x16x32_bf16 a[16:19], a[144:147], v[208:211], a[16:19]
 buffer_load_dwordx4 v1, s[4:7], s52 offen offset:1024 sc1 lds
 s_min_u32 s31, s31, 41
 v_mfma_f32_16x16x32_bf16 a[48:51], a[144:147], v[212:215], a[48:51]
 s_mul_i32 s29, s31, 40960
 v_exp_f32 v158, v158
 v_mfma_f32_16x16x32_bf16 a[80:83], a[144:147], v[216:219], a[80:83]
 ds_read_b128 a[184:187], v5 offset:14336
 v_add_f32 v159, v159, v231
 s_add_u32 s29, s29, s71
 v_mfma_f32_16x16x32_bf16 a[112:115], a[144:147], v[220:223], a[112:115]
 s_lshl_b32 s31, s31, 10
 v_cvt_pk_bf16_f32 v206, v156, v157
 v_mfma_f32_16x16x32_bf16 a[20:23], a[148:151], v[208:211], a[20:23]
 s_add_u32 s31, s31, 50462720
 v_exp_f32 v159, v159
 v_mfma_f32_16x16x32_bf16 a[52:55], a[148:151], v[212:215], a[52:55]
 s_add_u32 s35, s31, 13312
 v_mfma_f32_16x16x32_bf16 a[84:87], a[148:151], v[216:219], a[84:87]
 s_cmp_lt_u32 s49, 2
 s_cselect_b32 s35, s35, s51
 v_exp_f32 v128, v128
 ds_read_b128 a[188:191], v5 offset:15360
 v_mfma_f32_16x16x32_bf16 a[116:119], a[148:151], v[220:223], a[116:119]
 s_waitcnt lgkmcnt(8)
 s_and_b32 s32, s47, 7
 v_cvt_pk_bf16_f32 v207, v158, v159
 v_mfma_f32_16x16x32_bf16 a[24:27], a[152:155], v[208:211], a[24:27]
 v_exp_f32 v129, v129
 v_mfma_f32_16x16x32_bf16 a[56:59], a[152:155], v[212:215], a[56:59]
 s_lshl_b32 s32, s32, 1
 v_mfma_f32_16x16x32_bf16 a[88:91], a[152:155], v[216:219], a[88:91]
 v_add_u32 v6, 0x4000, v6
 v_and_b32 v6, 0xffff, v6
 ds_read_b128 a[128:131], v6
 s_lshl_b32 s33, s32, 11
 v_mfma_f32_16x16x32_bf16 a[120:123], a[152:155], v[220:223], a[120:123]
 s_add_u32 m0, s58, 0
 v_exp_f32 v130, v130
 s_and_b32 s71, s33, 0x4000
 v_cvt_pk_bf16_f32 v192, v128, v129
 v_mfma_f32_16x16x32_bf16 a[28:31], a[156:159], v[208:211], a[28:31]
 s_add_u32 s30, s30, s71
 v_exp_f32 v131, v131
 v_mfma_f32_16x16x32_bf16 a[60:63], a[156:159], v[212:215], a[60:63]
 ds_read_b128 a[132:135], v6 offset:1024
 v_exp_f32 v132, v132
 s_and_b32 s33, s33, 0x3fff
 v_mfma_f32_16x16x32_bf16 a[92:95], a[156:159], v[216:219], a[92:95]
 s_add_u32 s68, s28, 655360
 v_mfma_f32_16x16x32_bf16 a[124:127], a[156:159], v[220:223], a[124:127]
 s_waitcnt lgkmcnt(6)
 s_bitcmp1_b32 s47, 2
 s_cselect_b32 s71, s68, s28
 s_cselect_b32 s68, s28, s68
 v_cvt_pk_bf16_f32 v193, v130, v131
 v_mfma_f32_16x16x32_bf16 v[184:187], a[160:163], v[112:115], v[44:47]
 s_mov_b32 s28, s71
 v_exp_f32 v133, v133
 v_mfma_f32_16x16x32_bf16 v[184:187], a[164:167], v[116:119], v[184:187]
 ds_read_b128 a[136:139], v6 offset:2048
 v_exp_f32 v134, v134
 v_mfma_f32_16x16x32_bf16 v[184:187], a[168:171], v[120:123], v[184:187]
 s_and_b32 s32, s32, 7
 v_mfma_f32_16x16x32_bf16 v[184:187], a[172:175], v[124:127], v[184:187]
 buffer_load_dwordx4 v13, s[4:7], s52 offen sc1 lds
 v_cvt_pk_bf16_f32 v194, v132, v133
 v_mfma_f32_16x16x32_bf16 v[160:163], a[160:163], v[64:67], v[32:35]
 ds_read_b128 a[140:143], v6 offset:3072
 v_exp_f32 v135, v135
 s_lshl_b32 s50, s50, 3
 s_add_u32 s34, s34, s50
 v_mfma_f32_16x16x32_bf16 v[160:163], a[164:167], v[68:71], v[160:163]
 s_add_u32 s34, s34, s48
 v_exp_f32 v136, v136
 v_mfma_f32_16x16x32_bf16 v[160:163], a[168:171], v[72:75], v[160:163]
 s_lshl_b32 s34, s34, 2
 v_mfma_f32_16x16x32_bf16 v[160:163], a[172:175], v[76:79], v[160:163]
 s_add_u32 s34, s34, s44
 v_cvt_pk_bf16_f32 v195, v134, v135
 v_mfma_f32_16x16x32_bf16 v[168:171], a[160:163], v[80:83], v[36:39]
 ds_read_b128 a[144:147], v6 offset:4096
 v_exp_f32 v137, v137
 s_mul_i32 s34, s34, 10240
 v_mfma_f32_16x16x32_bf16 v[168:171], a[164:167], v[84:87], v[168:171]
 s_mul_i32 s50, s49, 2621440
 v_exp_f32 v138, v138
 v_mfma_f32_16x16x32_bf16 v[168:171], a[168:171], v[88:91], v[168:171]
 v_mfma_f32_16x16x32_bf16 v[168:171], a[172:175], v[92:95], v[168:171]
 s_waitcnt lgkmcnt(5)
 s_add_u32 s34, s34, s50
 v_cvt_pk_bf16_f32 v196, v136, v137
 v_mfma_f32_16x16x32_bf16 v[188:191], a[176:179], v[112:115], v[44:47]
 ds_read_b128 a[148:151], v6 offset:5120
 v_exp_f32 v139, v139
 s_add_u32 s34, s34, 75497472
 v_mfma_f32_16x16x32_bf16 v[188:191], a[180:183], v[116:119], v[188:191]
 buffer_load_dwordx4 v13, s[4:7], s52 offen offset:1024 sc1 lds
 s_and_b32 s49, s47, 28
 v_mfma_f32_16x16x32_bf16 v[188:191], a[184:187], v[120:123], v[188:191]
 s_lshl_b32 s49, s49, 2
 v_exp_f32 v140, v140
 v_mfma_f32_16x16x32_bf16 v[188:191], a[188:191], v[124:127], v[188:191]
 ds_read_b128 a[152:155], v6 offset:6144
 v_cvt_pk_bf16_f32 v197, v138, v139
 s_add_u32 s36, s36, s49
 v_mfma_f32_16x16x32_bf16 v[164:167], a[176:179], v[64:67], v[32:35]
 s_and_b32 s49, s3, 0xfffffe00
 v_exp_f32 v141, v141
 v_mfma_f32_16x16x32_bf16 v[164:167], a[180:183], v[68:71], v[164:167]
 s_add_u32 s36, s36, s49
 v_exp_f32 v142, v142
 v_mfma_f32_16x16x32_bf16 v[164:167], a[184:187], v[72:75], v[164:167]
 v_lshlrev_b32 v254, 2, v0
 v_mfma_f32_16x16x32_bf16 v[164:167], a[188:191], v[76:79], v[164:167]
 ds_read_b128 a[156:159], v6 offset:7168
 v_cvt_pk_bf16_f32 v198, v140, v141
 v_mfma_f32_16x16x32_bf16 v[172:175], a[176:179], v[80:83], v[36:39]
 v_exp_f32 v143, v143
 v_mfma_f32_16x16x32_bf16 v[172:175], a[180:183], v[84:87], v[172:175]
 v_cvt_pk_bf16_f32 v199, v142, v143
 v_mfma_f32_16x16x32_bf16 v[172:175], a[184:187], v[88:91], v[172:175]
 v_mfma_f32_16x16x32_bf16 v[172:175], a[188:191], v[92:95], v[172:175]
L_M3:
 v_mfma_f32_16x16x32_bf16 v[60:63], v[16:19], v[204:207], v[60:63]
 s_waitcnt vmcnt(10)
 s_barrier
 v_mfma_f32_16x16x32_bf16 v[48:51], v[16:19], v[192:195], v[48:51]
 v_xor_b32 v5, 0x4000, v5
 ds_read_b128 a[160:163], v5
 v_add_f32 v184, v184, v232
 s_add_u32 m0, s57, 8192
 v_mfma_f32_16x16x32_bf16 v[52:55], v[16:19], v[196:199], v[52:55]
 s_waitcnt lgkmcnt(7)
 v_exp_f32 v184, v184
 v_add_f32 v185, v185, v233
 v_cmp_nlt_f32 vcc, v56, v8
 s_nop 0
 s_cmp_lg_u64 vcc, 0
 s_cselect_b32 s61, 1, s61
 v_mfma_f32_16x16x32_bf16 a[96:99], a[128:131], v[204:207], a[96:99]
 ds_read_b128 a[164:167], v5 offset:1024
 v_exp_f32 v185, v185
 v_rcp_f32 v57, v56
 v_mfma_f32_16x16x32_bf16 a[0:3], a[128:131], v[192:195], a[0:3]
 v_add_f32 v186, v186, v234
 v_accvgpr_read_b32 v20, a64
 v_accvgpr_read_b32 v21, a65
 v_accvgpr_read_b32 v22, a66
 v_mfma_f32_16x16x32_bf16 a[32:35], a[128:131], v[196:199], a[32:35]
 buffer_load_dwordx4 v12, s[4:7], s52 offen sc1 lds
 v_accvgpr_read_b32 v23, a67
 v_accvgpr_read_b32 v24, a68
 v_mfma_f32_16x16x32_bf16 a[100:103], a[132:135], v[204:207], a[100:103]
 ds_read_b128 a[168:171], v5 offset:2048
 v_exp_f32 v186, v186
 v_add_f32 v187, v187, v235
 v_accvgpr_read_b32 v25, a69
 v_mfma_f32_16x16x32_bf16 a[4:7], a[132:135], v[192:195], a[4:7]
 v_cvt_pk_bf16_f32 v220, v184, v185
 v_accvgpr_read_b32 v26, a70
 v_accvgpr_read_b32 v27, a71
 v_mul_f32 v20, v57, v20
 v_mfma_f32_16x16x32_bf16 a[36:39], a[132:135], v[196:199], a[36:39]
 s_waitcnt lgkmcnt(7)
 ds_read_b128 a[172:175], v5 offset:3072
 v_exp_f32 v187, v187
 v_mul_f32 v21, v57, v21
 v_mul_f32 v22, v57, v22
 v_mfma_f32_16x16x32_bf16 a[104:107], a[136:139], v[204:207], a[104:107]
 buffer_load_dwordx4 v12, s[4:7], s52 offen offset:1024 sc1 lds
 v_add_f32 v188, v188, v236
 v_mul_f32 v23, v57, v23
 v_mfma_f32_16x16x32_bf16 a[8:11], a[136:139], v[192:195], a[8:11]
 v_exp_f32 v188, v188
 v_mul_f32 v24, v57, v24
 v_mul_f32 v25, v57, v25
 v_mfma_f32_16x16x32_bf16 a[40:43], a[136:139], v[196:199], a[40:43]
 ds_read_b128 a[176:179], v5 offset:4096
 v_add_f32 v189, v189, v237
 v_mul_f32 v26, v57, v26
 v_mul_f32 v27, v57, v27
 v_cvt_pk_bf16_f32 v28, v20, v21
 v_mfma_f32_16x16x32_bf16 a[108:111], a[140:143], v[204:207], a[108:111]
 v_cvt_pk_bf16_f32 v221, v186, v187
 v_cvt_pk_bf16_f32 v29, v22, v23
 v_cvt_pk_bf16_f32 v30, v24, v25
 v_cvt_pk_bf16_f32 v31, v26, v27
 v_mfma_f32_16x16x32_bf16 a[12:15], a[140:143], v[192:195], a[12:15]
 ds_read_b128 a[180:183], v5 offset:5120
 v_exp_f32 v189, v189
 s_add_u32 m0, s58, 8192
 v_mfma_f32_16x16x32_bf16 a[44:47], a[140:143], v[196:199], a[44:47]
 s_waitcnt lgkmcnt(8)
 v_add_f32 v190, v190, v238
 v_exp_f32 v190, v190
 v_mfma_f32_16x16x32_bf16 a[112:115], a[144:147], v[204:207], a[112:115]
 s_add_u32 s49, s63, 0
 buffer_store_dwordx4 v[28:31], v1, s[4:7], s49 offen sc1
 v_add_f32 v191, v191, v239
 v_mfma_f32_16x16x32_bf16 a[16:19], a[144:147], v[192:195], a[16:19]
 ds_read_b128 a[184:187], v5 offset:6144
 v_cvt_pk_bf16_f32 v222, v188, v189
 v_accvgpr_read_b32 v20, a72
 v_accvgpr_read_b32 v21, a73
 v_accvgpr_read_b32 v22, a74
 v_mfma_f32_16x16x32_bf16 a[48:51], a[144:147], v[196:199], a[48:51]
 buffer_load_dwordx4 v14, s[4:7], s52 offen sc1 lds
 v_accvgpr_read_b32 v23, a75
 v_accvgpr_read_b32 v24, a76
 v_mfma_f32_16x16x32_bf16 a[116:119], a[148:151], v[204:207], a[116:119]
 ds_read_b128 a[188:191], v5 offset:7168
 v_exp_f32 v191, v191
 v_accvgpr_read_b32 v25, a77
 v_accvgpr_read_b32 v26, a78
 v_mfma_f32_16x16x32_bf16 a[20:23], a[148:151], v[192:195], a[20:23]
 v_exp_f32 v160, v160
 v_cvt_pk_bf16_f32 v223, v190, v191
 v_accvgpr_read_b32 v27, a79
 v_mfma_f32_16x16x32_bf16 a[52:55], a[148:151], v[196:199], a[52:55]
 s_waitcnt lgkmcnt(8)
 v_exp_f32 v161, v161
 v_mul_f32 v20, v57, v20
 v_mul_f32 v21, v57, v21
 v_mfma_f32_16x16x32_bf16 a[120:123], a[152:155], v[204:207], a[120:123]
 ds_read_b128 a[128:131], v6 offset:8192
 v_exp_f32 v162, v162
 v_mul_f32 v22, v57, v22
 v_mul_f32 v23, v57, v23
 v_mfma_f32_16x16x32_bf16 a[24:27], a[152:155], v[192:195], a[24:27]
 buffer_load_dwordx4 v14, s[4:7], s52 offen offset:1024 sc1 lds
 v_cvt_pk_bf16_f32 v208, v160, v161
 v_mul_f32 v24, v57, v24
 v_mfma_f32_16x16x32_bf16 a[56:59], a[152:155], v[196:199], a[56:59]
 v_exp_f32 v163, v163
 v_mul_f32 v25, v57, v25
 v_mul_f32 v26, v57, v26
 v_mfma_f32_16x16x32_bf16 a[124:127], a[156:159], v[204:207], a[124:127]
 ds_read_b128 a[132:135], v6 offset:9216
 v_exp_f32 v164, v164
 v_mul_f32 v27, v57, v27
 v_cvt_pk_bf16_f32 v28, v20, v21
 v_mfma_f32_16x16x32_bf16 a[28:31], a[156:159], v[192:195], a[28:31]
 s_xor_b32 s57, s57, 0x4000
 v_cvt_pk_bf16_f32 v209, v162, v163
 v_cvt_pk_bf16_f32 v29, v22, v23
 v_cvt_pk_bf16_f32 v30, v24, v25
 v_cvt_pk_bf16_f32 v31, v26, v27
 v_mfma_f32_16x16x32_bf16 a[60:63], a[156:159], v[196:199], a[60:63]
 s_waitcnt lgkmcnt(6)
 ds_read_b128 a[136:139], v6 offset:10240
 v_exp_f32 v165, v165
 v_mfma_f32_16x16x32_bf16 v[128:131], a[160:163], v[64:67], v[32:35]
 s_add_u32 s49, s63, 0
 buffer_store_dwordx4 v[28:31], v1, s[4:7], s49 offen offset:1024 sc1
 v_exp_f32 v166, v166
 v_mfma_f32_16x16x32_bf16 v[128:131], a[164:167], v[68:71], v[128:131]
 v_cvt_pk_bf16_f32 v210, v164, v165
 v_exp_f32 v167, v167
 v_accvgpr_read_b32 v20, a80
 v_mfma_f32_16x16x32_bf16 v[128:131], a[168:171], v[72:75], v[128:131]
 ds_read_b128 a[140:143], v6 offset:11264
 v_exp_f32 v168, v168
 s_add_u32 s58, s58, 0x4000
 v_accvgpr_read_b32 v21, a81
 v_accvgpr_read_b32 v22, a82
 v_mfma_f32_16x16x32_bf16 v[128:131], a[172:175], v[76:79], v[128:131]
 v_cvt_pk_bf16_f32 v211, v166, v167
 v_accvgpr_read_b32 v23, a83
 v_accvgpr_read_b32 v24, a84
 v_accvgpr_read_b32 v25, a85
 v_mfma_f32_16x16x32_bf16 v[136:139], a[160:163], v[80:83], v[36:39]
 ds_read_b128 a[144:147], v6 offset:12288
 v_exp_f32 v169, v169
 v_accvgpr_read_b32 v26, a86
 v_accvgpr_read_b32 v27, a87
 v_mfma_f32_16x16x32_bf16 v[136:139], a[164:167], v[84:87], v[136:139]
 v_exp_f32 v170, v170
 v_mul_f32 v20, v57, v20
 v_mul_f32 v21, v57, v21
 v_mfma_f32_16x16x32_bf16 v[136:139], a[168:171], v[88:91], v[136:139]
 s_and_b32 s58, s58, 0xffff
 v_cvt_pk_bf16_f32 v212, v168, v169
 v_mul_f32 v22, v57, v22
 v_mul_f32 v23, v57, v23
 v_mul_f32 v24, v57, v24
 v_mfma_f32_16x16x32_bf16 v[136:139], a[172:175], v[92:95], v[136:139]
 s_waitcnt lgkmcnt(5)
 ds_read_b128 a[148:151], v6 offset:13312
 v_exp_f32 v171, v171
 v_mul_f32 v25, v57, v25
 v_mul_f32 v26, v57, v26
 v_mfma_f32_16x16x32_bf16 v[132:135], a[176:179], v[64:67], v[32:35]
 v_exp_f32 v172, v172
 v_mul_f32 v27, v57, v27
 v_cvt_pk_bf16_f32 v28, v20, v21
 v_mfma_f32_16x16x32_bf16 v[132:135], a[180:183], v[68:71], v[132:135]
 ds_read_b128 a[152:155], v6 offset:14336
 v_cvt_pk_bf16_f32 v213, v170, v171
 v_cvt_pk_bf16_f32 v29, v22, v23
 v_cvt_pk_bf16_f32 v30, v24, v25
 v_cvt_pk_bf16_f32 v31, v26, v27
 v_mfma_f32_16x16x32_bf16 v[132:135], a[184:187], v[72:75], v[132:135]
 s_add_u32 s52, s52, 0x4000
 v_exp_f32 v173, v173
 v_mfma_f32_16x16x32_bf16 v[132:135], a[188:191], v[76:79], v[132:135]
 s_add_u32 s49, s63, 0
 buffer_store_dwordx4 v[28:31], v1, s[4:7], s49 offen offset:2048 sc1
 v_exp_f32 v174, v174
 v_mfma_f32_16x16x32_bf16 v[140:143], a[176:179], v[80:83], v[36:39]
 ds_read_b128 a[156:159], v6 offset:15360
 v_cvt_pk_bf16_f32 v214, v172, v173
 v_accvgpr_read_b32 v20, a88
 v_accvgpr_read_b32 v21, a89
 v_accvgpr_read_b32 v22, a90
 v_mfma_f32_16x16x32_bf16 v[140:143], a[180:183], v[84:87], v[140:143]
 v_exp_f32 v175, v175
 v_accvgpr_read_b32 v23, a91
 v_accvgpr_read_b32 v24, a92
 v_mfma_f32_16x16x32_bf16 v[140:143], a[184:187], v[88:91], v[140:143]
 v_cvt_pk_bf16_f32 v215, v174, v175
 v_accvgpr_read_b32 v25, a93
 v_accvgpr_read_b32 v26, a94
 v_accvgpr_read_b32 v27, a95
 v_mfma_f32_16x16x32_bf16 v[140:143], a[188:191], v[92:95], v[140:143]
 v_mul_f32 v20, v57, v20
 v_mul_f32 v21, v57, v21
 v_mul_f32 v22, v57, v22
 v_mul_f32 v23, v57, v23
 v_mul_f32 v24, v57, v24
 v_mul_f32 v25, v57, v25
 v_mul_f32 v26, v57, v26
 v_mul_f32 v27, v57, v27
 v_cvt_pk_bf16_f32 v28, v20, v21
 v_cvt_pk_bf16_f32 v29, v22, v23
 v_cvt_pk_bf16_f32 v30, v24, v25
 v_cvt_pk_bf16_f32 v31, v26, v27
 s_add_u32 s49, s63, 0
 buffer_store_dwordx4 v[28:31], v1, s[4:7], s49 offen offset:3072 sc1
L_M4:
 v_max_f32 v20, v132, v140
 s_cmp_lg_u32 s48, 7
 s_cbranch_scc1 L_M4b
 v_add_f32 v128, v128, v224
 v_add_f32 v129, v129, v225
 v_add_f32 v130, v130, v226
 v_add_f32 v131, v131, v227
 v_add_f32 v132, v132, v228
 v_add_f32 v133, v133, v229
 v_add_f32 v134, v134, v230
 v_add_f32 v135, v135, v231
L_M4b:
 v_mfma_f32_16x16x32_bf16 v[60:63], v[16:19], v[220:223], v[60:63]
 s_waitcnt vmcnt(10)
 s_barrier
 v_mfma_f32_16x16x32_bf16 v[48:51], v[16:19], v[208:211], v[48:51]
 ds_read_b128 a[160:163], v5 offset:8192
 v_exp_f32 v128, v128
 v_mfma_f32_16x16x32_bf16 v[52:55], v[16:19], v[212:215], v[52:55]
 s_waitcnt lgkmcnt(7)
 buffer_store_dword v9, v4, s[4:7], s3 offen sc1
 v_mfma_f32_16x16x32_bf16 a[96:99], a[128:131], v[220:223], a[96:99]
 ds_read_b128 a[164:167], v5 offset:9216
 v_exp_f32 v129, v129
 v_mfma_f32_16x16x32_bf16 a[0:3], a[128:131], v[208:211], a[0:3]
 v_exp_f32 v130, v130
 v_mfma_f32_16x16x32_bf16 a[32:35], a[128:131], v[212:215], a[32:35]
 v_mfma_f32_16x16x32_bf16 a[100:103], a[132:135], v[220:223], a[100:103]
 ds_read_b128 a[168:171], v5 offset:10240
 s_add_u32 m0, s57, 0
 v_cvt_pk_bf16_f32 v192, v128, v129
 v_cmp_nlt_f32 vcc, v60, v8
 s_nop 0
 s_cmp_lg_u64 vcc, 0
 s_cselect_b32 s61, 1, s61
 v_mfma_f32_16x16x32_bf16 a[4:7], a[132:135], v[208:211], a[4:7]
 v_exp_f32 v131, v131
 v_mfma_f32_16x16x32_bf16 a[36:39], a[132:135], v[212:215], a[36:39]
 s_waitcnt lgkmcnt(7)
 ds_read_b128 a[172:175], v5 offset:11264
 v_mfma_f32_16x16x32_bf16 a[104:107], a[136:139], v[220:223], a[104:107]
 v_exp_f32 v132, v132
 v_mfma_f32_16x16x32_bf16 a[8:11], a[136:139], v[208:211], a[8:11]
 v_mfma_f32_16x16x32_bf16 a[40:43], a[136:139], v[212:215], a[40:43]
 ds_read_b128 a[176:179], v5 offset:12288
 v_cvt_pk_bf16_f32 v193, v130, v131
 v_mfma_f32_16x16x32_bf16 a[108:111], a[140:143], v[220:223], a[108:111]
 buffer_load_dwordx4 v1, s[4:7], s52 offen sc1 lds
 v_rcp_f32 v61, v60
 v_accvgpr_read_b32 v20, a96
 v_mfma_f32_16x16x32_bf16 a[12:15], a[140:143], v[208:211], a[12:15]
 ds_read_b128 a[180:183], v5 offset:13312
 v_exp_f32 v133, v133
 v_accvgpr_read_b32 v21, a97
 v_accvgpr_read_b32 v22, a98
 v_accvgpr_read_b32 v23, a99
 v_mfma_f32_16x16x32_bf16 a[44:47], a[140:143], v[212:215], a[44:47]
 s_waitcnt lgkmcnt(8)
 v_exp_f32 v134, v134
 v_accvgpr_read_b32 v24, a100
 v_accvgpr_read_b32 v25, a101
 v_accvgpr_read_b32 v26, a102
 v_mfma_f32_16x16x32_bf16 a[112:115], a[144:147], v[220:223], a[112:115]
 v_accvgpr_read_b32 v27, a103
 v_mul_f32 v20, v61, v20
 v_mul_f32 v21, v61, v21
 v_mul_f32 v22, v61, v22
 v_mul_f32 v23, v61, v23
 v_mfma_f32_16x16x32_bf16 a[16:19], a[144:147], v[208:211], a[16:19]
 ds_read_b128 a[184:187], v5 offset:14336
 v_cvt_pk_bf16_f32 v194, v132, v133
 v_mul_f32 v24, v61, v24
 v_mul_f32 v25, v61, v25
 v_mul_f32 v26, v61, v26
 v_mul_f32 v27, v61, v27
 v_mfma_f32_16x16x32_bf16 a[48:51], a[144:147], v[212:215], a[48:51]
 v_cvt_pk_bf16_f32 v28, v20, v21
 v_cvt_pk_bf16_f32 v29, v22, v23
 v_cvt_pk_bf16_f32 v30, v24, v25
 v_cvt_pk_bf16_f32 v31, v26, v27
 v_mfma_f32_16x16x32_bf16 a[116:119], a[148:151], v[220:223], a[116:119]
 s_add_u32 s49, s63, 745472
 buffer_store_dwordx4 v[28:31], v1, s[4:7], s49 offen sc1
 v_exp_f32 v135, v135
 ds_read_b128 a[188:191], v5 offset:15360
 v_mfma_f32_16x16x32_bf16 a[20:23], a[148:151], v[208:211], a[20:23]
 buffer_load_dwordx4 v1, s[4:7], s52 offen offset:1024 sc1 lds
 v_accvgpr_read_b32 v20, a104
 v_accvgpr_read_b32 v21, a105
 v_accvgpr_read_b32 v22, a106
 v_mfma_f32_16x16x32_bf16 a[52:55], a[148:151], v[212:215], a[52:55]
 s_waitcnt lgkmcnt(8)
 v_exp_f32 v136, v136
 v_accvgpr_read_b32 v23, a107
 v_accvgpr_read_b32 v24, a108
 v_accvgpr_read_b32 v25, a109
 v_mfma_f32_16x16x32_bf16 a[120:123], a[152:155], v[220:223], a[120:123]
 v_add_u32 v6, 0x4000, v6
 v_and_b32 v6, 0xffff, v6
 ds_read_b128 a[128:131], v6
 v_cvt_pk_bf16_f32 v195, v134, v135
 v_accvgpr_read_b32 v26, a110
 v_accvgpr_read_b32 v27, a111
 v_mfma_f32_16x16x32_bf16 a[24:27], a[152:155], v[208:211], a[24:27]
 v_mul_f32 v20, v61, v20
 v_mul_f32 v21, v61, v21
 v_mul_f32 v22, v61, v22
 v_mul_f32 v23, v61, v23
 v_mul_f32 v24, v61, v24
 v_mfma_f32_16x16x32_bf16 a[56:59], a[152:155], v[212:215], a[56:59]
 v_exp_f32 v137, v137
 v_mul_f32 v25, v61, v25
 v_mul_f32 v26, v61, v26
 v_mul_f32 v27, v61, v27
 v_mfma_f32_16x16x32_bf16 a[124:127], a[156:159], v[220:223], a[124:127]
 ds_read_b128 a[132:135], v6 offset:1024
 v_exp_f32 v138, v138
 s_add_u32 m0, s58, 0
 v_cvt_pk_bf16_f32 v28, v20, v21
 v_cvt_pk_bf16_f32 v29, v22, v23
 v_cvt_pk_bf16_f32 v30, v24, v25
 v_mfma_f32_16x16x32_bf16 a[28:31], a[156:159], v[208:211], a[28:31]
 v_cvt_pk_bf16_f32 v31, v26, v27
 s_add_u32 s49, s63, 745472
 buffer_store_dwordx4 v[28:31], v1, s[4:7], s49 offen offset:1024 sc1
 v_accvgpr_read_b32 v20, a112
 v_mfma_f32_16x16x32_bf16 a[60:63], a[156:159], v[212:215], a[60:63]
 s_waitcnt lgkmcnt(6)
 ds_read_b128 a[136:139], v6 offset:2048
 v_cvt_pk_bf16_f32 v196, v136, v137
 v_accvgpr_read_b32 v21, a113
 v_accvgpr_read_b32 v22, a114
 v_accvgpr_read_b32 v23, a115
 v_accvgpr_read_b32 v24, a116
 v_mfma_f32_16x16x32_bf16 v[160:163], a[160:163], v[64:67], v[32:35]
 v_accvgpr_read_b32 v25, a117
 v_accvgpr_read_b32 v26, a118
 v_accvgpr_read_b32 v27, a119
 v_mul_f32 v20, v61, v20
 v_mul_f32 v21, v61, v21
 v_mfma_f32_16x16x32_bf16 v[160:163], a[164:167], v[68:71], v[160:163]
 v_exp_f32 v139, v139
 v_mul_f32 v22, v61, v22
 v_mul_f32 v23, v61, v23
 v_mul_f32 v24, v61, v24
 v_mfma_f32_16x16x32_bf16 v[160:163], a[168:171], v[72:75], v[160:163]
 ds_read_b128 a[140:143], v6 offset:3072
 v_mul_f32 v25, v61, v25
 v_mul_f32 v26, v61, v26
 v_mul_f32 v27, v61, v27
 v_cvt_pk_bf16_f32 v28, v20, v21
 v_cvt_pk_bf16_f32 v29, v22, v23
 v_mfma_f32_16x16x32_bf16 v[160:163], a[172:175], v[76:79], v[160:163]
 buffer_load_dwordx4 v13, s[4:7], s52 offen sc1 lds
 v_cvt_pk_bf16_f32 v30, v24, v25
 v_cvt_pk_bf16_f32 v31, v26, v27
 v_mfma_f32_16x16x32_bf16 v[168:171], a[160:163], v[80:83], v[36:39]
 ds_read_b128 a[144:147], v6 offset:4096
 v_exp_f32 v140, v140
 v_cvt_pk_bf16_f32 v197, v138, v139
 v_mfma_f32_16x16x32_bf16 v[168:171], a[164:167], v[84:87], v[168:171]
 s_add_u32 s49, s63, 745472
 buffer_store_dwordx4 v[28:31], v1, s[4:7], s49 offen offset:2048 sc1
 v_accvgpr_read_b32 v20, a120
 v_accvgpr_read_b32 v21, a121
 v_mfma_f32_16x16x32_bf16 v[168:171], a[168:171], v[88:91], v[168:171]
 v_exp_f32 v141, v141
 v_accvgpr_read_b32 v22, a122
 v_accvgpr_read_b32 v23, a123
 v_accvgpr_read_b32 v24, a124
 v_mfma_f32_16x16x32_bf16 v[168:171], a[172:175], v[92:95], v[168:171]
 s_waitcnt lgkmcnt(5)
 ds_read_b128 a[148:151], v6 offset:5120
 v_accvgpr_read_b32 v25, a125
 v_accvgpr_read_b32 v26, a126
 v_accvgpr_read_b32 v27, a127
 v_mul_f32 v20, v61, v20
 v_mul_f32 v21, v61, v21
 v_mfma_f32_16x16x32_bf16 v[164:167], a[176:179], v[64:67], v[32:35]
 v_exp_f32 v142, v142
 v_mul_f32 v22, v61, v22
 v_mul_f32 v23, v61, v23
 v_mul_f32 v24, v61, v24
 v_mfma_f32_16x16x32_bf16 v[164:167], a[180:183], v[68:71], v[164:167]
 ds_read_b128 a[152:155], v6 offset:6144
 v_cvt_pk_bf16_f32 v198, v140, v141
 v_mul_f32 v25, v61, v25
 v_mul_f32 v26, v61, v26
 v_mul_f32 v27, v61, v27
 v_cvt_pk_bf16_f32 v28, v20, v21
 v_mfma_f32_16x16x32_bf16 v[164:167], a[184:187], v[72:75], v[164:167]
 buffer_load_dwordx4 v13, s[4:7], s52 offen offset:1024 sc1 lds
 v_cvt_pk_bf16_f32 v29, v22, v23
 v_cvt_pk_bf16_f32 v30, v24, v25
 v_cvt_pk_bf16_f32 v31, v26, v27
 v_mfma_f32_16x16x32_bf16 v[164:167], a[188:191], v[76:79], v[164:167]
 s_add_u32 s49, s63, 745472
 buffer_store_dwordx4 v[28:31], v1, s[4:7], s49 offen offset:3072 sc1
 v_exp_f32 v143, v143
 v_mfma_f32_16x16x32_bf16 v[172:175], a[176:179], v[80:83], v[36:39]
 ds_read_b128 a[156:159], v6 offset:7168
 v_mfma_f32_16x16x32_bf16 v[172:175], a[180:183], v[84:87], v[172:175]
 v_cvt_pk_bf16_f32 v199, v142, v143
 v_mfma_f32_16x16x32_bf16 v[172:175], a[184:187], v[88:91], v[172:175]
 v_mfma_f32_16x16x32_bf16 v[172:175], a[188:191], v[92:95], v[172:175]
 s_lshl_b32 s59, s48, 2
 s_sub_u32 s59, 25, s59
 s_cbranch_scc1 L_G7
 .p2align 6
L_S1:
 v_mfma_f32_16x16x32_bf16 v[48:51], v[16:19], v[192:195], v[48:51]
 s_waitcnt vmcnt(10)
 s_barrier
 v_mfma_f32_16x16x32_bf16 v[52:55], v[16:19], v[196:199], v[52:55]
 s_waitcnt lgkmcnt(6)
 v_xor_b32 v5, 0x4000, v5
 ds_read_b128 a[160:163], v5
 s_add_u32 m0, s57, 8192
 v_mfma_f32_16x16x32_bf16 a[0:3], a[128:131], v[192:195], a[0:3]
 v_exp_f32 v160, v160
 v_mfma_f32_16x16x32_bf16 a[32:35], a[128:131], v[196:199], a[32:35]
 ds_read_b128 a[164:167], v5 offset:1024
 v_exp_f32 v161, v161
 v_mfma_f32_16x16x32_bf16 a[4:7], a[132:135], v[192:195], a[4:7]
 buffer_load_dwordx4 v12, s[4:7], s52 offen sc1 lds
 v_mfma_f32_16x16x32_bf16 a[36:39], a[132:135], v[196:199], a[36:39]
 s_waitcnt lgkmcnt(6)
 ds_read_b128 a[168:171], v5 offset:2048
 v_exp_f32 v162, v162
 v_mfma_f32_16x16x32_bf16 a[8:11], a[136:139], v[192:195], a[8:11]
 v_cvt_pk_bf16_f32 v208, v160, v161
 v_mfma_f32_16x16x32_bf16 a[40:43], a[136:139], v[196:199], a[40:43]
 ds_read_b128 a[172:175], v5 offset:3072
 v_exp_f32 v163, v163
 v_mfma_f32_16x16x32_bf16 a[12:15], a[140:143], v[192:195], a[12:15]
 buffer_load_dwordx4 v12, s[4:7], s52 offen offset:1024 sc1 lds
 v_mfma_f32_16x16x32_bf16 a[44:47], a[140:143], v[196:199], a[44:47]
 s_waitcnt lgkmcnt(6)
 ds_read_b128 a[176:179], v5 offset:4096
 v_exp_f32 v164, v164
 v_mfma_f32_16x16x32_bf16 a[16:19], a[144:147], v[192:195], a[16:19]
 s_add_u32 m0, s58, 8192
 v_cvt_pk_bf16_f32 v209, v162, v163
 v_mfma_f32_16x16x32_bf16 a[48:51], a[144:147], v[196:199], a[48:51]
 ds_read_b128 a[180:183], v5 offset:5120
 v_exp_f32 v165, v165
 v_mfma_f32_16x16x32_bf16 a[20:23], a[148:151], v[192:195], a[20:23]
 v_exp_f32 v166, v166
 v_mfma_f32_16x16x32_bf16 a[52:55], a[148:151], v[196:199], a[52:55]
 s_waitcnt lgkmcnt(6)
 ds_read_b128 a[184:187], v5 offset:6144
 v_cvt_pk_bf16_f32 v210, v164, v165
 v_mfma_f32_16x16x32_bf16 a[24:27], a[152:155], v[192:195], a[24:27]
 buffer_load_dwordx4 v14, s[4:7], s52 offen sc1 lds
 v_mfma_f32_16x16x32_bf16 a[56:59], a[152:155], v[196:199], a[56:59]
 ds_read_b128 a[188:191], v5 offset:7168
 v_exp_f32 v167, v167
 v_mfma_f32_16x16x32_bf16 a[28:31], a[156:159], v[192:195], a[28:31]
 v_exp_f32 v168, v168
 v_mfma_f32_16x16x32_bf16 a[60:63], a[156:159], v[196:199], a[60:63]
 s_waitcnt lgkmcnt(4)
 ds_read_b128 a[128:131], v6 offset:8192
 v_cvt_pk_bf16_f32 v211, v166, v167
 v_mfma_f32_16x16x32_bf16 v[128:131], a[160:163], v[64:67], v[32:35]
 buffer_load_dwordx4 v14, s[4:7], s52 offen offset:1024 sc1 lds
 v_mfma_f32_16x16x32_bf16 v[128:131], a[164:167], v[68:71], v[128:131]
 ds_read_b128 a[132:135], v6 offset:9216
 v_exp_f32 v169, v169
 v_mfma_f32_16x16x32_bf16 v[128:131], a[168:171], v[72:75], v[128:131]
 s_xor_b32 s57, s57, 0x4000
 v_exp_f32 v170, v170
 v_mfma_f32_16x16x32_bf16 v[128:131], a[172:175], v[76:79], v[128:131]
 ds_read_b128 a[136:139], v6 offset:10240
 v_cvt_pk_bf16_f32 v212, v168, v169
 v_mfma_f32_16x16x32_bf16 v[136:139], a[160:163], v[80:83], v[36:39]
 v_exp_f32 v171, v171
 v_mfma_f32_16x16x32_bf16 v[136:139], a[164:167], v[84:87], v[136:139]
 ds_read_b128 a[140:143], v6 offset:11264
 v_exp_f32 v172, v172
 s_add_u32 s58, s58, 0x4000
 v_mfma_f32_16x16x32_bf16 v[136:139], a[168:171], v[88:91], v[136:139]
 v_mfma_f32_16x16x32_bf16 v[136:139], a[172:175], v[92:95], v[136:139]
 s_waitcnt lgkmcnt(4)
 ds_read_b128 a[144:147], v6 offset:12288
 v_cvt_pk_bf16_f32 v213, v170, v171
 v_mfma_f32_16x16x32_bf16 v[132:135], a[176:179], v[64:67], v[32:35]
 s_and_b32 s58, s58, 0xffff
 v_exp_f32 v173, v173
 v_mfma_f32_16x16x32_bf16 v[132:135], a[180:183], v[68:71], v[132:135]
 ds_read_b128 a[148:151], v6 offset:13312
 v_exp_f32 v174, v174
 v_mfma_f32_16x16x32_bf16 v[132:135], a[184:187], v[72:75], v[132:135]
 v_mfma_f32_16x16x32_bf16 v[132:135], a[188:191], v[76:79], v[132:135]
 ds_read_b128 a[152:155], v6 offset:14336
 v_cvt_pk_bf16_f32 v214, v172, v173
 s_add_u32 s52, s52, 0x4000
 v_mfma_f32_16x16x32_bf16 v[140:143], a[176:179], v[80:83], v[36:39]
 v_exp_f32 v175, v175
 v_mfma_f32_16x16x32_bf16 v[140:143], a[180:183], v[84:87], v[140:143]
 ds_read_b128 a[156:159], v6 offset:15360
 v_cvt_pk_bf16_f32 v215, v174, v175
 v_mfma_f32_16x16x32_bf16 v[140:143], a[184:187], v[88:91], v[140:143]
 v_mfma_f32_16x16x32_bf16 v[140:143], a[188:191], v[92:95], v[140:143]
 s_sub_u32 s59, s59, 1
 s_cbranch_scc1 L_P0
 v_mfma_f32_16x16x32_bf16 v[48:51], v[16:19], v[208:211], v[48:51]
 s_waitcnt vmcnt(10)
 s_barrier
 v_mfma_f32_16x16x32_bf16 v[52:55], v[16:19], v[212:215], v[52:55]
 s_waitcnt lgkmcnt(6)
 ds_read_b128 a[160:163], v5 offset:8192
 v_exp_f32 v128, v128
 s_add_u32 m0, s57, 0
 v_mfma_f32_16x16x32_bf16 a[0:3], a[128:131], v[208:211], a[0:3]
 v_exp_f32 v129, v129
 v_mfma_f32_16x16x32_bf16 a[32:35], a[128:131], v[212:215], a[32:35]
 ds_read_b128 a[164:167], v5 offset:9216
 v_exp_f32 v130, v130
 v_mfma_f32_16x16x32_bf16 a[4:7], a[132:135], v[208:211], a[4:7]
 v_mfma_f32_16x16x32_bf16 a[36:39], a[132:135], v[212:215], a[36:39]
 s_waitcnt lgkmcnt(6)
 ds_read_b128 a[168:171], v5 offset:10240
 v_cvt_pk_bf16_f32 v192, v128, v129
 v_mfma_f32_16x16x32_bf16 a[8:11], a[136:139], v[208:211], a[8:11]
 buffer_load_dwordx4 v1, s[4:7], s52 offen sc1 lds
 v_mfma_f32_16x16x32_bf16 a[40:43], a[136:139], v[212:215], a[40:43]
 ds_read_b128 a[172:175], v5 offset:11264
 v_exp_f32 v131, v131
 v_mfma_f32_16x16x32_bf16 a[12:15], a[140:143], v[208:211], a[12:15]
 v_exp_f32 v132, v132
 v_mfma_f32_16x16x32_bf16 a[44:47], a[140:143], v[212:215], a[44:47]
 s_waitcnt lgkmcnt(6)
 ds_read_b128 a[176:179], v5 offset:12288
 v_cvt_pk_bf16_f32 v193, v130, v131
 v_mfma_f32_16x16x32_bf16 a[16:19], a[144:147], v[208:211], a[16:19]
 v_exp_f32 v133, v133
 v_mfma_f32_16x16x32_bf16 a[48:51], a[144:147], v[212:215], a[48:51]
 ds_read_b128 a[180:183], v5 offset:13312
 v_exp_f32 v134, v134
 v_mfma_f32_16x16x32_bf16 a[20:23], a[148:151], v[208:211], a[20:23]
 buffer_load_dwordx4 v1, s[4:7], s52 offen offset:1024 sc1 lds
 v_mfma_f32_16x16x32_bf16 a[52:55], a[148:151], v[212:215], a[52:55]
 s_waitcnt lgkmcnt(6)
 ds_read_b128 a[184:187], v5 offset:14336
 v_cvt_pk_bf16_f32 v194, v132, v133
 v_mfma_f32_16x16x32_bf16 a[24:27], a[152:155], v[208:211], a[24:27]
 v_exp_f32 v135, v135
 v_mfma_f32_16x16x32_bf16 a[56:59], a[152:155], v[212:215], a[56:59]
 ds_read_b128 a[188:191], v5 offset:15360
 v_exp_f32 v136, v136
 v_mfma_f32_16x16x32_bf16 a[28:31], a[156:159], v[208:211], a[28:31]
 v_mfma_f32_16x16x32_bf16 a[60:63], a[156:159], v[212:215], a[60:63]
 s_waitcnt lgkmcnt(4)
 v_add_u32 v6, 0x4000, v6
 v_and_b32 v6, 0xffff, v6
 ds_read_b128 a[128:131], v6
 v_mfma_f32_16x16x32_bf16 v[160:163], a[160:163], v[64:67], v[32:35]
 s_add_u32 m0, s58, 0
 v_cvt_pk_bf16_f32 v195, v134, v135
 v_mfma_f32_16x16x32_bf16 v[160:163], a[164:167], v[68:71], v[160:163]
 ds_read_b128 a[132:135], v6 offset:1024
 v_exp_f32 v137, v137
 v_mfma_f32_16x16x32_bf16 v[160:163], a[168:171], v[72:75], v[160:163]
 v_exp_f32 v138, v138
 v_mfma_f32_16x16x32_bf16 v[160:163], a[172:175], v[76:79], v[160:163]
 ds_read_b128 a[136:139], v6 offset:2048
 v_cvt_pk_bf16_f32 v196, v136, v137
 v_mfma_f32_16x16x32_bf16 v[168:171], a[160:163], v[80:83], v[36:39]
 buffer_load_dwordx4 v13, s[4:7], s52 offen sc1 lds
 v_mfma_f32_16x16x32_bf16 v[168:171], a[164:167], v[84:87], v[168:171]
 ds_read_b128 a[140:143], v6 offset:3072
 v_exp_f32 v139, v139
 v_mfma_f32_16x16x32_bf16 v[168:171], a[168:171], v[88:91], v[168:171]
 v_exp_f32 v140, v140
 v_mfma_f32_16x16x32_bf16 v[168:171], a[172:175], v[92:95], v[168:171]
 s_waitcnt lgkmcnt(4)
 ds_read_b128 a[144:147], v6 offset:4096
 v_cvt_pk_bf16_f32 v197, v138, v139
 v_mfma_f32_16x16x32_bf16 v[164:167], a[176:179], v[64:67], v[32:35]
 v_exp_f32 v141, v141
 v_mfma_f32_16x16x32_bf16 v[164:167], a[180:183], v[68:71], v[164:167]
 ds_read_b128 a[148:151], v6 offset:5120
 v_exp_f32 v142, v142
 v_mfma_f32_16x16x32_bf16 v[164:167], a[184:187], v[72:75], v[164:167]
 buffer_load_dwordx4 v13, s[4:7], s52 offen offset:1024 sc1 lds
 v_mfma_f32_16x16x32_bf16 v[164:167], a[188:191], v[76:79], v[164:167]
 ds_read_b128 a[152:155], v6 offset:6144
 v_cvt_pk_bf16_f32 v198, v140, v141
 v_mfma_f32_16x16x32_bf16 v[172:175], a[176:179], v[80:83], v[36:39]
 v_exp_f32 v143, v143
 v_mfma_f32_16x16x32_bf16 v[172:175], a[180:183], v[84:87], v[172:175]
 ds_read_b128 a[156:159], v6 offset:7168
 v_cvt_pk_bf16_f32 v199, v142, v143
 v_mfma_f32_16x16x32_bf16 v[172:175], a[184:187], v[88:91], v[172:175]
 v_mfma_f32_16x16x32_bf16 v[172:175], a[188:191], v[92:95], v[172:175]
 s_branch L_S1
L_P0:
 v_mfma_f32_16x16x32_bf16 v[48:51], v[16:19], v[208:211], v[48:51]
 s_waitcnt vmcnt(10)
 s_barrier
 v_mfma_f32_16x16x32_bf16 v[52:55], v[16:19], v[212:215], v[52:55]
 s_waitcnt lgkmcnt(6)
 s_and_b32 s27, s3, 0xfffffe00
 buffer_load_dword v241, v254, s[4:7], s27 offen sc1
 ds_read_b128 a[160:163], v5 offset:8192
 v_mfma_f32_16x16x32_bf16 a[0:3], a[128:131], v[208:211], a[0:3]
 s_add_u32 s55, s29, 0
 v_exp_f32 v128, v128
 v_mfma_f32_16x16x32_bf16 a[32:35], a[128:131], v[212:215], a[32:35]
 ds_read_b128 a[164:167], v5 offset:9216
 v_exp_f32 v129, v129
 v_mfma_f32_16x16x32_bf16 a[4:7], a[132:135], v[208:211], a[4:7]
 s_add_u32 m0, s38, 65536
 v_exp_f32 v130, v130
 v_mfma_f32_16x16x32_bf16 a[36:39], a[132:135], v[212:215], a[36:39]
 s_waitcnt lgkmcnt(6)
 ds_read_b128 a[168:171], v5 offset:10240
 v_cvt_pk_bf16_f32 v192, v128, v129
 v_mfma_f32_16x16x32_bf16 a[8:11], a[136:139], v[208:211], a[8:11]
 buffer_load_dwordx4 v247, s[12:15], s55 offen lds
 v_mfma_f32_16x16x32_bf16 a[40:43], a[136:139], v[212:215], a[40:43]
 ds_read_b128 a[172:175], v5 offset:11264
 v_exp_f32 v131, v131
 v_mfma_f32_16x16x32_bf16 a[12:15], a[140:143], v[208:211], a[12:15]
 s_add_u32 m0, s38, 66560
 v_exp_f32 v132, v132
 v_mfma_f32_16x16x32_bf16 a[44:47], a[140:143], v[212:215], a[44:47]
 s_waitcnt lgkmcnt(6)
 ds_read_b128 a[176:179], v5 offset:12288
 buffer_load_dwordx4 v248, s[12:15], s55 offen lds
 v_mfma_f32_16x16x32_bf16 a[16:19], a[144:147], v[208:211], a[16:19]
 v_cvt_pk_bf16_f32 v193, v130, v131
 v_mfma_f32_16x16x32_bf16 a[48:51], a[144:147], v[212:215], a[48:51]
 ds_read_b128 a[180:183], v5 offset:13312
 v_exp_f32 v133, v133
 s_add_u32 m0, s38, 67584
 v_mfma_f32_16x16x32_bf16 a[20:23], a[148:151], v[208:211], a[20:23]
 v_exp_f32 v134, v134
 v_mfma_f32_16x16x32_bf16 a[52:55], a[148:151], v[212:215], a[52:55]
 s_waitcnt lgkmcnt(6)
 ds_read_b128 a[184:187], v5 offset:14336
 buffer_load_dwordx4 v249, s[12:15], s55 offen lds
 v_mfma_f32_16x16x32_bf16 a[24:27], a[152:155], v[208:211], a[24:27]
 v_cvt_pk_bf16_f32 v194, v132, v133
 v_mfma_f32_16x16x32_bf16 a[56:59], a[152:155], v[212:215], a[56:59]
 ds_read_b128 a[188:191], v5 offset:15360
 v_exp_f32 v135, v135
 s_add_u32 m0, s38, 68608
 v_mfma_f32_16x16x32_bf16 a[28:31], a[156:159], v[208:211], a[28:31]
 v_exp_f32 v136, v136
 v_mfma_f32_16x16x32_bf16 a[60:63], a[156:159], v[212:215], a[60:63]
 s_waitcnt lgkmcnt(4)
 v_add_u32 v6, 0x4000, v6
 v_and_b32 v6, 0xffff, v6
 ds_read_b128 a[128:131], v6
 v_mfma_f32_16x16x32_bf16 v[160:163], a[160:163], v[64:67], v[32:35]
 buffer_load_dwordx4 v250, s[12:15], s55 offen lds
 s_add_u32 m0, s38, 69632
 v_mfma_f32_16x16x32_bf16 v[160:163], a[164:167], v[68:71], v[160:163]
 ds_read_b128 a[132:135], v6 offset:1024
 v_cvt_pk_bf16_f32 v195, v134, v135
 v_mfma_f32_16x16x32_bf16 v[160:163], a[168:171], v[72:75], v[160:163]
 buffer_load_dwordx4 v251, s[12:15], s55 offen lds
 v_mfma_f32_16x16x32_bf16 v[160:163], a[172:175], v[76:79], v[160:163]
 ds_read_b128 a[136:139], v6 offset:2048
 v_exp_f32 v137, v137
 v_mfma_f32_16x16x32_bf16 v[168:171], a[160:163], v[80:83], v[36:39]
 s_add_u32 m0, s57, 0
 v_exp_f32 v138, v138
 v_mfma_f32_16x16x32_bf16 v[168:171], a[164:167], v[84:87], v[168:171]
 ds_read_b128 a[140:143], v6 offset:3072
 v_cvt_pk_bf16_f32 v196, v136, v137
 v_mfma_f32_16x16x32_bf16 v[168:171], a[168:171], v[88:91], v[168:171]
 buffer_load_dwordx4 v1, s[4:7], s52 offen sc1 lds
 v_mfma_f32_16x16x32_bf16 v[168:171], a[172:175], v[92:95], v[168:171]
 s_waitcnt lgkmcnt(4)
 ds_read_b128 a[144:147], v6 offset:4096
 buffer_load_dwordx4 v1, s[4:7], s52 offen offset:1024 sc1 lds
 v_mfma_f32_16x16x32_bf16 v[164:167], a[176:179], v[64:67], v[32:35]
 v_exp_f32 v139, v139
 v_mfma_f32_16x16x32_bf16 v[164:167], a[180:183], v[68:71], v[164:167]
 ds_read_b128 a[148:151], v6 offset:5120
 v_exp_f32 v140, v140
 s_add_u32 m0, s58, 0
 v_mfma_f32_16x16x32_bf16 v[164:167], a[184:187], v[72:75], v[164:167]
 v_cvt_pk_bf16_f32 v197, v138, v139
 v_mfma_f32_16x16x32_bf16 v[164:167], a[188:191], v[76:79], v[164:167]
 ds_read_b128 a[152:155], v6 offset:6144
 buffer_load_dwordx4 v13, s[4:7], s52 offen sc1 lds
 v_mfma_f32_16x16x32_bf16 v[172:175], a[176:179], v[80:83], v[36:39]
 v_exp_f32 v141, v141
 v_mfma_f32_16x16x32_bf16 v[172:175], a[180:183], v[84:87], v[172:175]
 ds_read_b128 a[156:159], v6 offset:7168
 buffer_load_dwordx4 v13, s[4:7], s52 offen offset:1024 sc1 lds
 v_mfma_f32_16x16x32_bf16 v[172:175], a[184:187], v[88:91], v[172:175]
 v_exp_f32 v142, v142
 v_mfma_f32_16x16x32_bf16 v[172:175], a[188:191], v[92:95], v[172:175]
 v_cvt_pk_bf16_f32 v198, v140, v141
 v_exp_f32 v143, v143
 s_nop 0
 v_cvt_pk_bf16_f32 v199, v142, v143
 v_mfma_f32_16x16x32_bf16 v[48:51], v[16:19], v[192:195], v[48:51]
 s_waitcnt vmcnt(16)
 s_barrier
 v_mfma_f32_16x16x32_bf16 v[52:55], v[16:19], v[196:199], v[52:55]
 s_waitcnt lgkmcnt(6)
 v_xor_b32 v5, 0x4000, v5
 ds_read_b128 a[160:163], v5
 v_lshlrev_b32 v20, 7, v0
 v_mfma_f32_16x16x32_bf16 a[0:3], a[128:131], v[192:195], a[0:3]
 s_lshl_b32 s49, s44, 13
 s_add_u32 s49, s49, L_N1-parallel_sum__compressed_kv_cla__mixer_channel_mlp__prompt_kernel
 buffer_load_dword v255, v20, s[88:91], s49 offen
 v_mfma_f32_16x16x32_bf16 a[32:35], a[128:131], v[196:199], a[32:35]
 ds_read_b128 a[164:167], v5 offset:1024
 v_exp_f32 v160, v160
 s_add_u32 s55, s29, 81920
 v_mfma_f32_16x16x32_bf16 a[4:7], a[132:135], v[192:195], a[4:7]
 v_exp_f32 v161, v161
 v_mfma_f32_16x16x32_bf16 a[36:39], a[132:135], v[196:199], a[36:39]
 s_waitcnt lgkmcnt(6)
 ds_read_b128 a[168:171], v5 offset:2048
 v_exp_f32 v162, v162
 s_add_u32 m0, s38, 86016
 v_mfma_f32_16x16x32_bf16 a[8:11], a[136:139], v[192:195], a[8:11]
 buffer_load_dwordx4 v247, s[12:15], s55 offen lds
 v_mfma_f32_16x16x32_bf16 a[40:43], a[136:139], v[196:199], a[40:43]
 ds_read_b128 a[172:175], v5 offset:3072
 v_cvt_pk_bf16_f32 v208, v160, v161
 s_add_u32 m0, s38, 87040
 v_mfma_f32_16x16x32_bf16 a[12:15], a[140:143], v[192:195], a[12:15]
 v_exp_f32 v163, v163
 v_mfma_f32_16x16x32_bf16 a[44:47], a[140:143], v[196:199], a[44:47]
 s_waitcnt lgkmcnt(6)
 ds_read_b128 a[176:179], v5 offset:4096
 buffer_load_dwordx4 v248, s[12:15], s55 offen lds
 v_mfma_f32_16x16x32_bf16 a[16:19], a[144:147], v[192:195], a[16:19]
 s_add_u32 m0, s38, 88064
 v_exp_f32 v164, v164
 v_mfma_f32_16x16x32_bf16 a[48:51], a[144:147], v[196:199], a[48:51]
 ds_read_b128 a[180:183], v5 offset:5120
 v_cvt_pk_bf16_f32 v209, v162, v163
 v_mfma_f32_16x16x32_bf16 a[20:23], a[148:151], v[192:195], a[20:23]
 buffer_load_dwordx4 v249, s[12:15], s55 offen lds
 v_mfma_f32_16x16x32_bf16 a[52:55], a[148:151], v[196:199], a[52:55]
 s_waitcnt lgkmcnt(6)
 ds_read_b128 a[184:187], v5 offset:6144
 v_exp_f32 v165, v165
 s_add_u32 m0, s38, 89088
 v_mfma_f32_16x16x32_bf16 a[24:27], a[152:155], v[192:195], a[24:27]
 buffer_load_dwordx4 v250, s[12:15], s55 offen lds
 v_mfma_f32_16x16x32_bf16 a[56:59], a[152:155], v[196:199], a[56:59]
 ds_read_b128 a[188:191], v5 offset:7168
 v_exp_f32 v166, v166
 v_mfma_f32_16x16x32_bf16 a[28:31], a[156:159], v[192:195], a[28:31]
 s_add_u32 m0, s38, 90112
 v_cvt_pk_bf16_f32 v210, v164, v165
 v_mfma_f32_16x16x32_bf16 a[60:63], a[156:159], v[196:199], a[60:63]
 s_waitcnt lgkmcnt(4)
 ds_read_b128 a[128:131], v6 offset:8192
 buffer_load_dwordx4 v251, s[12:15], s55 offen lds
 v_mfma_f32_16x16x32_bf16 v[128:131], a[160:163], v[64:67], v[32:35]
 v_exp_f32 v167, v167
 v_mfma_f32_16x16x32_bf16 v[128:131], a[164:167], v[68:71], v[128:131]
 ds_read_b128 a[132:135], v6 offset:9216
 v_exp_f32 v168, v168
 s_add_u32 m0, s57, 8192
 v_mfma_f32_16x16x32_bf16 v[128:131], a[168:171], v[72:75], v[128:131]
 buffer_load_dwordx4 v12, s[4:7], s52 offen sc1 lds
 v_mfma_f32_16x16x32_bf16 v[128:131], a[172:175], v[76:79], v[128:131]
 ds_read_b128 a[136:139], v6 offset:10240
 buffer_load_dwordx4 v12, s[4:7], s52 offen offset:1024 sc1 lds
 v_mfma_f32_16x16x32_bf16 v[136:139], a[160:163], v[80:83], v[36:39]
 v_cvt_pk_bf16_f32 v211, v166, v167
 v_mfma_f32_16x16x32_bf16 v[136:139], a[164:167], v[84:87], v[136:139]
 ds_read_b128 a[140:143], v6 offset:11264
 v_exp_f32 v169, v169
 s_add_u32 m0, s58, 8192
 v_mfma_f32_16x16x32_bf16 v[136:139], a[168:171], v[88:91], v[136:139]
 buffer_load_dwordx4 v14, s[4:7], s52 offen sc1 lds
 v_mfma_f32_16x16x32_bf16 v[136:139], a[172:175], v[92:95], v[136:139]
 s_waitcnt lgkmcnt(4)
 ds_read_b128 a[144:147], v6 offset:12288
 v_exp_f32 v170, v170
 v_mfma_f32_16x16x32_bf16 v[132:135], a[176:179], v[64:67], v[32:35]
 buffer_load_dwordx4 v14, s[4:7], s52 offen offset:1024 sc1 lds
 v_mfma_f32_16x16x32_bf16 v[132:135], a[180:183], v[68:71], v[132:135]
 ds_read_b128 a[148:151], v6 offset:13312
 v_cvt_pk_bf16_f32 v212, v168, v169
 s_xor_b32 s57, s57, 0x4000
 v_mfma_f32_16x16x32_bf16 v[132:135], a[184:187], v[72:75], v[132:135]
 s_add_u32 s58, s58, 0x4000
 v_exp_f32 v171, v171
 v_mfma_f32_16x16x32_bf16 v[132:135], a[188:191], v[76:79], v[132:135]
 ds_read_b128 a[152:155], v6 offset:14336
 v_exp_f32 v172, v172
 v_mfma_f32_16x16x32_bf16 v[140:143], a[176:179], v[80:83], v[36:39]
 s_and_b32 s58, s58, 0xffff
 v_cvt_pk_bf16_f32 v213, v170, v171
 v_mfma_f32_16x16x32_bf16 v[140:143], a[180:183], v[84:87], v[140:143]
 ds_read_b128 a[156:159], v6 offset:15360
 v_exp_f32 v173, v173
 s_add_u32 s52, s52, 0x4000
 v_mfma_f32_16x16x32_bf16 v[140:143], a[184:187], v[88:91], v[140:143]
 v_exp_f32 v174, v174
 v_mfma_f32_16x16x32_bf16 v[140:143], a[188:191], v[92:95], v[140:143]
 v_cvt_pk_bf16_f32 v214, v172, v173
 v_exp_f32 v175, v175
 s_nop 0
 v_cvt_pk_bf16_f32 v215, v174, v175
 v_mfma_f32_16x16x32_bf16 v[48:51], v[16:19], v[208:211], v[48:51]
 s_waitcnt vmcnt(19)
 s_barrier
 v_mfma_f32_16x16x32_bf16 v[52:55], v[16:19], v[212:215], v[52:55]
 s_waitcnt lgkmcnt(6)
 ds_read_b128 a[160:163], v5 offset:8192
 v_exp_f32 v128, v128
 v_mfma_f32_16x16x32_bf16 a[0:3], a[128:131], v[208:211], a[0:3]
 v_cmp_eq_u32 vcc, s100, v241
 s_nop 1
 s_and_b32 s71, vcc_lo, -1
 s_cmp_eq_u32 s71, -1
 s_cbranch_scc0 L_slow_h
L_back_h:
 v_mfma_f32_16x16x32_bf16 a[32:35], a[128:131], v[212:215], a[32:35]
 ds_read_b128 a[164:167], v5 offset:9216
 v_exp_f32 v129, v129
 s_add_u32 s53, s31, 0
 v_mfma_f32_16x16x32_bf16 a[4:7], a[132:135], v[208:211], a[4:7]
 v_exp_f32 v130, v130
 v_mfma_f32_16x16x32_bf16 a[36:39], a[132:135], v[212:215], a[36:39]
 s_waitcnt lgkmcnt(6)
 ds_read_b128 a[168:171], v5 offset:10240
 v_cvt_pk_bf16_f32 v192, v128, v129
 v_mfma_f32_16x16x32_bf16 a[8:11], a[136:139], v[208:211], a[8:11]
 buffer_load_dwordx4 a[192:195], v252, s[4:7], s53 offen sc1
 v_mfma_f32_16x16x32_bf16 a[40:43], a[136:139], v[212:215], a[40:43]
 ds_read_b128 a[172:175], v5 offset:11264
 v_exp_f32 v131, v131
 v_mfma_f32_16x16x32_bf16 a[12:15], a[140:143], v[208:211], a[12:15]
 buffer_load_dwordx4 a[196:199], v253, s[4:7], s53 offen sc1
 v_mfma_f32_16x16x32_bf16 a[44:47], a[140:143], v[212:215], a[44:47]
 s_waitcnt lgkmcnt(6)
 ds_read_b128 a[176:179], v5 offset:12288
 v_exp_f32 v132, v132
 s_add_u32 s53, s31, 1024
 v_mfma_f32_16x16x32_bf16 a[16:19], a[144:147], v[208:211], a[16:19]
 v_cvt_pk_bf16_f32 v193, v130, v131
 v_mfma_f32_16x16x32_bf16 a[48:51], a[144:147], v[212:215], a[48:51]
 ds_read_b128 a[180:183], v5 offset:13312
 v_exp_f32 v133, v133
 v_mfma_f32_16x16x32_bf16 a[20:23], a[148:151], v[208:211], a[20:23]
 buffer_load_dwordx4 a[200:203], v252, s[4:7], s53 offen sc1
 v_mfma_f32_16x16x32_bf16 a[52:55], a[148:151], v[212:215], a[52:55]
 s_waitcnt lgkmcnt(6)
 ds_read_b128 a[184:187], v5 offset:14336
 v_exp_f32 v134, v134
 v_mfma_f32_16x16x32_bf16 a[24:27], a[152:155], v[208:211], a[24:27]
 buffer_load_dwordx4 a[204:207], v253, s[4:7], s53 offen sc1
 v_mfma_f32_16x16x32_bf16 a[56:59], a[152:155], v[212:215], a[56:59]
 ds_read_b128 a[188:191], v5 offset:15360
 v_cvt_pk_bf16_f32 v194, v132, v133
 s_add_u32 s53, s31, 2048
 v_mfma_f32_16x16x32_bf16 a[28:31], a[156:159], v[208:211], a[28:31]
 v_exp_f32 v135, v135
 v_mfma_f32_16x16x32_bf16 a[60:63], a[156:159], v[212:215], a[60:63]
 s_waitcnt lgkmcnt(4)
 v_add_u32 v6, 0x4000, v6
 v_and_b32 v6, 0xffff, v6
 ds_read_b128 a[128:131], v6
 v_mfma_f32_16x16x32_bf16 v[160:163], a[160:163], v[64:67], v[32:35]
 buffer_load_dwordx4 a[208:211], v252, s[4:7], s53 offen sc1
 v_mfma_f32_16x16x32_bf16 v[160:163], a[164:167], v[68:71], v[160:163]
 ds_read_b128 a[132:135], v6 offset:1024
 v_exp_f32 v136, v136
 v_mfma_f32_16x16x32_bf16 v[160:163], a[168:171], v[72:75], v[160:163]
 buffer_load_dwordx4 a[212:215], v253, s[4:7], s53 offen sc1
 v_mfma_f32_16x16x32_bf16 v[160:163], a[172:175], v[76:79], v[160:163]
 ds_read_b128 a[136:139], v6 offset:2048
 v_cvt_pk_bf16_f32 v195, v134, v135
 s_add_u32 m0, s57, 0
 v_mfma_f32_16x16x32_bf16 v[168:171], a[160:163], v[80:83], v[36:39]
 v_exp_f32 v137, v137
 v_mfma_f32_16x16x32_bf16 v[168:171], a[164:167], v[84:87], v[168:171]
 ds_read_b128 a[140:143], v6 offset:3072
 v_exp_f32 v138, v138
 v_mfma_f32_16x16x32_bf16 v[168:171], a[168:171], v[88:91], v[168:171]
 buffer_load_dwordx4 v1, s[4:7], s52 offen sc1 lds
 v_mfma_f32_16x16x32_bf16 v[168:171], a[172:175], v[92:95], v[168:171]
 s_waitcnt lgkmcnt(4)
 ds_read_b128 a[144:147], v6 offset:4096
 v_cvt_pk_bf16_f32 v196, v136, v137
 v_mfma_f32_16x16x32_bf16 v[164:167], a[176:179], v[64:67], v[32:35]
 buffer_load_dwordx4 v1, s[4:7], s52 offen offset:1024 sc1 lds
 v_mfma_f32_16x16x32_bf16 v[164:167], a[180:183], v[68:71], v[164:167]
 ds_read_b128 a[148:151], v6 offset:5120
 v_exp_f32 v139, v139
 s_add_u32 m0, s58, 0
 v_mfma_f32_16x16x32_bf16 v[164:167], a[184:187], v[72:75], v[164:167]
 v_exp_f32 v140, v140
 v_mfma_f32_16x16x32_bf16 v[164:167], a[188:191], v[76:79], v[164:167]
 ds_read_b128 a[152:155], v6 offset:6144
 v_cvt_pk_bf16_f32 v197, v138, v139
 v_mfma_f32_16x16x32_bf16 v[172:175], a[176:179], v[80:83], v[36:39]
 buffer_load_dwordx4 v13, s[4:7], s52 offen sc1 lds
 v_mfma_f32_16x16x32_bf16 v[172:175], a[180:183], v[84:87], v[172:175]
 ds_read_b128 a[156:159], v6 offset:7168
 v_exp_f32 v141, v141
 v_mfma_f32_16x16x32_bf16 v[172:175], a[184:187], v[88:91], v[172:175]
 buffer_load_dwordx4 v13, s[4:7], s52 offen offset:1024 sc1 lds
 v_mfma_f32_16x16x32_bf16 v[172:175], a[188:191], v[92:95], v[172:175]
 v_exp_f32 v142, v142
 v_cvt_pk_bf16_f32 v198, v140, v141
 v_exp_f32 v143, v143
 s_nop 0
 v_cvt_pk_bf16_f32 v199, v142, v143
 v_mfma_f32_16x16x32_bf16 v[48:51], v[16:19], v[192:195], v[48:51]
 s_waitcnt vmcnt(22)
 s_barrier
 v_mfma_f32_16x16x32_bf16 v[52:55], v[16:19], v[196:199], v[52:55]
 s_waitcnt lgkmcnt(6)
 v_xor_b32 v5, 0x4000, v5
 ds_read_b128 a[160:163], v5
 s_add_u32 s55, s29, 163840
 v_mfma_f32_16x16x32_bf16 a[0:3], a[128:131], v[192:195], a[0:3]
 s_add_u32 m0, s38, 106496
 v_exp_f32 v160, v160
 v_mfma_f32_16x16x32_bf16 a[32:35], a[128:131], v[196:199], a[32:35]
 ds_read_b128 a[164:167], v5 offset:1024
 v_exp_f32 v161, v161
 v_mfma_f32_16x16x32_bf16 a[4:7], a[132:135], v[192:195], a[4:7]
 buffer_load_dwordx4 v247, s[12:15], s55 offen lds
 v_mfma_f32_16x16x32_bf16 a[36:39], a[132:135], v[196:199], a[36:39]
 s_waitcnt lgkmcnt(6)
 ds_read_b128 a[168:171], v5 offset:2048
 v_exp_f32 v162, v162
 s_add_u32 m0, s38, 107520
 v_mfma_f32_16x16x32_bf16 a[8:11], a[136:139], v[192:195], a[8:11]
 v_cvt_pk_bf16_f32 v208, v160, v161
 v_mfma_f32_16x16x32_bf16 a[40:43], a[136:139], v[196:199], a[40:43]
 ds_read_b128 a[172:175], v5 offset:3072
 buffer_load_dwordx4 v248, s[12:15], s55 offen lds
 v_mfma_f32_16x16x32_bf16 a[12:15], a[140:143], v[192:195], a[12:15]
 s_add_u32 m0, s38, 108544
 v_exp_f32 v163, v163
 v_mfma_f32_16x16x32_bf16 a[44:47], a[140:143], v[196:199], a[44:47]
 s_waitcnt lgkmcnt(6)
 ds_read_b128 a[176:179], v5 offset:4096
 v_exp_f32 v164, v164
 v_mfma_f32_16x16x32_bf16 a[16:19], a[144:147], v[192:195], a[16:19]
 buffer_load_dwordx4 v249, s[12:15], s55 offen lds
 v_mfma_f32_16x16x32_bf16 a[48:51], a[144:147], v[196:199], a[48:51]
 ds_read_b128 a[180:183], v5 offset:5120
 v_cvt_pk_bf16_f32 v209, v162, v163
 s_add_u32 m0, s38, 109568
 v_mfma_f32_16x16x32_bf16 a[20:23], a[148:151], v[192:195], a[20:23]
 v_exp_f32 v165, v165
 v_mfma_f32_16x16x32_bf16 a[52:55], a[148:151], v[196:199], a[52:55]
 s_waitcnt lgkmcnt(6)
 ds_read_b128 a[184:187], v5 offset:6144
 buffer_load_dwordx4 v250, s[12:15], s55 offen lds
 v_mfma_f32_16x16x32_bf16 a[24:27], a[152:155], v[192:195], a[24:27]
 s_add_u32 m0, s38, 110592
 v_exp_f32 v166, v166
 v_mfma_f32_16x16x32_bf16 a[56:59], a[152:155], v[196:199], a[56:59]
 ds_read_b128 a[188:191], v5 offset:7168
 v_cvt_pk_bf16_f32 v210, v164, v165
 v_mfma_f32_16x16x32_bf16 a[28:31], a[156:159], v[192:195], a[28:31]
 buffer_load_dwordx4 v251, s[12:15], s55 offen lds
 v_mfma_f32_16x16x32_bf16 a[60:63], a[156:159], v[196:199], a[60:63]
 s_waitcnt lgkmcnt(4)
 ds_read_b128 a[128:131], v6 offset:8192
 v_exp_f32 v167, v167
 s_add_u32 m0, s57, 8192
 v_mfma_f32_16x16x32_bf16 v[128:131], a[160:163], v[64:67], v[32:35]
 v_exp_f32 v168, v168
 v_mfma_f32_16x16x32_bf16 v[128:131], a[164:167], v[68:71], v[128:131]
 ds_read_b128 a[132:135], v6 offset:9216
 buffer_load_dwordx4 v12, s[4:7], s52 offen sc1 lds
 v_mfma_f32_16x16x32_bf16 v[128:131], a[168:171], v[72:75], v[128:131]
 buffer_load_dwordx4 v12, s[4:7], s52 offen offset:1024 sc1 lds
 v_mfma_f32_16x16x32_bf16 v[128:131], a[172:175], v[76:79], v[128:131]
 ds_read_b128 a[136:139], v6 offset:10240
 v_cvt_pk_bf16_f32 v211, v166, v167
 v_mfma_f32_16x16x32_bf16 v[136:139], a[160:163], v[80:83], v[36:39]
 s_add_u32 m0, s58, 8192
 v_exp_f32 v169, v169
 v_mfma_f32_16x16x32_bf16 v[136:139], a[164:167], v[84:87], v[136:139]
 ds_read_b128 a[140:143], v6 offset:11264
 buffer_load_dwordx4 v14, s[4:7], s52 offen sc1 lds
 v_mfma_f32_16x16x32_bf16 v[136:139], a[168:171], v[88:91], v[136:139]
 v_exp_f32 v170, v170
 v_mfma_f32_16x16x32_bf16 v[136:139], a[172:175], v[92:95], v[136:139]
 s_waitcnt lgkmcnt(4)
 ds_read_b128 a[144:147], v6 offset:12288
 buffer_load_dwordx4 v14, s[4:7], s52 offen offset:1024 sc1 lds
 v_mfma_f32_16x16x32_bf16 v[132:135], a[176:179], v[64:67], v[32:35]
 s_xor_b32 s57, s57, 0x4000
 v_cvt_pk_bf16_f32 v212, v168, v169
 v_mfma_f32_16x16x32_bf16 v[132:135], a[180:183], v[68:71], v[132:135]
 ds_read_b128 a[148:151], v6 offset:13312
 v_exp_f32 v171, v171
 v_mfma_f32_16x16x32_bf16 v[132:135], a[184:187], v[72:75], v[132:135]
 s_add_u32 s58, s58, 0x4000
 v_exp_f32 v172, v172
 v_mfma_f32_16x16x32_bf16 v[132:135], a[188:191], v[76:79], v[132:135]
 ds_read_b128 a[152:155], v6 offset:14336
 v_cvt_pk_bf16_f32 v213, v170, v171
 s_and_b32 s58, s58, 0xffff
 v_mfma_f32_16x16x32_bf16 v[140:143], a[176:179], v[80:83], v[36:39]
 v_exp_f32 v173, v173
 v_mfma_f32_16x16x32_bf16 v[140:143], a[180:183], v[84:87], v[140:143]
 ds_read_b128 a[156:159], v6 offset:15360
 v_exp_f32 v174, v174
 s_add_u32 s52, s52, 0x4000
 v_mfma_f32_16x16x32_bf16 v[140:143], a[184:187], v[88:91], v[140:143]
 v_cvt_pk_bf16_f32 v214, v172, v173
 v_mfma_f32_16x16x32_bf16 v[140:143], a[188:191], v[92:95], v[140:143]
 v_exp_f32 v175, v175
 s_nop 0
 v_cvt_pk_bf16_f32 v215, v174, v175
L_N0:
 v_mfma_f32_16x16x32_bf16 v[48:51], v[16:19], v[208:211], v[48:51]
 s_waitcnt vmcnt(21)
 s_barrier
 v_mfma_f32_16x16x32_bf16 v[52:55], v[16:19], v[212:215], v[52:55]
 s_waitcnt lgkmcnt(6)
 ds_read_b128 a[160:163], v5 offset:8192
 v_add_f32 v128, v128, v224
 s_add_u32 s53, s31, 3072
 v_mfma_f32_16x16x32_bf16 a[0:3], a[128:131], v[208:211], a[0:3]
 v_exp_f32 v128, v128
 v_mfma_f32_16x16x32_bf16 a[32:35], a[128:131], v[212:215], a[32:35]
 ds_read_b128 a[164:167], v5 offset:9216
 v_add_f32 v129, v129, v225
 v_mfma_f32_16x16x32_bf16 a[4:7], a[132:135], v[208:211], a[4:7]
 buffer_load_dwordx4 a[216:219], v252, s[4:7], s53 offen sc1
 v_mfma_f32_16x16x32_bf16 a[36:39], a[132:135], v[212:215], a[36:39]
 s_waitcnt lgkmcnt(6)
 ds_read_b128 a[168:171], v5 offset:10240
 v_exp_f32 v129, v129
 v_add_f32 v130, v130, v226
 v_mfma_f32_16x16x32_bf16 a[8:11], a[136:139], v[208:211], a[8:11]
 buffer_load_dwordx4 a[220:223], v253, s[4:7], s53 offen sc1
 v_mfma_f32_16x16x32_bf16 a[40:43], a[136:139], v[212:215], a[40:43]
 ds_read_b128 a[172:175], v5 offset:11264
 v_exp_f32 v130, v130
 s_add_u32 s53, s31, 4096
 v_add_f32 v131, v131, v227
 v_mfma_f32_16x16x32_bf16 a[12:15], a[140:143], v[208:211], a[12:15]
 v_cvt_pk_bf16_f32 v192, v128, v129
 v_mfma_f32_16x16x32_bf16 a[44:47], a[140:143], v[212:215], a[44:47]
 s_waitcnt lgkmcnt(6)
 ds_read_b128 a[176:179], v5 offset:12288
 v_exp_f32 v131, v131
 v_mfma_f32_16x16x32_bf16 a[16:19], a[144:147], v[208:211], a[16:19]
 buffer_load_dwordx4 a[224:227], v252, s[4:7], s53 offen sc1
 v_add_f32 v132, v132, v228
 v_mfma_f32_16x16x32_bf16 a[48:51], a[144:147], v[212:215], a[48:51]
 ds_read_b128 a[180:183], v5 offset:13312
 v_exp_f32 v132, v132
 v_mfma_f32_16x16x32_bf16 a[20:23], a[148:151], v[208:211], a[20:23]
 buffer_load_dwordx4 a[228:231], v253, s[4:7], s53 offen sc1
 v_add_f32 v133, v133, v229
 v_mfma_f32_16x16x32_bf16 a[52:55], a[148:151], v[212:215], a[52:55]
 s_waitcnt lgkmcnt(6)
 ds_read_b128 a[184:187], v5 offset:14336
 v_cvt_pk_bf16_f32 v193, v130, v131
 s_add_u32 s53, s31, 5120
 v_mfma_f32_16x16x32_bf16 a[24:27], a[152:155], v[208:211], a[24:27]
 v_exp_f32 v133, v133
 v_mfma_f32_16x16x32_bf16 a[56:59], a[152:155], v[212:215], a[56:59]
 ds_read_b128 a[188:191], v5 offset:15360
 v_add_f32 v134, v134, v230
 v_mfma_f32_16x16x32_bf16 a[28:31], a[156:159], v[208:211], a[28:31]
 buffer_load_dwordx4 a[232:235], v252, s[4:7], s53 offen sc1
 v_mfma_f32_16x16x32_bf16 a[60:63], a[156:159], v[212:215], a[60:63]
 s_waitcnt lgkmcnt(4)
 v_add_u32 v6, 0x4000, v6
 v_and_b32 v6, 0xffff, v6
 ds_read_b128 a[128:131], v6
 v_mfma_f32_16x16x32_bf16 v[160:163], a[160:163], v[64:67], v[32:35]
 buffer_load_dwordx4 a[236:239], v253, s[4:7], s53 offen sc1
 v_mfma_f32_16x16x32_bf16 v[160:163], a[164:167], v[68:71], v[160:163]
 ds_read_b128 a[132:135], v6 offset:1024
 v_exp_f32 v134, v134
 v_add_f32 v135, v135, v231
 v_mfma_f32_16x16x32_bf16 v[160:163], a[168:171], v[72:75], v[160:163]
 s_add_u32 s53, s31, 6144
 v_cvt_pk_bf16_f32 v194, v132, v133
 v_exp_f32 v135, v135
 v_mfma_f32_16x16x32_bf16 v[160:163], a[172:175], v[76:79], v[160:163]
 ds_read_b128 a[136:139], v6 offset:2048
 v_exp_f32 v136, v136
 v_cvt_pk_bf16_f32 v195, v134, v135
 v_mfma_f32_16x16x32_bf16 v[168:171], a[160:163], v[80:83], v[36:39]
 buffer_load_dwordx4 a[240:243], v252, s[4:7], s53 offen sc1
 v_mfma_f32_16x16x32_bf16 v[168:171], a[164:167], v[84:87], v[168:171]
 ds_read_b128 a[140:143], v6 offset:3072
 v_exp_f32 v137, v137
 v_mfma_f32_16x16x32_bf16 v[168:171], a[168:171], v[88:91], v[168:171]
 buffer_load_dwordx4 a[244:247], v253, s[4:7], s53 offen sc1
 v_mfma_f32_16x16x32_bf16 v[168:171], a[172:175], v[92:95], v[168:171]
 s_waitcnt lgkmcnt(4)
 ds_read_b128 a[144:147], v6 offset:4096
 v_exp_f32 v138, v138
 v_cvt_pk_bf16_f32 v196, v136, v137
 v_mfma_f32_16x16x32_bf16 v[164:167], a[176:179], v[64:67], v[32:35]
 s_add_u32 s53, s31, 7168
 v_exp_f32 v139, v139
 v_mfma_f32_16x16x32_bf16 v[164:167], a[180:183], v[68:71], v[164:167]
 ds_read_b128 a[148:151], v6 offset:5120
 v_exp_f32 v140, v140
 v_cvt_pk_bf16_f32 v197, v138, v139
 v_mfma_f32_16x16x32_bf16 v[164:167], a[184:187], v[72:75], v[164:167]
 buffer_load_dwordx4 a[248:251], v252, s[4:7], s53 offen sc1
 v_mfma_f32_16x16x32_bf16 v[164:167], a[188:191], v[76:79], v[164:167]
 ds_read_b128 a[152:155], v6 offset:6144
 v_exp_f32 v141, v141
 v_mfma_f32_16x16x32_bf16 v[172:175], a[176:179], v[80:83], v[36:39]
 buffer_load_dwordx4 a[252:255], v253, s[4:7], s53 offen sc1
 v_mfma_f32_16x16x32_bf16 v[172:175], a[180:183], v[84:87], v[172:175]
 ds_read_b128 a[156:159], v6 offset:7168
 v_exp_f32 v142, v142
 v_cvt_pk_bf16_f32 v198, v140, v141
 v_mfma_f32_16x16x32_bf16 v[172:175], a[184:187], v[88:91], v[172:175]
 v_exp_f32 v143, v143
 s_nop 0
 v_cvt_pk_bf16_f32 v199, v142, v143
 v_mfma_f32_16x16x32_bf16 v[172:175], a[188:191], v[92:95], v[172:175]
L_N1:
 v_mfma_f32_16x16x32_bf16 v[48:51], v[16:19], v[192:195], v[48:51]
 s_waitcnt vmcnt(21)
 s_barrier
 v_mfma_f32_16x16x32_bf16 v[52:55], v[16:19], v[196:199], v[52:55]
 s_waitcnt lgkmcnt(6)
 v_xor_b32 v5, 0x4000, v5
 ds_read_b128 a[160:163], v5
 v_add_f32 v160, v160, v232
 v_mfma_f32_16x16x32_bf16 a[0:3], a[128:131], v[192:195], a[0:3]
 ds_read_b128 a[164:167], v5 offset:1024
 v_exp_f32 v160, v160
 v_add_f32 v161, v161, v233
 v_mfma_f32_16x16x32_bf16 a[32:35], a[128:131], v[196:199], a[32:35]
 v_exp_f32 v161, v161
 v_mfma_f32_16x16x32_bf16 a[4:7], a[132:135], v[192:195], a[4:7]
 ds_read_b128 a[168:171], v5 offset:2048
 v_add_f32 v162, v162, v234
 v_exp_f32 v162, v162
 v_mfma_f32_16x16x32_bf16 a[36:39], a[132:135], v[196:199], a[36:39]
 s_waitcnt lgkmcnt(7)
 ds_read_b128 a[172:175], v5 offset:3072
 v_add_f32 v163, v163, v235
 v_mfma_f32_16x16x32_bf16 a[8:11], a[136:139], v[192:195], a[8:11]
 v_cvt_pk_bf16_f32 v208, v160, v161
 v_mfma_f32_16x16x32_bf16 a[40:43], a[136:139], v[196:199], a[40:43]
 ds_read_b128 a[176:179], v5 offset:4096
 v_exp_f32 v163, v163
 v_add_f32 v164, v164, v236
 v_mfma_f32_16x16x32_bf16 a[12:15], a[140:143], v[192:195], a[12:15]
 ds_read_b128 a[180:183], v5 offset:5120
 v_exp_f32 v164, v164
 v_mfma_f32_16x16x32_bf16 a[44:47], a[140:143], v[196:199], a[44:47]
 s_waitcnt lgkmcnt(8)
 v_add_f32 v165, v165, v237
 v_mfma_f32_16x16x32_bf16 a[16:19], a[144:147], v[192:195], a[16:19]
 ds_read_b128 a[184:187], v5 offset:6144
 v_cvt_pk_bf16_f32 v209, v162, v163
 v_exp_f32 v165, v165
 v_mfma_f32_16x16x32_bf16 a[48:51], a[144:147], v[196:199], a[48:51]
 ds_read_b128 a[188:191], v5 offset:7168
 v_add_f32 v166, v166, v238
 v_mfma_f32_16x16x32_bf16 a[20:23], a[148:151], v[192:195], a[20:23]
 v_exp_f32 v166, v166
 v_mfma_f32_16x16x32_bf16 a[52:55], a[148:151], v[196:199], a[52:55]
 s_waitcnt lgkmcnt(8)
 ds_read_b128 a[128:131], v6 offset:8192
 v_add_f32 v167, v167, v239
 v_cvt_pk_bf16_f32 v210, v164, v165
 v_mfma_f32_16x16x32_bf16 a[24:27], a[152:155], v[192:195], a[24:27]
 ds_read_b128 a[132:135], v6 offset:9216
 v_exp_f32 v167, v167
 v_mfma_f32_16x16x32_bf16 a[56:59], a[152:155], v[196:199], a[56:59]
 v_exp_f32 v168, v168
 v_mfma_f32_16x16x32_bf16 a[28:31], a[156:159], v[192:195], a[28:31]
 ds_read_b128 a[136:139], v6 offset:10240
 v_cvt_pk_bf16_f32 v211, v166, v167
 v_exp_f32 v169, v169
 v_mfma_f32_16x16x32_bf16 a[60:63], a[156:159], v[196:199], a[60:63]
 s_waitcnt lgkmcnt(7)
 ds_read_b128 a[140:143], v6 offset:11264
 v_exp_f32 v170, v170
 v_mfma_f32_16x16x32_bf16 v[136:139], a[160:163], v[80:83], v[36:39]
 v_cvt_pk_bf16_f32 v212, v168, v169
 v_mfma_f32_16x16x32_bf16 v[136:139], a[164:167], v[84:87], v[136:139]
 ds_read_b128 a[144:147], v6 offset:12288
 v_exp_f32 v171, v171
 v_mfma_f32_16x16x32_bf16 v[136:139], a[168:171], v[88:91], v[136:139]
 ds_read_b128 a[148:151], v6 offset:13312
 v_exp_f32 v172, v172
 v_cvt_pk_bf16_f32 v213, v170, v171
 v_mfma_f32_16x16x32_bf16 v[136:139], a[172:175], v[92:95], v[136:139]
 s_waitcnt lgkmcnt(6)
 v_exp_f32 v173, v173
 v_mfma_f32_16x16x32_bf16 v[140:143], a[176:179], v[80:83], v[36:39]
 ds_read_b128 a[152:155], v6 offset:14336
 v_exp_f32 v174, v174
 v_cvt_pk_bf16_f32 v214, v172, v173
 v_mfma_f32_16x16x32_bf16 v[140:143], a[180:183], v[84:87], v[140:143]
 ds_read_b128 a[156:159], v6 offset:15360
 v_exp_f32 v175, v175
 v_mfma_f32_16x16x32_bf16 v[140:143], a[184:187], v[88:91], v[140:143]
 v_cvt_pk_bf16_f32 v215, v174, v175
 v_mfma_f32_16x16x32_bf16 v[140:143], a[188:191], v[92:95], v[140:143]
L_N2:
 v_mfma_f32_16x16x32_bf16 v[48:51], v[16:19], v[208:211], v[48:51]
 s_waitcnt vmcnt(12)
 s_barrier
 v_mfma_f32_16x16x32_bf16 v[52:55], v[16:19], v[212:215], v[52:55]
 s_waitcnt lgkmcnt(6)
 ds_read_b128 a[160:163], v5 offset:8192
 v_add_f32 v136, v136, v224
 v_mfma_f32_16x16x32_bf16 a[0:3], a[128:131], v[208:211], a[0:3]
 ds_read_b128 a[164:167], v5 offset:9216
 v_exp_f32 v136, v136
 v_mfma_f32_16x16x32_bf16 a[32:35], a[128:131], v[212:215], a[32:35]
 v_add_f32 v137, v137, v225
 v_mfma_f32_16x16x32_bf16 a[4:7], a[132:135], v[208:211], a[4:7]
 ds_read_b128 a[168:171], v5 offset:10240
 v_exp_f32 v137, v137
 v_mfma_f32_16x16x32_bf16 a[36:39], a[132:135], v[212:215], a[36:39]
 s_waitcnt lgkmcnt(7)
 ds_read_b128 a[172:175], v5 offset:11264
 v_add_f32 v138, v138, v226
 v_mfma_f32_16x16x32_bf16 a[8:11], a[136:139], v[208:211], a[8:11]
 v_mfma_f32_16x16x32_bf16 a[40:43], a[136:139], v[212:215], a[40:43]
 ds_read_b128 a[176:179], v5 offset:12288
 v_exp_f32 v138, v138
 v_mfma_f32_16x16x32_bf16 a[12:15], a[140:143], v[208:211], a[12:15]
 ds_read_b128 a[180:183], v5 offset:13312
 v_add_f32 v139, v139, v227
 v_mfma_f32_16x16x32_bf16 a[44:47], a[140:143], v[212:215], a[44:47]
 s_waitcnt lgkmcnt(8)
 v_cvt_pk_bf16_f32 v196, v136, v137
 v_mfma_f32_16x16x32_bf16 a[16:19], a[144:147], v[208:211], a[16:19]
 ds_read_b128 a[184:187], v5 offset:14336
 v_exp_f32 v139, v139
 v_mfma_f32_16x16x32_bf16 a[48:51], a[144:147], v[212:215], a[48:51]
 ds_read_b128 a[188:191], v5 offset:15360
 v_add_f32 v140, v140, v228
 v_mfma_f32_16x16x32_bf16 a[20:23], a[148:151], v[208:211], a[20:23]
 v_mfma_f32_16x16x32_bf16 a[52:55], a[148:151], v[212:215], a[52:55]
 s_waitcnt lgkmcnt(8)
 v_add_u32 v6, 0x4000, v6
 v_and_b32 v6, 0xffff, v6
 ds_read_b128 a[128:131], v6
 v_mfma_f32_16x16x32_bf16 a[24:27], a[152:155], v[208:211], a[24:27]
 ds_read_b128 a[132:135], v6 offset:1024
 v_exp_f32 v140, v140
 v_add_f32 v141, v141, v229
 v_mfma_f32_16x16x32_bf16 a[56:59], a[152:155], v[212:215], a[56:59]
 v_cvt_pk_bf16_f32 v197, v138, v139
 v_mfma_f32_16x16x32_bf16 a[28:31], a[156:159], v[208:211], a[28:31]
 ds_read_b128 a[136:139], v6 offset:2048
 v_exp_f32 v141, v141
 v_mfma_f32_16x16x32_bf16 a[60:63], a[156:159], v[212:215], a[60:63]
 s_waitcnt lgkmcnt(7)
 ds_read_b128 a[140:143], v6 offset:3072
 v_add_f32 v142, v142, v230
 v_mfma_f32_16x16x32_bf16 v[168:171], a[160:163], v[80:83], v[36:39]
 v_mfma_f32_16x16x32_bf16 v[168:171], a[164:167], v[84:87], v[168:171]
 ds_read_b128 a[144:147], v6 offset:4096
 v_exp_f32 v142, v142
 v_mfma_f32_16x16x32_bf16 v[168:171], a[168:171], v[88:91], v[168:171]
 ds_read_b128 a[148:151], v6 offset:5120
 v_add_f32 v143, v143, v231
 v_mfma_f32_16x16x32_bf16 v[168:171], a[172:175], v[92:95], v[168:171]
 s_waitcnt lgkmcnt(6)
 v_cvt_pk_bf16_f32 v198, v140, v141
 v_mfma_f32_16x16x32_bf16 v[172:175], a[176:179], v[80:83], v[36:39]
 ds_read_b128 a[152:155], v6 offset:6144
 v_exp_f32 v143, v143
 v_mfma_f32_16x16x32_bf16 v[172:175], a[180:183], v[84:87], v[172:175]
 ds_read_b128 a[156:159], v6 offset:7168
 v_cvt_pk_bf16_f32 v199, v142, v143
 v_mfma_f32_16x16x32_bf16 v[172:175], a[184:187], v[88:91], v[172:175]
 v_mfma_f32_16x16x32_bf16 v[172:175], a[188:191], v[92:95], v[172:175]
L_N3:
 v_mfma_f32_16x16x32_bf16 v[52:55], v[16:19], v[196:199], v[52:55]
 s_waitcnt lgkmcnt(6)
 s_waitcnt vmcnt(0)
 s_barrier
 v_mfma_f32_16x16x32_bf16 a[32:35], a[128:131], v[196:199], a[32:35]
 ds_read_b128 a[128:131], v6 offset:8192
 v_add_f32 v168, v168, v232
 v_exp_f32 v168, v168
 v_mfma_f32_16x16x32_bf16 a[36:39], a[132:135], v[196:199], a[36:39]
 s_waitcnt lgkmcnt(5)
 ds_read_b128 a[132:135], v6 offset:9216
 v_add_f32 v169, v169, v233
 v_exp_f32 v169, v169
 v_mfma_f32_16x16x32_bf16 a[40:43], a[136:139], v[196:199], a[40:43]
 ds_read_b128 a[136:139], v6 offset:10240
 v_add_f32 v170, v170, v234
 v_exp_f32 v170, v170
 v_mfma_f32_16x16x32_bf16 a[44:47], a[140:143], v[196:199], a[44:47]
 s_waitcnt lgkmcnt(5)
 ds_read_b128 a[140:143], v6 offset:11264
 v_add_f32 v171, v171, v235
 v_cvt_pk_bf16_f32 v212, v168, v169
 v_mfma_f32_16x16x32_bf16 a[48:51], a[144:147], v[196:199], a[48:51]
 ds_read_b128 a[144:147], v6 offset:12288
 v_exp_f32 v171, v171
 v_add_f32 v172, v172, v236
 v_mfma_f32_16x16x32_bf16 a[52:55], a[148:151], v[196:199], a[52:55]
 s_waitcnt lgkmcnt(5)
 ds_read_b128 a[148:151], v6 offset:13312
 v_exp_f32 v172, v172
 v_add_f32 v173, v173, v237
 v_mfma_f32_16x16x32_bf16 a[56:59], a[152:155], v[196:199], a[56:59]
 ds_read_b128 a[152:155], v6 offset:14336
 v_cvt_pk_bf16_f32 v213, v170, v171
 v_exp_f32 v173, v173
 v_mfma_f32_16x16x32_bf16 a[60:63], a[156:159], v[196:199], a[60:63]
 ds_read_b128 a[156:159], v6 offset:15360
 v_add_f32 v174, v174, v238
 v_exp_f32 v174, v174
 v_add_f32 v175, v175, v239
 v_cvt_pk_bf16_f32 v214, v172, v173
 v_exp_f32 v175, v175
 s_nop 0
 v_cvt_pk_bf16_f32 v215, v174, v175
 v_cmp_nlt_f32 vcc, v48, v8
 s_nop 0
 s_cmp_lg_u64 vcc, 0
 s_cselect_b32 s61, 1, s61
 v_mfma_f32_16x16x32_bf16 v[52:55], v[16:19], v[212:215], v[52:55]
 ds_read_b64_tr_b16 a[160:161], v245
 ds_read_b64_tr_b16 a[162:163], v245 offset:5120
 s_waitcnt lgkmcnt(8)
 v_mfma_f32_16x16x32_bf16 a[32:35], a[128:131], v[212:215], a[32:35]
 ds_read_b64_tr_b16 a[164:165], v245 offset:10240
 ds_read_b64_tr_b16 a[166:167], v245 offset:15360
 v_mfma_f32_16x16x32_bf16 a[36:39], a[132:135], v[212:215], a[36:39]
 ds_read_b64_tr_b16 a[168:169], v246
 ds_read_b64_tr_b16 a[170:171], v246 offset:5120
 s_waitcnt lgkmcnt(10)
 v_mfma_f32_16x16x32_bf16 a[40:43], a[136:139], v[212:215], a[40:43]
 ds_read_b64_tr_b16 a[172:173], v246 offset:10240
 ds_read_b64_tr_b16 a[174:175], v246 offset:15360
 v_mfma_f32_16x16x32_bf16 a[44:47], a[140:143], v[212:215], a[44:47]
 ds_read_b64_tr_b16 a[176:177], v245 offset:64
 ds_read_b64_tr_b16 a[178:179], v245 offset:5184
 s_waitcnt lgkmcnt(12)
 v_mfma_f32_16x16x32_bf16 a[48:51], a[144:147], v[212:215], a[48:51]
 ds_read_b64_tr_b16 a[180:181], v245 offset:10304
 ds_read_b64_tr_b16 a[182:183], v245 offset:15424
 v_cmp_nlt_f32 vcc, v52, v8
 s_nop 0
 s_cmp_lg_u64 vcc, 0
 s_cselect_b32 s61, 1, s61
 v_mfma_f32_16x16x32_bf16 a[52:55], a[148:151], v[212:215], a[52:55]
 s_waitcnt lgkmcnt(12)
 s_lshl_b32 s49, s44, 2
 v_mov_b32 v20, 0x1f000
 v_add_u32 v21, s49, v20
 v_mov_b32 v22, s61
 ds_write_b32 v21, v22
 v_mfma_f32_16x16x32_bf16 a[56:59], a[152:155], v[212:215], a[56:59]
 v_mfma_f32_16x16x32_bf16 a[60:63], a[156:159], v[212:215], a[60:63]
 s_waitcnt lgkmcnt(11)
 v_mfma_f32_16x16x32_bf16 v[128:131], a[160:163], a[192:195], 0
 ds_read_b64_tr_b16 a[184:185], v246 offset:64
 s_waitcnt lgkmcnt(10)
 v_mfma_f32_16x16x32_bf16 v[128:131], a[164:167], a[200:203], v[128:131]
 ds_read_b64_tr_b16 a[186:187], v246 offset:5184
 v_mfma_f32_16x16x32_bf16 v[132:135], a[160:163], a[196:199], 0
 ds_read_b64_tr_b16 a[188:189], v246 offset:10304
 v_mfma_f32_16x16x32_bf16 v[132:135], a[164:167], a[204:207], v[132:135]
 ds_read_b64_tr_b16 a[190:191], v246 offset:15424
 s_waitcnt lgkmcnt(8)
 s_waitcnt lgkmcnt(4)
 s_barrier
 ds_read_b128 v[24:27], v20
 v_mfma_f32_16x16x32_bf16 v[136:139], a[168:171], a[192:195], 0
 ds_read_b64_tr_b16 a[128:129], v245 offset:128
 v_mfma_f32_16x16x32_bf16 v[136:139], a[172:175], a[200:203], v[136:139]
 ds_read_b64_tr_b16 a[130:131], v245 offset:5248
 v_mfma_f32_16x16x32_bf16 v[140:143], a[168:171], a[196:199], 0
 ds_read_b64_tr_b16 a[132:133], v245 offset:10368
 v_mfma_f32_16x16x32_bf16 v[140:143], a[172:175], a[204:207], v[140:143]
 ds_read_b64_tr_b16 a[134:135], v245 offset:15488
 s_waitcnt lgkmcnt(8)
 v_mfma_f32_16x16x32_bf16 v[144:147], a[176:179], a[192:195], 0
 ds_read_b64_tr_b16 a[136:137], v246 offset:128
 v_mfma_f32_16x16x32_bf16 v[144:147], a[180:183], a[200:203], v[144:147]
 ds_read_b64_tr_b16 a[138:139], v246 offset:5248
 v_mfma_f32_16x16x32_bf16 v[148:151], a[176:179], a[196:199], 0
 ds_read_b64_tr_b16 a[140:141], v246 offset:10368
 v_mfma_f32_16x16x32_bf16 v[148:151], a[180:183], a[204:207], v[148:151]
 ds_read_b64_tr_b16 a[142:143], v246 offset:15488
 s_waitcnt lgkmcnt(8)
 v_mfma_f32_16x16x32_bf16 v[152:155], a[184:187], a[192:195], 0
 ds_read_b64_tr_b16 a[144:145], v245 offset:192
 v_or3_b32 v24, v24, v25, v26
 v_or_b32 v24, v24, v27
 s_nop 0
 v_readfirstlane_b32 s49, v24
 s_nop 0
 s_cmp_gt_u32 s49, s39
 s_cbranch_scc1 L_fb
 v_mfma_f32_16x16x32_bf16 v[152:155], a[188:191], a[200:203], v[152:155]
 ds_read_b64_tr_b16 a[146:147], v245 offset:5312
 v_rcp_f32 v49, v48
 buffer_store_dword v9, v4, s[4:7], s3 offen offset:256 sc1
 v_accvgpr_read_b32 v20, a0
 v_accvgpr_read_b32 v21, a1
 v_accvgpr_read_b32 v22, a2
 v_mfma_f32_16x16x32_bf16 v[156:159], a[184:187], a[196:199], 0
 ds_read_b64_tr_b16 a[148:149], v245 offset:10432
 v_accvgpr_read_b32 v23, a3
 v_accvgpr_read_b32 v24, a4
 v_accvgpr_read_b32 v25, a5
 v_accvgpr_read_b32 v26, a6
 s_add_u32 s55, s29, 245760
 v_mfma_f32_16x16x32_bf16 v[156:159], a[188:191], a[204:207], v[156:159]
 ds_read_b64_tr_b16 a[150:151], v245 offset:15552
 v_accvgpr_read_b32 v27, a7
 v_mul_f32 v20, v49, v20
 v_mul_f32 v21, v49, v21
 v_mul_f32 v22, v49, v22
 s_waitcnt lgkmcnt(8)
 v_mfma_f32_16x16x32_bf16 v[160:163], a[128:131], a[192:195], 0
 ds_read_b64_tr_b16 a[152:153], v246 offset:192
 v_mul_f32 v23, v49, v23
 v_mul_f32 v24, v49, v24
 v_mul_f32 v25, v49, v25
 v_mul_f32 v26, v49, v26
 s_add_u32 m0, s38, 0
 v_mfma_f32_16x16x32_bf16 v[160:163], a[132:135], a[200:203], v[160:163]
 ds_read_b64_tr_b16 a[154:155], v246 offset:5312
 v_mul_f32 v27, v49, v27
 v_cvt_pk_bf16_f32 v28, v20, v21
 v_cvt_pk_bf16_f32 v29, v22, v23
 v_cvt_pk_bf16_f32 v30, v24, v25
 v_cvt_pk_bf16_f32 v31, v26, v27
 v_mfma_f32_16x16x32_bf16 v[164:167], a[128:131], a[196:199], 0
 s_add_u32 s49, s62, 0
 buffer_store_dwordx4 v[28:31], v1, s[4:7], s49 offen sc1
 v_accvgpr_read_b32 v20, a8
 v_accvgpr_read_b32 v21, a9
 ds_read_b64_tr_b16 a[156:157], v246 offset:10432
 buffer_load_dwordx4 v247, s[12:15], s55 offen lds
 v_mfma_f32_16x16x32_bf16 v[164:167], a[132:135], a[204:207], v[164:167]
 ds_read_b64_tr_b16 a[158:159], v246 offset:15552
 v_accvgpr_read_b32 v22, a10
 v_accvgpr_read_b32 v23, a11
 v_accvgpr_read_b32 v24, a12
 v_accvgpr_read_b32 v25, a13
 s_waitcnt lgkmcnt(8)
 v_mfma_f32_16x16x32_bf16 v[168:171], a[136:139], a[192:195], 0
 ds_read_b64_tr_b16 a[160:161], v245 offset:256
 v_accvgpr_read_b32 v26, a14
 v_accvgpr_read_b32 v27, a15
 v_mul_f32 v20, v49, v20
 v_mul_f32 v21, v49, v21
 s_add_u32 m0, s38, 1024
 v_mfma_f32_16x16x32_bf16 v[168:171], a[140:143], a[200:203], v[168:171]
 ds_read_b64_tr_b16 a[162:163], v245 offset:5376
 v_mul_f32 v22, v49, v22
 v_mul_f32 v23, v49, v23
 v_mul_f32 v24, v49, v24
 v_mul_f32 v25, v49, v25
 v_mul_f32 v26, v49, v26
 v_mfma_f32_16x16x32_bf16 v[172:175], a[136:139], a[196:199], 0
 ds_read_b64_tr_b16 a[164:165], v245 offset:10496
 v_mul_f32 v27, v49, v27
 v_cvt_pk_bf16_f32 v28, v20, v21
 v_cvt_pk_bf16_f32 v29, v22, v23
 v_cvt_pk_bf16_f32 v30, v24, v25
 buffer_load_dwordx4 v248, s[12:15], s55 offen lds
 v_mfma_f32_16x16x32_bf16 v[172:175], a[140:143], a[204:207], v[172:175]
 ds_read_b64_tr_b16 a[166:167], v245 offset:15616
 s_waitcnt lgkmcnt(8)
 v_cvt_pk_bf16_f32 v31, v26, v27
 s_add_u32 s49, s62, 0
 buffer_store_dwordx4 v[28:31], v1, s[4:7], s49 offen offset:1024 sc1
 v_accvgpr_read_b32 v20, a16
 v_mfma_f32_16x16x32_bf16 v[176:179], a[144:147], a[192:195], 0
 ds_read_b64_tr_b16 a[168:169], v246 offset:256
 v_accvgpr_read_b32 v21, a17
 v_accvgpr_read_b32 v22, a18
 v_accvgpr_read_b32 v23, a19
 v_accvgpr_read_b32 v24, a20
 s_add_u32 m0, s38, 2048
 v_mfma_f32_16x16x32_bf16 v[176:179], a[148:151], a[200:203], v[176:179]
 ds_read_b64_tr_b16 a[170:171], v246 offset:5376
 v_accvgpr_read_b32 v25, a21
 v_accvgpr_read_b32 v26, a22
 v_accvgpr_read_b32 v27, a23
 v_mul_f32 v20, v49, v20
 v_mul_f32 v21, v49, v21
 v_mfma_f32_16x16x32_bf16 v[180:183], a[144:147], a[196:199], 0
 s_barrier
 v_mul_f32 v22, v49, v22
 v_mul_f32 v23, v49, v23
 v_mul_f32 v24, v49, v24
 ds_read_b64_tr_b16 a[172:173], v246 offset:10496
 buffer_load_dwordx4 v249, s[12:15], s55 offen lds
 v_mfma_f32_16x16x32_bf16 v[180:183], a[148:151], a[204:207], v[180:183]
 ds_read_b64_tr_b16 a[174:175], v246 offset:15616
 v_mul_f32 v25, v49, v25
 v_mul_f32 v26, v49, v26
 v_mul_f32 v27, v49, v27
 v_cvt_pk_bf16_f32 v28, v20, v21
 s_waitcnt lgkmcnt(8)
 v_mfma_f32_16x16x32_bf16 v[184:187], a[152:155], a[192:195], 0
 ds_read_b64_tr_b16 a[176:177], v245 offset:20480
 v_cvt_pk_bf16_f32 v29, v22, v23
 v_cvt_pk_bf16_f32 v30, v24, v25
 v_cvt_pk_bf16_f32 v31, v26, v27
 s_add_u32 m0, s38, 3072
 v_mfma_f32_16x16x32_bf16 v[184:187], a[156:159], a[200:203], v[184:187]
 s_add_u32 s49, s62, 0
 buffer_store_dwordx4 v[28:31], v1, s[4:7], s49 offen offset:2048 sc1
 v_accvgpr_read_b32 v20, a24
 v_accvgpr_read_b32 v21, a25
 v_accvgpr_read_b32 v22, a26
 ds_read_b64_tr_b16 a[178:179], v245 offset:25600
 v_mfma_f32_16x16x32_bf16 v[188:191], a[152:155], a[196:199], 0
 ds_read_b64_tr_b16 a[180:181], v245 offset:30720
 v_accvgpr_read_b32 v23, a27
 v_accvgpr_read_b32 v24, a28
 v_accvgpr_read_b32 v25, a29
 v_accvgpr_read_b32 v26, a30
 buffer_load_dwordx4 v250, s[12:15], s55 offen lds
 v_mfma_f32_16x16x32_bf16 v[188:191], a[156:159], a[204:207], v[188:191]
 ds_read_b64_tr_b16 a[182:183], v245 offset:35840
 v_accvgpr_read_b32 v27, a31
 v_mul_f32 v20, v49, v20
 v_mul_f32 v21, v49, v21
 v_mul_f32 v22, v49, v22
 s_waitcnt lgkmcnt(8)
 v_mfma_f32_16x16x32_bf16 v[192:195], a[160:163], a[192:195], 0
 ds_read_b64_tr_b16 a[184:185], v246 offset:20480
 v_mul_f32 v23, v49, v23
 v_mul_f32 v24, v49, v24
 v_mul_f32 v25, v49, v25
 v_mul_f32 v26, v49, v26
 s_add_u32 m0, s38, 4096
 v_mfma_f32_16x16x32_bf16 v[192:195], a[164:167], a[200:203], v[192:195]
 ds_read_b64_tr_b16 a[186:187], v246 offset:25600
 v_mul_f32 v27, v49, v27
 v_cvt_pk_bf16_f32 v28, v20, v21
 v_cvt_pk_bf16_f32 v29, v22, v23
 v_cvt_pk_bf16_f32 v30, v24, v25
 v_cvt_pk_bf16_f32 v31, v26, v27
 v_mfma_f32_16x16x32_bf16 v[196:199], a[160:163], a[196:199], 0
 s_add_u32 s49, s62, 0
 buffer_store_dwordx4 v[28:31], v1, s[4:7], s49 offen offset:3072 sc1
 v_rcp_f32 v53, v52
 ds_read_b64_tr_b16 a[188:189], v246 offset:30720
 v_accvgpr_read_b32 v20, a32
 buffer_load_dwordx4 v251, s[12:15], s55 offen lds
 v_mfma_f32_16x16x32_bf16 v[196:199], a[164:167], a[204:207], v[196:199]
 ds_read_b64_tr_b16 a[190:191], v246 offset:35840
 v_accvgpr_read_b32 v21, a33
 v_accvgpr_read_b32 v22, a34
 v_accvgpr_read_b32 v23, a35
 v_accvgpr_read_b32 v24, a36
 s_waitcnt lgkmcnt(8)
 v_mfma_f32_16x16x32_bf16 v[200:203], a[168:171], a[192:195], 0
 ds_read_b64_tr_b16 a[128:129], v245 offset:20544
 v_accvgpr_read_b32 v25, a37
 v_accvgpr_read_b32 v26, a38
 v_accvgpr_read_b32 v27, a39
 v_mul_f32 v20, v53, v20
 v_mul_f32 v21, v53, v21
 v_mfma_f32_16x16x32_bf16 v[200:203], a[172:175], a[200:203], v[200:203]
 ds_read_b64_tr_b16 a[130:131], v245 offset:25664
 v_mul_f32 v22, v53, v22
 v_mul_f32 v23, v53, v23
 v_mul_f32 v24, v53, v24
 v_mul_f32 v25, v53, v25
 v_mul_f32 v26, v53, v26
 v_mfma_f32_16x16x32_bf16 v[204:207], a[168:171], a[196:199], 0
 ds_read_b64_tr_b16 a[132:133], v245 offset:30784
 v_mul_f32 v27, v53, v27
 v_cvt_pk_bf16_f32 v28, v20, v21
 v_cvt_pk_bf16_f32 v29, v22, v23
 v_cvt_pk_bf16_f32 v30, v24, v25
 v_cvt_pk_bf16_f32 v31, v26, v27
 v_mfma_f32_16x16x32_bf16 v[204:207], a[172:175], a[204:207], v[204:207]
 ds_read_b64_tr_b16 a[134:135], v245 offset:35904
 s_waitcnt lgkmcnt(8)
 s_add_u32 s49, s62, 745472
 buffer_store_dwordx4 v[28:31], v1, s[4:7], s49 offen sc1
 v_accvgpr_read_b32 v20, a40
 v_accvgpr_read_b32 v21, a41
 v_mfma_f32_16x16x32_bf16 v[128:131], a[176:179], a[208:211], v[128:131]
 ds_read_b64_tr_b16 a[136:137], v246 offset:20544
 v_accvgpr_read_b32 v22, a42
 v_accvgpr_read_b32 v23, a43
 v_accvgpr_read_b32 v24, a44
 v_accvgpr_read_b32 v25, a45
 v_accvgpr_read_b32 v26, a46
 v_mfma_f32_16x16x32_bf16 v[128:131], a[180:183], a[216:219], v[128:131]
 ds_read_b64_tr_b16 a[138:139], v246 offset:25664
 v_accvgpr_read_b32 v27, a47
 v_mul_f32 v20, v53, v20
 v_mul_f32 v21, v53, v21
 v_mul_f32 v22, v53, v22
 v_mul_f32 v23, v53, v23
 v_mfma_f32_16x16x32_bf16 v[132:135], a[176:179], a[212:215], v[132:135]
 ds_read_b64_tr_b16 a[140:141], v246 offset:30784
 v_mul_f32 v24, v53, v24
 v_mul_f32 v25, v53, v25
 v_mul_f32 v26, v53, v26
 v_mul_f32 v27, v53, v27
 s_add_u32 s55, s29, 327680
 v_mfma_f32_16x16x32_bf16 v[132:135], a[180:183], a[220:223], v[132:135]
 ds_read_b64_tr_b16 a[142:143], v246 offset:35904
 v_cvt_pk_bf16_f32 v28, v20, v21
 v_cvt_pk_bf16_f32 v29, v22, v23
 v_cvt_pk_bf16_f32 v30, v24, v25
 s_waitcnt lgkmcnt(8)
 s_add_u32 s53, s31, 8192
 v_mfma_f32_16x16x32_bf16 v[136:139], a[184:187], a[208:211], v[136:139]
 ds_read_b64_tr_b16 a[144:145], v245 offset:20608
 s_add_u32 m0, s38, 20480
 v_cvt_pk_bf16_f32 v31, v26, v27
 s_add_u32 s49, s62, 745472
 buffer_store_dwordx4 v[28:31], v1, s[4:7], s49 offen offset:1024 sc1
 v_accvgpr_read_b32 v20, a48
 v_mfma_f32_16x16x32_bf16 v[136:139], a[188:191], a[216:219], v[136:139]
 ds_read_b64_tr_b16 a[146:147], v245 offset:25728
 v_accvgpr_read_b32 v21, a49
 v_accvgpr_read_b32 v22, a50
 v_accvgpr_read_b32 v23, a51
 v_accvgpr_read_b32 v24, a52
 v_accvgpr_read_b32 v25, a53
 v_mfma_f32_16x16x32_bf16 v[140:143], a[184:187], a[212:215], v[140:143]
 ds_read_b64_tr_b16 a[148:149], v245 offset:30848
 v_accvgpr_read_b32 v26, a54
 v_accvgpr_read_b32 v27, a55
 v_mul_f32 v20, v53, v20
 v_mul_f32 v21, v53, v21
 buffer_load_dwordx4 v247, s[12:15], s55 offen lds
 v_mfma_f32_16x16x32_bf16 v[140:143], a[188:191], a[220:223], v[140:143]
 ds_read_b64_tr_b16 a[150:151], v245 offset:35968
 v_mul_f32 v22, v53, v22
 v_mul_f32 v23, v53, v23
 v_mul_f32 v24, v53, v24
 v_mul_f32 v25, v53, v25
 s_waitcnt lgkmcnt(8)
 v_mfma_f32_16x16x32_bf16 v[144:147], a[128:131], a[208:211], v[144:147]
 ds_read_b64_tr_b16 a[152:153], v246 offset:20608
 v_mul_f32 v26, v53, v26
 v_mul_f32 v27, v53, v27
 v_cvt_pk_bf16_f32 v28, v20, v21
 s_add_u32 m0, s38, 21504
 buffer_load_dwordx4 a[192:195], v252, s[4:7], s53 offen sc1
 v_mfma_f32_16x16x32_bf16 v[144:147], a[132:135], a[216:219], v[144:147]
 ds_read_b64_tr_b16 a[154:155], v246 offset:25728
 v_cvt_pk_bf16_f32 v29, v22, v23
 v_cvt_pk_bf16_f32 v30, v24, v25
 v_cvt_pk_bf16_f32 v31, v26, v27
 s_add_u32 s49, s62, 745472
 buffer_store_dwordx4 v[28:31], v1, s[4:7], s49 offen offset:2048 sc1
 v_mfma_f32_16x16x32_bf16 v[148:151], a[128:131], a[212:215], v[148:151]
 ds_read_b64_tr_b16 a[156:157], v246 offset:30848
 v_accvgpr_read_b32 v20, a56
 v_accvgpr_read_b32 v21, a57
 v_accvgpr_read_b32 v22, a58
 v_accvgpr_read_b32 v23, a59
 buffer_load_dwordx4 v248, s[12:15], s55 offen lds
 v_mfma_f32_16x16x32_bf16 v[148:151], a[132:135], a[220:223], v[148:151]
 ds_read_b64_tr_b16 a[158:159], v246 offset:35968
 v_accvgpr_read_b32 v24, a60
 v_accvgpr_read_b32 v25, a61
 v_accvgpr_read_b32 v26, a62
 v_accvgpr_read_b32 v27, a63
 s_waitcnt lgkmcnt(8)
 v_mfma_f32_16x16x32_bf16 v[152:155], a[136:139], a[208:211], v[152:155]
 ds_read_b64_tr_b16 a[160:161], v245 offset:20672
 v_mul_f32 v20, v53, v20
 v_mul_f32 v21, v53, v21
 v_mul_f32 v22, v53, v22
 v_mul_f32 v23, v53, v23
 s_add_u32 m0, s38, 22528
 v_mfma_f32_16x16x32_bf16 v[152:155], a[140:143], a[216:219], v[152:155]
 ds_read_b64_tr_b16 a[162:163], v245 offset:25792
 v_mul_f32 v24, v53, v24
 v_mul_f32 v25, v53, v25
 v_mul_f32 v26, v53, v26
 v_mul_f32 v27, v53, v27
 buffer_load_dwordx4 a[196:199], v253, s[4:7], s53 offen sc1
 v_mfma_f32_16x16x32_bf16 v[156:159], a[136:139], a[212:215], v[156:159]
 ds_read_b64_tr_b16 a[164:165], v245 offset:30912
 v_cvt_pk_bf16_f32 v28, v20, v21
 v_cvt_pk_bf16_f32 v29, v22, v23
 v_cvt_pk_bf16_f32 v30, v24, v25
 v_cvt_pk_bf16_f32 v31, v26, v27
 buffer_load_dwordx4 v249, s[12:15], s55 offen lds
 v_mfma_f32_16x16x32_bf16 v[156:159], a[140:143], a[220:223], v[156:159]
 ds_read_b64_tr_b16 a[166:167], v245 offset:36032
 s_waitcnt lgkmcnt(8)
 s_add_u32 s49, s62, 745472
 buffer_store_dwordx4 v[28:31], v1, s[4:7], s49 offen offset:3072 sc1
 v_mfma_f32_16x16x32_bf16 v[160:163], a[144:147], a[208:211], v[160:163]
 ds_read_b64_tr_b16 a[168:169], v246 offset:20672
 s_add_u32 m0, s38, 23552
 v_mfma_f32_16x16x32_bf16 v[160:163], a[148:151], a[216:219], v[160:163]
 ds_read_b64_tr_b16 a[170:171], v246 offset:25792
 v_mfma_f32_16x16x32_bf16 v[164:167], a[144:147], a[212:215], v[164:167]
 ds_read_b64_tr_b16 a[172:173], v246 offset:30912
 buffer_load_dwordx4 v250, s[12:15], s55 offen lds
 v_mfma_f32_16x16x32_bf16 v[164:167], a[148:151], a[220:223], v[164:167]
 ds_read_b64_tr_b16 a[174:175], v246 offset:36032
 s_waitcnt lgkmcnt(8)
 v_mfma_f32_16x16x32_bf16 v[168:171], a[152:155], a[208:211], v[168:171]
 ds_read_b64_tr_b16 a[176:177], v245 offset:20736
 s_add_u32 m0, s38, 24576
 v_mfma_f32_16x16x32_bf16 v[168:171], a[156:159], a[216:219], v[168:171]
 ds_read_b64_tr_b16 a[178:179], v245 offset:25856
 v_mfma_f32_16x16x32_bf16 v[172:175], a[152:155], a[212:215], v[172:175]
 ds_read_b64_tr_b16 a[180:181], v245 offset:30976
 buffer_load_dwordx4 v251, s[12:15], s55 offen lds
 v_mfma_f32_16x16x32_bf16 v[172:175], a[156:159], a[220:223], v[172:175]
 ds_read_b64_tr_b16 a[182:183], v245 offset:36096
 s_waitcnt lgkmcnt(8)
 s_add_u32 s53, s31, 9216
 v_mfma_f32_16x16x32_bf16 v[176:179], a[160:163], a[208:211], v[176:179]
 ds_read_b64_tr_b16 a[184:185], v246 offset:20736
 v_mfma_f32_16x16x32_bf16 v[176:179], a[164:167], a[216:219], v[176:179]
 ds_read_b64_tr_b16 a[186:187], v246 offset:25856
 v_mfma_f32_16x16x32_bf16 v[180:183], a[160:163], a[212:215], v[180:183]
 s_barrier
 ds_read_b64_tr_b16 a[188:189], v246 offset:30976
 v_mfma_f32_16x16x32_bf16 v[180:183], a[164:167], a[220:223], v[180:183]
 ds_read_b64_tr_b16 a[190:191], v246 offset:36096
 s_waitcnt lgkmcnt(8)
 v_mfma_f32_16x16x32_bf16 v[184:187], a[168:171], a[208:211], v[184:187]
 ds_read_b64_tr_b16 a[128:129], v245 offset:40960
 buffer_load_dwordx4 a[200:203], v252, s[4:7], s53 offen sc1
 v_mfma_f32_16x16x32_bf16 v[184:187], a[172:175], a[216:219], v[184:187]
 ds_read_b64_tr_b16 a[130:131], v245 offset:46080
 v_mfma_f32_16x16x32_bf16 v[188:191], a[168:171], a[212:215], v[188:191]
 ds_read_b64_tr_b16 a[132:133], v245 offset:51200
 v_mfma_f32_16x16x32_bf16 v[188:191], a[172:175], a[220:223], v[188:191]
 ds_read_b64_tr_b16 a[134:135], v245 offset:56320
 s_waitcnt lgkmcnt(8)
 v_mfma_f32_16x16x32_bf16 v[192:195], a[176:179], a[208:211], v[192:195]
 ds_read_b64_tr_b16 a[136:137], v246 offset:40960
 v_mfma_f32_16x16x32_bf16 v[192:195], a[180:183], a[216:219], v[192:195]
 ds_read_b64_tr_b16 a[138:139], v246 offset:46080
 buffer_load_dwordx4 a[204:207], v253, s[4:7], s53 offen sc1
 v_mfma_f32_16x16x32_bf16 v[196:199], a[176:179], a[212:215], v[196:199]
 ds_read_b64_tr_b16 a[140:141], v246 offset:51200
 v_mfma_f32_16x16x32_bf16 v[196:199], a[180:183], a[220:223], v[196:199]
 ds_read_b64_tr_b16 a[142:143], v246 offset:56320
 s_waitcnt lgkmcnt(8)
 v_mfma_f32_16x16x32_bf16 v[200:203], a[184:187], a[208:211], v[200:203]
 ds_read_b64_tr_b16 a[144:145], v245 offset:41024
 v_mfma_f32_16x16x32_bf16 v[200:203], a[188:191], a[216:219], v[200:203]
 ds_read_b64_tr_b16 a[146:147], v245 offset:46144
 v_mfma_f32_16x16x32_bf16 v[204:207], a[184:187], a[212:215], v[204:207]
 ds_read_b64_tr_b16 a[148:149], v245 offset:51264
 v_mfma_f32_16x16x32_bf16 v[204:207], a[188:191], a[220:223], v[204:207]
 ds_read_b64_tr_b16 a[150:151], v245 offset:56384
 s_waitcnt lgkmcnt(8)
 v_mfma_f32_16x16x32_bf16 v[128:131], a[128:131], a[224:227], v[128:131]
 ds_read_b64_tr_b16 a[152:153], v246 offset:41024
 v_mfma_f32_16x16x32_bf16 v[128:131], a[132:135], a[232:235], v[128:131]
 ds_read_b64_tr_b16 a[154:155], v246 offset:46144
 v_mfma_f32_16x16x32_bf16 v[132:135], a[128:131], a[228:231], v[132:135]
 ds_read_b64_tr_b16 a[156:157], v246 offset:51264
 s_add_u32 s55, s29, 409600
 v_mfma_f32_16x16x32_bf16 v[132:135], a[132:135], a[236:239], v[132:135]
 ds_read_b64_tr_b16 a[158:159], v246 offset:56384
 s_waitcnt lgkmcnt(8)
 s_add_u32 s53, s31, 10240
 v_mfma_f32_16x16x32_bf16 v[136:139], a[136:139], a[224:227], v[136:139]
 ds_read_b64_tr_b16 a[160:161], v245 offset:41088
 s_add_u32 m0, s38, 40960
 v_mfma_f32_16x16x32_bf16 v[136:139], a[140:143], a[232:235], v[136:139]
 ds_read_b64_tr_b16 a[162:163], v245 offset:46208
 v_mfma_f32_16x16x32_bf16 v[140:143], a[136:139], a[228:231], v[140:143]
 ds_read_b64_tr_b16 a[164:165], v245 offset:51328
 buffer_load_dwordx4 v247, s[12:15], s55 offen lds
 v_mfma_f32_16x16x32_bf16 v[140:143], a[140:143], a[236:239], v[140:143]
 ds_read_b64_tr_b16 a[166:167], v245 offset:56448
 s_waitcnt lgkmcnt(8)
 v_mfma_f32_16x16x32_bf16 v[144:147], a[144:147], a[224:227], v[144:147]
 ds_read_b64_tr_b16 a[168:169], v246 offset:41088
 s_add_u32 m0, s38, 41984
 buffer_load_dwordx4 a[208:211], v252, s[4:7], s53 offen sc1
 v_mfma_f32_16x16x32_bf16 v[144:147], a[148:151], a[232:235], v[144:147]
 ds_read_b64_tr_b16 a[170:171], v246 offset:46208
 v_mfma_f32_16x16x32_bf16 v[148:151], a[144:147], a[228:231], v[148:151]
 ds_read_b64_tr_b16 a[172:173], v246 offset:51328
 buffer_load_dwordx4 v248, s[12:15], s55 offen lds
 v_mfma_f32_16x16x32_bf16 v[148:151], a[148:151], a[236:239], v[148:151]
 ds_read_b64_tr_b16 a[174:175], v246 offset:56448
 s_waitcnt lgkmcnt(8)
 v_mfma_f32_16x16x32_bf16 v[152:155], a[152:155], a[224:227], v[152:155]
 ds_read_b64_tr_b16 a[176:177], v245 offset:41152
 s_add_u32 m0, s38, 43008
 v_mfma_f32_16x16x32_bf16 v[152:155], a[156:159], a[232:235], v[152:155]
 ds_read_b64_tr_b16 a[178:179], v245 offset:46272
 buffer_load_dwordx4 a[212:215], v253, s[4:7], s53 offen sc1
 v_mfma_f32_16x16x32_bf16 v[156:159], a[152:155], a[228:231], v[156:159]
 ds_read_b64_tr_b16 a[180:181], v245 offset:51392
 buffer_load_dwordx4 v249, s[12:15], s55 offen lds
 v_mfma_f32_16x16x32_bf16 v[156:159], a[156:159], a[236:239], v[156:159]
 ds_read_b64_tr_b16 a[182:183], v245 offset:56512
 s_waitcnt lgkmcnt(8)
 v_mfma_f32_16x16x32_bf16 v[160:163], a[160:163], a[224:227], v[160:163]
 ds_read_b64_tr_b16 a[184:185], v246 offset:41152
 s_add_u32 m0, s38, 44032
 v_mfma_f32_16x16x32_bf16 v[160:163], a[164:167], a[232:235], v[160:163]
 ds_read_b64_tr_b16 a[186:187], v246 offset:46272
 v_mfma_f32_16x16x32_bf16 v[164:167], a[160:163], a[228:231], v[164:167]
 ds_read_b64_tr_b16 a[188:189], v246 offset:51392
 buffer_load_dwordx4 v250, s[12:15], s55 offen lds
 v_mfma_f32_16x16x32_bf16 v[164:167], a[164:167], a[236:239], v[164:167]
 ds_read_b64_tr_b16 a[190:191], v246 offset:56512
 s_waitcnt lgkmcnt(8)
 v_mfma_f32_16x16x32_bf16 v[168:171], a[168:171], a[224:227], v[168:171]
 ds_read_b64_tr_b16 a[128:129], v245 offset:41216
 s_add_u32 m0, s38, 45056
 v_mfma_f32_16x16x32_bf16 v[168:171], a[172:175], a[232:235], v[168:171]
 ds_read_b64_tr_b16 a[130:131], v245 offset:46336
 v_mfma_f32_16x16x32_bf16 v[172:175], a[168:171], a[228:231], v[172:175]
 ds_read_b64_tr_b16 a[132:133], v245 offset:51456
 buffer_load_dwordx4 v251, s[12:15], s55 offen lds
 v_mfma_f32_16x16x32_bf16 v[172:175], a[172:175], a[236:239], v[172:175]
 ds_read_b64_tr_b16 a[134:135], v245 offset:56576
 s_waitcnt lgkmcnt(8)
 s_add_u32 s53, s31, 11264
 v_mfma_f32_16x16x32_bf16 v[176:179], a[176:179], a[224:227], v[176:179]
 ds_read_b64_tr_b16 a[136:137], v246 offset:41216
 v_mfma_f32_16x16x32_bf16 v[176:179], a[180:183], a[232:235], v[176:179]
 ds_read_b64_tr_b16 a[138:139], v246 offset:46336
 v_mfma_f32_16x16x32_bf16 v[180:183], a[176:179], a[228:231], v[180:183]
 s_waitcnt vmcnt(11)
 s_barrier
 ds_read_b64_tr_b16 a[140:141], v246 offset:51456
 v_mfma_f32_16x16x32_bf16 v[180:183], a[180:183], a[236:239], v[180:183]
 buffer_store_dword v9, v4, s[4:7], s3 offen offset:128 sc1
 ds_read_b64_tr_b16 a[142:143], v246 offset:56576
 s_waitcnt lgkmcnt(8)
 v_mfma_f32_16x16x32_bf16 v[184:187], a[184:187], a[224:227], v[184:187]
 v_xor_b32 v245, 0x10000, v245
 ds_read_b64_tr_b16 a[144:145], v245
 buffer_load_dwordx4 a[216:219], v252, s[4:7], s53 offen sc1
 v_mfma_f32_16x16x32_bf16 v[184:187], a[188:191], a[232:235], v[184:187]
 ds_read_b64_tr_b16 a[146:147], v245 offset:5120
 v_mfma_f32_16x16x32_bf16 v[188:191], a[184:187], a[228:231], v[188:191]
 ds_read_b64_tr_b16 a[148:149], v245 offset:10240
 v_mfma_f32_16x16x32_bf16 v[188:191], a[188:191], a[236:239], v[188:191]
 ds_read_b64_tr_b16 a[150:151], v245 offset:15360
 s_waitcnt lgkmcnt(8)
 v_mfma_f32_16x16x32_bf16 v[192:195], a[128:131], a[224:227], v[192:195]
 v_xor_b32 v246, 0x10000, v246
 ds_read_b64_tr_b16 a[152:153], v246
 v_mfma_f32_16x16x32_bf16 v[192:195], a[132:135], a[232:235], v[192:195]
 ds_read_b64_tr_b16 a[154:155], v246 offset:5120
 buffer_load_dwordx4 a[220:223], v253, s[4:7], s53 offen sc1
 v_mfma_f32_16x16x32_bf16 v[196:199], a[128:131], a[228:231], v[196:199]
 ds_read_b64_tr_b16 a[156:157], v246 offset:10240
 v_mfma_f32_16x16x32_bf16 v[196:199], a[132:135], a[236:239], v[196:199]
 ds_read_b64_tr_b16 a[158:159], v246 offset:15360
 s_waitcnt lgkmcnt(8)
 v_mfma_f32_16x16x32_bf16 v[200:203], a[136:139], a[224:227], v[200:203]
 ds_read_b64_tr_b16 a[160:161], v245 offset:64
 v_mfma_f32_16x16x32_bf16 v[200:203], a[140:143], a[232:235], v[200:203]
 ds_read_b64_tr_b16 a[162:163], v245 offset:5184
 v_mfma_f32_16x16x32_bf16 v[204:207], a[136:139], a[228:231], v[204:207]
 ds_read_b64_tr_b16 a[164:165], v245 offset:10304
 v_mfma_f32_16x16x32_bf16 v[204:207], a[140:143], a[236:239], v[204:207]
 ds_read_b64_tr_b16 a[166:167], v245 offset:15424
 s_waitcnt lgkmcnt(8)
 v_mfma_f32_16x16x32_bf16 v[128:131], a[144:147], a[240:243], v[128:131]
 ds_read_b64_tr_b16 a[168:169], v246 offset:64
 v_mfma_f32_16x16x32_bf16 v[128:131], a[148:151], a[248:251], v[128:131]
 ds_read_b64_tr_b16 a[170:171], v246 offset:5184
 v_mfma_f32_16x16x32_bf16 v[132:135], a[144:147], a[244:247], v[132:135]
 ds_read_b64_tr_b16 a[172:173], v246 offset:10304
 s_add_u32 s55, s29, 491520
 v_mfma_f32_16x16x32_bf16 v[132:135], a[148:151], a[252:255], v[132:135]
 ds_read_b64_tr_b16 a[174:175], v246 offset:15424
 s_waitcnt lgkmcnt(8)
 s_add_u32 s53, s31, 12288
 v_mfma_f32_16x16x32_bf16 v[136:139], a[152:155], a[240:243], v[136:139]
 ds_read_b64_tr_b16 a[176:177], v245 offset:128
 s_add_u32 m0, s38, 65536
 v_mfma_f32_16x16x32_bf16 v[136:139], a[156:159], a[248:251], v[136:139]
 ds_read_b64_tr_b16 a[178:179], v245 offset:5248
 v_mfma_f32_16x16x32_bf16 v[140:143], a[152:155], a[244:247], v[140:143]
 ds_read_b64_tr_b16 a[180:181], v245 offset:10368
 buffer_load_dwordx4 v247, s[12:15], s55 offen lds
 v_mfma_f32_16x16x32_bf16 v[140:143], a[156:159], a[252:255], v[140:143]
 ds_read_b64_tr_b16 a[182:183], v245 offset:15488
 s_waitcnt lgkmcnt(8)
 v_mfma_f32_16x16x32_bf16 v[144:147], a[160:163], a[240:243], v[144:147]
 ds_read_b64_tr_b16 a[184:185], v246 offset:128
 s_add_u32 m0, s38, 66560
 buffer_load_dwordx4 a[224:227], v252, s[4:7], s53 offen sc1
 v_mfma_f32_16x16x32_bf16 v[144:147], a[164:167], a[248:251], v[144:147]
 ds_read_b64_tr_b16 a[186:187], v246 offset:5248
 v_mfma_f32_16x16x32_bf16 v[148:151], a[160:163], a[244:247], v[148:151]
 ds_read_b64_tr_b16 a[188:189], v246 offset:10368
 buffer_load_dwordx4 v248, s[12:15], s55 offen lds
 v_mfma_f32_16x16x32_bf16 v[148:151], a[164:167], a[252:255], v[148:151]
 ds_read_b64_tr_b16 a[190:191], v246 offset:15488
 s_waitcnt lgkmcnt(8)
 v_mfma_f32_16x16x32_bf16 v[152:155], a[168:171], a[240:243], v[152:155]
 ds_read_b64_tr_b16 a[128:129], v245 offset:192
 s_add_u32 m0, s38, 67584
 v_mfma_f32_16x16x32_bf16 v[152:155], a[172:175], a[248:251], v[152:155]
 ds_read_b64_tr_b16 a[130:131], v245 offset:5312
 buffer_load_dwordx4 a[228:231], v253, s[4:7], s53 offen sc1
 v_mfma_f32_16x16x32_bf16 v[156:159], a[168:171], a[244:247], v[156:159]
 ds_read_b64_tr_b16 a[132:133], v245 offset:10432
 buffer_load_dwordx4 v249, s[12:15], s55 offen lds
 v_mfma_f32_16x16x32_bf16 v[156:159], a[172:175], a[252:255], v[156:159]
 ds_read_b64_tr_b16 a[134:135], v245 offset:15552
 s_waitcnt lgkmcnt(8)
 v_mfma_f32_16x16x32_bf16 v[160:163], a[176:179], a[240:243], v[160:163]
 ds_read_b64_tr_b16 a[136:137], v246 offset:192
 s_add_u32 m0, s38, 68608
 v_mfma_f32_16x16x32_bf16 v[160:163], a[180:183], a[248:251], v[160:163]
 ds_read_b64_tr_b16 a[138:139], v246 offset:5312
 v_mfma_f32_16x16x32_bf16 v[164:167], a[176:179], a[244:247], v[164:167]
 ds_read_b64_tr_b16 a[140:141], v246 offset:10432
 buffer_load_dwordx4 v250, s[12:15], s55 offen lds
 v_mfma_f32_16x16x32_bf16 v[164:167], a[180:183], a[252:255], v[164:167]
 ds_read_b64_tr_b16 a[142:143], v246 offset:15552
 s_waitcnt lgkmcnt(8)
 v_mfma_f32_16x16x32_bf16 v[168:171], a[184:187], a[240:243], v[168:171]
 ds_read_b64_tr_b16 a[144:145], v245 offset:256
 s_add_u32 m0, s38, 69632
 v_mfma_f32_16x16x32_bf16 v[168:171], a[188:191], a[248:251], v[168:171]
 ds_read_b64_tr_b16 a[146:147], v245 offset:5376
 v_mfma_f32_16x16x32_bf16 v[172:175], a[184:187], a[244:247], v[172:175]
 ds_read_b64_tr_b16 a[148:149], v245 offset:10496
 buffer_load_dwordx4 v251, s[12:15], s55 offen lds
 v_mfma_f32_16x16x32_bf16 v[172:175], a[188:191], a[252:255], v[172:175]
 ds_read_b64_tr_b16 a[150:151], v245 offset:15616
 s_waitcnt lgkmcnt(8)
 s_mov_b32 s53, s35
 v_mfma_f32_16x16x32_bf16 v[176:179], a[128:131], a[240:243], v[176:179]
 ds_read_b64_tr_b16 a[152:153], v246 offset:256
 v_mfma_f32_16x16x32_bf16 v[176:179], a[132:135], a[248:251], v[176:179]
 ds_read_b64_tr_b16 a[154:155], v246 offset:5376
 v_mfma_f32_16x16x32_bf16 v[180:183], a[128:131], a[244:247], v[180:183]
 s_waitcnt vmcnt(19)
 s_barrier
 ds_read_b64_tr_b16 a[156:157], v246 offset:10496
 v_mfma_f32_16x16x32_bf16 v[180:183], a[132:135], a[252:255], v[180:183]
 ds_read_b64_tr_b16 a[158:159], v246 offset:15616
 s_waitcnt lgkmcnt(8)
 v_mfma_f32_16x16x32_bf16 v[184:187], a[136:139], a[240:243], v[184:187]
 ds_read_b64_tr_b16 a[160:161], v245 offset:20480
 buffer_load_dwordx4 a[232:235], v252, s[4:7], s53 offen sc1
 v_mfma_f32_16x16x32_bf16 v[184:187], a[140:143], a[248:251], v[184:187]
 ds_read_b64_tr_b16 a[162:163], v245 offset:25600
 v_mfma_f32_16x16x32_bf16 v[188:191], a[136:139], a[244:247], v[188:191]
 ds_read_b64_tr_b16 a[164:165], v245 offset:30720
 v_mfma_f32_16x16x32_bf16 v[188:191], a[140:143], a[252:255], v[188:191]
 ds_read_b64_tr_b16 a[166:167], v245 offset:35840
 s_waitcnt lgkmcnt(8)
 v_mfma_f32_16x16x32_bf16 v[192:195], a[144:147], a[240:243], v[192:195]
 ds_read_b64_tr_b16 a[168:169], v246 offset:20480
 v_mfma_f32_16x16x32_bf16 v[192:195], a[148:151], a[248:251], v[192:195]
 ds_read_b64_tr_b16 a[170:171], v246 offset:25600
 buffer_load_dwordx4 a[236:239], v253, s[4:7], s53 offen sc1
 v_mfma_f32_16x16x32_bf16 v[196:199], a[144:147], a[244:247], v[196:199]
 ds_read_b64_tr_b16 a[172:173], v246 offset:30720
 v_mfma_f32_16x16x32_bf16 v[196:199], a[148:151], a[252:255], v[196:199]
 ds_read_b64_tr_b16 a[174:175], v246 offset:35840
 s_waitcnt lgkmcnt(8)
 v_mfma_f32_16x16x32_bf16 v[200:203], a[152:155], a[240:243], v[200:203]
 ds_read_b64_tr_b16 a[176:177], v245 offset:20544
 v_mfma_f32_16x16x32_bf16 v[200:203], a[156:159], a[248:251], v[200:203]
 ds_read_b64_tr_b16 a[178:179], v245 offset:25664
 v_mfma_f32_16x16x32_bf16 v[204:207], a[152:155], a[244:247], v[204:207]
 ds_read_b64_tr_b16 a[180:181], v245 offset:30784
 v_mfma_f32_16x16x32_bf16 v[204:207], a[156:159], a[252:255], v[204:207]
 ds_read_b64_tr_b16 a[182:183], v245 offset:35904
 s_waitcnt lgkmcnt(8)
 v_mfma_f32_16x16x32_bf16 v[128:131], a[160:163], a[192:195], v[128:131]
 ds_read_b64_tr_b16 a[184:185], v246 offset:20544
 s_waitcnt vmcnt(20)
 v_mfma_f32_16x16x32_bf16 v[128:131], a[164:167], a[200:203], v[128:131]
 ds_read_b64_tr_b16 a[186:187], v246 offset:25664
 v_mfma_f32_16x16x32_bf16 v[132:135], a[160:163], a[196:199], v[132:135]
 s_mul_i32 s55, s32, 81920
 s_add_u32 s55, s55, s28
 ds_read_b64_tr_b16 a[188:189], v246 offset:30784
 s_waitcnt vmcnt(19)
 v_mfma_f32_16x16x32_bf16 v[132:135], a[164:167], a[204:207], v[132:135]
 ds_read_b64_tr_b16 a[190:191], v246 offset:35904
 s_waitcnt lgkmcnt(8)
 v_mfma_f32_16x16x32_bf16 v[136:139], a[168:171], a[192:195], v[136:139]
 s_add_u32 s53, s30, s33
 s_add_u32 s33, s33, 1024
 s_and_b32 s33, s33, 0x3fff
 ds_read_b64_tr_b16 a[128:129], v245 offset:20608
 v_mfma_f32_16x16x32_bf16 v[136:139], a[172:175], a[200:203], v[136:139]
 ds_read_b64_tr_b16 a[130:131], v245 offset:25728
 s_add_u32 m0, s38, 86016
 v_mfma_f32_16x16x32_bf16 v[140:143], a[168:171], a[196:199], v[140:143]
 ds_read_b64_tr_b16 a[132:133], v245 offset:30848
 v_mfma_f32_16x16x32_bf16 v[140:143], a[172:175], a[204:207], v[140:143]
 ds_read_b64_tr_b16 a[134:135], v245 offset:35968
 s_waitcnt lgkmcnt(8)
 v_mfma_f32_16x16x32_bf16 v[144:147], a[176:179], a[192:195], v[144:147]
 ds_read_b64_tr_b16 a[136:137], v246 offset:20608
 buffer_load_dwordx4 v247, s[8:11], s55 offen lds
 buffer_load_dwordx4 a[240:243], v252, s[4:7], s53 offen sc1
 v_mfma_f32_16x16x32_bf16 v[144:147], a[180:183], a[200:203], v[144:147]
 ds_read_b64_tr_b16 a[138:139], v246 offset:25728
 v_mfma_f32_16x16x32_bf16 v[148:151], a[176:179], a[196:199], v[148:151]
 ds_read_b64_tr_b16 a[140:141], v246 offset:30848
 v_mfma_f32_16x16x32_bf16 v[148:151], a[180:183], a[204:207], v[148:151]
 ds_read_b64_tr_b16 a[142:143], v246 offset:35968
 s_waitcnt lgkmcnt(8)
 s_add_u32 m0, s38, 87040
 v_mfma_f32_16x16x32_bf16 v[152:155], a[184:187], a[192:195], v[152:155]
 ds_read_b64_tr_b16 a[144:145], v245 offset:20672
 v_mfma_f32_16x16x32_bf16 v[152:155], a[188:191], a[200:203], v[152:155]
 ds_read_b64_tr_b16 a[146:147], v245 offset:25792
 buffer_load_dwordx4 a[244:247], v253, s[4:7], s53 offen sc1
 v_mfma_f32_16x16x32_bf16 v[156:159], a[184:187], a[196:199], v[156:159]
 ds_read_b64_tr_b16 a[148:149], v245 offset:30912
 buffer_load_dwordx4 v248, s[8:11], s55 offen lds
 v_mfma_f32_16x16x32_bf16 v[156:159], a[188:191], a[204:207], v[156:159]
 ds_read_b64_tr_b16 a[150:151], v245 offset:36032
 s_waitcnt lgkmcnt(8)
 v_mfma_f32_16x16x32_bf16 v[160:163], a[128:131], a[192:195], v[160:163]
 ds_read_b64_tr_b16 a[152:153], v246 offset:20672
 v_mfma_f32_16x16x32_bf16 v[160:163], a[132:135], a[200:203], v[160:163]
 ds_read_b64_tr_b16 a[154:155], v246 offset:25792
 s_add_u32 m0, s38, 88064
 v_mfma_f32_16x16x32_bf16 v[164:167], a[128:131], a[196:199], v[164:167]
 ds_read_b64_tr_b16 a[156:157], v246 offset:30912
 v_mfma_f32_16x16x32_bf16 v[164:167], a[132:135], a[204:207], v[164:167]
 ds_read_b64_tr_b16 a[158:159], v246 offset:36032
 s_waitcnt lgkmcnt(8)
 v_mfma_f32_16x16x32_bf16 v[168:171], a[136:139], a[192:195], v[168:171]
 ds_read_b64_tr_b16 a[160:161], v245 offset:20736
 buffer_load_dwordx4 v249, s[8:11], s55 offen lds
 v_mfma_f32_16x16x32_bf16 v[168:171], a[140:143], a[200:203], v[168:171]
 ds_read_b64_tr_b16 a[162:163], v245 offset:25856
 v_mfma_f32_16x16x32_bf16 v[172:175], a[136:139], a[196:199], v[172:175]
 ds_read_b64_tr_b16 a[164:165], v245 offset:30976
 v_mfma_f32_16x16x32_bf16 v[172:175], a[140:143], a[204:207], v[172:175]
 ds_read_b64_tr_b16 a[166:167], v245 offset:36096
 s_waitcnt lgkmcnt(8)
 s_add_u32 m0, s38, 89088
 v_mfma_f32_16x16x32_bf16 v[176:179], a[144:147], a[192:195], v[176:179]
 s_add_u32 s53, s30, s33
 s_add_u32 s33, s33, 1024
 s_and_b32 s33, s33, 0x3fff
 ds_read_b64_tr_b16 a[168:169], v246 offset:20736
 v_mfma_f32_16x16x32_bf16 v[176:179], a[148:151], a[200:203], v[176:179]
 ds_read_b64_tr_b16 a[170:171], v246 offset:25856
 v_mfma_f32_16x16x32_bf16 v[180:183], a[144:147], a[196:199], v[180:183]
 s_waitcnt vmcnt(17)
 s_barrier
 ds_read_b64_tr_b16 a[172:173], v246 offset:30976
 buffer_load_dwordx4 v250, s[8:11], s55 offen lds
 v_mfma_f32_16x16x32_bf16 v[180:183], a[148:151], a[204:207], v[180:183]
 ds_read_b64_tr_b16 a[174:175], v246 offset:36096
 s_waitcnt lgkmcnt(8)
 v_mfma_f32_16x16x32_bf16 v[184:187], a[152:155], a[192:195], v[184:187]
 ds_read_b64_tr_b16 a[176:177], v245 offset:40960
 buffer_load_dwordx4 a[248:251], v252, s[4:7], s53 offen sc1
 v_mfma_f32_16x16x32_bf16 v[184:187], a[156:159], a[200:203], v[184:187]
 ds_read_b64_tr_b16 a[178:179], v245 offset:46080
 s_add_u32 m0, s38, 90112
 v_mfma_f32_16x16x32_bf16 v[188:191], a[152:155], a[196:199], v[188:191]
 ds_read_b64_tr_b16 a[180:181], v245 offset:51200
 v_mfma_f32_16x16x32_bf16 v[188:191], a[156:159], a[204:207], v[188:191]
 ds_read_b64_tr_b16 a[182:183], v245 offset:56320
 s_waitcnt lgkmcnt(8)
 v_mfma_f32_16x16x32_bf16 v[192:195], a[160:163], a[192:195], v[192:195]
 ds_read_b64_tr_b16 a[184:185], v246 offset:40960
 buffer_load_dwordx4 v251, s[8:11], s55 offen lds
 v_mfma_f32_16x16x32_bf16 v[192:195], a[164:167], a[200:203], v[192:195]
 ds_read_b64_tr_b16 a[186:187], v246 offset:46080
 buffer_load_dwordx4 a[252:255], v253, s[4:7], s53 offen sc1
 v_mfma_f32_16x16x32_bf16 v[196:199], a[160:163], a[196:199], v[196:199]
 ds_read_b64_tr_b16 a[188:189], v246 offset:51200
 v_mfma_f32_16x16x32_bf16 v[196:199], a[164:167], a[204:207], v[196:199]
 s_add_u32 s32, s32, 1
 s_and_b32 s32, s32, 7
 ds_read_b64_tr_b16 a[190:191], v246 offset:56320
 s_waitcnt lgkmcnt(8)
 v_mfma_f32_16x16x32_bf16 v[200:203], a[168:171], a[192:195], v[200:203]
 ds_read_b64_tr_b16 a[128:129], v245 offset:41024
 v_mfma_f32_16x16x32_bf16 v[200:203], a[172:175], a[200:203], v[200:203]
 ds_read_b64_tr_b16 a[130:131], v245 offset:46144
 v_mfma_f32_16x16x32_bf16 v[204:207], a[168:171], a[196:199], v[204:207]
 ds_read_b64_tr_b16 a[132:133], v245 offset:51264
 v_mfma_f32_16x16x32_bf16 v[204:207], a[172:175], a[204:207], v[204:207]
 ds_read_b64_tr_b16 a[134:135], v245 offset:56384
 s_waitcnt lgkmcnt(8)
 v_mfma_f32_16x16x32_bf16 v[128:131], a[176:179], a[208:211], v[128:131]
 ds_read_b64_tr_b16 a[136:137], v246 offset:41024
 s_waitcnt vmcnt(19)
 v_mfma_f32_16x16x32_bf16 v[128:131], a[180:183], a[216:219], v[128:131]
 ds_read_b64_tr_b16 a[138:139], v246 offset:46144
 v_mfma_f32_16x16x32_bf16 v[132:135], a[176:179], a[212:215], v[132:135]
 s_mul_i32 s55, s32, 81920
 s_add_u32 s55, s55, s28
 ds_read_b64_tr_b16 a[140:141], v246 offset:51264
 s_waitcnt vmcnt(18)
 v_mfma_f32_16x16x32_bf16 v[132:135], a[180:183], a[220:223], v[132:135]
 ds_read_b64_tr_b16 a[142:143], v246 offset:56384
 s_waitcnt lgkmcnt(8)
 v_mfma_f32_16x16x32_bf16 v[136:139], a[184:187], a[208:211], v[136:139]
 s_add_u32 s53, s30, s33
 s_add_u32 s33, s33, 1024
 s_and_b32 s33, s33, 0x3fff
 ds_read_b64_tr_b16 a[144:145], v245 offset:41088
 v_mfma_f32_16x16x32_bf16 v[136:139], a[188:191], a[216:219], v[136:139]
 ds_read_b64_tr_b16 a[146:147], v245 offset:46208
 s_add_u32 m0, s38, 106496
 v_mfma_f32_16x16x32_bf16 v[140:143], a[184:187], a[212:215], v[140:143]
 ds_read_b64_tr_b16 a[148:149], v245 offset:51328
 v_mfma_f32_16x16x32_bf16 v[140:143], a[188:191], a[220:223], v[140:143]
 ds_read_b64_tr_b16 a[150:151], v245 offset:56448
 s_waitcnt lgkmcnt(8)
 v_mfma_f32_16x16x32_bf16 v[144:147], a[128:131], a[208:211], v[144:147]
 ds_read_b64_tr_b16 a[152:153], v246 offset:41088
 buffer_load_dwordx4 v247, s[8:11], s55 offen lds
 buffer_load_dwordx4 a[192:195], v252, s[4:7], s53 offen sc1
 v_mfma_f32_16x16x32_bf16 v[144:147], a[132:135], a[216:219], v[144:147]
 ds_read_b64_tr_b16 a[154:155], v246 offset:46208
 v_mfma_f32_16x16x32_bf16 v[148:151], a[128:131], a[212:215], v[148:151]
 ds_read_b64_tr_b16 a[156:157], v246 offset:51328
 v_mfma_f32_16x16x32_bf16 v[148:151], a[132:135], a[220:223], v[148:151]
 ds_read_b64_tr_b16 a[158:159], v246 offset:56448
 s_waitcnt lgkmcnt(8)
 s_add_u32 m0, s38, 107520
 v_mfma_f32_16x16x32_bf16 v[152:155], a[136:139], a[208:211], v[152:155]
 ds_read_b64_tr_b16 a[160:161], v245 offset:41152
 v_mfma_f32_16x16x32_bf16 v[152:155], a[140:143], a[216:219], v[152:155]
 ds_read_b64_tr_b16 a[162:163], v245 offset:46272
 buffer_load_dwordx4 a[196:199], v253, s[4:7], s53 offen sc1
 v_mfma_f32_16x16x32_bf16 v[156:159], a[136:139], a[212:215], v[156:159]
 ds_read_b64_tr_b16 a[164:165], v245 offset:51392
 buffer_load_dwordx4 v248, s[8:11], s55 offen lds
 v_mfma_f32_16x16x32_bf16 v[156:159], a[140:143], a[220:223], v[156:159]
 ds_read_b64_tr_b16 a[166:167], v245 offset:56512
 s_waitcnt lgkmcnt(8)
 v_mfma_f32_16x16x32_bf16 v[160:163], a[144:147], a[208:211], v[160:163]
 ds_read_b64_tr_b16 a[168:169], v246 offset:41152
 v_mfma_f32_16x16x32_bf16 v[160:163], a[148:151], a[216:219], v[160:163]
 ds_read_b64_tr_b16 a[170:171], v246 offset:46272
 s_add_u32 m0, s38, 108544
 v_mfma_f32_16x16x32_bf16 v[164:167], a[144:147], a[212:215], v[164:167]
 ds_read_b64_tr_b16 a[172:173], v246 offset:51392
 v_mfma_f32_16x16x32_bf16 v[164:167], a[148:151], a[220:223], v[164:167]
 ds_read_b64_tr_b16 a[174:175], v246 offset:56512
 s_waitcnt lgkmcnt(8)
 v_mfma_f32_16x16x32_bf16 v[168:171], a[152:155], a[208:211], v[168:171]
 ds_read_b64_tr_b16 a[176:177], v245 offset:41216
 buffer_load_dwordx4 v249, s[8:11], s55 offen lds
 v_mfma_f32_16x16x32_bf16 v[168:171], a[156:159], a[216:219], v[168:171]
 ds_read_b64_tr_b16 a[178:179], v245 offset:46336
 v_mfma_f32_16x16x32_bf16 v[172:175], a[152:155], a[212:215], v[172:175]
 ds_read_b64_tr_b16 a[180:181], v245 offset:51456
 v_mfma_f32_16x16x32_bf16 v[172:175], a[156:159], a[220:223], v[172:175]
 ds_read_b64_tr_b16 a[182:183], v245 offset:56576
 s_waitcnt lgkmcnt(8)
 s_add_u32 m0, s38, 109568
 v_mfma_f32_16x16x32_bf16 v[176:179], a[160:163], a[208:211], v[176:179]
 s_add_u32 s53, s30, s33
 s_add_u32 s33, s33, 1024
 s_and_b32 s33, s33, 0x3fff
 ds_read_b64_tr_b16 a[184:185], v246 offset:41216
 v_mfma_f32_16x16x32_bf16 v[176:179], a[164:167], a[216:219], v[176:179]
 ds_read_b64_tr_b16 a[186:187], v246 offset:46336
 v_mfma_f32_16x16x32_bf16 v[180:183], a[160:163], a[212:215], v[180:183]
 s_waitcnt vmcnt(16)
 s_barrier
 ds_read_b64_tr_b16 a[188:189], v246 offset:51456
 buffer_load_dwordx4 v250, s[8:11], s55 offen lds
 v_mfma_f32_16x16x32_bf16 v[180:183], a[164:167], a[220:223], v[180:183]
 ds_read_b64_tr_b16 a[190:191], v246 offset:56576
 s_waitcnt lgkmcnt(8)
 v_mfma_f32_16x16x32_bf16 v[184:187], a[168:171], a[208:211], v[184:187]
 v_xor_b32 v245, 0x10000, v245
 ds_read_b64_tr_b16 a[128:129], v245
 buffer_load_dwordx4 a[200:203], v252, s[4:7], s53 offen sc1
 v_mfma_f32_16x16x32_bf16 v[184:187], a[172:175], a[216:219], v[184:187]
 ds_read_b64_tr_b16 a[130:131], v245 offset:5120
 s_add_u32 m0, s38, 110592
 v_mfma_f32_16x16x32_bf16 v[188:191], a[168:171], a[212:215], v[188:191]
 ds_read_b64_tr_b16 a[132:133], v245 offset:10240
 v_mfma_f32_16x16x32_bf16 v[188:191], a[172:175], a[220:223], v[188:191]
 ds_read_b64_tr_b16 a[134:135], v245 offset:15360
 s_waitcnt lgkmcnt(8)
 v_mfma_f32_16x16x32_bf16 v[192:195], a[176:179], a[208:211], v[192:195]
 v_xor_b32 v246, 0x10000, v246
 ds_read_b64_tr_b16 a[136:137], v246
 buffer_load_dwordx4 v251, s[8:11], s55 offen lds
 v_mfma_f32_16x16x32_bf16 v[192:195], a[180:183], a[216:219], v[192:195]
 ds_read_b64_tr_b16 a[138:139], v246 offset:5120
 buffer_load_dwordx4 a[204:207], v253, s[4:7], s53 offen sc1
 v_mfma_f32_16x16x32_bf16 v[196:199], a[176:179], a[212:215], v[196:199]
 ds_read_b64_tr_b16 a[140:141], v246 offset:10240
 v_mfma_f32_16x16x32_bf16 v[196:199], a[180:183], a[220:223], v[196:199]
 s_add_u32 s32, s32, 1
 s_and_b32 s32, s32, 7
 ds_read_b64_tr_b16 a[142:143], v246 offset:15360
 s_waitcnt lgkmcnt(8)
 v_mfma_f32_16x16x32_bf16 v[200:203], a[184:187], a[208:211], v[200:203]
 ds_read_b64_tr_b16 a[144:145], v245 offset:64
 buffer_load_dword v240, v254, s[4:7], s36 offen sc1
 v_mfma_f32_16x16x32_bf16 v[200:203], a[188:191], a[216:219], v[200:203]
 ds_read_b64_tr_b16 a[146:147], v245 offset:5184
 v_mfma_f32_16x16x32_bf16 v[204:207], a[184:187], a[212:215], v[204:207]
 ds_read_b64_tr_b16 a[148:149], v245 offset:10304
 v_mfma_f32_16x16x32_bf16 v[204:207], a[188:191], a[220:223], v[204:207]
 ds_read_b64_tr_b16 a[150:151], v245 offset:15424
 s_waitcnt lgkmcnt(8)
 v_mfma_f32_16x16x32_bf16 v[128:131], a[128:131], a[224:227], v[128:131]
 ds_read_b64_tr_b16 a[152:153], v246 offset:64
 s_waitcnt vmcnt(20)
 v_mfma_f32_16x16x32_bf16 v[128:131], a[132:135], a[232:235], v[128:131]
 ds_read_b64_tr_b16 a[154:155], v246 offset:5184
 v_mfma_f32_16x16x32_bf16 v[132:135], a[128:131], a[228:231], v[132:135]
 s_mul_i32 s55, s32, 81920
 s_add_u32 s55, s55, s28
 ds_read_b64_tr_b16 a[156:157], v246 offset:10304
 s_waitcnt vmcnt(19)
 v_mfma_f32_16x16x32_bf16 v[132:135], a[132:135], a[236:239], v[132:135]
 ds_read_b64_tr_b16 a[158:159], v246 offset:15424
 s_waitcnt lgkmcnt(8)
 v_mfma_f32_16x16x32_bf16 v[136:139], a[136:139], a[224:227], v[136:139]
 ds_read_b64_tr_b16 a[160:161], v245 offset:128
 v_mfma_f32_16x16x32_bf16 v[136:139], a[140:143], a[232:235], v[136:139]
 ds_read_b64_tr_b16 a[162:163], v245 offset:5248
 s_add_u32 m0, s38, 0
 v_mfma_f32_16x16x32_bf16 v[140:143], a[136:139], a[228:231], v[140:143]
 ds_read_b64_tr_b16 a[164:165], v245 offset:10368
 v_mfma_f32_16x16x32_bf16 v[140:143], a[140:143], a[236:239], v[140:143]
 ds_read_b64_tr_b16 a[166:167], v245 offset:15488
 s_waitcnt lgkmcnt(8)
 v_mfma_f32_16x16x32_bf16 v[144:147], a[144:147], a[224:227], v[144:147]
 ds_read_b64_tr_b16 a[168:169], v246 offset:128
 buffer_load_dwordx4 v247, s[8:11], s55 offen lds
 v_mfma_f32_16x16x32_bf16 v[144:147], a[148:151], a[232:235], v[144:147]
 ds_read_b64_tr_b16 a[170:171], v246 offset:5248
 v_mfma_f32_16x16x32_bf16 v[148:151], a[144:147], a[228:231], v[148:151]
 ds_read_b64_tr_b16 a[172:173], v246 offset:10368
 v_mfma_f32_16x16x32_bf16 v[148:151], a[148:151], a[236:239], v[148:151]
 ds_read_b64_tr_b16 a[174:175], v246 offset:15488
 s_waitcnt lgkmcnt(8)
 s_add_u32 m0, s38, 1024
 v_mfma_f32_16x16x32_bf16 v[152:155], a[152:155], a[224:227], v[152:155]
 ds_read_b64_tr_b16 a[176:177], v245 offset:192
 v_mfma_f32_16x16x32_bf16 v[152:155], a[156:159], a[232:235], v[152:155]
 ds_read_b64_tr_b16 a[178:179], v245 offset:5312
 v_mfma_f32_16x16x32_bf16 v[156:159], a[152:155], a[228:231], v[156:159]
 ds_read_b64_tr_b16 a[180:181], v245 offset:10432
 buffer_load_dwordx4 v248, s[8:11], s55 offen lds
 v_mfma_f32_16x16x32_bf16 v[156:159], a[156:159], a[236:239], v[156:159]
 ds_read_b64_tr_b16 a[182:183], v245 offset:15552
 s_waitcnt lgkmcnt(8)
 v_mfma_f32_16x16x32_bf16 v[160:163], a[160:163], a[224:227], v[160:163]
 ds_read_b64_tr_b16 a[184:185], v246 offset:192
 v_mfma_f32_16x16x32_bf16 v[160:163], a[164:167], a[232:235], v[160:163]
 ds_read_b64_tr_b16 a[186:187], v246 offset:5312
 s_add_u32 m0, s38, 2048
 v_mfma_f32_16x16x32_bf16 v[164:167], a[160:163], a[228:231], v[164:167]
 ds_read_b64_tr_b16 a[188:189], v246 offset:10432
 v_mfma_f32_16x16x32_bf16 v[164:167], a[164:167], a[236:239], v[164:167]
 ds_read_b64_tr_b16 a[190:191], v246 offset:15552
 s_waitcnt lgkmcnt(8)
 v_mfma_f32_16x16x32_bf16 v[168:171], a[168:171], a[224:227], v[168:171]
 ds_read_b64_tr_b16 a[128:129], v245 offset:256
 buffer_load_dwordx4 v249, s[8:11], s55 offen lds
 v_mfma_f32_16x16x32_bf16 v[168:171], a[172:175], a[232:235], v[168:171]
 ds_read_b64_tr_b16 a[130:131], v245 offset:5376
 v_mfma_f32_16x16x32_bf16 v[172:175], a[168:171], a[228:231], v[172:175]
 ds_read_b64_tr_b16 a[132:133], v245 offset:10496
 v_mfma_f32_16x16x32_bf16 v[172:175], a[172:175], a[236:239], v[172:175]
 ds_read_b64_tr_b16 a[134:135], v245 offset:15616
 s_waitcnt lgkmcnt(8)
 s_add_u32 m0, s38, 3072
 v_mfma_f32_16x16x32_bf16 v[176:179], a[176:179], a[224:227], v[176:179]
 ds_read_b64_tr_b16 a[136:137], v246 offset:256
 v_mfma_f32_16x16x32_bf16 v[176:179], a[180:183], a[232:235], v[176:179]
 ds_read_b64_tr_b16 a[138:139], v246 offset:5376
 v_mfma_f32_16x16x32_bf16 v[180:183], a[176:179], a[228:231], v[180:183]
 s_waitcnt vmcnt(14)
 s_barrier
 ds_read_b64_tr_b16 a[140:141], v246 offset:10496
 buffer_load_dwordx4 v250, s[8:11], s55 offen lds
 v_mfma_f32_16x16x32_bf16 v[180:183], a[180:183], a[236:239], v[180:183]
 ds_read_b64_tr_b16 a[142:143], v246 offset:15616
 s_waitcnt lgkmcnt(8)
 v_mfma_f32_16x16x32_bf16 v[184:187], a[184:187], a[224:227], v[184:187]
 ds_read_b64_tr_b16 a[144:145], v245 offset:20480
 v_mfma_f32_16x16x32_bf16 v[184:187], a[188:191], a[232:235], v[184:187]
 ds_read_b64_tr_b16 a[146:147], v245 offset:25600
 s_add_u32 m0, s38, 4096
 v_mfma_f32_16x16x32_bf16 v[188:191], a[184:187], a[228:231], v[188:191]
 ds_read_b64_tr_b16 a[148:149], v245 offset:30720
 v_mfma_f32_16x16x32_bf16 v[188:191], a[188:191], a[236:239], v[188:191]
 ds_read_b64_tr_b16 a[150:151], v245 offset:35840
 s_waitcnt lgkmcnt(8)
 v_mfma_f32_16x16x32_bf16 v[192:195], a[128:131], a[224:227], v[192:195]
 ds_read_b64_tr_b16 a[152:153], v246 offset:20480
 buffer_load_dwordx4 v251, s[8:11], s55 offen lds
 s_waitcnt vmcnt(5)
 v_cmp_eq_u32 vcc, s100, v240
 s_nop 1
 s_and_b32 s71, vcc_lo, 15
 s_cmp_eq_u32 s71, 15
 s_cbranch_scc0 L_slow_cx
L_back_cx:
 v_mfma_f32_16x16x32_bf16 v[192:195], a[132:135], a[232:235], v[192:195]
 s_add_u32 s53, s30, s33
 s_add_u32 s33, s33, 1024
 s_and_b32 s33, s33, 0x3fff
 ds_read_b64_tr_b16 a[154:155], v246 offset:25600
 v_mfma_f32_16x16x32_bf16 v[196:199], a[128:131], a[228:231], v[196:199]
 ds_read_b64_tr_b16 a[156:157], v246 offset:30720
 v_mfma_f32_16x16x32_bf16 v[196:199], a[132:135], a[236:239], v[196:199]
 s_add_u32 s32, s32, 1
 s_and_b32 s32, s32, 7
 ds_read_b64_tr_b16 a[158:159], v246 offset:35840
 s_waitcnt lgkmcnt(8)
 v_mfma_f32_16x16x32_bf16 v[200:203], a[136:139], a[224:227], v[200:203]
 ds_read_b64_tr_b16 a[160:161], v245 offset:20544
 buffer_load_dwordx4 a[208:211], v252, s[4:7], s53 offen sc1
 v_mfma_f32_16x16x32_bf16 v[200:203], a[140:143], a[232:235], v[200:203]
 ds_read_b64_tr_b16 a[162:163], v245 offset:25664
 buffer_load_dwordx4 a[212:215], v253, s[4:7], s53 offen sc1
 v_mfma_f32_16x16x32_bf16 v[204:207], a[136:139], a[228:231], v[204:207]
 ds_read_b64_tr_b16 a[164:165], v245 offset:30784
 v_mfma_f32_16x16x32_bf16 v[204:207], a[140:143], a[236:239], v[204:207]
 ds_read_b64_tr_b16 a[166:167], v245 offset:35904
 s_waitcnt lgkmcnt(8)
 v_mfma_f32_16x16x32_bf16 v[128:131], a[144:147], a[240:243], v[128:131]
 ds_read_b64_tr_b16 a[168:169], v246 offset:20544
 v_mfma_f32_16x16x32_bf16 v[128:131], a[148:151], a[248:251], v[128:131]
 s_add_u32 s53, s30, s33
 s_add_u32 s33, s33, 1024
 s_and_b32 s33, s33, 0x3fff
 ds_read_b64_tr_b16 a[170:171], v246 offset:25664
 v_mfma_f32_16x16x32_bf16 v[132:135], a[144:147], a[244:247], v[132:135]
 s_mul_i32 s55, s32, 81920
 s_add_u32 s55, s55, s28
 ds_read_b64_tr_b16 a[172:173], v246 offset:30784
 v_mfma_f32_16x16x32_bf16 v[132:135], a[148:151], a[252:255], v[132:135]
 ds_read_b64_tr_b16 a[174:175], v246 offset:35904
 s_waitcnt lgkmcnt(8)
 buffer_load_dwordx4 a[216:219], v252, s[4:7], s53 offen sc1
 v_mfma_f32_16x16x32_bf16 v[136:139], a[152:155], a[240:243], v[136:139]
 ds_read_b64_tr_b16 a[176:177], v245 offset:20608
 v_mfma_f32_16x16x32_bf16 v[136:139], a[156:159], a[248:251], v[136:139]
 ds_read_b64_tr_b16 a[178:179], v245 offset:25728
 s_add_u32 m0, s38, 20480
 buffer_load_dwordx4 a[220:223], v253, s[4:7], s53 offen sc1
 v_mfma_f32_16x16x32_bf16 v[140:143], a[152:155], a[244:247], v[140:143]
 ds_read_b64_tr_b16 a[180:181], v245 offset:30848
 v_mfma_f32_16x16x32_bf16 v[140:143], a[156:159], a[252:255], v[140:143]
 ds_read_b64_tr_b16 a[182:183], v245 offset:35968
 s_waitcnt lgkmcnt(8)
 v_mfma_f32_16x16x32_bf16 v[144:147], a[160:163], a[240:243], v[144:147]
 ds_read_b64_tr_b16 a[184:185], v246 offset:20608
 buffer_load_dwordx4 v247, s[8:11], s55 offen lds
 v_mfma_f32_16x16x32_bf16 v[144:147], a[164:167], a[248:251], v[144:147]
 s_add_u32 s53, s30, s33
 s_add_u32 s33, s33, 1024
 s_and_b32 s33, s33, 0x3fff
 ds_read_b64_tr_b16 a[186:187], v246 offset:25728
 v_mfma_f32_16x16x32_bf16 v[148:151], a[160:163], a[244:247], v[148:151]
 ds_read_b64_tr_b16 a[188:189], v246 offset:30848
 v_mfma_f32_16x16x32_bf16 v[148:151], a[164:167], a[252:255], v[148:151]
 ds_read_b64_tr_b16 a[190:191], v246 offset:35968
 s_waitcnt lgkmcnt(8)
 s_add_u32 m0, s38, 21504
 buffer_load_dwordx4 a[224:227], v252, s[4:7], s53 offen sc1
 v_mfma_f32_16x16x32_bf16 v[152:155], a[168:171], a[240:243], v[152:155]
 ds_read_b64_tr_b16 a[128:129], v245 offset:20672
 v_mfma_f32_16x16x32_bf16 v[152:155], a[172:175], a[248:251], v[152:155]
 ds_read_b64_tr_b16 a[130:131], v245 offset:25792
 buffer_load_dwordx4 a[228:231], v253, s[4:7], s53 offen sc1
 v_mfma_f32_16x16x32_bf16 v[156:159], a[168:171], a[244:247], v[156:159]
 ds_read_b64_tr_b16 a[132:133], v245 offset:30912
 buffer_load_dwordx4 v248, s[8:11], s55 offen lds
 v_mfma_f32_16x16x32_bf16 v[156:159], a[172:175], a[252:255], v[156:159]
 ds_read_b64_tr_b16 a[134:135], v245 offset:36032
 s_waitcnt lgkmcnt(8)
 v_mfma_f32_16x16x32_bf16 v[160:163], a[176:179], a[240:243], v[160:163]
 ds_read_b64_tr_b16 a[136:137], v246 offset:20672
 v_mfma_f32_16x16x32_bf16 v[160:163], a[180:183], a[248:251], v[160:163]
 ds_read_b64_tr_b16 a[138:139], v246 offset:25792
 s_add_u32 m0, s38, 22528
 v_mfma_f32_16x16x32_bf16 v[164:167], a[176:179], a[244:247], v[164:167]
 ds_read_b64_tr_b16 a[140:141], v246 offset:30912
 v_mfma_f32_16x16x32_bf16 v[164:167], a[180:183], a[252:255], v[164:167]
 ds_read_b64_tr_b16 a[142:143], v246 offset:36032
 s_waitcnt lgkmcnt(8)
 v_mfma_f32_16x16x32_bf16 v[168:171], a[184:187], a[240:243], v[168:171]
 ds_read_b64_tr_b16 a[144:145], v245 offset:20736
 buffer_load_dwordx4 v249, s[8:11], s55 offen lds
 v_mfma_f32_16x16x32_bf16 v[168:171], a[188:191], a[248:251], v[168:171]
 ds_read_b64_tr_b16 a[146:147], v245 offset:25856
 v_mfma_f32_16x16x32_bf16 v[172:175], a[184:187], a[244:247], v[172:175]
 ds_read_b64_tr_b16 a[148:149], v245 offset:30976
 v_mfma_f32_16x16x32_bf16 v[172:175], a[188:191], a[252:255], v[172:175]
 ds_read_b64_tr_b16 a[150:151], v245 offset:36096
 s_waitcnt lgkmcnt(8)
 s_add_u32 m0, s38, 23552
 v_mfma_f32_16x16x32_bf16 v[176:179], a[128:131], a[240:243], v[176:179]
 s_add_u32 s53, s30, s33
 s_add_u32 s33, s33, 1024
 s_and_b32 s33, s33, 0x3fff
 ds_read_b64_tr_b16 a[152:153], v246 offset:20736
 v_mfma_f32_16x16x32_bf16 v[176:179], a[132:135], a[248:251], v[176:179]
 ds_read_b64_tr_b16 a[154:155], v246 offset:25856
 v_mfma_f32_16x16x32_bf16 v[180:183], a[128:131], a[244:247], v[180:183]
 s_barrier
 ds_read_b64_tr_b16 a[156:157], v246 offset:30976
 buffer_load_dwordx4 v250, s[8:11], s55 offen lds
 v_mfma_f32_16x16x32_bf16 v[180:183], a[132:135], a[252:255], v[180:183]
 ds_read_b64_tr_b16 a[158:159], v246 offset:36096
 s_waitcnt lgkmcnt(8)
 v_mfma_f32_16x16x32_bf16 v[184:187], a[136:139], a[240:243], v[184:187]
 ds_read_b64_tr_b16 a[160:161], v245 offset:40960
 buffer_load_dwordx4 a[232:235], v252, s[4:7], s53 offen sc1
 v_mfma_f32_16x16x32_bf16 v[184:187], a[140:143], a[248:251], v[184:187]
 ds_read_b64_tr_b16 a[162:163], v245 offset:46080
 s_add_u32 m0, s38, 24576
 v_mfma_f32_16x16x32_bf16 v[188:191], a[136:139], a[244:247], v[188:191]
 ds_read_b64_tr_b16 a[164:165], v245 offset:51200
 v_mfma_f32_16x16x32_bf16 v[188:191], a[140:143], a[252:255], v[188:191]
 ds_read_b64_tr_b16 a[166:167], v245 offset:56320
 s_waitcnt lgkmcnt(8)
 v_mfma_f32_16x16x32_bf16 v[192:195], a[144:147], a[240:243], v[192:195]
 ds_read_b64_tr_b16 a[168:169], v246 offset:40960
 buffer_load_dwordx4 v251, s[8:11], s55 offen lds
 v_mfma_f32_16x16x32_bf16 v[192:195], a[148:151], a[248:251], v[192:195]
 ds_read_b64_tr_b16 a[170:171], v246 offset:46080
 buffer_load_dwordx4 a[236:239], v253, s[4:7], s53 offen sc1
 v_mfma_f32_16x16x32_bf16 v[196:199], a[144:147], a[244:247], v[196:199]
 ds_read_b64_tr_b16 a[172:173], v246 offset:51200
 v_mfma_f32_16x16x32_bf16 v[196:199], a[148:151], a[252:255], v[196:199]
 s_add_u32 s32, s32, 1
 s_and_b32 s32, s32, 7
 ds_read_b64_tr_b16 a[174:175], v246 offset:56320
 s_waitcnt lgkmcnt(8)
 v_mfma_f32_16x16x32_bf16 v[200:203], a[152:155], a[240:243], v[200:203]
 ds_read_b64_tr_b16 a[176:177], v245 offset:41024
 v_mfma_f32_16x16x32_bf16 v[200:203], a[156:159], a[248:251], v[200:203]
 ds_read_b64_tr_b16 a[178:179], v245 offset:46144
 v_mfma_f32_16x16x32_bf16 v[204:207], a[152:155], a[244:247], v[204:207]
 ds_read_b64_tr_b16 a[180:181], v245 offset:51264
 v_mfma_f32_16x16x32_bf16 v[204:207], a[156:159], a[252:255], v[204:207]
 ds_read_b64_tr_b16 a[182:183], v245 offset:56384
 s_waitcnt lgkmcnt(8)
 v_mfma_f32_16x16x32_bf16 v[128:131], a[160:163], a[192:195], v[128:131]
 ds_read_b64_tr_b16 a[184:185], v246 offset:41024
 v_mfma_f32_16x16x32_bf16 v[128:131], a[164:167], a[200:203], v[128:131]
 ds_read_b64_tr_b16 a[186:187], v246 offset:46144
 v_mfma_f32_16x16x32_bf16 v[132:135], a[160:163], a[196:199], v[132:135]
 s_mul_i32 s55, s32, 81920
 s_add_u32 s55, s55, s28
 ds_read_b64_tr_b16 a[188:189], v246 offset:51264
 v_mfma_f32_16x16x32_bf16 v[132:135], a[164:167], a[204:207], v[132:135]
 ds_read_b64_tr_b16 a[190:191], v246 offset:56384
 s_waitcnt lgkmcnt(8)
 v_mfma_f32_16x16x32_bf16 v[136:139], a[168:171], a[192:195], v[136:139]
 s_add_u32 s53, s30, s33
 s_add_u32 s33, s33, 1024
 s_and_b32 s33, s33, 0x3fff
 ds_read_b64_tr_b16 a[128:129], v245 offset:41088
 v_mfma_f32_16x16x32_bf16 v[136:139], a[172:175], a[200:203], v[136:139]
 ds_read_b64_tr_b16 a[130:131], v245 offset:46208
 s_add_u32 m0, s38, 40960
 v_mfma_f32_16x16x32_bf16 v[140:143], a[168:171], a[196:199], v[140:143]
 ds_read_b64_tr_b16 a[132:133], v245 offset:51328
 v_mfma_f32_16x16x32_bf16 v[140:143], a[172:175], a[204:207], v[140:143]
 ds_read_b64_tr_b16 a[134:135], v245 offset:56448
 s_waitcnt lgkmcnt(8)
 v_mfma_f32_16x16x32_bf16 v[144:147], a[176:179], a[192:195], v[144:147]
 ds_read_b64_tr_b16 a[136:137], v246 offset:41088
 buffer_load_dwordx4 v247, s[8:11], s55 offen lds
 buffer_load_dwordx4 a[240:243], v252, s[4:7], s53 offen sc1
 v_mfma_f32_16x16x32_bf16 v[144:147], a[180:183], a[200:203], v[144:147]
 ds_read_b64_tr_b16 a[138:139], v246 offset:46208
 v_mfma_f32_16x16x32_bf16 v[148:151], a[176:179], a[196:199], v[148:151]
 ds_read_b64_tr_b16 a[140:141], v246 offset:51328
 v_mfma_f32_16x16x32_bf16 v[148:151], a[180:183], a[204:207], v[148:151]
 ds_read_b64_tr_b16 a[142:143], v246 offset:56448
 s_waitcnt lgkmcnt(8)
 s_add_u32 m0, s38, 41984
 v_mfma_f32_16x16x32_bf16 v[152:155], a[184:187], a[192:195], v[152:155]
 ds_read_b64_tr_b16 a[144:145], v245 offset:41152
 v_mfma_f32_16x16x32_bf16 v[152:155], a[188:191], a[200:203], v[152:155]
 ds_read_b64_tr_b16 a[146:147], v245 offset:46272
 buffer_load_dwordx4 a[244:247], v253, s[4:7], s53 offen sc1
 v_mfma_f32_16x16x32_bf16 v[156:159], a[184:187], a[196:199], v[156:159]
 ds_read_b64_tr_b16 a[148:149], v245 offset:51392
 buffer_load_dwordx4 v248, s[8:11], s55 offen lds
 v_mfma_f32_16x16x32_bf16 v[156:159], a[188:191], a[204:207], v[156:159]
 ds_read_b64_tr_b16 a[150:151], v245 offset:56512
 s_waitcnt lgkmcnt(8)
 v_mfma_f32_16x16x32_bf16 v[160:163], a[128:131], a[192:195], v[160:163]
 ds_read_b64_tr_b16 a[152:153], v246 offset:41152
 v_mfma_f32_16x16x32_bf16 v[160:163], a[132:135], a[200:203], v[160:163]
 ds_read_b64_tr_b16 a[154:155], v246 offset:46272
 s_add_u32 m0, s38, 43008
 v_mfma_f32_16x16x32_bf16 v[164:167], a[128:131], a[196:199], v[164:167]
 ds_read_b64_tr_b16 a[156:157], v246 offset:51392
 v_mfma_f32_16x16x32_bf16 v[164:167], a[132:135], a[204:207], v[164:167]
 ds_read_b64_tr_b16 a[158:159], v246 offset:56512
 s_waitcnt lgkmcnt(8)
 v_mfma_f32_16x16x32_bf16 v[168:171], a[136:139], a[192:195], v[168:171]
 ds_read_b64_tr_b16 a[160:161], v245 offset:41216
 buffer_load_dwordx4 v249, s[8:11], s55 offen lds
 v_mfma_f32_16x16x32_bf16 v[168:171], a[140:143], a[200:203], v[168:171]
 ds_read_b64_tr_b16 a[162:163], v245 offset:46336
 v_mfma_f32_16x16x32_bf16 v[172:175], a[136:139], a[196:199], v[172:175]
 ds_read_b64_tr_b16 a[164:165], v245 offset:51456
 v_mfma_f32_16x16x32_bf16 v[172:175], a[140:143], a[204:207], v[172:175]
 ds_read_b64_tr_b16 a[166:167], v245 offset:56576
 s_waitcnt lgkmcnt(8)
 s_add_u32 m0, s38, 44032
 v_mfma_f32_16x16x32_bf16 v[176:179], a[144:147], a[192:195], v[176:179]
 s_add_u32 s53, s30, s33
 s_add_u32 s33, s33, 1024
 s_and_b32 s33, s33, 0x3fff
 ds_read_b64_tr_b16 a[168:169], v246 offset:41216
 v_mfma_f32_16x16x32_bf16 v[176:179], a[148:151], a[200:203], v[176:179]
 ds_read_b64_tr_b16 a[170:171], v246 offset:46336
 v_mfma_f32_16x16x32_bf16 v[180:183], a[144:147], a[196:199], v[180:183]
 s_waitcnt vmcnt(18)
 s_barrier
 ds_read_b64_tr_b16 a[172:173], v246 offset:51456
 buffer_load_dwordx4 v250, s[8:11], s55 offen lds
 v_mfma_f32_16x16x32_bf16 v[180:183], a[148:151], a[204:207], v[180:183]
 ds_read_b64_tr_b16 a[174:175], v246 offset:56576
 s_waitcnt lgkmcnt(8)
 v_mfma_f32_16x16x32_bf16 v[184:187], a[152:155], a[192:195], v[184:187]
 v_xor_b32 v245, 0x10000, v245
 ds_read_b64_tr_b16 a[176:177], v245
 buffer_load_dwordx4 a[248:251], v252, s[4:7], s53 offen sc1
 v_mfma_f32_16x16x32_bf16 v[184:187], a[156:159], a[200:203], v[184:187]
 ds_read_b64_tr_b16 a[178:179], v245 offset:5120
 s_add_u32 m0, s38, 45056
 v_mfma_f32_16x16x32_bf16 v[188:191], a[152:155], a[196:199], v[188:191]
 ds_read_b64_tr_b16 a[180:181], v245 offset:10240
 v_mfma_f32_16x16x32_bf16 v[188:191], a[156:159], a[204:207], v[188:191]
 ds_read_b64_tr_b16 a[182:183], v245 offset:15360
 s_waitcnt lgkmcnt(8)
 v_mfma_f32_16x16x32_bf16 v[192:195], a[160:163], a[192:195], v[192:195]
 v_xor_b32 v246, 0x10000, v246
 ds_read_b64_tr_b16 a[184:185], v246
 buffer_load_dwordx4 v251, s[8:11], s55 offen lds
 v_mfma_f32_16x16x32_bf16 v[192:195], a[164:167], a[200:203], v[192:195]
 ds_read_b64_tr_b16 a[186:187], v246 offset:5120
 buffer_load_dwordx4 a[252:255], v253, s[4:7], s53 offen sc1
 v_mfma_f32_16x16x32_bf16 v[196:199], a[160:163], a[196:199], v[196:199]
 ds_read_b64_tr_b16 a[188:189], v246 offset:10240
 v_mfma_f32_16x16x32_bf16 v[196:199], a[164:167], a[204:207], v[196:199]
 s_add_u32 s32, s32, 1
 s_and_b32 s32, s32, 7
 ds_read_b64_tr_b16 a[190:191], v246 offset:15360
 s_waitcnt lgkmcnt(8)
 v_mfma_f32_16x16x32_bf16 v[200:203], a[168:171], a[192:195], v[200:203]
 ds_read_b64_tr_b16 a[128:129], v245 offset:64
 v_mfma_f32_16x16x32_bf16 v[200:203], a[172:175], a[200:203], v[200:203]
 ds_read_b64_tr_b16 a[130:131], v245 offset:5184
 v_mfma_f32_16x16x32_bf16 v[204:207], a[168:171], a[196:199], v[204:207]
 ds_read_b64_tr_b16 a[132:133], v245 offset:10304
 v_mfma_f32_16x16x32_bf16 v[204:207], a[172:175], a[204:207], v[204:207]
 ds_read_b64_tr_b16 a[134:135], v245 offset:15424
 s_waitcnt lgkmcnt(8)
 s_waitcnt vmcnt(21)
 v_mfma_f32_16x16x32_bf16 v[128:131], a[176:179], a[208:211], v[128:131]
 ds_read_b64_tr_b16 a[136:137], v246 offset:64
 s_waitcnt vmcnt(19)
 v_mfma_f32_16x16x32_bf16 v[128:131], a[180:183], a[216:219], v[128:131]
 ds_read_b64_tr_b16 a[138:139], v246 offset:5184
 v_mfma_f32_16x16x32_bf16 v[132:135], a[176:179], a[212:215], v[132:135]
 s_mul_i32 s55, s32, 81920
 s_add_u32 s55, s55, s28
 ds_read_b64_tr_b16 a[140:141], v246 offset:10304
 s_waitcnt vmcnt(18)
 v_mfma_f32_16x16x32_bf16 v[132:135], a[180:183], a[220:223], v[132:135]
 ds_read_b64_tr_b16 a[142:143], v246 offset:15424
 s_waitcnt lgkmcnt(8)
 v_mfma_f32_16x16x32_bf16 v[136:139], a[184:187], a[208:211], v[136:139]
 s_add_u32 s53, s30, s33
 s_add_u32 s33, s33, 1024
 s_and_b32 s33, s33, 0x3fff
 ds_read_b64_tr_b16 a[144:145], v245 offset:128
 v_mfma_f32_16x16x32_bf16 v[136:139], a[188:191], a[216:219], v[136:139]
 ds_read_b64_tr_b16 a[146:147], v245 offset:5248
 s_add_u32 m0, s38, 65536
 v_mfma_f32_16x16x32_bf16 v[140:143], a[184:187], a[212:215], v[140:143]
 ds_read_b64_tr_b16 a[148:149], v245 offset:10368
 v_mfma_f32_16x16x32_bf16 v[140:143], a[188:191], a[220:223], v[140:143]
 ds_read_b64_tr_b16 a[150:151], v245 offset:15488
 s_waitcnt lgkmcnt(8)
 v_mfma_f32_16x16x32_bf16 v[144:147], a[128:131], a[208:211], v[144:147]
 ds_read_b64_tr_b16 a[152:153], v246 offset:128
 buffer_load_dwordx4 v247, s[8:11], s55 offen lds
 buffer_load_dwordx4 a[192:195], v252, s[4:7], s53 offen sc1
 v_mfma_f32_16x16x32_bf16 v[144:147], a[132:135], a[216:219], v[144:147]
 ds_read_b64_tr_b16 a[154:155], v246 offset:5248
 v_mfma_f32_16x16x32_bf16 v[148:151], a[128:131], a[212:215], v[148:151]
 ds_read_b64_tr_b16 a[156:157], v246 offset:10368
 v_mfma_f32_16x16x32_bf16 v[148:151], a[132:135], a[220:223], v[148:151]
 ds_read_b64_tr_b16 a[158:159], v246 offset:15488
 s_waitcnt lgkmcnt(8)
 s_add_u32 m0, s38, 66560
 v_mfma_f32_16x16x32_bf16 v[152:155], a[136:139], a[208:211], v[152:155]
 ds_read_b64_tr_b16 a[160:161], v245 offset:192
 v_mfma_f32_16x16x32_bf16 v[152:155], a[140:143], a[216:219], v[152:155]
 ds_read_b64_tr_b16 a[162:163], v245 offset:5312
 buffer_load_dwordx4 a[196:199], v253, s[4:7], s53 offen sc1
 v_mfma_f32_16x16x32_bf16 v[156:159], a[136:139], a[212:215], v[156:159]
 ds_read_b64_tr_b16 a[164:165], v245 offset:10432
 buffer_load_dwordx4 v248, s[8:11], s55 offen lds
 v_mfma_f32_16x16x32_bf16 v[156:159], a[140:143], a[220:223], v[156:159]
 ds_read_b64_tr_b16 a[166:167], v245 offset:15552
 s_waitcnt lgkmcnt(8)
 v_mfma_f32_16x16x32_bf16 v[160:163], a[144:147], a[208:211], v[160:163]
 ds_read_b64_tr_b16 a[168:169], v246 offset:192
 v_mfma_f32_16x16x32_bf16 v[160:163], a[148:151], a[216:219], v[160:163]
 ds_read_b64_tr_b16 a[170:171], v246 offset:5312
 s_add_u32 m0, s38, 67584
 v_mfma_f32_16x16x32_bf16 v[164:167], a[144:147], a[212:215], v[164:167]
 ds_read_b64_tr_b16 a[172:173], v246 offset:10432
 v_mfma_f32_16x16x32_bf16 v[164:167], a[148:151], a[220:223], v[164:167]
 ds_read_b64_tr_b16 a[174:175], v246 offset:15552
 s_waitcnt lgkmcnt(8)
 v_mfma_f32_16x16x32_bf16 v[168:171], a[152:155], a[208:211], v[168:171]
 ds_read_b64_tr_b16 a[176:177], v245 offset:256
 buffer_load_dwordx4 v249, s[8:11], s55 offen lds
 v_mfma_f32_16x16x32_bf16 v[168:171], a[156:159], a[216:219], v[168:171]
 ds_read_b64_tr_b16 a[178:179], v245 offset:5376
 v_mfma_f32_16x16x32_bf16 v[172:175], a[152:155], a[212:215], v[172:175]
 ds_read_b64_tr_b16 a[180:181], v245 offset:10496
 v_mfma_f32_16x16x32_bf16 v[172:175], a[156:159], a[220:223], v[172:175]
 ds_read_b64_tr_b16 a[182:183], v245 offset:15616
 s_waitcnt lgkmcnt(8)
 s_add_u32 m0, s38, 68608
 v_mfma_f32_16x16x32_bf16 v[176:179], a[160:163], a[208:211], v[176:179]
 s_add_u32 s53, s30, s33
 s_add_u32 s33, s33, 1024
 s_and_b32 s33, s33, 0x3fff
 ds_read_b64_tr_b16 a[184:185], v246 offset:256
 v_mfma_f32_16x16x32_bf16 v[176:179], a[164:167], a[216:219], v[176:179]
 ds_read_b64_tr_b16 a[186:187], v246 offset:5376
 v_mfma_f32_16x16x32_bf16 v[180:183], a[160:163], a[212:215], v[180:183]
 s_waitcnt vmcnt(15)
 s_barrier
 ds_read_b64_tr_b16 a[188:189], v246 offset:10496
 buffer_load_dwordx4 v250, s[8:11], s55 offen lds
 v_mfma_f32_16x16x32_bf16 v[180:183], a[164:167], a[220:223], v[180:183]
 ds_read_b64_tr_b16 a[190:191], v246 offset:15616
 s_waitcnt lgkmcnt(8)
 v_mfma_f32_16x16x32_bf16 v[184:187], a[168:171], a[208:211], v[184:187]
 ds_read_b64_tr_b16 a[128:129], v245 offset:20480
 buffer_load_dwordx4 a[200:203], v252, s[4:7], s53 offen sc1
 v_mfma_f32_16x16x32_bf16 v[184:187], a[172:175], a[216:219], v[184:187]
 ds_read_b64_tr_b16 a[130:131], v245 offset:25600
 s_add_u32 m0, s38, 69632
 v_mfma_f32_16x16x32_bf16 v[188:191], a[168:171], a[212:215], v[188:191]
 ds_read_b64_tr_b16 a[132:133], v245 offset:30720
 v_mfma_f32_16x16x32_bf16 v[188:191], a[172:175], a[220:223], v[188:191]
 ds_read_b64_tr_b16 a[134:135], v245 offset:35840
 s_waitcnt lgkmcnt(8)
 v_mfma_f32_16x16x32_bf16 v[192:195], a[176:179], a[208:211], v[192:195]
 ds_read_b64_tr_b16 a[136:137], v246 offset:20480
 buffer_load_dwordx4 v251, s[8:11], s55 offen lds
 v_mfma_f32_16x16x32_bf16 v[192:195], a[180:183], a[216:219], v[192:195]
 ds_read_b64_tr_b16 a[138:139], v246 offset:25600
 buffer_load_dwordx4 a[204:207], v253, s[4:7], s53 offen sc1
 v_mfma_f32_16x16x32_bf16 v[196:199], a[176:179], a[212:215], v[196:199]
 ds_read_b64_tr_b16 a[140:141], v246 offset:30720
 v_mfma_f32_16x16x32_bf16 v[196:199], a[180:183], a[220:223], v[196:199]
 s_add_u32 s32, s32, 1
 s_and_b32 s32, s32, 7
 ds_read_b64_tr_b16 a[142:143], v246 offset:35840
 s_waitcnt lgkmcnt(8)
 v_mfma_f32_16x16x32_bf16 v[200:203], a[184:187], a[208:211], v[200:203]
 ds_read_b64_tr_b16 a[144:145], v245 offset:20544
 v_mfma_f32_16x16x32_bf16 v[200:203], a[188:191], a[216:219], v[200:203]
 ds_read_b64_tr_b16 a[146:147], v245 offset:25664
 v_mfma_f32_16x16x32_bf16 v[204:207], a[184:187], a[212:215], v[204:207]
 ds_read_b64_tr_b16 a[148:149], v245 offset:30784
 v_mfma_f32_16x16x32_bf16 v[204:207], a[188:191], a[220:223], v[204:207]
 ds_read_b64_tr_b16 a[150:151], v245 offset:35904
 s_waitcnt lgkmcnt(8)
 v_mfma_f32_16x16x32_bf16 v[128:131], a[128:131], a[224:227], v[128:131]
 ds_read_b64_tr_b16 a[152:153], v246 offset:20544
 v_mfma_f32_16x16x32_bf16 v[128:131], a[132:135], a[232:235], v[128:131]
 ds_read_b64_tr_b16 a[154:155], v246 offset:25664
 v_mfma_f32_16x16x32_bf16 v[132:135], a[128:131], a[228:231], v[132:135]
 s_mul_i32 s55, s32, 81920
 s_add_u32 s55, s55, s28
 ds_read_b64_tr_b16 a[156:157], v246 offset:30784
 s_waitcnt vmcnt(18)
 v_mfma_f32_16x16x32_bf16 v[132:135], a[132:135], a[236:239], v[132:135]
 ds_read_b64_tr_b16 a[158:159], v246 offset:35904
 s_waitcnt lgkmcnt(8)
 v_mfma_f32_16x16x32_bf16 v[136:139], a[136:139], a[224:227], v[136:139]
 s_add_u32 s53, s30, s33
 s_add_u32 s33, s33, 1024
 s_and_b32 s33, s33, 0x3fff
 ds_read_b64_tr_b16 a[160:161], v245 offset:20608
 v_mfma_f32_16x16x32_bf16 v[136:139], a[140:143], a[232:235], v[136:139]
 ds_read_b64_tr_b16 a[162:163], v245 offset:25728
 s_add_u32 m0, s38, 86016
 v_mfma_f32_16x16x32_bf16 v[140:143], a[136:139], a[228:231], v[140:143]
 ds_read_b64_tr_b16 a[164:165], v245 offset:30848
 v_mfma_f32_16x16x32_bf16 v[140:143], a[140:143], a[236:239], v[140:143]
 ds_read_b64_tr_b16 a[166:167], v245 offset:35968
 s_waitcnt lgkmcnt(8)
 v_mfma_f32_16x16x32_bf16 v[144:147], a[144:147], a[224:227], v[144:147]
 ds_read_b64_tr_b16 a[168:169], v246 offset:20608
 buffer_load_dwordx4 v247, s[8:11], s55 offen lds
 buffer_load_dwordx4 a[208:211], v252, s[4:7], s53 offen sc1
 v_mfma_f32_16x16x32_bf16 v[144:147], a[148:151], a[232:235], v[144:147]
 ds_read_b64_tr_b16 a[170:171], v246 offset:25728
 v_mfma_f32_16x16x32_bf16 v[148:151], a[144:147], a[228:231], v[148:151]
 ds_read_b64_tr_b16 a[172:173], v246 offset:30848
 v_mfma_f32_16x16x32_bf16 v[148:151], a[148:151], a[236:239], v[148:151]
 ds_read_b64_tr_b16 a[174:175], v246 offset:35968
 s_waitcnt lgkmcnt(8)
 s_add_u32 m0, s38, 87040
 v_mfma_f32_16x16x32_bf16 v[152:155], a[152:155], a[224:227], v[152:155]
 ds_read_b64_tr_b16 a[176:177], v245 offset:20672
 v_mfma_f32_16x16x32_bf16 v[152:155], a[156:159], a[232:235], v[152:155]
 ds_read_b64_tr_b16 a[178:179], v245 offset:25792
 buffer_load_dwordx4 a[212:215], v253, s[4:7], s53 offen sc1
 v_mfma_f32_16x16x32_bf16 v[156:159], a[152:155], a[228:231], v[156:159]
 ds_read_b64_tr_b16 a[180:181], v245 offset:30912
 buffer_load_dwordx4 v248, s[8:11], s55 offen lds
 v_mfma_f32_16x16x32_bf16 v[156:159], a[156:159], a[236:239], v[156:159]
 ds_read_b64_tr_b16 a[182:183], v245 offset:36032
 s_waitcnt lgkmcnt(8)
 v_mfma_f32_16x16x32_bf16 v[160:163], a[160:163], a[224:227], v[160:163]
 ds_read_b64_tr_b16 a[184:185], v246 offset:20672
 v_mfma_f32_16x16x32_bf16 v[160:163], a[164:167], a[232:235], v[160:163]
 ds_read_b64_tr_b16 a[186:187], v246 offset:25792
 s_add_u32 m0, s38, 88064
 v_mfma_f32_16x16x32_bf16 v[164:167], a[160:163], a[228:231], v[164:167]
 ds_read_b64_tr_b16 a[188:189], v246 offset:30912
 v_mfma_f32_16x16x32_bf16 v[164:167], a[164:167], a[236:239], v[164:167]
 ds_read_b64_tr_b16 a[190:191], v246 offset:36032
 s_waitcnt lgkmcnt(8)
 v_mfma_f32_16x16x32_bf16 v[168:171], a[168:171], a[224:227], v[168:171]
 ds_read_b64_tr_b16 a[128:129], v245 offset:20736
 buffer_load_dwordx4 v249, s[8:11], s55 offen lds
 v_mfma_f32_16x16x32_bf16 v[168:171], a[172:175], a[232:235], v[168:171]
 ds_read_b64_tr_b16 a[130:131], v245 offset:25856
 v_mfma_f32_16x16x32_bf16 v[172:175], a[168:171], a[228:231], v[172:175]
 ds_read_b64_tr_b16 a[132:133], v245 offset:30976
 v_mfma_f32_16x16x32_bf16 v[172:175], a[172:175], a[236:239], v[172:175]
 ds_read_b64_tr_b16 a[134:135], v245 offset:36096
 s_waitcnt lgkmcnt(8)
 s_add_u32 m0, s38, 89088
 v_mfma_f32_16x16x32_bf16 v[176:179], a[176:179], a[224:227], v[176:179]
 s_add_u32 s53, s30, s33
 s_add_u32 s33, s33, 1024
 s_and_b32 s33, s33, 0x3fff
 ds_read_b64_tr_b16 a[136:137], v246 offset:20736
 v_mfma_f32_16x16x32_bf16 v[176:179], a[180:183], a[232:235], v[176:179]
 ds_read_b64_tr_b16 a[138:139], v246 offset:25856
 v_mfma_f32_16x16x32_bf16 v[180:183], a[176:179], a[228:231], v[180:183]
 s_waitcnt vmcnt(15)
 s_barrier
 ds_read_b64_tr_b16 a[140:141], v246 offset:30976
 buffer_load_dwordx4 v250, s[8:11], s55 offen lds
 v_mfma_f32_16x16x32_bf16 v[180:183], a[180:183], a[236:239], v[180:183]
 ds_read_b64_tr_b16 a[142:143], v246 offset:36096
 s_waitcnt lgkmcnt(8)
 v_mfma_f32_16x16x32_bf16 v[184:187], a[184:187], a[224:227], v[184:187]
 ds_read_b64_tr_b16 a[144:145], v245 offset:40960
 buffer_load_dwordx4 a[216:219], v252, s[4:7], s53 offen sc1
 v_mfma_f32_16x16x32_bf16 v[184:187], a[188:191], a[232:235], v[184:187]
 ds_read_b64_tr_b16 a[146:147], v245 offset:46080
 s_add_u32 m0, s38, 90112
 v_mfma_f32_16x16x32_bf16 v[188:191], a[184:187], a[228:231], v[188:191]
 ds_read_b64_tr_b16 a[148:149], v245 offset:51200
 v_mfma_f32_16x16x32_bf16 v[188:191], a[188:191], a[236:239], v[188:191]
 ds_read_b64_tr_b16 a[150:151], v245 offset:56320
 s_waitcnt lgkmcnt(8)
 v_mfma_f32_16x16x32_bf16 v[192:195], a[128:131], a[224:227], v[192:195]
 ds_read_b64_tr_b16 a[152:153], v246 offset:40960
 buffer_load_dwordx4 v251, s[8:11], s55 offen lds
 v_mfma_f32_16x16x32_bf16 v[192:195], a[132:135], a[232:235], v[192:195]
 ds_read_b64_tr_b16 a[154:155], v246 offset:46080
 buffer_load_dwordx4 a[220:223], v253, s[4:7], s53 offen sc1
 v_mfma_f32_16x16x32_bf16 v[196:199], a[128:131], a[228:231], v[196:199]
 ds_read_b64_tr_b16 a[156:157], v246 offset:51200
 v_mfma_f32_16x16x32_bf16 v[196:199], a[132:135], a[236:239], v[196:199]
 s_add_u32 s32, s32, 1
 s_and_b32 s32, s32, 7
 ds_read_b64_tr_b16 a[158:159], v246 offset:56320
 s_waitcnt lgkmcnt(8)
 v_mfma_f32_16x16x32_bf16 v[200:203], a[136:139], a[224:227], v[200:203]
 ds_read_b64_tr_b16 a[160:161], v245 offset:41024
 v_mfma_f32_16x16x32_bf16 v[200:203], a[140:143], a[232:235], v[200:203]
 ds_read_b64_tr_b16 a[162:163], v245 offset:46144
 v_mfma_f32_16x16x32_bf16 v[204:207], a[136:139], a[228:231], v[204:207]
 ds_read_b64_tr_b16 a[164:165], v245 offset:51264
 v_mfma_f32_16x16x32_bf16 v[204:207], a[140:143], a[236:239], v[204:207]
 ds_read_b64_tr_b16 a[166:167], v245 offset:56384
 s_waitcnt lgkmcnt(8)
 v_mfma_f32_16x16x32_bf16 v[128:131], a[144:147], a[240:243], v[128:131]
 s_xor_b32 s36, s36, 16
 buffer_load_dword v240, v254, s[4:7], s36 offen sc1
 ds_read_b64_tr_b16 a[168:169], v246 offset:41024
 v_mfma_f32_16x16x32_bf16 v[128:131], a[148:151], a[248:251], v[128:131]
 ds_read_b64_tr_b16 a[170:171], v246 offset:46144
 v_mfma_f32_16x16x32_bf16 v[132:135], a[144:147], a[244:247], v[132:135]
 s_mul_i32 s55, s32, 81920
 s_add_u32 s55, s55, s28
 ds_read_b64_tr_b16 a[172:173], v246 offset:51264
 s_waitcnt vmcnt(19)
 v_mfma_f32_16x16x32_bf16 v[132:135], a[148:151], a[252:255], v[132:135]
 ds_read_b64_tr_b16 a[174:175], v246 offset:56384
 s_waitcnt lgkmcnt(8)
 v_mfma_f32_16x16x32_bf16 v[136:139], a[152:155], a[240:243], v[136:139]
 s_add_u32 s53, s30, s33
 s_add_u32 s33, s33, 1024
 s_and_b32 s33, s33, 0x3fff
 ds_read_b64_tr_b16 a[176:177], v245 offset:41088
 v_mfma_f32_16x16x32_bf16 v[136:139], a[156:159], a[248:251], v[136:139]
 ds_read_b64_tr_b16 a[178:179], v245 offset:46208
 s_add_u32 m0, s38, 106496
 v_mfma_f32_16x16x32_bf16 v[140:143], a[152:155], a[244:247], v[140:143]
 ds_read_b64_tr_b16 a[180:181], v245 offset:51328
 v_mfma_f32_16x16x32_bf16 v[140:143], a[156:159], a[252:255], v[140:143]
 ds_read_b64_tr_b16 a[182:183], v245 offset:56448
 s_waitcnt lgkmcnt(8)
 v_mfma_f32_16x16x32_bf16 v[144:147], a[160:163], a[240:243], v[144:147]
 ds_read_b64_tr_b16 a[184:185], v246 offset:41088
 buffer_load_dwordx4 v247, s[8:11], s55 offen lds
 buffer_load_dwordx4 a[224:227], v252, s[4:7], s53 offen sc1
 v_mfma_f32_16x16x32_bf16 v[144:147], a[164:167], a[248:251], v[144:147]
 ds_read_b64_tr_b16 a[186:187], v246 offset:46208
 v_mfma_f32_16x16x32_bf16 v[148:151], a[160:163], a[244:247], v[148:151]
 ds_read_b64_tr_b16 a[188:189], v246 offset:51328
 v_mfma_f32_16x16x32_bf16 v[148:151], a[164:167], a[252:255], v[148:151]
 ds_read_b64_tr_b16 a[190:191], v246 offset:56448
 s_waitcnt lgkmcnt(8)
 s_add_u32 m0, s38, 107520
 v_mfma_f32_16x16x32_bf16 v[152:155], a[168:171], a[240:243], v[152:155]
 ds_read_b64_tr_b16 a[128:129], v245 offset:41152
 v_mfma_f32_16x16x32_bf16 v[152:155], a[172:175], a[248:251], v[152:155]
 ds_read_b64_tr_b16 a[130:131], v245 offset:46272
 buffer_load_dwordx4 a[228:231], v253, s[4:7], s53 offen sc1
 v_mfma_f32_16x16x32_bf16 v[156:159], a[168:171], a[244:247], v[156:159]
 ds_read_b64_tr_b16 a[132:133], v245 offset:51392
 buffer_load_dwordx4 v248, s[8:11], s55 offen lds
 v_mfma_f32_16x16x32_bf16 v[156:159], a[172:175], a[252:255], v[156:159]
 ds_read_b64_tr_b16 a[134:135], v245 offset:56512
 s_waitcnt lgkmcnt(8)
 v_mfma_f32_16x16x32_bf16 v[160:163], a[176:179], a[240:243], v[160:163]
 ds_read_b64_tr_b16 a[136:137], v246 offset:41152
 v_mfma_f32_16x16x32_bf16 v[160:163], a[180:183], a[248:251], v[160:163]
 ds_read_b64_tr_b16 a[138:139], v246 offset:46272
 s_add_u32 m0, s38, 108544
 v_mfma_f32_16x16x32_bf16 v[164:167], a[176:179], a[244:247], v[164:167]
 ds_read_b64_tr_b16 a[140:141], v246 offset:51392
 v_mfma_f32_16x16x32_bf16 v[164:167], a[180:183], a[252:255], v[164:167]
 ds_read_b64_tr_b16 a[142:143], v246 offset:56512
 s_waitcnt lgkmcnt(8)
 v_mfma_f32_16x16x32_bf16 v[168:171], a[184:187], a[240:243], v[168:171]
 ds_read_b64_tr_b16 a[144:145], v245 offset:41216
 buffer_load_dwordx4 v249, s[8:11], s55 offen lds
 v_mfma_f32_16x16x32_bf16 v[168:171], a[188:191], a[248:251], v[168:171]
 ds_read_b64_tr_b16 a[146:147], v245 offset:46336
 v_mfma_f32_16x16x32_bf16 v[172:175], a[184:187], a[244:247], v[172:175]
 ds_read_b64_tr_b16 a[148:149], v245 offset:51456
 v_mfma_f32_16x16x32_bf16 v[172:175], a[188:191], a[252:255], v[172:175]
 ds_read_b64_tr_b16 a[150:151], v245 offset:56576
 s_waitcnt lgkmcnt(8)
 s_add_u32 m0, s38, 109568
 v_mfma_f32_16x16x32_bf16 v[176:179], a[128:131], a[240:243], v[176:179]
 s_add_u32 s53, s30, s33
 s_add_u32 s33, s33, 1024
 s_and_b32 s33, s33, 0x3fff
 ds_read_b64_tr_b16 a[152:153], v246 offset:41216
 v_mfma_f32_16x16x32_bf16 v[176:179], a[132:135], a[248:251], v[176:179]
 ds_read_b64_tr_b16 a[154:155], v246 offset:46336
 v_mfma_f32_16x16x32_bf16 v[180:183], a[128:131], a[244:247], v[180:183]
 s_waitcnt vmcnt(16)
 s_barrier
 ds_read_b64_tr_b16 a[156:157], v246 offset:51456
 buffer_load_dwordx4 v250, s[8:11], s55 offen lds
 v_mfma_f32_16x16x32_bf16 v[180:183], a[132:135], a[252:255], v[180:183]
 ds_read_b64_tr_b16 a[158:159], v246 offset:56576
 s_waitcnt lgkmcnt(8)
 v_mfma_f32_16x16x32_bf16 v[184:187], a[136:139], a[240:243], v[184:187]
 v_xor_b32 v245, 0x10000, v245
 ds_read_b64_tr_b16 a[160:161], v245
 buffer_load_dwordx4 a[232:235], v252, s[4:7], s53 offen sc1
 v_mfma_f32_16x16x32_bf16 v[184:187], a[140:143], a[248:251], v[184:187]
 ds_read_b64_tr_b16 a[162:163], v245 offset:5120
 s_add_u32 m0, s38, 110592
 v_mfma_f32_16x16x32_bf16 v[188:191], a[136:139], a[244:247], v[188:191]
 ds_read_b64_tr_b16 a[164:165], v245 offset:10240
 v_mfma_f32_16x16x32_bf16 v[188:191], a[140:143], a[252:255], v[188:191]
 ds_read_b64_tr_b16 a[166:167], v245 offset:15360
 s_waitcnt lgkmcnt(8)
 v_mfma_f32_16x16x32_bf16 v[192:195], a[144:147], a[240:243], v[192:195]
 v_xor_b32 v246, 0x10000, v246
 ds_read_b64_tr_b16 a[168:169], v246
 buffer_load_dwordx4 v251, s[8:11], s55 offen lds
 v_mfma_f32_16x16x32_bf16 v[192:195], a[148:151], a[248:251], v[192:195]
 ds_read_b64_tr_b16 a[170:171], v246 offset:5120
 buffer_load_dwordx4 a[236:239], v253, s[4:7], s53 offen sc1
 v_mfma_f32_16x16x32_bf16 v[196:199], a[144:147], a[244:247], v[196:199]
 ds_read_b64_tr_b16 a[172:173], v246 offset:10240
 v_mfma_f32_16x16x32_bf16 v[196:199], a[148:151], a[252:255], v[196:199]
 s_add_u32 s32, s32, 1
 s_and_b32 s32, s32, 7
 ds_read_b64_tr_b16 a[174:175], v246 offset:15360
 s_waitcnt lgkmcnt(8)
 v_mfma_f32_16x16x32_bf16 v[200:203], a[152:155], a[240:243], v[200:203]
 ds_read_b64_tr_b16 a[176:177], v245 offset:64
 v_mfma_f32_16x16x32_bf16 v[200:203], a[156:159], a[248:251], v[200:203]
 ds_read_b64_tr_b16 a[178:179], v245 offset:5184
 v_mfma_f32_16x16x32_bf16 v[204:207], a[152:155], a[244:247], v[204:207]
 ds_read_b64_tr_b16 a[180:181], v245 offset:10304
 s_mov_b32 s28, s68
 s_xor_b32 s30, s30, 0x4000
 v_mfma_f32_16x16x32_bf16 v[204:207], a[156:159], a[252:255], v[204:207]
 ds_read_b64_tr_b16 a[182:183], v245 offset:15424
 s_waitcnt lgkmcnt(8)
 v_mfma_f32_16x16x32_bf16 v[128:131], a[160:163], a[192:195], v[128:131]
 ds_read_b64_tr_b16 a[184:185], v246 offset:64
 s_waitcnt vmcnt(9)
 v_cmp_eq_u32 vcc, s100, v240
 s_nop 1
 s_and_b32 s71, vcc_lo, 15
 s_cmp_eq_u32 s71, 15
 s_cbranch_scc0 L_slow_cy
L_back_cy:
 v_mfma_f32_16x16x32_bf16 v[128:131], a[164:167], a[200:203], v[128:131]
 ds_read_b64_tr_b16 a[186:187], v246 offset:5184
 v_mfma_f32_16x16x32_bf16 v[132:135], a[160:163], a[196:199], v[132:135]
 s_mul_i32 s55, s32, 81920
 s_add_u32 s55, s55, s28
 ds_read_b64_tr_b16 a[188:189], v246 offset:10304
 v_mfma_f32_16x16x32_bf16 v[132:135], a[164:167], a[204:207], v[132:135]
 ds_read_b64_tr_b16 a[190:191], v246 offset:15424
 s_waitcnt lgkmcnt(8)
 v_mfma_f32_16x16x32_bf16 v[136:139], a[168:171], a[192:195], v[136:139]
 s_add_u32 s53, s30, s33
 s_add_u32 s33, s33, 1024
 s_and_b32 s33, s33, 0x3fff
 ds_read_b64_tr_b16 a[128:129], v245 offset:128
 v_mfma_f32_16x16x32_bf16 v[136:139], a[172:175], a[200:203], v[136:139]
 ds_read_b64_tr_b16 a[130:131], v245 offset:5248
 s_add_u32 m0, s38, 0
 v_mfma_f32_16x16x32_bf16 v[140:143], a[168:171], a[196:199], v[140:143]
 ds_read_b64_tr_b16 a[132:133], v245 offset:10368
 v_mfma_f32_16x16x32_bf16 v[140:143], a[172:175], a[204:207], v[140:143]
 ds_read_b64_tr_b16 a[134:135], v245 offset:15488
 s_waitcnt lgkmcnt(8)
 v_mfma_f32_16x16x32_bf16 v[144:147], a[176:179], a[192:195], v[144:147]
 ds_read_b64_tr_b16 a[136:137], v246 offset:128
 buffer_load_dwordx4 v247, s[8:11], s55 offen lds
 buffer_load_dwordx4 a[240:243], v252, s[4:7], s53 offen sc1
 v_mfma_f32_16x16x32_bf16 v[144:147], a[180:183], a[200:203], v[144:147]
 ds_read_b64_tr_b16 a[138:139], v246 offset:5248
 v_mfma_f32_16x16x32_bf16 v[148:151], a[176:179], a[196:199], v[148:151]
 ds_read_b64_tr_b16 a[140:141], v246 offset:10368
 v_mfma_f32_16x16x32_bf16 v[148:151], a[180:183], a[204:207], v[148:151]
 ds_read_b64_tr_b16 a[142:143], v246 offset:15488
 s_waitcnt lgkmcnt(8)
 s_add_u32 m0, s38, 1024
 v_mfma_f32_16x16x32_bf16 v[152:155], a[184:187], a[192:195], v[152:155]
 ds_read_b64_tr_b16 a[144:145], v245 offset:192
 v_mfma_f32_16x16x32_bf16 v[152:155], a[188:191], a[200:203], v[152:155]
 ds_read_b64_tr_b16 a[146:147], v245 offset:5312
 buffer_load_dwordx4 a[244:247], v253, s[4:7], s53 offen sc1
 v_mfma_f32_16x16x32_bf16 v[156:159], a[184:187], a[196:199], v[156:159]
 ds_read_b64_tr_b16 a[148:149], v245 offset:10432
 buffer_load_dwordx4 v248, s[8:11], s55 offen lds
 v_mfma_f32_16x16x32_bf16 v[156:159], a[188:191], a[204:207], v[156:159]
 ds_read_b64_tr_b16 a[150:151], v245 offset:15552
 s_waitcnt lgkmcnt(8)
 v_mfma_f32_16x16x32_bf16 v[160:163], a[128:131], a[192:195], v[160:163]
 ds_read_b64_tr_b16 a[152:153], v246 offset:192
 v_mfma_f32_16x16x32_bf16 v[160:163], a[132:135], a[200:203], v[160:163]
 ds_read_b64_tr_b16 a[154:155], v246 offset:5312
 s_add_u32 m0, s38, 2048
 v_mfma_f32_16x16x32_bf16 v[164:167], a[128:131], a[196:199], v[164:167]
 ds_read_b64_tr_b16 a[156:157], v246 offset:10432
 v_mfma_f32_16x16x32_bf16 v[164:167], a[132:135], a[204:207], v[164:167]
 ds_read_b64_tr_b16 a[158:159], v246 offset:15552
 s_waitcnt lgkmcnt(8)
 v_mfma_f32_16x16x32_bf16 v[168:171], a[136:139], a[192:195], v[168:171]
 ds_read_b64_tr_b16 a[160:161], v245 offset:256
 buffer_load_dwordx4 v249, s[8:11], s55 offen lds
 v_mfma_f32_16x16x32_bf16 v[168:171], a[140:143], a[200:203], v[168:171]
 ds_read_b64_tr_b16 a[162:163], v245 offset:5376
 v_mfma_f32_16x16x32_bf16 v[172:175], a[136:139], a[196:199], v[172:175]
 ds_read_b64_tr_b16 a[164:165], v245 offset:10496
 v_mfma_f32_16x16x32_bf16 v[172:175], a[140:143], a[204:207], v[172:175]
 ds_read_b64_tr_b16 a[166:167], v245 offset:15616
 s_waitcnt lgkmcnt(8)
 s_add_u32 m0, s38, 3072
 v_mfma_f32_16x16x32_bf16 v[176:179], a[144:147], a[192:195], v[176:179]
 s_add_u32 s53, s30, s33
 s_add_u32 s33, s33, 1024
 s_and_b32 s33, s33, 0x3fff
 ds_read_b64_tr_b16 a[168:169], v246 offset:256
 v_mfma_f32_16x16x32_bf16 v[176:179], a[148:151], a[200:203], v[176:179]
 ds_read_b64_tr_b16 a[170:171], v246 offset:5376
 v_mfma_f32_16x16x32_bf16 v[180:183], a[144:147], a[196:199], v[180:183]
 s_barrier
 ds_read_b64_tr_b16 a[172:173], v246 offset:10496
 buffer_load_dwordx4 v250, s[8:11], s55 offen lds
 v_mfma_f32_16x16x32_bf16 v[180:183], a[148:151], a[204:207], v[180:183]
 ds_read_b64_tr_b16 a[174:175], v246 offset:15616
 s_waitcnt lgkmcnt(8)
 v_mfma_f32_16x16x32_bf16 v[184:187], a[152:155], a[192:195], v[184:187]
 ds_read_b64_tr_b16 a[176:177], v245 offset:20480
 buffer_load_dwordx4 a[248:251], v252, s[4:7], s53 offen sc1
 v_mfma_f32_16x16x32_bf16 v[184:187], a[156:159], a[200:203], v[184:187]
 ds_read_b64_tr_b16 a[178:179], v245 offset:25600
 s_add_u32 m0, s38, 4096
 v_mfma_f32_16x16x32_bf16 v[188:191], a[152:155], a[196:199], v[188:191]
 ds_read_b64_tr_b16 a[180:181], v245 offset:30720
 v_mfma_f32_16x16x32_bf16 v[188:191], a[156:159], a[204:207], v[188:191]
 ds_read_b64_tr_b16 a[182:183], v245 offset:35840
 s_waitcnt lgkmcnt(8)
 v_mfma_f32_16x16x32_bf16 v[192:195], a[160:163], a[192:195], v[192:195]
 ds_read_b64_tr_b16 a[184:185], v246 offset:20480
 buffer_load_dwordx4 v251, s[8:11], s55 offen lds
 v_mfma_f32_16x16x32_bf16 v[192:195], a[164:167], a[200:203], v[192:195]
 ds_read_b64_tr_b16 a[186:187], v246 offset:25600
 buffer_load_dwordx4 a[252:255], v253, s[4:7], s53 offen sc1
 v_mfma_f32_16x16x32_bf16 v[196:199], a[160:163], a[196:199], v[196:199]
 ds_read_b64_tr_b16 a[188:189], v246 offset:30720
 v_mfma_f32_16x16x32_bf16 v[196:199], a[164:167], a[204:207], v[196:199]
 s_add_u32 s32, s32, 1
 s_and_b32 s32, s32, 7
 ds_read_b64_tr_b16 a[190:191], v246 offset:35840
 s_waitcnt lgkmcnt(8)
 v_mfma_f32_16x16x32_bf16 v[200:203], a[168:171], a[192:195], v[200:203]
 ds_read_b64_tr_b16 a[128:129], v245 offset:20544
 v_mfma_f32_16x16x32_bf16 v[200:203], a[172:175], a[200:203], v[200:203]
 ds_read_b64_tr_b16 a[130:131], v245 offset:25664
 v_mfma_f32_16x16x32_bf16 v[204:207], a[168:171], a[196:199], v[204:207]
 ds_read_b64_tr_b16 a[132:133], v245 offset:30784
 v_mfma_f32_16x16x32_bf16 v[204:207], a[172:175], a[204:207], v[204:207]
 ds_read_b64_tr_b16 a[134:135], v245 offset:35904
 s_waitcnt lgkmcnt(8)
 v_mfma_f32_16x16x32_bf16 v[128:131], a[176:179], a[208:211], v[128:131]
 ds_read_b64_tr_b16 a[136:137], v246 offset:20544
 v_mfma_f32_16x16x32_bf16 v[128:131], a[180:183], a[216:219], v[128:131]
 ds_read_b64_tr_b16 a[138:139], v246 offset:25664
 v_mfma_f32_16x16x32_bf16 v[132:135], a[176:179], a[212:215], v[132:135]
 s_mul_i32 s55, s32, 81920
 s_add_u32 s55, s55, s28
 ds_read_b64_tr_b16 a[140:141], v246 offset:30784
 v_mfma_f32_16x16x32_bf16 v[132:135], a[180:183], a[220:223], v[132:135]
 ds_read_b64_tr_b16 a[142:143], v246 offset:35904
 s_waitcnt lgkmcnt(8)
 v_mfma_f32_16x16x32_bf16 v[136:139], a[184:187], a[208:211], v[136:139]
 s_add_u32 s53, s30, s33
 s_add_u32 s33, s33, 1024
 s_and_b32 s33, s33, 0x3fff
 ds_read_b64_tr_b16 a[144:145], v245 offset:20608
 v_mfma_f32_16x16x32_bf16 v[136:139], a[188:191], a[216:219], v[136:139]
 ds_read_b64_tr_b16 a[146:147], v245 offset:25728
 s_add_u32 m0, s38, 20480
 v_mfma_f32_16x16x32_bf16 v[140:143], a[184:187], a[212:215], v[140:143]
 ds_read_b64_tr_b16 a[148:149], v245 offset:30848
 v_mfma_f32_16x16x32_bf16 v[140:143], a[188:191], a[220:223], v[140:143]
 ds_read_b64_tr_b16 a[150:151], v245 offset:35968
 s_waitcnt lgkmcnt(8)
 v_mfma_f32_16x16x32_bf16 v[144:147], a[128:131], a[208:211], v[144:147]
 ds_read_b64_tr_b16 a[152:153], v246 offset:20608
 buffer_load_dwordx4 v247, s[8:11], s55 offen lds
 buffer_load_dwordx4 a[192:195], v252, s[4:7], s53 offen sc1
 v_mfma_f32_16x16x32_bf16 v[144:147], a[132:135], a[216:219], v[144:147]
 ds_read_b64_tr_b16 a[154:155], v246 offset:25728
 v_mfma_f32_16x16x32_bf16 v[148:151], a[128:131], a[212:215], v[148:151]
 ds_read_b64_tr_b16 a[156:157], v246 offset:30848
 v_mfma_f32_16x16x32_bf16 v[148:151], a[132:135], a[220:223], v[148:151]
 ds_read_b64_tr_b16 a[158:159], v246 offset:35968
 s_waitcnt lgkmcnt(8)
 s_add_u32 m0, s38, 21504
 v_mfma_f32_16x16x32_bf16 v[152:155], a[136:139], a[208:211], v[152:155]
 ds_read_b64_tr_b16 a[160:161], v245 offset:20672
 v_mfma_f32_16x16x32_bf16 v[152:155], a[140:143], a[216:219], v[152:155]
 ds_read_b64_tr_b16 a[162:163], v245 offset:25792
 buffer_load_dwordx4 a[196:199], v253, s[4:7], s53 offen sc1
 v_mfma_f32_16x16x32_bf16 v[156:159], a[136:139], a[212:215], v[156:159]
 ds_read_b64_tr_b16 a[164:165], v245 offset:30912
 buffer_load_dwordx4 v248, s[8:11], s55 offen lds
 v_mfma_f32_16x16x32_bf16 v[156:159], a[140:143], a[220:223], v[156:159]
 ds_read_b64_tr_b16 a[166:167], v245 offset:36032
 s_waitcnt lgkmcnt(8)
 v_mfma_f32_16x16x32_bf16 v[160:163], a[144:147], a[208:211], v[160:163]
 ds_read_b64_tr_b16 a[168:169], v246 offset:20672
 v_mfma_f32_16x16x32_bf16 v[160:163], a[148:151], a[216:219], v[160:163]
 ds_read_b64_tr_b16 a[170:171], v246 offset:25792
 s_add_u32 m0, s38, 22528
 v_mfma_f32_16x16x32_bf16 v[164:167], a[144:147], a[212:215], v[164:167]
 ds_read_b64_tr_b16 a[172:173], v246 offset:30912
 v_mfma_f32_16x16x32_bf16 v[164:167], a[148:151], a[220:223], v[164:167]
 ds_read_b64_tr_b16 a[174:175], v246 offset:36032
 s_waitcnt lgkmcnt(8)
 v_mfma_f32_16x16x32_bf16 v[168:171], a[152:155], a[208:211], v[168:171]
 ds_read_b64_tr_b16 a[176:177], v245 offset:20736
 buffer_load_dwordx4 v249, s[8:11], s55 offen lds
 v_mfma_f32_16x16x32_bf16 v[168:171], a[156:159], a[216:219], v[168:171]
 ds_read_b64_tr_b16 a[178:179], v245 offset:25856
 v_mfma_f32_16x16x32_bf16 v[172:175], a[152:155], a[212:215], v[172:175]
 ds_read_b64_tr_b16 a[180:181], v245 offset:30976
 v_mfma_f32_16x16x32_bf16 v[172:175], a[156:159], a[220:223], v[172:175]
 ds_read_b64_tr_b16 a[182:183], v245 offset:36096
 s_waitcnt lgkmcnt(8)
 s_add_u32 m0, s38, 23552
 v_mfma_f32_16x16x32_bf16 v[176:179], a[160:163], a[208:211], v[176:179]
 s_add_u32 s53, s30, s33
 s_add_u32 s33, s33, 1024
 s_and_b32 s33, s33, 0x3fff
 ds_read_b64_tr_b16 a[184:185], v246 offset:20736
 v_mfma_f32_16x16x32_bf16 v[176:179], a[164:167], a[216:219], v[176:179]
 ds_read_b64_tr_b16 a[186:187], v246 offset:25856
 v_mfma_f32_16x16x32_bf16 v[180:183], a[160:163], a[212:215], v[180:183]
 s_waitcnt vmcnt(15)
 s_barrier
 ds_read_b64_tr_b16 a[188:189], v246 offset:30976
 buffer_load_dwordx4 v250, s[8:11], s55 offen lds
 v_mfma_f32_16x16x32_bf16 v[180:183], a[164:167], a[220:223], v[180:183]
 ds_read_b64_tr_b16 a[190:191], v246 offset:36096
 s_waitcnt lgkmcnt(8)
 v_mfma_f32_16x16x32_bf16 v[184:187], a[168:171], a[208:211], v[184:187]
 ds_read_b64_tr_b16 a[128:129], v245 offset:40960
 buffer_load_dwordx4 a[200:203], v252, s[4:7], s53 offen sc1
 v_mfma_f32_16x16x32_bf16 v[184:187], a[172:175], a[216:219], v[184:187]
 ds_read_b64_tr_b16 a[130:131], v245 offset:46080
 s_add_u32 m0, s38, 24576
 v_mfma_f32_16x16x32_bf16 v[188:191], a[168:171], a[212:215], v[188:191]
 ds_read_b64_tr_b16 a[132:133], v245 offset:51200
 v_mfma_f32_16x16x32_bf16 v[188:191], a[172:175], a[220:223], v[188:191]
 ds_read_b64_tr_b16 a[134:135], v245 offset:56320
 s_waitcnt lgkmcnt(8)
 v_mfma_f32_16x16x32_bf16 v[192:195], a[176:179], a[208:211], v[192:195]
 ds_read_b64_tr_b16 a[136:137], v246 offset:40960
 buffer_load_dwordx4 v251, s[8:11], s55 offen lds
 v_mfma_f32_16x16x32_bf16 v[192:195], a[180:183], a[216:219], v[192:195]
 ds_read_b64_tr_b16 a[138:139], v246 offset:46080
 buffer_load_dwordx4 a[204:207], v253, s[4:7], s53 offen sc1
 v_mfma_f32_16x16x32_bf16 v[196:199], a[176:179], a[212:215], v[196:199]
 ds_read_b64_tr_b16 a[140:141], v246 offset:51200
 v_mfma_f32_16x16x32_bf16 v[196:199], a[180:183], a[220:223], v[196:199]
 s_add_u32 s32, s32, 1
 s_and_b32 s32, s32, 7
 ds_read_b64_tr_b16 a[142:143], v246 offset:56320
 s_waitcnt lgkmcnt(8)
 v_mfma_f32_16x16x32_bf16 v[200:203], a[184:187], a[208:211], v[200:203]
 ds_read_b64_tr_b16 a[144:145], v245 offset:41024
 v_mfma_f32_16x16x32_bf16 v[200:203], a[188:191], a[216:219], v[200:203]
 ds_read_b64_tr_b16 a[146:147], v245 offset:46144
 v_mfma_f32_16x16x32_bf16 v[204:207], a[184:187], a[212:215], v[204:207]
 ds_read_b64_tr_b16 a[148:149], v245 offset:51264
 v_mfma_f32_16x16x32_bf16 v[204:207], a[188:191], a[220:223], v[204:207]
 ds_read_b64_tr_b16 a[150:151], v245 offset:56384
 s_waitcnt lgkmcnt(8)
 v_mfma_f32_16x16x32_bf16 v[128:131], a[128:131], a[224:227], v[128:131]
 ds_read_b64_tr_b16 a[152:153], v246 offset:41024
 v_mfma_f32_16x16x32_bf16 v[128:131], a[132:135], a[232:235], v[128:131]
 ds_read_b64_tr_b16 a[154:155], v246 offset:46144
 v_mfma_f32_16x16x32_bf16 v[132:135], a[128:131], a[228:231], v[132:135]
 s_mul_i32 s55, s32, 81920
 s_add_u32 s55, s55, s28
 ds_read_b64_tr_b16 a[156:157], v246 offset:51264
 s_waitcnt vmcnt(18)
 v_mfma_f32_16x16x32_bf16 v[132:135], a[132:135], a[236:239], v[132:135]
 ds_read_b64_tr_b16 a[158:159], v246 offset:56384
 s_waitcnt lgkmcnt(8)
 v_mfma_f32_16x16x32_bf16 v[136:139], a[136:139], a[224:227], v[136:139]
 s_add_u32 s53, s30, s33
 s_add_u32 s33, s33, 1024
 s_and_b32 s33, s33, 0x3fff
 ds_read_b64_tr_b16 a[160:161], v245 offset:41088
 v_mfma_f32_16x16x32_bf16 v[136:139], a[140:143], a[232:235], v[136:139]
 ds_read_b64_tr_b16 a[162:163], v245 offset:46208
 s_add_u32 m0, s38, 40960
 v_mfma_f32_16x16x32_bf16 v[140:143], a[136:139], a[228:231], v[140:143]
 ds_read_b64_tr_b16 a[164:165], v245 offset:51328
 v_mfma_f32_16x16x32_bf16 v[140:143], a[140:143], a[236:239], v[140:143]
 ds_read_b64_tr_b16 a[166:167], v245 offset:56448
 s_waitcnt lgkmcnt(8)
 v_mfma_f32_16x16x32_bf16 v[144:147], a[144:147], a[224:227], v[144:147]
 ds_read_b64_tr_b16 a[168:169], v246 offset:41088
 buffer_load_dwordx4 v247, s[8:11], s55 offen lds
 buffer_load_dwordx4 a[208:211], v252, s[4:7], s53 offen sc1
 v_mfma_f32_16x16x32_bf16 v[144:147], a[148:151], a[232:235], v[144:147]
 ds_read_b64_tr_b16 a[170:171], v246 offset:46208
 v_mfma_f32_16x16x32_bf16 v[148:151], a[144:147], a[228:231], v[148:151]
 ds_read_b64_tr_b16 a[172:173], v246 offset:51328
 v_mfma_f32_16x16x32_bf16 v[148:151], a[148:151], a[236:239], v[148:151]
 ds_read_b64_tr_b16 a[174:175], v246 offset:56448
 s_waitcnt lgkmcnt(8)
 s_add_u32 m0, s38, 41984
 v_mfma_f32_16x16x32_bf16 v[152:155], a[152:155], a[224:227], v[152:155]
 ds_read_b64_tr_b16 a[176:177], v245 offset:41152
 v_mfma_f32_16x16x32_bf16 v[152:155], a[156:159], a[232:235], v[152:155]
 ds_read_b64_tr_b16 a[178:179], v245 offset:46272
 buffer_load_dwordx4 a[212:215], v253, s[4:7], s53 offen sc1
 v_mfma_f32_16x16x32_bf16 v[156:159], a[152:155], a[228:231], v[156:159]
 ds_read_b64_tr_b16 a[180:181], v245 offset:51392
 buffer_load_dwordx4 v248, s[8:11], s55 offen lds
 v_mfma_f32_16x16x32_bf16 v[156:159], a[156:159], a[236:239], v[156:159]
 ds_read_b64_tr_b16 a[182:183], v245 offset:56512
 s_waitcnt lgkmcnt(8)
 v_mfma_f32_16x16x32_bf16 v[160:163], a[160:163], a[224:227], v[160:163]
 ds_read_b64_tr_b16 a[184:185], v246 offset:41152
 v_mfma_f32_16x16x32_bf16 v[160:163], a[164:167], a[232:235], v[160:163]
 ds_read_b64_tr_b16 a[186:187], v246 offset:46272
 s_add_u32 m0, s38, 43008
 v_mfma_f32_16x16x32_bf16 v[164:167], a[160:163], a[228:231], v[164:167]
 ds_read_b64_tr_b16 a[188:189], v246 offset:51392
 v_mfma_f32_16x16x32_bf16 v[164:167], a[164:167], a[236:239], v[164:167]
 ds_read_b64_tr_b16 a[190:191], v246 offset:56512
 s_waitcnt lgkmcnt(8)
 v_mfma_f32_16x16x32_bf16 v[168:171], a[168:171], a[224:227], v[168:171]
 ds_read_b64_tr_b16 a[128:129], v245 offset:41216
 buffer_load_dwordx4 v249, s[8:11], s55 offen lds
 v_mfma_f32_16x16x32_bf16 v[168:171], a[172:175], a[232:235], v[168:171]
 ds_read_b64_tr_b16 a[130:131], v245 offset:46336
 v_mfma_f32_16x16x32_bf16 v[172:175], a[168:171], a[228:231], v[172:175]
 ds_read_b64_tr_b16 a[132:133], v245 offset:51456
 v_mfma_f32_16x16x32_bf16 v[172:175], a[172:175], a[236:239], v[172:175]
 ds_read_b64_tr_b16 a[134:135], v245 offset:56576
 s_waitcnt lgkmcnt(8)
 s_add_u32 m0, s38, 44032
 v_mfma_f32_16x16x32_bf16 v[176:179], a[176:179], a[224:227], v[176:179]
 s_add_u32 s53, s30, s33
 s_add_u32 s33, s33, 1024
 s_and_b32 s33, s33, 0x3fff
 ds_read_b64_tr_b16 a[136:137], v246 offset:41216
 v_mfma_f32_16x16x32_bf16 v[176:179], a[180:183], a[232:235], v[176:179]
 ds_read_b64_tr_b16 a[138:139], v246 offset:46336
 v_mfma_f32_16x16x32_bf16 v[180:183], a[176:179], a[228:231], v[180:183]
 s_waitcnt vmcnt(15)
 s_barrier
 ds_read_b64_tr_b16 a[140:141], v246 offset:51456
 buffer_load_dwordx4 v250, s[8:11], s55 offen lds
 v_mfma_f32_16x16x32_bf16 v[180:183], a[180:183], a[236:239], v[180:183]
 ds_read_b64_tr_b16 a[142:143], v246 offset:56576
 s_waitcnt lgkmcnt(8)
 v_mfma_f32_16x16x32_bf16 v[184:187], a[184:187], a[224:227], v[184:187]
 v_xor_b32 v245, 0x10000, v245
 ds_read_b64_tr_b16 a[144:145], v245
 buffer_load_dwordx4 a[216:219], v252, s[4:7], s53 offen sc1
 v_mfma_f32_16x16x32_bf16 v[184:187], a[188:191], a[232:235], v[184:187]
 ds_read_b64_tr_b16 a[146:147], v245 offset:5120
 s_add_u32 m0, s38, 45056
 v_mfma_f32_16x16x32_bf16 v[188:191], a[184:187], a[228:231], v[188:191]
 ds_read_b64_tr_b16 a[148:149], v245 offset:10240
 v_mfma_f32_16x16x32_bf16 v[188:191], a[188:191], a[236:239], v[188:191]
 ds_read_b64_tr_b16 a[150:151], v245 offset:15360
 s_waitcnt lgkmcnt(8)
 v_mfma_f32_16x16x32_bf16 v[192:195], a[128:131], a[224:227], v[192:195]
 v_xor_b32 v246, 0x10000, v246
 ds_read_b64_tr_b16 a[152:153], v246
 buffer_load_dwordx4 v251, s[8:11], s55 offen lds
 v_mfma_f32_16x16x32_bf16 v[192:195], a[132:135], a[232:235], v[192:195]
 ds_read_b64_tr_b16 a[154:155], v246 offset:5120
 buffer_load_dwordx4 a[220:223], v253, s[4:7], s53 offen sc1
 v_mfma_f32_16x16x32_bf16 v[196:199], a[128:131], a[228:231], v[196:199]
 ds_read_b64_tr_b16 a[156:157], v246 offset:10240
 v_mfma_f32_16x16x32_bf16 v[196:199], a[132:135], a[236:239], v[196:199]
 s_add_u32 s32, s32, 1
 s_and_b32 s32, s32, 7
 ds_read_b64_tr_b16 a[158:159], v246 offset:15360
 s_waitcnt lgkmcnt(8)
 v_mfma_f32_16x16x32_bf16 v[200:203], a[136:139], a[224:227], v[200:203]
 ds_read_b64_tr_b16 a[160:161], v245 offset:64
 v_mfma_f32_16x16x32_bf16 v[200:203], a[140:143], a[232:235], v[200:203]
 ds_read_b64_tr_b16 a[162:163], v245 offset:5184
 v_mfma_f32_16x16x32_bf16 v[204:207], a[136:139], a[228:231], v[204:207]
 ds_read_b64_tr_b16 a[164:165], v245 offset:10304
 v_mfma_f32_16x16x32_bf16 v[204:207], a[140:143], a[236:239], v[204:207]
 ds_read_b64_tr_b16 a[166:167], v245 offset:15424
 s_waitcnt lgkmcnt(8)
 v_mfma_f32_16x16x32_bf16 v[128:131], a[144:147], a[240:243], v[128:131]
 ds_read_b64_tr_b16 a[168:169], v246 offset:64
 v_mfma_f32_16x16x32_bf16 v[128:131], a[148:151], a[248:251], v[128:131]
 ds_read_b64_tr_b16 a[170:171], v246 offset:5184
 v_mfma_f32_16x16x32_bf16 v[132:135], a[144:147], a[244:247], v[132:135]
 s_mul_i32 s55, s32, 81920
 s_add_u32 s55, s55, s28
 ds_read_b64_tr_b16 a[172:173], v246 offset:10304
 s_waitcnt vmcnt(18)
 v_mfma_f32_16x16x32_bf16 v[132:135], a[148:151], a[252:255], v[132:135]
 ds_read_b64_tr_b16 a[174:175], v246 offset:15424
 s_waitcnt lgkmcnt(8)
 v_mfma_f32_16x16x32_bf16 v[136:139], a[152:155], a[240:243], v[136:139]
 s_add_u32 s53, s30, s33
 s_add_u32 s33, s33, 1024
 s_and_b32 s33, s33, 0x3fff
 ds_read_b64_tr_b16 a[176:177], v245 offset:128
 v_mfma_f32_16x16x32_bf16 v[136:139], a[156:159], a[248:251], v[136:139]
 ds_read_b64_tr_b16 a[178:179], v245 offset:5248
 s_add_u32 m0, s38, 65536
 v_mfma_f32_16x16x32_bf16 v[140:143], a[152:155], a[244:247], v[140:143]
 ds_read_b64_tr_b16 a[180:181], v245 offset:10368
 v_mfma_f32_16x16x32_bf16 v[140:143], a[156:159], a[252:255], v[140:143]
 ds_read_b64_tr_b16 a[182:183], v245 offset:15488
 s_waitcnt lgkmcnt(8)
 v_mfma_f32_16x16x32_bf16 v[144:147], a[160:163], a[240:243], v[144:147]
 ds_read_b64_tr_b16 a[184:185], v246 offset:128
 buffer_load_dwordx4 v247, s[8:11], s55 offen lds
 buffer_load_dwordx4 a[224:227], v252, s[4:7], s53 offen sc1
 v_mfma_f32_16x16x32_bf16 v[144:147], a[164:167], a[248:251], v[144:147]
 ds_read_b64_tr_b16 a[186:187], v246 offset:5248
 v_mfma_f32_16x16x32_bf16 v[148:151], a[160:163], a[244:247], v[148:151]
 ds_read_b64_tr_b16 a[188:189], v246 offset:10368
 v_mfma_f32_16x16x32_bf16 v[148:151], a[164:167], a[252:255], v[148:151]
 ds_read_b64_tr_b16 a[190:191], v246 offset:15488
 s_waitcnt lgkmcnt(8)
 s_add_u32 m0, s38, 66560
 v_mfma_f32_16x16x32_bf16 v[152:155], a[168:171], a[240:243], v[152:155]
 ds_read_b64_tr_b16 a[128:129], v245 offset:192
 v_mfma_f32_16x16x32_bf16 v[152:155], a[172:175], a[248:251], v[152:155]
 ds_read_b64_tr_b16 a[130:131], v245 offset:5312
 buffer_load_dwordx4 a[228:231], v253, s[4:7], s53 offen sc1
 v_mfma_f32_16x16x32_bf16 v[156:159], a[168:171], a[244:247], v[156:159]
 ds_read_b64_tr_b16 a[132:133], v245 offset:10432
 buffer_load_dwordx4 v248, s[8:11], s55 offen lds
 v_mfma_f32_16x16x32_bf16 v[156:159], a[172:175], a[252:255], v[156:159]
 ds_read_b64_tr_b16 a[134:135], v245 offset:15552
 s_waitcnt lgkmcnt(8)
 v_mfma_f32_16x16x32_bf16 v[160:163], a[176:179], a[240:243], v[160:163]
 ds_read_b64_tr_b16 a[136:137], v246 offset:192
 v_mfma_f32_16x16x32_bf16 v[160:163], a[180:183], a[248:251], v[160:163]
 ds_read_b64_tr_b16 a[138:139], v246 offset:5312
 s_add_u32 m0, s38, 67584
 v_mfma_f32_16x16x32_bf16 v[164:167], a[176:179], a[244:247], v[164:167]
 ds_read_b64_tr_b16 a[140:141], v246 offset:10432
 v_mfma_f32_16x16x32_bf16 v[164:167], a[180:183], a[252:255], v[164:167]
 ds_read_b64_tr_b16 a[142:143], v246 offset:15552
 s_waitcnt lgkmcnt(8)
 v_mfma_f32_16x16x32_bf16 v[168:171], a[184:187], a[240:243], v[168:171]
 ds_read_b64_tr_b16 a[144:145], v245 offset:256
 buffer_load_dwordx4 v249, s[8:11], s55 offen lds
 v_mfma_f32_16x16x32_bf16 v[168:171], a[188:191], a[248:251], v[168:171]
 ds_read_b64_tr_b16 a[146:147], v245 offset:5376
 v_mfma_f32_16x16x32_bf16 v[172:175], a[184:187], a[244:247], v[172:175]
 ds_read_b64_tr_b16 a[148:149], v245 offset:10496
 v_mfma_f32_16x16x32_bf16 v[172:175], a[188:191], a[252:255], v[172:175]
 ds_read_b64_tr_b16 a[150:151], v245 offset:15616
 s_waitcnt lgkmcnt(8)
 s_add_u32 m0, s38, 68608
 v_mfma_f32_16x16x32_bf16 v[176:179], a[128:131], a[240:243], v[176:179]
 s_add_u32 s53, s30, s33
 s_add_u32 s33, s33, 1024
 s_and_b32 s33, s33, 0x3fff
 ds_read_b64_tr_b16 a[152:153], v246 offset:256
 v_mfma_f32_16x16x32_bf16 v[176:179], a[132:135], a[248:251], v[176:179]
 ds_read_b64_tr_b16 a[154:155], v246 offset:5376
 v_mfma_f32_16x16x32_bf16 v[180:183], a[128:131], a[244:247], v[180:183]
 s_waitcnt vmcnt(15)
 s_barrier
 ds_read_b64_tr_b16 a[156:157], v246 offset:10496
 buffer_load_dwordx4 v250, s[8:11], s55 offen lds
 v_mfma_f32_16x16x32_bf16 v[180:183], a[132:135], a[252:255], v[180:183]
 ds_read_b64_tr_b16 a[158:159], v246 offset:15616
 s_waitcnt lgkmcnt(8)
 v_mfma_f32_16x16x32_bf16 v[184:187], a[136:139], a[240:243], v[184:187]
 ds_read_b64_tr_b16 a[160:161], v245 offset:20480
 buffer_load_dwordx4 a[232:235], v252, s[4:7], s53 offen sc1
 v_mfma_f32_16x16x32_bf16 v[184:187], a[140:143], a[248:251], v[184:187]
 ds_read_b64_tr_b16 a[162:163], v245 offset:25600
 s_add_u32 m0, s38, 69632
 v_mfma_f32_16x16x32_bf16 v[188:191], a[136:139], a[244:247], v[188:191]
 ds_read_b64_tr_b16 a[164:165], v245 offset:30720
 v_mfma_f32_16x16x32_bf16 v[188:191], a[140:143], a[252:255], v[188:191]
 ds_read_b64_tr_b16 a[166:167], v245 offset:35840
 s_waitcnt lgkmcnt(8)
 v_mfma_f32_16x16x32_bf16 v[192:195], a[144:147], a[240:243], v[192:195]
 ds_read_b64_tr_b16 a[168:169], v246 offset:20480
 buffer_load_dwordx4 v251, s[8:11], s55 offen lds
 v_mfma_f32_16x16x32_bf16 v[192:195], a[148:151], a[248:251], v[192:195]
 ds_read_b64_tr_b16 a[170:171], v246 offset:25600
 buffer_load_dwordx4 a[236:239], v253, s[4:7], s53 offen sc1
 v_mfma_f32_16x16x32_bf16 v[196:199], a[144:147], a[244:247], v[196:199]
 ds_read_b64_tr_b16 a[172:173], v246 offset:30720
 v_mfma_f32_16x16x32_bf16 v[196:199], a[148:151], a[252:255], v[196:199]
 s_add_u32 s32, s32, 1
 s_and_b32 s32, s32, 7
 ds_read_b64_tr_b16 a[174:175], v246 offset:35840
 s_waitcnt lgkmcnt(8)
 v_mfma_f32_16x16x32_bf16 v[200:203], a[152:155], a[240:243], v[200:203]
 ds_read_b64_tr_b16 a[176:177], v245 offset:20544
 v_mfma_f32_16x16x32_bf16 v[200:203], a[156:159], a[248:251], v[200:203]
 ds_read_b64_tr_b16 a[178:179], v245 offset:25664
 v_mfma_f32_16x16x32_bf16 v[204:207], a[152:155], a[244:247], v[204:207]
 ds_read_b64_tr_b16 a[180:181], v245 offset:30784
 v_mfma_f32_16x16x32_bf16 v[204:207], a[156:159], a[252:255], v[204:207]
 ds_read_b64_tr_b16 a[182:183], v245 offset:35904
 s_waitcnt lgkmcnt(8)
 v_mfma_f32_16x16x32_bf16 v[128:131], a[160:163], a[192:195], v[128:131]
 ds_read_b64_tr_b16 a[184:185], v246 offset:20544
 v_mfma_f32_16x16x32_bf16 v[128:131], a[164:167], a[200:203], v[128:131]
 ds_read_b64_tr_b16 a[186:187], v246 offset:25664
 v_mfma_f32_16x16x32_bf16 v[132:135], a[160:163], a[196:199], v[132:135]
 s_mul_i32 s55, s32, 81920
 s_add_u32 s55, s55, s28
 ds_read_b64_tr_b16 a[188:189], v246 offset:30784
 s_waitcnt vmcnt(18)
 v_mfma_f32_16x16x32_bf16 v[132:135], a[164:167], a[204:207], v[132:135]
 ds_read_b64_tr_b16 a[190:191], v246 offset:35904
 s_waitcnt lgkmcnt(8)
 v_mfma_f32_16x16x32_bf16 v[136:139], a[168:171], a[192:195], v[136:139]
 s_add_u32 s53, s30, s33
 s_add_u32 s33, s33, 1024
 s_and_b32 s33, s33, 0x3fff
 ds_read_b64_tr_b16 a[128:129], v245 offset:20608
 v_mfma_f32_16x16x32_bf16 v[136:139], a[172:175], a[200:203], v[136:139]
 ds_read_b64_tr_b16 a[130:131], v245 offset:25728
 s_add_u32 m0, s38, 86016
 v_mfma_f32_16x16x32_bf16 v[140:143], a[168:171], a[196:199], v[140:143]
 ds_read_b64_tr_b16 a[132:133], v245 offset:30848
 v_mfma_f32_16x16x32_bf16 v[140:143], a[172:175], a[204:207], v[140:143]
 ds_read_b64_tr_b16 a[134:135], v245 offset:35968
 s_waitcnt lgkmcnt(8)
 v_mfma_f32_16x16x32_bf16 v[144:147], a[176:179], a[192:195], v[144:147]
 ds_read_b64_tr_b16 a[136:137], v246 offset:20608
 buffer_load_dwordx4 v247, s[8:11], s55 offen lds
 buffer_load_dwordx4 a[240:243], v252, s[4:7], s53 offen sc1
 v_mfma_f32_16x16x32_bf16 v[144:147], a[180:183], a[200:203], v[144:147]
 ds_read_b64_tr_b16 a[138:139], v246 offset:25728
 v_mfma_f32_16x16x32_bf16 v[148:151], a[176:179], a[196:199], v[148:151]
 ds_read_b64_tr_b16 a[140:141], v246 offset:30848
 v_mfma_f32_16x16x32_bf16 v[148:151], a[180:183], a[204:207], v[148:151]
 ds_read_b64_tr_b16 a[142:143], v246 offset:35968
 s_waitcnt lgkmcnt(8)
 s_add_u32 m0, s38, 87040
 v_mfma_f32_16x16x32_bf16 v[152:155], a[184:187], a[192:195], v[152:155]
 ds_read_b64_tr_b16 a[144:145], v245 offset:20672
 v_mfma_f32_16x16x32_bf16 v[152:155], a[188:191], a[200:203], v[152:155]
 ds_read_b64_tr_b16 a[146:147], v245 offset:25792
 buffer_load_dwordx4 a[244:247], v253, s[4:7], s53 offen sc1
 v_mfma_f32_16x16x32_bf16 v[156:159], a[184:187], a[196:199], v[156:159]
 ds_read_b64_tr_b16 a[148:149], v245 offset:30912
 buffer_load_dwordx4 v248, s[8:11], s55 offen lds
 v_mfma_f32_16x16x32_bf16 v[156:159], a[188:191], a[204:207], v[156:159]
 ds_read_b64_tr_b16 a[150:151], v245 offset:36032
 s_waitcnt lgkmcnt(8)
 v_mfma_f32_16x16x32_bf16 v[160:163], a[128:131], a[192:195], v[160:163]
 ds_read_b64_tr_b16 a[152:153], v246 offset:20672
 v_mfma_f32_16x16x32_bf16 v[160:163], a[132:135], a[200:203], v[160:163]
 ds_read_b64_tr_b16 a[154:155], v246 offset:25792
 s_add_u32 m0, s38, 88064
 v_mfma_f32_16x16x32_bf16 v[164:167], a[128:131], a[196:199], v[164:167]
 ds_read_b64_tr_b16 a[156:157], v246 offset:30912
 v_mfma_f32_16x16x32_bf16 v[164:167], a[132:135], a[204:207], v[164:167]
 ds_read_b64_tr_b16 a[158:159], v246 offset:36032
 s_waitcnt lgkmcnt(8)
 v_mfma_f32_16x16x32_bf16 v[168:171], a[136:139], a[192:195], v[168:171]
 ds_read_b64_tr_b16 a[160:161], v245 offset:20736
 buffer_load_dwordx4 v249, s[8:11], s55 offen lds
 v_mfma_f32_16x16x32_bf16 v[168:171], a[140:143], a[200:203], v[168:171]
 ds_read_b64_tr_b16 a[162:163], v245 offset:25856
 v_mfma_f32_16x16x32_bf16 v[172:175], a[136:139], a[196:199], v[172:175]
 ds_read_b64_tr_b16 a[164:165], v245 offset:30976
 v_mfma_f32_16x16x32_bf16 v[172:175], a[140:143], a[204:207], v[172:175]
 ds_read_b64_tr_b16 a[166:167], v245 offset:36096
 s_waitcnt lgkmcnt(8)
 s_add_u32 m0, s38, 89088
 v_mfma_f32_16x16x32_bf16 v[176:179], a[144:147], a[192:195], v[176:179]
 s_add_u32 s53, s30, s33
 s_add_u32 s33, s33, 1024
 s_and_b32 s33, s33, 0x3fff
 ds_read_b64_tr_b16 a[168:169], v246 offset:20736
 v_mfma_f32_16x16x32_bf16 v[176:179], a[148:151], a[200:203], v[176:179]
 ds_read_b64_tr_b16 a[170:171], v246 offset:25856
 v_mfma_f32_16x16x32_bf16 v[180:183], a[144:147], a[196:199], v[180:183]
 s_waitcnt vmcnt(15)
 s_barrier
 ds_read_b64_tr_b16 a[172:173], v246 offset:30976
 buffer_load_dwordx4 v250, s[8:11], s55 offen lds
 v_mfma_f32_16x16x32_bf16 v[180:183], a[148:151], a[204:207], v[180:183]
 ds_read_b64_tr_b16 a[174:175], v246 offset:36096
 s_waitcnt lgkmcnt(8)
 v_mfma_f32_16x16x32_bf16 v[184:187], a[152:155], a[192:195], v[184:187]
 ds_read_b64_tr_b16 a[176:177], v245 offset:40960
 buffer_load_dwordx4 a[248:251], v252, s[4:7], s53 offen sc1
 v_mfma_f32_16x16x32_bf16 v[184:187], a[156:159], a[200:203], v[184:187]
 ds_read_b64_tr_b16 a[178:179], v245 offset:46080
 s_add_u32 m0, s38, 90112
 v_mfma_f32_16x16x32_bf16 v[188:191], a[152:155], a[196:199], v[188:191]
 ds_read_b64_tr_b16 a[180:181], v245 offset:51200
 v_mfma_f32_16x16x32_bf16 v[188:191], a[156:159], a[204:207], v[188:191]
 ds_read_b64_tr_b16 a[182:183], v245 offset:56320
 s_waitcnt lgkmcnt(8)
 v_mfma_f32_16x16x32_bf16 v[192:195], a[160:163], a[192:195], v[192:195]
 ds_read_b64_tr_b16 a[184:185], v246 offset:40960
 buffer_load_dwordx4 v251, s[8:11], s55 offen lds
 v_mfma_f32_16x16x32_bf16 v[192:195], a[164:167], a[200:203], v[192:195]
 ds_read_b64_tr_b16 a[186:187], v246 offset:46080
 buffer_load_dwordx4 a[252:255], v253, s[4:7], s53 offen sc1
 v_mfma_f32_16x16x32_bf16 v[196:199], a[160:163], a[196:199], v[196:199]
 ds_read_b64_tr_b16 a[188:189], v246 offset:51200
 v_mfma_f32_16x16x32_bf16 v[196:199], a[164:167], a[204:207], v[196:199]
 s_add_u32 s32, s32, 1
 s_and_b32 s32, s32, 7
 ds_read_b64_tr_b16 a[190:191], v246 offset:56320
 s_waitcnt lgkmcnt(8)
 v_mfma_f32_16x16x32_bf16 v[200:203], a[168:171], a[192:195], v[200:203]
 ds_read_b64_tr_b16 a[128:129], v245 offset:41024
 v_mfma_f32_16x16x32_bf16 v[200:203], a[172:175], a[200:203], v[200:203]
 ds_read_b64_tr_b16 a[130:131], v245 offset:46144
 v_mfma_f32_16x16x32_bf16 v[204:207], a[168:171], a[196:199], v[204:207]
 ds_read_b64_tr_b16 a[132:133], v245 offset:51264
 v_mfma_f32_16x16x32_bf16 v[204:207], a[172:175], a[204:207], v[204:207]
 ds_read_b64_tr_b16 a[134:135], v245 offset:56384
 s_waitcnt lgkmcnt(8)
 v_mfma_f32_16x16x32_bf16 v[128:131], a[176:179], a[208:211], v[128:131]
 ds_read_b64_tr_b16 a[136:137], v246 offset:41024
 v_mfma_f32_16x16x32_bf16 v[128:131], a[180:183], a[216:219], v[128:131]
 ds_read_b64_tr_b16 a[138:139], v246 offset:46144
 v_mfma_f32_16x16x32_bf16 v[132:135], a[176:179], a[212:215], v[132:135]
 s_mul_i32 s55, s32, 81920
 s_add_u32 s55, s55, s28
 ds_read_b64_tr_b16 a[140:141], v246 offset:51264
 s_waitcnt vmcnt(18)
 v_mfma_f32_16x16x32_bf16 v[132:135], a[180:183], a[220:223], v[132:135]
 ds_read_b64_tr_b16 a[142:143], v246 offset:56384
 s_waitcnt lgkmcnt(8)
 v_mfma_f32_16x16x32_bf16 v[136:139], a[184:187], a[208:211], v[136:139]
 s_add_u32 s53, s30, s33
 s_add_u32 s33, s33, 1024
 s_and_b32 s33, s33, 0x3fff
 ds_read_b64_tr_b16 a[144:145], v245 offset:41088
 v_mfma_f32_16x16x32_bf16 v[136:139], a[188:191], a[216:219], v[136:139]
 ds_read_b64_tr_b16 a[146:147], v245 offset:46208
 s_add_u32 m0, s38, 106496
 v_mfma_f32_16x16x32_bf16 v[140:143], a[184:187], a[212:215], v[140:143]
 ds_read_b64_tr_b16 a[148:149], v245 offset:51328
 v_mfma_f32_16x16x32_bf16 v[140:143], a[188:191], a[220:223], v[140:143]
 ds_read_b64_tr_b16 a[150:151], v245 offset:56448
 s_waitcnt lgkmcnt(8)
 v_mfma_f32_16x16x32_bf16 v[144:147], a[128:131], a[208:211], v[144:147]
 ds_read_b64_tr_b16 a[152:153], v246 offset:41088
 buffer_load_dwordx4 v247, s[8:11], s55 offen lds
 buffer_load_dwordx4 a[192:195], v252, s[4:7], s53 offen sc1
 v_mfma_f32_16x16x32_bf16 v[144:147], a[132:135], a[216:219], v[144:147]
 ds_read_b64_tr_b16 a[154:155], v246 offset:46208
 v_mfma_f32_16x16x32_bf16 v[148:151], a[128:131], a[212:215], v[148:151]
 ds_read_b64_tr_b16 a[156:157], v246 offset:51328
 v_mfma_f32_16x16x32_bf16 v[148:151], a[132:135], a[220:223], v[148:151]
 ds_read_b64_tr_b16 a[158:159], v246 offset:56448
 s_waitcnt lgkmcnt(8)
 s_add_u32 m0, s38, 107520
 v_mfma_f32_16x16x32_bf16 v[152:155], a[136:139], a[208:211], v[152:155]
 ds_read_b64_tr_b16 a[160:161], v245 offset:41152
 v_mfma_f32_16x16x32_bf16 v[152:155], a[140:143], a[216:219], v[152:155]
 ds_read_b64_tr_b16 a[162:163], v245 offset:46272
 buffer_load_dwordx4 a[196:199], v253, s[4:7], s53 offen sc1
 v_mfma_f32_16x16x32_bf16 v[156:159], a[136:139], a[212:215], v[156:159]
 ds_read_b64_tr_b16 a[164:165], v245 offset:51392
 buffer_load_dwordx4 v248, s[8:11], s55 offen lds
 v_mfma_f32_16x16x32_bf16 v[156:159], a[140:143], a[220:223], v[156:159]
 ds_read_b64_tr_b16 a[166:167], v245 offset:56512
 s_waitcnt lgkmcnt(8)
 v_mfma_f32_16x16x32_bf16 v[160:163], a[144:147], a[208:211], v[160:163]
 s_add_u32 s53, s30, s33
 s_add_u32 s33, s33, 1024
 s_and_b32 s33, s33, 0x3fff
 ds_read_b64_tr_b16 a[168:169], v246 offset:41152
 v_mfma_f32_16x16x32_bf16 v[160:163], a[148:151], a[216:219], v[160:163]
 ds_read_b64_tr_b16 a[170:171], v246 offset:46272
 s_add_u32 m0, s38, 108544
 buffer_load_dwordx4 a[200:203], v252, s[4:7], s53 offen sc1
 v_mfma_f32_16x16x32_bf16 v[164:167], a[144:147], a[212:215], v[164:167]
 ds_read_b64_tr_b16 a[172:173], v246 offset:51392
 buffer_load_dwordx4 a[204:207], v253, s[4:7], s53 offen sc1
 v_mfma_f32_16x16x32_bf16 v[164:167], a[148:151], a[220:223], v[164:167]
 ds_read_b64_tr_b16 a[174:175], v246 offset:56512
 s_waitcnt lgkmcnt(8)
 v_mfma_f32_16x16x32_bf16 v[168:171], a[152:155], a[208:211], v[168:171]
 ds_read_b64_tr_b16 a[176:177], v245 offset:41216
 buffer_load_dwordx4 v249, s[8:11], s55 offen lds
 v_mfma_f32_16x16x32_bf16 v[168:171], a[156:159], a[216:219], v[168:171]
 ds_read_b64_tr_b16 a[178:179], v245 offset:46336
 v_mfma_f32_16x16x32_bf16 v[172:175], a[152:155], a[212:215], v[172:175]
 ds_read_b64_tr_b16 a[180:181], v245 offset:51456
 v_mfma_f32_16x16x32_bf16 v[172:175], a[156:159], a[220:223], v[172:175]
 ds_read_b64_tr_b16 a[182:183], v245 offset:56576
 s_waitcnt lgkmcnt(8)
 s_add_u32 m0, s38, 109568
 v_mfma_f32_16x16x32_bf16 v[176:179], a[160:163], a[208:211], v[176:179]
 ds_read_b64_tr_b16 a[184:185], v246 offset:41216
 v_mfma_f32_16x16x32_bf16 v[176:179], a[164:167], a[216:219], v[176:179]
 ds_read_b64_tr_b16 a[186:187], v246 offset:46336
 v_mfma_f32_16x16x32_bf16 v[180:183], a[160:163], a[212:215], v[180:183]
 s_waitcnt vmcnt(17)
 s_barrier
 ds_read_b64_tr_b16 a[188:189], v246 offset:51456
 buffer_load_dwordx4 v250, s[8:11], s55 offen lds
 v_mfma_f32_16x16x32_bf16 v[180:183], a[164:167], a[220:223], v[180:183]
 ds_read_b64_tr_b16 a[190:191], v246 offset:56576
 s_waitcnt lgkmcnt(8)
 v_mfma_f32_16x16x32_bf16 v[184:187], a[168:171], a[208:211], v[184:187]
 v_xor_b32 v245, 0x10000, v245
 ds_read_b64_tr_b16 a[128:129], v245
 v_mfma_f32_16x16x32_bf16 v[184:187], a[172:175], a[216:219], v[184:187]
 ds_read_b64_tr_b16 a[130:131], v245 offset:5120
 s_add_u32 m0, s38, 110592
 v_mfma_f32_16x16x32_bf16 v[188:191], a[168:171], a[212:215], v[188:191]
 ds_read_b64_tr_b16 a[132:133], v245 offset:10240
 v_mfma_f32_16x16x32_bf16 v[188:191], a[172:175], a[220:223], v[188:191]
 ds_read_b64_tr_b16 a[134:135], v245 offset:15360
 s_waitcnt lgkmcnt(8)
 v_mfma_f32_16x16x32_bf16 v[192:195], a[176:179], a[208:211], v[192:195]
 v_xor_b32 v246, 0x10000, v246
 ds_read_b64_tr_b16 a[136:137], v246
 buffer_load_dwordx4 v251, s[8:11], s55 offen lds
 v_mfma_f32_16x16x32_bf16 v[192:195], a[180:183], a[216:219], v[192:195]
 ds_read_b64_tr_b16 a[138:139], v246 offset:5120
 v_mfma_f32_16x16x32_bf16 v[196:199], a[176:179], a[212:215], v[196:199]
 ds_read_b64_tr_b16 a[140:141], v246 offset:10240
 v_mfma_f32_16x16x32_bf16 v[196:199], a[180:183], a[220:223], v[196:199]
 s_add_u32 s32, s32, 1
 s_and_b32 s32, s32, 7
 ds_read_b64_tr_b16 a[142:143], v246 offset:15360
 s_waitcnt lgkmcnt(8)
 v_mfma_f32_16x16x32_bf16 v[200:203], a[184:187], a[208:211], v[200:203]
 ds_read_b64_tr_b16 a[144:145], v245 offset:64
 v_mfma_f32_16x16x32_bf16 v[200:203], a[188:191], a[216:219], v[200:203]
 ds_read_b64_tr_b16 a[146:147], v245 offset:5184
 v_mfma_f32_16x16x32_bf16 v[204:207], a[184:187], a[212:215], v[204:207]
 ds_read_b64_tr_b16 a[148:149], v245 offset:10304
 v_mfma_f32_16x16x32_bf16 v[204:207], a[188:191], a[220:223], v[204:207]
 ds_read_b64_tr_b16 a[150:151], v245 offset:15424
 s_waitcnt lgkmcnt(8)
 v_mfma_f32_16x16x32_bf16 v[128:131], a[128:131], a[224:227], v[128:131]
 ds_read_b64_tr_b16 a[152:153], v246 offset:64
 v_mfma_f32_16x16x32_bf16 v[128:131], a[132:135], a[232:235], v[128:131]
 ds_read_b64_tr_b16 a[154:155], v246 offset:5184
 v_mfma_f32_16x16x32_bf16 v[132:135], a[128:131], a[228:231], v[132:135]
 s_mul_i32 s55, s32, 81920
 s_add_u32 s55, s55, s28
 ds_read_b64_tr_b16 a[156:157], v246 offset:10304
 s_waitcnt vmcnt(18)
 v_mfma_f32_16x16x32_bf16 v[132:135], a[132:135], a[236:239], v[132:135]
 ds_read_b64_tr_b16 a[158:159], v246 offset:15424
 s_waitcnt lgkmcnt(8)
 v_mfma_f32_16x16x32_bf16 v[136:139], a[136:139], a[224:227], v[136:139]
 s_add_u32 s53, s30, s33
 s_add_u32 s33, s33, 1024
 s_and_b32 s33, s33, 0x3fff
 ds_read_b64_tr_b16 a[160:161], v245 offset:128
 v_mfma_f32_16x16x32_bf16 v[136:139], a[140:143], a[232:235], v[136:139]
 ds_read_b64_tr_b16 a[162:163], v245 offset:5248
 s_add_u32 m0, s38, 0
 v_mfma_f32_16x16x32_bf16 v[140:143], a[136:139], a[228:231], v[140:143]
 ds_read_b64_tr_b16 a[164:165], v245 offset:10368
 v_mfma_f32_16x16x32_bf16 v[140:143], a[140:143], a[236:239], v[140:143]
 ds_read_b64_tr_b16 a[166:167], v245 offset:15488
 s_waitcnt lgkmcnt(8)
 v_mfma_f32_16x16x32_bf16 v[144:147], a[144:147], a[224:227], v[144:147]
 ds_read_b64_tr_b16 a[168:169], v246 offset:128
 buffer_load_dwordx4 v247, s[8:11], s55 offen lds
 buffer_load_dwordx4 a[208:211], v252, s[4:7], s53 offen sc1
 v_mfma_f32_16x16x32_bf16 v[144:147], a[148:151], a[232:235], v[144:147]
 ds_read_b64_tr_b16 a[170:171], v246 offset:5248
 v_mfma_f32_16x16x32_bf16 v[148:151], a[144:147], a[228:231], v[148:151]
 ds_read_b64_tr_b16 a[172:173], v246 offset:10368
 v_mfma_f32_16x16x32_bf16 v[148:151], a[148:151], a[236:239], v[148:151]
 ds_read_b64_tr_b16 a[174:175], v246 offset:15488
 s_waitcnt lgkmcnt(8)
 s_add_u32 m0, s38, 1024
 v_mfma_f32_16x16x32_bf16 v[152:155], a[152:155], a[224:227], v[152:155]
 ds_read_b64_tr_b16 a[176:177], v245 offset:192
 v_mfma_f32_16x16x32_bf16 v[152:155], a[156:159], a[232:235], v[152:155]
 ds_read_b64_tr_b16 a[178:179], v245 offset:5312
 buffer_load_dwordx4 a[212:215], v253, s[4:7], s53 offen sc1
 v_mfma_f32_16x16x32_bf16 v[156:159], a[152:155], a[228:231], v[156:159]
 ds_read_b64_tr_b16 a[180:181], v245 offset:10432
 buffer_load_dwordx4 v248, s[8:11], s55 offen lds
 v_mfma_f32_16x16x32_bf16 v[156:159], a[156:159], a[236:239], v[156:159]
 ds_read_b64_tr_b16 a[182:183], v245 offset:15552
 s_waitcnt lgkmcnt(8)
 v_mfma_f32_16x16x32_bf16 v[160:163], a[160:163], a[224:227], v[160:163]
 s_add_u32 s53, s30, s33
 s_add_u32 s33, s33, 1024
 s_and_b32 s33, s33, 0x3fff
 ds_read_b64_tr_b16 a[184:185], v246 offset:192
 v_mfma_f32_16x16x32_bf16 v[160:163], a[164:167], a[232:235], v[160:163]
 ds_read_b64_tr_b16 a[186:187], v246 offset:5312
 s_add_u32 m0, s38, 2048
 buffer_load_dwordx4 a[216:219], v252, s[4:7], s53 offen sc1
 v_mfma_f32_16x16x32_bf16 v[164:167], a[160:163], a[228:231], v[164:167]
 ds_read_b64_tr_b16 a[188:189], v246 offset:10432
 buffer_load_dwordx4 a[220:223], v253, s[4:7], s53 offen sc1
 v_mfma_f32_16x16x32_bf16 v[164:167], a[164:167], a[236:239], v[164:167]
 ds_read_b64_tr_b16 a[190:191], v246 offset:15552
 s_waitcnt lgkmcnt(8)
 v_mfma_f32_16x16x32_bf16 v[168:171], a[168:171], a[224:227], v[168:171]
 ds_read_b64_tr_b16 a[128:129], v245 offset:256
 buffer_load_dwordx4 v249, s[8:11], s55 offen lds
 v_mfma_f32_16x16x32_bf16 v[168:171], a[172:175], a[232:235], v[168:171]
 ds_read_b64_tr_b16 a[130:131], v245 offset:5376
 v_mfma_f32_16x16x32_bf16 v[172:175], a[168:171], a[228:231], v[172:175]
 ds_read_b64_tr_b16 a[132:133], v245 offset:10496
 v_mfma_f32_16x16x32_bf16 v[172:175], a[172:175], a[236:239], v[172:175]
 ds_read_b64_tr_b16 a[134:135], v245 offset:15616
 s_waitcnt lgkmcnt(8)
 s_add_u32 m0, s38, 3072
 v_mfma_f32_16x16x32_bf16 v[176:179], a[176:179], a[224:227], v[176:179]
 ds_read_b64_tr_b16 a[136:137], v246 offset:256
 v_mfma_f32_16x16x32_bf16 v[176:179], a[180:183], a[232:235], v[176:179]
 ds_read_b64_tr_b16 a[138:139], v246 offset:5376
 v_mfma_f32_16x16x32_bf16 v[180:183], a[176:179], a[228:231], v[180:183]
 s_waitcnt vmcnt(17)
 s_barrier
 ds_read_b64_tr_b16 a[140:141], v246 offset:10496
 buffer_load_dwordx4 v250, s[8:11], s55 offen lds
 v_mfma_f32_16x16x32_bf16 v[180:183], a[180:183], a[236:239], v[180:183]
 ds_read_b64_tr_b16 a[142:143], v246 offset:15616
 s_waitcnt lgkmcnt(8)
 v_mfma_f32_16x16x32_bf16 v[184:187], a[184:187], a[224:227], v[184:187]
 ds_read_b64_tr_b16 a[144:145], v245 offset:20480
 v_mfma_f32_16x16x32_bf16 v[184:187], a[188:191], a[232:235], v[184:187]
 ds_read_b64_tr_b16 a[146:147], v245 offset:25600
 s_add_u32 m0, s38, 4096
 v_mfma_f32_16x16x32_bf16 v[188:191], a[184:187], a[228:231], v[188:191]
 ds_read_b64_tr_b16 a[148:149], v245 offset:30720
 v_mfma_f32_16x16x32_bf16 v[188:191], a[188:191], a[236:239], v[188:191]
 ds_read_b64_tr_b16 a[150:151], v245 offset:35840
 s_waitcnt lgkmcnt(8)
 v_mfma_f32_16x16x32_bf16 v[192:195], a[128:131], a[224:227], v[192:195]
 ds_read_b64_tr_b16 a[152:153], v246 offset:20480
 buffer_load_dwordx4 v251, s[8:11], s55 offen lds
 v_mfma_f32_16x16x32_bf16 v[192:195], a[132:135], a[232:235], v[192:195]
 ds_read_b64_tr_b16 a[154:155], v246 offset:25600
 v_mfma_f32_16x16x32_bf16 v[196:199], a[128:131], a[228:231], v[196:199]
 ds_read_b64_tr_b16 a[156:157], v246 offset:30720
 v_mfma_f32_16x16x32_bf16 v[196:199], a[132:135], a[236:239], v[196:199]
 s_add_u32 s32, s32, 1
 s_and_b32 s32, s32, 7
 ds_read_b64_tr_b16 a[158:159], v246 offset:35840
 s_waitcnt lgkmcnt(8)
 v_mfma_f32_16x16x32_bf16 v[200:203], a[136:139], a[224:227], v[200:203]
 ds_read_b64_tr_b16 a[160:161], v245 offset:20544
 v_mfma_f32_16x16x32_bf16 v[200:203], a[140:143], a[232:235], v[200:203]
 ds_read_b64_tr_b16 a[162:163], v245 offset:25664
 v_mfma_f32_16x16x32_bf16 v[204:207], a[136:139], a[228:231], v[204:207]
 ds_read_b64_tr_b16 a[164:165], v245 offset:30784
 v_mfma_f32_16x16x32_bf16 v[204:207], a[140:143], a[236:239], v[204:207]
 ds_read_b64_tr_b16 a[166:167], v245 offset:35904
 s_waitcnt lgkmcnt(8)
 v_mfma_f32_16x16x32_bf16 v[128:131], a[144:147], a[240:243], v[128:131]
 ds_read_b64_tr_b16 a[168:169], v246 offset:20544
 s_mov_b32 s16, s94
 v_mfma_f32_16x16x32_bf16 v[128:131], a[148:151], a[248:251], v[128:131]
 ds_read_b64_tr_b16 a[170:171], v246 offset:25664
 s_mov_b32 s17, s95
 v_mfma_f32_16x16x32_bf16 v[132:135], a[144:147], a[244:247], v[132:135]
 s_mul_i32 s55, s32, 81920
 s_add_u32 s55, s55, s28
 ds_read_b64_tr_b16 a[172:173], v246 offset:30784
 s_mov_b32 s18, 1280
 s_waitcnt vmcnt(18)
 v_mfma_f32_16x16x32_bf16 v[132:135], a[148:151], a[252:255], v[132:135]
 ds_read_b64_tr_b16 a[174:175], v246 offset:35904
 s_waitcnt lgkmcnt(8)
 s_mov_b32 s19, 0x20000
 v_mfma_f32_16x16x32_bf16 v[136:139], a[152:155], a[240:243], v[136:139]
 s_add_u32 s53, s30, s33
 s_add_u32 s33, s33, 1024
 s_and_b32 s33, s33, 0x3fff
 ds_read_b64_tr_b16 a[176:177], v245 offset:20608
 v_mfma_f32_16x16x32_bf16 v[136:139], a[156:159], a[248:251], v[136:139]
 ds_read_b64_tr_b16 a[178:179], v245 offset:25728
 s_add_u32 m0, s38, 20480
 s_mov_b32 s26, 2621440
 v_mfma_f32_16x16x32_bf16 v[140:143], a[152:155], a[244:247], v[140:143]
 ds_read_b64_tr_b16 a[180:181], v245 offset:30848
 s_mov_b32 s27, 0x20000
 v_mfma_f32_16x16x32_bf16 v[140:143], a[156:159], a[252:255], v[140:143]
 ds_read_b64_tr_b16 a[182:183], v245 offset:35968
 v_and_b32 v20, 15, v0
 s_waitcnt lgkmcnt(8)
 v_mfma_f32_16x16x32_bf16 v[144:147], a[160:163], a[240:243], v[144:147]
 ds_read_b64_tr_b16 a[184:185], v246 offset:20608
 v_lshrrev_b32 v21, 4, v0
 buffer_load_dwordx4 v247, s[8:11], s55 offen lds
 buffer_load_dwordx4 a[224:227], v252, s[4:7], s53 offen sc1
 v_mfma_f32_16x16x32_bf16 v[144:147], a[164:167], a[248:251], v[144:147]
 ds_read_b64_tr_b16 a[186:187], v246 offset:25728
 v_lshlrev_b32 v21, 3, v21
 v_mfma_f32_16x16x32_bf16 v[148:151], a[160:163], a[244:247], v[148:151]
 ds_read_b64_tr_b16 a[188:189], v246 offset:30848
 v_mul_u32_u24 v20, 1280, v20
 v_mfma_f32_16x16x32_bf16 v[148:151], a[164:167], a[252:255], v[148:151]
 ds_read_b64_tr_b16 a[190:191], v246 offset:35968
 v_add_u32 v20, v20, v21
 s_waitcnt lgkmcnt(8)
 s_add_u32 m0, s38, 21504
 v_mfma_f32_16x16x32_bf16 v[152:155], a[168:171], a[240:243], v[152:155]
 ds_read_b64_tr_b16 a[128:129], v245 offset:20672
 s_sub_u32 s67, 15, s48
 v_mfma_f32_16x16x32_bf16 v[152:155], a[172:175], a[248:251], v[152:155]
 ds_read_b64_tr_b16 a[130:131], v245 offset:25792
 buffer_load_dwordx4 a[228:231], v253, s[4:7], s53 offen sc1
 v_mfma_f32_16x16x32_bf16 v[156:159], a[168:171], a[244:247], v[156:159]
 ds_read_b64_tr_b16 a[132:133], v245 offset:30912
 buffer_load_dwordx4 v248, s[8:11], s55 offen lds
 v_mfma_f32_16x16x32_bf16 v[156:159], a[172:175], a[252:255], v[156:159]
 ds_read_b64_tr_b16 a[134:135], v245 offset:36032
 s_waitcnt lgkmcnt(8)
 v_mfma_f32_16x16x32_bf16 v[160:163], a[176:179], a[240:243], v[160:163]
 s_add_u32 s53, s30, s33
 s_add_u32 s33, s33, 1024
 s_and_b32 s33, s33, 0x3fff
 ds_read_b64_tr_b16 a[136:137], v246 offset:20672
 v_mfma_f32_16x16x32_bf16 v[160:163], a[180:183], a[248:251], v[160:163]
 ds_read_b64_tr_b16 a[138:139], v246 offset:25792
 s_add_u32 m0, s38, 22528
 buffer_load_dwordx4 a[232:235], v252, s[4:7], s53 offen sc1
 v_mfma_f32_16x16x32_bf16 v[164:167], a[176:179], a[244:247], v[164:167]
 ds_read_b64_tr_b16 a[140:141], v246 offset:30912
 buffer_load_dwordx4 a[236:239], v253, s[4:7], s53 offen sc1
 v_mfma_f32_16x16x32_bf16 v[164:167], a[180:183], a[252:255], v[164:167]
 ds_read_b64_tr_b16 a[142:143], v246 offset:36032
 s_waitcnt lgkmcnt(8)
 v_mfma_f32_16x16x32_bf16 v[168:171], a[184:187], a[240:243], v[168:171]
 ds_read_b64_tr_b16 a[144:145], v245 offset:20736
 buffer_load_dwordx4 v249, s[8:11], s55 offen lds
 v_mfma_f32_16x16x32_bf16 v[168:171], a[188:191], a[248:251], v[168:171]
 s_bitcmp1_b32 s47, 2
 s_cselect_b32 s67, s48, s67
 s_cselect_b32 s66, 32, 0
 ds_read_b64_tr_b16 a[146:147], v245 offset:25856
 v_mfma_f32_16x16x32_bf16 v[172:175], a[184:187], a[244:247], v[172:175]
 ds_read_b64_tr_b16 a[148:149], v245 offset:30976
 s_lshl_b32 s67, s67, 3
 v_mfma_f32_16x16x32_bf16 v[172:175], a[188:191], a[252:255], v[172:175]
 ds_read_b64_tr_b16 a[150:151], v245 offset:36096
 s_waitcnt lgkmcnt(8)
 s_add_u32 m0, s38, 23552
 s_lshr_b32 s68, s47, 3
 v_mfma_f32_16x16x32_bf16 v[176:179], a[128:131], a[240:243], v[176:179]
 ds_read_b64_tr_b16 a[152:153], v246 offset:20736
 s_lshl_b32 s69, s68, 1
 v_mfma_f32_16x16x32_bf16 v[176:179], a[132:135], a[248:251], v[176:179]
 ds_read_b64_tr_b16 a[154:155], v246 offset:25856
 s_add_u32 s67, s67, s69
 v_mfma_f32_16x16x32_bf16 v[180:183], a[128:131], a[244:247], v[180:183]
 s_waitcnt vmcnt(16)
 s_barrier
 ds_read_b64_tr_b16 a[156:157], v246 offset:30976
 buffer_load_dwordx4 v250, s[8:11], s55 offen lds
 s_and_b32 s69, s47, 3
 v_mfma_f32_16x16x32_bf16 v[180:183], a[132:135], a[252:255], v[180:183]
 ds_read_b64_tr_b16 a[158:159], v246 offset:36096
 s_waitcnt lgkmcnt(8)
 s_lshl_b32 s70, s69, 3
 v_mfma_f32_16x16x32_bf16 v[184:187], a[136:139], a[240:243], v[184:187]
 ds_read_b64_tr_b16 a[160:161], v245 offset:40960
 s_add_u32 s66, s66, s70
 v_mfma_f32_16x16x32_bf16 v[184:187], a[140:143], a[248:251], v[184:187]
 ds_read_b64_tr_b16 a[162:163], v245 offset:46080
 s_add_u32 m0, s38, 24576
 s_add_u32 s66, s66, s48
 v_mfma_f32_16x16x32_bf16 v[188:191], a[136:139], a[244:247], v[188:191]
 ds_read_b64_tr_b16 a[164:165], v245 offset:51200
 s_mul_i32 s69, s69, 320
 v_mfma_f32_16x16x32_bf16 v[188:191], a[140:143], a[252:255], v[188:191]
 ds_read_b64_tr_b16 a[166:167], v245 offset:56320
 s_waitcnt lgkmcnt(8)
 s_lshl_b32 s70, s66, 2
 v_mfma_f32_16x16x32_bf16 v[192:195], a[144:147], a[240:243], v[192:195]
 ds_read_b64_tr_b16 a[168:169], v246 offset:40960
 buffer_load_dwordx4 v251, s[8:11], s55 offen lds
 s_add_u32 s70, s70, s68
 v_mfma_f32_16x16x32_bf16 v[192:195], a[148:151], a[248:251], v[192:195]
 ds_read_b64_tr_b16 a[170:171], v246 offset:46080
 s_mul_i32 s70, s70, 10240
 v_mfma_f32_16x16x32_bf16 v[196:199], a[144:147], a[244:247], v[196:199]
 ds_read_b64_tr_b16 a[172:173], v246 offset:51200
 s_add_u32 s70, s70, 75497472
 v_mfma_f32_16x16x32_bf16 v[196:199], a[148:151], a[252:255], v[196:199]
 s_add_u32 s32, s32, 1
 s_and_b32 s32, s32, 7
 ds_read_b64_tr_b16 a[174:175], v246 offset:56320
 s_waitcnt lgkmcnt(8)
 v_mfma_f32_16x16x32_bf16 v[200:203], a[152:155], a[240:243], v[200:203]
 ds_read_b64_tr_b16 a[176:177], v245 offset:41024
 s_lshl_b32 s66, s66, 7
 v_mfma_f32_16x16x32_bf16 v[200:203], a[156:159], a[248:251], v[200:203]
 ds_read_b64_tr_b16 a[178:179], v245 offset:46144
 s_add_u32 s66, s66, 3276800
 v_mfma_f32_16x16x32_bf16 v[204:207], a[152:155], a[244:247], v[204:207]
 ds_read_b64_tr_b16 a[180:181], v245 offset:51264
 s_add_u32 s54, s44, 0
 v_mfma_f32_16x16x32_bf16 v[204:207], a[156:159], a[252:255], v[204:207]
 ds_read_b64_tr_b16 a[182:183], v245 offset:56384
 s_waitcnt lgkmcnt(8)
 s_lshl_b32 s62, s54, 10
 v_mfma_f32_16x16x32_bf16 v[128:131], a[160:163], a[192:195], v[128:131]
 ds_read_b64_tr_b16 a[184:185], v246 offset:41024
 s_add_u32 s62, s62, s70
 v_mfma_f32_16x16x32_bf16 v[128:131], a[164:167], a[200:203], v[128:131]
 s_cmp_ge_u32 s54, 5
 s_cselect_b32 s52, 1, 0
 s_cselect_b32 s59, 5, 0
 ds_read_b64_tr_b16 a[186:187], v246 offset:46144
 v_mfma_f32_16x16x32_bf16 v[132:135], a[160:163], a[196:199], v[132:135]
 ds_read_b64_tr_b16 a[188:189], v246 offset:51264
 s_sub_u32 s59, s54, s59
 v_mfma_f32_16x16x32_bf16 v[132:135], a[164:167], a[204:207], v[132:135]
 ds_read_b64_tr_b16 a[190:191], v246 offset:56384
 s_waitcnt lgkmcnt(8)
 s_lshl_b32 s59, s59, 6
 v_mfma_f32_16x16x32_bf16 v[136:139], a[168:171], a[192:195], v[136:139]
 ds_read_b64_tr_b16 a[128:129], v245 offset:41088
 s_add_u32 s59, s59, s69
 v_mfma_f32_16x16x32_bf16 v[136:139], a[172:175], a[200:203], v[136:139]
 ds_read_b64_tr_b16 a[130:131], v245 offset:46208
 s_add_u32 s52, s52, s67
 v_mfma_f32_16x16x32_bf16 v[140:143], a[168:171], a[196:199], v[140:143]
 ds_read_b64_tr_b16 a[132:133], v245 offset:51328
 s_mul_i32 s56, s52, 20480
 v_mfma_f32_16x16x32_bf16 v[140:143], a[172:175], a[204:207], v[140:143]
 ds_read_b64_tr_b16 a[134:135], v245 offset:56448
 s_waitcnt lgkmcnt(8)
 s_add_u32 s56, s56, s59
 v_mfma_f32_16x16x32_bf16 v[144:147], a[176:179], a[192:195], v[144:147]
 ds_read_b64_tr_b16 a[136:137], v246 offset:41088
 buffer_load_dwordx2 v[64:65], v20, s[20:23], s56 offen
 v_mfma_f32_16x16x32_bf16 v[144:147], a[180:183], a[200:203], v[144:147]
 ds_read_b64_tr_b16 a[138:139], v246 offset:46208
 buffer_load_dwordx2 v[66:67], v20, s[20:23], s56 offen offset:32
 v_mfma_f32_16x16x32_bf16 v[148:151], a[176:179], a[196:199], v[148:151]
 ds_read_b64_tr_b16 a[140:141], v246 offset:51328
 buffer_load_dwordx2 v[68:69], v21, s[16:19], s59 offen
 v_mfma_f32_16x16x32_bf16 v[148:151], a[180:183], a[204:207], v[148:151]
 ds_read_b64_tr_b16 a[142:143], v246 offset:56448
 s_waitcnt lgkmcnt(8)
 buffer_load_dwordx2 v[70:71], v21, s[16:19], s59 offen offset:32
 v_mfma_f32_16x16x32_bf16 v[152:155], a[184:187], a[192:195], v[152:155]
 ds_read_b64_tr_b16 a[144:145], v245 offset:41152
 s_add_u32 s54, s44, 4
 v_mfma_f32_16x16x32_bf16 v[152:155], a[188:191], a[200:203], v[152:155]
 ds_read_b64_tr_b16 a[146:147], v245 offset:46272
 s_lshl_b32 s63, s54, 10
 v_mfma_f32_16x16x32_bf16 v[156:159], a[184:187], a[196:199], v[156:159]
 ds_read_b64_tr_b16 a[148:149], v245 offset:51392
 s_add_u32 s63, s63, s70
 v_mfma_f32_16x16x32_bf16 v[156:159], a[188:191], a[204:207], v[156:159]
 ds_read_b64_tr_b16 a[150:151], v245 offset:56512
 s_waitcnt lgkmcnt(8)
 v_mfma_f32_16x16x32_bf16 v[160:163], a[128:131], a[192:195], v[160:163]
 s_cmp_ge_u32 s54, 5
 s_cselect_b32 s52, 1, 0
 s_cselect_b32 s60, 5, 0
 ds_read_b64_tr_b16 a[152:153], v246 offset:41152
 v_mfma_f32_16x16x32_bf16 v[160:163], a[132:135], a[200:203], v[160:163]
 ds_read_b64_tr_b16 a[154:155], v246 offset:46272
 s_sub_u32 s60, s54, s60
 v_mfma_f32_16x16x32_bf16 v[164:167], a[128:131], a[196:199], v[164:167]
 ds_read_b64_tr_b16 a[156:157], v246 offset:51392
 s_lshl_b32 s60, s60, 6
 v_mfma_f32_16x16x32_bf16 v[164:167], a[132:135], a[204:207], v[164:167]
 ds_read_b64_tr_b16 a[158:159], v246 offset:56512
 s_waitcnt lgkmcnt(8)
 s_add_u32 s60, s60, s69
 v_mfma_f32_16x16x32_bf16 v[168:171], a[136:139], a[192:195], v[168:171]
 ds_read_b64_tr_b16 a[160:161], v245 offset:41216
 s_add_u32 s52, s52, s67
 v_mfma_f32_16x16x32_bf16 v[168:171], a[140:143], a[200:203], v[168:171]
 ds_read_b64_tr_b16 a[162:163], v245 offset:46336
 s_mul_i32 s57, s52, 20480
 v_mfma_f32_16x16x32_bf16 v[172:175], a[136:139], a[196:199], v[172:175]
 ds_read_b64_tr_b16 a[164:165], v245 offset:51456
 s_add_u32 s57, s57, s60
 v_mfma_f32_16x16x32_bf16 v[172:175], a[140:143], a[204:207], v[172:175]
 ds_read_b64_tr_b16 a[166:167], v245 offset:56576
 s_waitcnt lgkmcnt(8)
 buffer_load_dwordx2 v[72:73], v20, s[20:23], s57 offen
 v_mfma_f32_16x16x32_bf16 v[176:179], a[144:147], a[192:195], v[176:179]
 ds_read_b64_tr_b16 a[168:169], v246 offset:41216
 buffer_load_dwordx2 v[74:75], v20, s[20:23], s57 offen offset:32
 v_mfma_f32_16x16x32_bf16 v[176:179], a[148:151], a[200:203], v[176:179]
 ds_read_b64_tr_b16 a[170:171], v246 offset:46336
 buffer_load_dwordx2 v[76:77], v21, s[16:19], s60 offen
 v_mfma_f32_16x16x32_bf16 v[180:183], a[144:147], a[196:199], v[180:183]
 s_waitcnt vmcnt(7)
 s_barrier
 ds_read_b64_tr_b16 a[172:173], v246 offset:51456
 buffer_load_dwordx2 v[78:79], v21, s[16:19], s60 offen offset:32
 v_mfma_f32_16x16x32_bf16 v[180:183], a[148:151], a[204:207], v[180:183]
 ds_read_b64_tr_b16 a[174:175], v246 offset:56576
 s_waitcnt lgkmcnt(8)
 s_add_u32 s54, s44, 8
 v_mfma_f32_16x16x32_bf16 v[184:187], a[152:155], a[192:195], v[184:187]
 v_xor_b32 v245, 0x10000, v245
 ds_read_b64_tr_b16 a[176:177], v245
 s_lshl_b32 s64, s54, 10
 v_mfma_f32_16x16x32_bf16 v[184:187], a[156:159], a[200:203], v[184:187]
 ds_read_b64_tr_b16 a[178:179], v245 offset:5120
 s_add_u32 s64, s64, s70
 v_mfma_f32_16x16x32_bf16 v[188:191], a[152:155], a[196:199], v[188:191]
 s_cmp_ge_u32 s54, 5
 s_cselect_b32 s52, 1, 0
 s_cselect_b32 s61, 5, 0
 ds_read_b64_tr_b16 a[180:181], v245 offset:10240
 v_mfma_f32_16x16x32_bf16 v[188:191], a[156:159], a[204:207], v[188:191]
 ds_read_b64_tr_b16 a[182:183], v245 offset:15360
 s_waitcnt lgkmcnt(8)
 s_sub_u32 s61, s54, s61
 v_mfma_f32_16x16x32_bf16 v[192:195], a[160:163], a[192:195], v[192:195]
 ds_read_b64_tr_b16 a[184:185], v245 offset:20480
 s_lshl_b32 s61, s61, 6
 v_mfma_f32_16x16x32_bf16 v[192:195], a[164:167], a[200:203], v[192:195]
 ds_read_b64_tr_b16 a[186:187], v245 offset:25600
 s_add_u32 s61, s61, s69
 v_mfma_f32_16x16x32_bf16 v[196:199], a[160:163], a[196:199], v[196:199]
 ds_read_b64_tr_b16 a[188:189], v245 offset:30720
 s_add_u32 s52, s52, s67
 v_mfma_f32_16x16x32_bf16 v[196:199], a[164:167], a[204:207], v[196:199]
 ds_read_b64_tr_b16 a[190:191], v245 offset:35840
 s_waitcnt lgkmcnt(8)
 s_mul_i32 s58, s52, 20480
 v_mfma_f32_16x16x32_bf16 v[200:203], a[168:171], a[192:195], v[200:203]
 v_xor_b32 v246, 0x10000, v246
 ds_read_b64_tr_b16 a[128:129], v246
 s_add_u32 s58, s58, s61
 v_mfma_f32_16x16x32_bf16 v[200:203], a[172:175], a[200:203], v[200:203]
 s_cmp_lt_u32 s44, 2
 s_cselect_b32 s58, s58, s51
 s_cselect_b32 s64, s64, s51
 ds_read_b64_tr_b16 a[130:131], v246 offset:5120
 v_mfma_f32_16x16x32_bf16 v[204:207], a[168:171], a[196:199], v[204:207]
 ds_read_b64_tr_b16 a[132:133], v246 offset:10240
 buffer_load_dwordx2 v[80:81], v20, s[20:23], s58 offen
 v_mfma_f32_16x16x32_bf16 v[204:207], a[172:175], a[204:207], v[204:207]
 ds_read_b64_tr_b16 a[134:135], v246 offset:15360
 s_waitcnt lgkmcnt(8)
 buffer_load_dwordx2 v[82:83], v20, s[20:23], s58 offen offset:32
 v_mfma_f32_16x16x32_bf16 v[128:131], a[176:179], a[208:211], v[128:131]
 ds_read_b64_tr_b16 a[136:137], v246 offset:20480
 buffer_load_dwordx2 v[84:85], v21, s[16:19], s61 offen
 v_mfma_f32_16x16x32_bf16 v[128:131], a[180:183], a[216:219], v[128:131]
 ds_read_b64_tr_b16 a[138:139], v246 offset:25600
 buffer_load_dwordx2 v[86:87], v21, s[16:19], s61 offen offset:32
 v_mfma_f32_16x16x32_bf16 v[132:135], a[176:179], a[212:215], v[132:135]
 ds_read_b64_tr_b16 a[140:141], v246 offset:30720
 s_lshl_b32 s67, s68, 7
 v_mfma_f32_16x16x32_bf16 v[132:135], a[180:183], a[220:223], v[132:135]
 ds_read_b64_tr_b16 a[142:143], v246 offset:35840
 s_waitcnt lgkmcnt(8)
 s_lshl_b32 s68, s68, 2
 v_mfma_f32_16x16x32_bf16 v[128:131], a[184:187], a[224:227], v[128:131]
 ds_read_b64_tr_b16 a[144:145], v245 offset:64
 s_add_u32 s68, s68, s66
 v_mfma_f32_16x16x32_bf16 v[128:131], a[188:191], a[232:235], v[128:131]
 ds_read_b64_tr_b16 a[146:147], v245 offset:5184
 v_mov_b32 v24, v4
 v_mfma_f32_16x16x32_bf16 v[132:135], a[184:187], a[228:231], v[132:135]
 ds_read_b64_tr_b16 a[148:149], v245 offset:10304
 v_mfma_f32_16x16x32_bf16 v[132:135], a[188:191], a[236:239], v[132:135]
 ds_read_b64_tr_b16 a[150:151], v245 offset:15424
 s_waitcnt lgkmcnt(8)
 v_mfma_f32_16x16x32_bf16 v[136:139], a[128:131], a[208:211], v[136:139]
 ds_read_b64_tr_b16 a[152:153], v245 offset:20544
 v_mfma_f32_16x16x32_bf16 v[136:139], a[132:135], a[216:219], v[136:139]
 ds_read_b64_tr_b16 a[154:155], v245 offset:25664
 v_mfma_f32_16x16x32_bf16 v[140:143], a[128:131], a[212:215], v[140:143]
 ds_read_b64_tr_b16 a[156:157], v245 offset:30784
 v_mfma_f32_16x16x32_bf16 v[140:143], a[132:135], a[220:223], v[140:143]
 ds_read_b64_tr_b16 a[158:159], v245 offset:35904
 s_waitcnt lgkmcnt(8)
 v_mfma_f32_16x16x32_bf16 v[136:139], a[136:139], a[224:227], v[136:139]
 ds_read_b64_tr_b16 a[160:161], v246 offset:64
 v_mfma_f32_16x16x32_bf16 v[136:139], a[140:143], a[232:235], v[136:139]
 ds_read_b64_tr_b16 a[162:163], v246 offset:5184
 v_mfma_f32_16x16x32_bf16 v[140:143], a[136:139], a[228:231], v[140:143]
 ds_read_b64_tr_b16 a[164:165], v246 offset:10304
 v_mfma_f32_16x16x32_bf16 v[140:143], a[140:143], a[236:239], v[140:143]
 ds_read_b64_tr_b16 a[166:167], v246 offset:15424
 s_waitcnt lgkmcnt(8)
 v_mfma_f32_16x16x32_bf16 v[144:147], a[144:147], a[208:211], v[144:147]
 ds_read_b64_tr_b16 a[168:169], v246 offset:20544
 v_mfma_f32_16x16x32_bf16 v[144:147], a[148:151], a[216:219], v[144:147]
 ds_read_b64_tr_b16 a[170:171], v246 offset:25664
 v_mfma_f32_16x16x32_bf16 v[148:151], a[144:147], a[212:215], v[148:151]
 ds_read_b64_tr_b16 a[172:173], v246 offset:30784
 v_mfma_f32_16x16x32_bf16 v[148:151], a[148:151], a[220:223], v[148:151]
 ds_read_b64_tr_b16 a[174:175], v246 offset:35904
 s_waitcnt lgkmcnt(8)
 v_mfma_f32_16x16x32_bf16 v[144:147], a[152:155], a[224:227], v[144:147]
 ds_read_b64_tr_b16 a[176:177], v245 offset:128
 v_cvt_pk_bf16_f32 v128, v128, v129
 v_cvt_pk_bf16_f32 v129, v130, v131
 v_mfma_f32_16x16x32_bf16 v[144:147], a[156:159], a[232:235], v[144:147]
 ds_read_b64_tr_b16 a[178:179], v245 offset:5248
 v_cvt_pk_bf16_f32 v130, v136, v137
 v_cvt_pk_bf16_f32 v131, v138, v139
 v_mfma_f32_16x16x32_bf16 v[148:151], a[152:155], a[228:231], v[148:151]
 s_add_u32 s49, s34, 0
 buffer_store_dwordx4 v[128:131], v1, s[4:7], s49 offen sc1
 ds_read_b64_tr_b16 a[180:181], v245 offset:10368
 v_mfma_f32_16x16x32_bf16 v[148:151], a[156:159], a[236:239], v[148:151]
 ds_read_b64_tr_b16 a[182:183], v245 offset:15488
 v_cvt_pk_bf16_f32 v132, v132, v133
 s_waitcnt lgkmcnt(8)
 v_mfma_f32_16x16x32_bf16 v[152:155], a[160:163], a[208:211], v[152:155]
 ds_read_b64_tr_b16 a[184:185], v245 offset:20608
 v_cvt_pk_bf16_f32 v133, v134, v135
 v_cvt_pk_bf16_f32 v134, v140, v141
 v_mfma_f32_16x16x32_bf16 v[152:155], a[164:167], a[216:219], v[152:155]
 ds_read_b64_tr_b16 a[186:187], v245 offset:25728
 v_cvt_pk_bf16_f32 v135, v142, v143
 v_mfma_f32_16x16x32_bf16 v[156:159], a[160:163], a[212:215], v[156:159]
 s_add_u32 s49, s34, 5120
 buffer_store_dwordx4 v[132:135], v1, s[4:7], s49 offen sc1
 ds_read_b64_tr_b16 a[188:189], v245 offset:30848
 v_mfma_f32_16x16x32_bf16 v[156:159], a[164:167], a[220:223], v[156:159]
 ds_read_b64_tr_b16 a[190:191], v245 offset:35968
 s_waitcnt lgkmcnt(8)
 v_mfma_f32_16x16x32_bf16 v[152:155], a[168:171], a[224:227], v[152:155]
 ds_read_b64_tr_b16 a[128:129], v246 offset:128
 v_mfma_f32_16x16x32_bf16 v[152:155], a[172:175], a[232:235], v[152:155]
 ds_read_b64_tr_b16 a[130:131], v246 offset:5248
 v_mfma_f32_16x16x32_bf16 v[156:159], a[168:171], a[228:231], v[156:159]
 ds_read_b64_tr_b16 a[132:133], v246 offset:10368
 v_mfma_f32_16x16x32_bf16 v[156:159], a[172:175], a[236:239], v[156:159]
 ds_read_b64_tr_b16 a[134:135], v246 offset:15488
 s_waitcnt lgkmcnt(8)
 v_mfma_f32_16x16x32_bf16 v[160:163], a[176:179], a[208:211], v[160:163]
 ds_read_b64_tr_b16 a[136:137], v246 offset:20608
 v_mfma_f32_16x16x32_bf16 v[160:163], a[180:183], a[216:219], v[160:163]
 ds_read_b64_tr_b16 a[138:139], v246 offset:25728
 v_mfma_f32_16x16x32_bf16 v[164:167], a[176:179], a[212:215], v[164:167]
 ds_read_b64_tr_b16 a[140:141], v246 offset:30848
 v_mfma_f32_16x16x32_bf16 v[164:167], a[180:183], a[220:223], v[164:167]
 ds_read_b64_tr_b16 a[142:143], v246 offset:35968
 s_waitcnt lgkmcnt(8)
 v_mfma_f32_16x16x32_bf16 v[160:163], a[184:187], a[224:227], v[160:163]
 ds_read_b64_tr_b16 a[144:145], v245 offset:192
 v_cvt_pk_bf16_f32 v144, v144, v145
 v_cvt_pk_bf16_f32 v145, v146, v147
 v_mfma_f32_16x16x32_bf16 v[160:163], a[188:191], a[232:235], v[160:163]
 ds_read_b64_tr_b16 a[146:147], v245 offset:5312
 v_cvt_pk_bf16_f32 v146, v152, v153
 v_cvt_pk_bf16_f32 v147, v154, v155
 v_mfma_f32_16x16x32_bf16 v[164:167], a[184:187], a[228:231], v[164:167]
 s_add_u32 s49, s34, 1024
 buffer_store_dwordx4 v[144:147], v1, s[4:7], s49 offen sc1
 ds_read_b64_tr_b16 a[148:149], v245 offset:10432
 v_mfma_f32_16x16x32_bf16 v[164:167], a[188:191], a[236:239], v[164:167]
 ds_read_b64_tr_b16 a[150:151], v245 offset:15552
 v_cvt_pk_bf16_f32 v148, v148, v149
 s_waitcnt lgkmcnt(8)
 v_mfma_f32_16x16x32_bf16 v[168:171], a[128:131], a[208:211], v[168:171]
 ds_read_b64_tr_b16 a[152:153], v245 offset:20672
 v_cvt_pk_bf16_f32 v149, v150, v151
 v_cvt_pk_bf16_f32 v150, v156, v157
 v_mfma_f32_16x16x32_bf16 v[168:171], a[132:135], a[216:219], v[168:171]
 ds_read_b64_tr_b16 a[154:155], v245 offset:25792
 v_cvt_pk_bf16_f32 v151, v158, v159
 v_mfma_f32_16x16x32_bf16 v[172:175], a[128:131], a[212:215], v[172:175]
 s_add_u32 s49, s34, 6144
 buffer_store_dwordx4 v[148:151], v1, s[4:7], s49 offen sc1
 ds_read_b64_tr_b16 a[156:157], v245 offset:30912
 v_mfma_f32_16x16x32_bf16 v[172:175], a[132:135], a[220:223], v[172:175]
 ds_read_b64_tr_b16 a[158:159], v245 offset:36032
 s_waitcnt lgkmcnt(8)
 v_mfma_f32_16x16x32_bf16 v[168:171], a[136:139], a[224:227], v[168:171]
 ds_read_b64_tr_b16 a[160:161], v246 offset:192
 v_mfma_f32_16x16x32_bf16 v[168:171], a[140:143], a[232:235], v[168:171]
 ds_read_b64_tr_b16 a[162:163], v246 offset:5312
 v_mfma_f32_16x16x32_bf16 v[172:175], a[136:139], a[228:231], v[172:175]
 ds_read_b64_tr_b16 a[164:165], v246 offset:10432
 v_mfma_f32_16x16x32_bf16 v[172:175], a[140:143], a[236:239], v[172:175]
 ds_read_b64_tr_b16 a[166:167], v246 offset:15552
 s_waitcnt lgkmcnt(8)
 v_mfma_f32_16x16x32_bf16 v[176:179], a[144:147], a[208:211], v[176:179]
 ds_read_b64_tr_b16 a[168:169], v246 offset:20672
 v_mfma_f32_16x16x32_bf16 v[176:179], a[148:151], a[216:219], v[176:179]
 ds_read_b64_tr_b16 a[170:171], v246 offset:25792
 v_mfma_f32_16x16x32_bf16 v[180:183], a[144:147], a[212:215], v[180:183]
 ds_read_b64_tr_b16 a[172:173], v246 offset:30912
 v_mfma_f32_16x16x32_bf16 v[180:183], a[148:151], a[220:223], v[180:183]
 ds_read_b64_tr_b16 a[174:175], v246 offset:36032
 s_waitcnt lgkmcnt(8)
 v_mfma_f32_16x16x32_bf16 v[176:179], a[152:155], a[224:227], v[176:179]
 ds_read_b64_tr_b16 a[176:177], v245 offset:256
 v_cvt_pk_bf16_f32 v160, v160, v161
 v_cvt_pk_bf16_f32 v161, v162, v163
 v_mfma_f32_16x16x32_bf16 v[176:179], a[156:159], a[232:235], v[176:179]
 ds_read_b64_tr_b16 a[178:179], v245 offset:5376
 v_cvt_pk_bf16_f32 v162, v168, v169
 v_cvt_pk_bf16_f32 v163, v170, v171
 v_mfma_f32_16x16x32_bf16 v[180:183], a[152:155], a[228:231], v[180:183]
 s_add_u32 s49, s34, 2048
 buffer_store_dwordx4 v[160:163], v1, s[4:7], s49 offen sc1
 ds_read_b64_tr_b16 a[180:181], v245 offset:10496
 v_mfma_f32_16x16x32_bf16 v[180:183], a[156:159], a[236:239], v[180:183]
 ds_read_b64_tr_b16 a[182:183], v245 offset:15616
 v_cvt_pk_bf16_f32 v164, v164, v165
 s_waitcnt lgkmcnt(8)
 v_mfma_f32_16x16x32_bf16 v[184:187], a[160:163], a[208:211], v[184:187]
 ds_read_b64_tr_b16 a[184:185], v245 offset:20736
 v_cvt_pk_bf16_f32 v165, v166, v167
 v_cvt_pk_bf16_f32 v166, v172, v173
 v_mfma_f32_16x16x32_bf16 v[184:187], a[164:167], a[216:219], v[184:187]
 ds_read_b64_tr_b16 a[186:187], v245 offset:25856
 v_cvt_pk_bf16_f32 v167, v174, v175
 v_mfma_f32_16x16x32_bf16 v[188:191], a[160:163], a[212:215], v[188:191]
 s_add_u32 s49, s34, 7168
 buffer_store_dwordx4 v[164:167], v1, s[4:7], s49 offen sc1
 ds_read_b64_tr_b16 a[188:189], v245 offset:30976
 v_mfma_f32_16x16x32_bf16 v[188:191], a[164:167], a[220:223], v[188:191]
 ds_read_b64_tr_b16 a[190:191], v245 offset:36096
 s_waitcnt lgkmcnt(8)
 v_mfma_f32_16x16x32_bf16 v[184:187], a[168:171], a[224:227], v[184:187]
 ds_read_b64_tr_b16 a[128:129], v246 offset:256
 v_mfma_f32_16x16x32_bf16 v[184:187], a[172:175], a[232:235], v[184:187]
 ds_read_b64_tr_b16 a[130:131], v246 offset:5376
 v_mfma_f32_16x16x32_bf16 v[188:191], a[168:171], a[228:231], v[188:191]
 ds_read_b64_tr_b16 a[132:133], v246 offset:10496
 v_mfma_f32_16x16x32_bf16 v[188:191], a[172:175], a[236:239], v[188:191]
 ds_read_b64_tr_b16 a[134:135], v246 offset:15616
 s_waitcnt lgkmcnt(8)
 v_mfma_f32_16x16x32_bf16 v[192:195], a[176:179], a[208:211], v[192:195]
 ds_read_b64_tr_b16 a[136:137], v246 offset:20736
 v_mfma_f32_16x16x32_bf16 v[192:195], a[180:183], a[216:219], v[192:195]
 ds_read_b64_tr_b16 a[138:139], v246 offset:25856
 v_mfma_f32_16x16x32_bf16 v[196:199], a[176:179], a[212:215], v[196:199]
 ds_read_b64_tr_b16 a[140:141], v246 offset:30976
 v_mfma_f32_16x16x32_bf16 v[196:199], a[180:183], a[220:223], v[196:199]
 ds_read_b64_tr_b16 a[142:143], v246 offset:36096
 s_waitcnt lgkmcnt(10)
 v_mfma_f32_16x16x32_bf16 v[192:195], a[184:187], a[224:227], v[192:195]
 v_cvt_pk_bf16_f32 v176, v176, v177
 v_cvt_pk_bf16_f32 v177, v178, v179
 s_waitcnt lgkmcnt(8)
 v_mfma_f32_16x16x32_bf16 v[192:195], a[188:191], a[232:235], v[192:195]
 v_cvt_pk_bf16_f32 v178, v184, v185
 v_cvt_pk_bf16_f32 v179, v186, v187
 v_mfma_f32_16x16x32_bf16 v[196:199], a[184:187], a[228:231], v[196:199]
 s_add_u32 s49, s34, 3072
 buffer_store_dwordx4 v[176:179], v1, s[4:7], s49 offen sc1
 v_cvt_pk_bf16_f32 v180, v180, v181
 v_mfma_f32_16x16x32_bf16 v[196:199], a[188:191], a[236:239], v[196:199]
 v_cvt_pk_bf16_f32 v181, v182, v183
 v_cvt_pk_bf16_f32 v182, v188, v189
 s_waitcnt lgkmcnt(6)
 v_mfma_f32_16x16x32_bf16 v[200:203], a[128:131], a[208:211], v[200:203]
 v_cvt_pk_bf16_f32 v183, v190, v191
 s_add_u32 s49, s34, 8192
 buffer_store_dwordx4 v[180:183], v1, s[4:7], s49 offen sc1
 s_waitcnt lgkmcnt(4)
 v_mfma_f32_16x16x32_bf16 v[200:203], a[132:135], a[216:219], v[200:203]
 v_mfma_f32_16x16x32_bf16 v[204:207], a[128:131], a[212:215], v[204:207]
 v_mfma_f32_16x16x32_bf16 v[204:207], a[132:135], a[220:223], v[204:207]
 s_waitcnt lgkmcnt(2)
 v_mfma_f32_16x16x32_bf16 v[200:203], a[136:139], a[224:227], v[200:203]
 s_waitcnt lgkmcnt(0)
 v_mfma_f32_16x16x32_bf16 v[200:203], a[140:143], a[232:235], v[200:203]
 v_mfma_f32_16x16x32_bf16 v[204:207], a[136:139], a[228:231], v[204:207]
 v_mfma_f32_16x16x32_bf16 v[204:207], a[140:143], a[236:239], v[204:207]
 v_cvt_pk_bf16_f32 v192, v192, v193
 v_cvt_pk_bf16_f32 v193, v194, v195
 s_nop 3
 v_cvt_pk_bf16_f32 v194, v200, v201
 v_cvt_pk_bf16_f32 v195, v202, v203
 s_add_u32 s49, s34, 4096
 buffer_store_dwordx4 v[192:195], v1, s[4:7], s49 offen sc1
 v_cvt_pk_bf16_f32 v196, v196, v197
 v_cvt_pk_bf16_f32 v197, v198, v199
 v_cvt_pk_bf16_f32 v198, v204, v205
 v_cvt_pk_bf16_f32 v199, v206, v207
 s_add_u32 s49, s34, 9216
 buffer_store_dwordx4 v[196:199], v1, s[4:7], s49 offen sc1
 s_waitcnt vmcnt(21)
 v_lshlrev_b32 v96, 16, v64
 v_and_b32 v97, 0xffff0000, v64
 s_waitcnt vmcnt(19)
 v_lshlrev_b32 v22, 16, v68
 v_and_b32 v23, 0xffff0000, v68
 v_add_f32 v96, v96, v22
 v_add_f32 v97, v97, v23
 v_lshlrev_b32 v98, 16, v65
 v_and_b32 v99, 0xffff0000, v65
 v_lshlrev_b32 v22, 16, v69
 v_and_b32 v23, 0xffff0000, v69
 v_add_f32 v98, v98, v22
 v_add_f32 v99, v99, v23
 v_lshlrev_b32 v100, 16, v66
 v_and_b32 v101, 0xffff0000, v66
 s_waitcnt vmcnt(18)
 v_lshlrev_b32 v22, 16, v70
 v_and_b32 v23, 0xffff0000, v70
 v_add_f32 v100, v100, v22
 v_add_f32 v101, v101, v23
 v_lshlrev_b32 v102, 16, v67
 v_and_b32 v103, 0xffff0000, v67
 v_lshlrev_b32 v22, 16, v71
 v_and_b32 v23, 0xffff0000, v71
 v_add_f32 v102, v102, v22
 v_add_f32 v103, v103, v23
 s_waitcnt vmcnt(17)
 v_lshlrev_b32 v104, 16, v72
 v_and_b32 v105, 0xffff0000, v72
 s_waitcnt vmcnt(15)
 v_lshlrev_b32 v22, 16, v76
 v_and_b32 v23, 0xffff0000, v76
 v_add_f32 v104, v104, v22
 v_add_f32 v105, v105, v23
 v_lshlrev_b32 v106, 16, v73
 v_and_b32 v107, 0xffff0000, v73
 v_lshlrev_b32 v22, 16, v77
 v_and_b32 v23, 0xffff0000, v77
 v_add_f32 v106, v106, v22
 v_add_f32 v107, v107, v23
 v_lshlrev_b32 v108, 16, v74
 v_and_b32 v109, 0xffff0000, v74
 s_waitcnt vmcnt(14)
 v_lshlrev_b32 v22, 16, v78
 v_and_b32 v23, 0xffff0000, v78
 v_add_f32 v108, v108, v22
 v_add_f32 v109, v109, v23
 v_lshlrev_b32 v110, 16, v75
 v_and_b32 v111, 0xffff0000, v75
 v_lshlrev_b32 v22, 16, v79
 v_and_b32 v23, 0xffff0000, v79
 v_add_f32 v110, v110, v22
 v_add_f32 v111, v111, v23
 s_waitcnt vmcnt(13)
 v_lshlrev_b32 v112, 16, v80
 v_and_b32 v113, 0xffff0000, v80
 s_waitcnt vmcnt(11)
 v_lshlrev_b32 v22, 16, v84
 v_and_b32 v23, 0xffff0000, v84
 v_add_f32 v112, v112, v22
 v_add_f32 v113, v113, v23
 v_lshlrev_b32 v114, 16, v81
 v_and_b32 v115, 0xffff0000, v81
 v_lshlrev_b32 v22, 16, v85
 v_and_b32 v23, 0xffff0000, v85
 v_add_f32 v114, v114, v22
 v_add_f32 v115, v115, v23
 v_lshlrev_b32 v116, 16, v82
 v_and_b32 v117, 0xffff0000, v82
 s_waitcnt vmcnt(10)
 v_lshlrev_b32 v22, 16, v86
 v_and_b32 v23, 0xffff0000, v86
 v_add_f32 v116, v116, v22
 v_add_f32 v117, v117, v23
 v_lshlrev_b32 v118, 16, v83
 v_and_b32 v119, 0xffff0000, v83
 v_lshlrev_b32 v22, 16, v87
 v_and_b32 v23, 0xffff0000, v87
 v_add_f32 v118, v118, v22
 v_add_f32 v119, v119, v23
 s_waitcnt vmcnt(0)
 s_barrier
 buffer_store_dword v9, v24, s[4:7], s68 offen sc1
 s_cmp_lg_u32 s44, 0
 s_cbranch_scc1 L_back_pt
 buffer_load_dword v240, v254, s[4:7], s66 offen sc1
 s_waitcnt vmcnt(0)
 v_cmp_eq_u32 vcc, s100, v240
 s_nop 1
 s_and_b32 s71, vcc_lo, 15
 s_cmp_eq_u32 s71, 15
 s_cbranch_scc0 L_slow_pt
L_back_pt:
 s_barrier
 buffer_load_dwordx4 v[160:163], v1, s[4:7], s62 offen sc1
 s_add_u32 s62, s62, 2621440
 buffer_load_dwordx4 v[164:167], v1, s[4:7], s62 offen sc1
 s_add_u32 s62, s62, 2621440
 buffer_load_dwordx4 v[168:171], v1, s[4:7], s62 offen sc1
 s_add_u32 s62, s62, 2621440
 buffer_load_dwordx4 v[172:175], v1, s[4:7], s62 offen sc1
 s_add_u32 s62, s62, 2621440
 buffer_load_dwordx4 v[176:179], v1, s[4:7], s63 offen sc1
 s_add_u32 s63, s63, 2621440
 buffer_load_dwordx4 v[180:183], v1, s[4:7], s63 offen sc1
 s_add_u32 s63, s63, 2621440
 buffer_load_dwordx4 v[184:187], v1, s[4:7], s63 offen sc1
 s_add_u32 s63, s63, 2621440
 buffer_load_dwordx4 v[188:191], v1, s[4:7], s63 offen sc1
 s_add_u32 s63, s63, 2621440
 buffer_load_dwordx4 v[192:195], v1, s[4:7], s64 offen sc1
 s_add_u32 s64, s64, 2621440
 buffer_load_dwordx4 v[196:199], v1, s[4:7], s64 offen sc1
 s_add_u32 s64, s64, 2621440
 buffer_load_dwordx4 v[200:203], v1, s[4:7], s64 offen sc1
 s_add_u32 s64, s64, 2621440
 buffer_load_dwordx4 v[204:207], v1, s[4:7], s64 offen sc1
 s_add_u32 s64, s64, 2621440
 s_waitcnt vmcnt(11)
 v_lshlrev_b32 v22, 16, v160
 v_and_b32 v23, 0xffff0000, v160
 v_add_f32 v96, v96, v22
 v_add_f32 v97, v97, v23
 v_lshlrev_b32 v22, 16, v161
 v_and_b32 v23, 0xffff0000, v161
 v_add_f32 v98, v98, v22
 v_add_f32 v99, v99, v23
 v_lshlrev_b32 v22, 16, v162
 v_and_b32 v23, 0xffff0000, v162
 v_add_f32 v100, v100, v22
 v_add_f32 v101, v101, v23
 v_lshlrev_b32 v22, 16, v163
 v_and_b32 v23, 0xffff0000, v163
 v_add_f32 v102, v102, v22
 v_add_f32 v103, v103, v23
 s_waitcnt vmcnt(10)
 v_lshlrev_b32 v22, 16, v164
 v_and_b32 v23, 0xffff0000, v164
 v_add_f32 v96, v96, v22
 v_add_f32 v97, v97, v23
 v_lshlrev_b32 v22, 16, v165
 v_and_b32 v23, 0xffff0000, v165
 v_add_f32 v98, v98, v22
 v_add_f32 v99, v99, v23
 v_lshlrev_b32 v22, 16, v166
 v_and_b32 v23, 0xffff0000, v166
 v_add_f32 v100, v100, v22
 v_add_f32 v101, v101, v23
 v_lshlrev_b32 v22, 16, v167
 v_and_b32 v23, 0xffff0000, v167
 v_add_f32 v102, v102, v22
 v_add_f32 v103, v103, v23
 s_waitcnt vmcnt(9)
 v_lshlrev_b32 v22, 16, v168
 v_and_b32 v23, 0xffff0000, v168
 v_add_f32 v96, v96, v22
 v_add_f32 v97, v97, v23
 v_lshlrev_b32 v22, 16, v169
 v_and_b32 v23, 0xffff0000, v169
 v_add_f32 v98, v98, v22
 v_add_f32 v99, v99, v23
 v_lshlrev_b32 v22, 16, v170
 v_and_b32 v23, 0xffff0000, v170
 v_add_f32 v100, v100, v22
 v_add_f32 v101, v101, v23
 v_lshlrev_b32 v22, 16, v171
 v_and_b32 v23, 0xffff0000, v171
 v_add_f32 v102, v102, v22
 v_add_f32 v103, v103, v23
 s_waitcnt vmcnt(8)
 v_lshlrev_b32 v22, 16, v172
 v_and_b32 v23, 0xffff0000, v172
 v_add_f32 v96, v96, v22
 v_add_f32 v97, v97, v23
 v_lshlrev_b32 v22, 16, v173
 v_and_b32 v23, 0xffff0000, v173
 v_add_f32 v98, v98, v22
 v_add_f32 v99, v99, v23
 v_lshlrev_b32 v22, 16, v174
 v_and_b32 v23, 0xffff0000, v174
 v_add_f32 v100, v100, v22
 v_add_f32 v101, v101, v23
 v_lshlrev_b32 v22, 16, v175
 v_and_b32 v23, 0xffff0000, v175
 v_add_f32 v102, v102, v22
 v_add_f32 v103, v103, v23
 v_cvt_pk_bf16_f32 v64, v96, v97
 v_cvt_pk_bf16_f32 v65, v98, v99
 v_cvt_pk_bf16_f32 v66, v100, v101
 v_cvt_pk_bf16_f32 v67, v102, v103
 buffer_store_dwordx2 v[64:65], v20, s[24:27], s56 offen
 buffer_store_dwordx2 v[66:67], v20, s[24:27], s56 offen offset:32
 s_waitcnt vmcnt(9)
 v_lshlrev_b32 v22, 16, v176
 v_and_b32 v23, 0xffff0000, v176
 v_add_f32 v104, v104, v22
 v_add_f32 v105, v105, v23
 v_lshlrev_b32 v22, 16, v177
 v_and_b32 v23, 0xffff0000, v177
 v_add_f32 v106, v106, v22
 v_add_f32 v107, v107, v23
 v_lshlrev_b32 v22, 16, v178
 v_and_b32 v23, 0xffff0000, v178
 v_add_f32 v108, v108, v22
 v_add_f32 v109, v109, v23
 v_lshlrev_b32 v22, 16, v179
 v_and_b32 v23, 0xffff0000, v179
 v_add_f32 v110, v110, v22
 v_add_f32 v111, v111, v23
 s_waitcnt vmcnt(8)
 v_lshlrev_b32 v22, 16, v180
 v_and_b32 v23, 0xffff0000, v180
 v_add_f32 v104, v104, v22
 v_add_f32 v105, v105, v23
 v_lshlrev_b32 v22, 16, v181
 v_and_b32 v23, 0xffff0000, v181
 v_add_f32 v106, v106, v22
 v_add_f32 v107, v107, v23
 v_lshlrev_b32 v22, 16, v182
 v_and_b32 v23, 0xffff0000, v182
 v_add_f32 v108, v108, v22
 v_add_f32 v109, v109, v23
 v_lshlrev_b32 v22, 16, v183
 v_and_b32 v23, 0xffff0000, v183
 v_add_f32 v110, v110, v22
 v_add_f32 v111, v111, v23
 s_waitcnt vmcnt(7)
 v_lshlrev_b32 v22, 16, v184
 v_and_b32 v23, 0xffff0000, v184
 v_add_f32 v104, v104, v22
 v_add_f32 v105, v105, v23
 v_lshlrev_b32 v22, 16, v185
 v_and_b32 v23, 0xffff0000, v185
 v_add_f32 v106, v106, v22
 v_add_f32 v107, v107, v23
 v_lshlrev_b32 v22, 16, v186
 v_and_b32 v23, 0xffff0000, v186
 v_add_f32 v108, v108, v22
 v_add_f32 v109, v109, v23
 v_lshlrev_b32 v22, 16, v187
 v_and_b32 v23, 0xffff0000, v187
 v_add_f32 v110, v110, v22
 v_add_f32 v111, v111, v23
 s_waitcnt vmcnt(6)
 v_lshlrev_b32 v22, 16, v188
 v_and_b32 v23, 0xffff0000, v188
 v_add_f32 v104, v104, v22
 v_add_f32 v105, v105, v23
 v_lshlrev_b32 v22, 16, v189
 v_and_b32 v23, 0xffff0000, v189
 v_add_f32 v106, v106, v22
 v_add_f32 v107, v107, v23
 v_lshlrev_b32 v22, 16, v190
 v_and_b32 v23, 0xffff0000, v190
 v_add_f32 v108, v108, v22
 v_add_f32 v109, v109, v23
 v_lshlrev_b32 v22, 16, v191
 v_and_b32 v23, 0xffff0000, v191
 v_add_f32 v110, v110, v22
 v_add_f32 v111, v111, v23
 v_cvt_pk_bf16_f32 v68, v104, v105
 v_cvt_pk_bf16_f32 v69, v106, v107
 v_cvt_pk_bf16_f32 v70, v108, v109
 v_cvt_pk_bf16_f32 v71, v110, v111
 buffer_store_dwordx2 v[68:69], v20, s[24:27], s57 offen
 buffer_store_dwordx2 v[70:71], v20, s[24:27], s57 offen offset:32
 s_waitcnt vmcnt(7)
 v_lshlrev_b32 v22, 16, v192
 v_and_b32 v23, 0xffff0000, v192
 v_add_f32 v112, v112, v22
 v_add_f32 v113, v113, v23
 v_lshlrev_b32 v22, 16, v193
 v_and_b32 v23, 0xffff0000, v193
 v_add_f32 v114, v114, v22
 v_add_f32 v115, v115, v23
 v_lshlrev_b32 v22, 16, v194
 v_and_b32 v23, 0xffff0000, v194
 v_add_f32 v116, v116, v22
 v_add_f32 v117, v117, v23
 v_lshlrev_b32 v22, 16, v195
 v_and_b32 v23, 0xffff0000, v195
 v_add_f32 v118, v118, v22
 v_add_f32 v119, v119, v23
 s_waitcnt vmcnt(6)
 v_lshlrev_b32 v22, 16, v196
 v_and_b32 v23, 0xffff0000, v196
 v_add_f32 v112, v112, v22
 v_add_f32 v113, v113, v23
 v_lshlrev_b32 v22, 16, v197
 v_and_b32 v23, 0xffff0000, v197
 v_add_f32 v114, v114, v22
 v_add_f32 v115, v115, v23
 v_lshlrev_b32 v22, 16, v198
 v_and_b32 v23, 0xffff0000, v198
 v_add_f32 v116, v116, v22
 v_add_f32 v117, v117, v23
 v_lshlrev_b32 v22, 16, v199
 v_and_b32 v23, 0xffff0000, v199
 v_add_f32 v118, v118, v22
 v_add_f32 v119, v119, v23
 s_waitcnt vmcnt(5)
 v_lshlrev_b32 v22, 16, v200
 v_and_b32 v23, 0xffff0000, v200
 v_add_f32 v112, v112, v22
 v_add_f32 v113, v113, v23
 v_lshlrev_b32 v22, 16, v201
 v_and_b32 v23, 0xffff0000, v201
 v_add_f32 v114, v114, v22
 v_add_f32 v115, v115, v23
 v_lshlrev_b32 v22, 16, v202
 v_and_b32 v23, 0xffff0000, v202
 v_add_f32 v116, v116, v22
 v_add_f32 v117, v117, v23
 v_lshlrev_b32 v22, 16, v203
 v_and_b32 v23, 0xffff0000, v203
 v_add_f32 v118, v118, v22
 v_add_f32 v119, v119, v23
 s_waitcnt vmcnt(4)
 v_lshlrev_b32 v22, 16, v204
 v_and_b32 v23, 0xffff0000, v204
 v_add_f32 v112, v112, v22
 v_add_f32 v113, v113, v23
 v_lshlrev_b32 v22, 16, v205
 v_and_b32 v23, 0xffff0000, v205
 v_add_f32 v114, v114, v22
 v_add_f32 v115, v115, v23
 v_lshlrev_b32 v22, 16, v206
 v_and_b32 v23, 0xffff0000, v206
 v_add_f32 v116, v116, v22
 v_add_f32 v117, v117, v23
 v_lshlrev_b32 v22, 16, v207
 v_and_b32 v23, 0xffff0000, v207
 v_add_f32 v118, v118, v22
 v_add_f32 v119, v119, v23
 v_cvt_pk_bf16_f32 v72, v112, v113
 v_cvt_pk_bf16_f32 v73, v114, v115
 v_cvt_pk_bf16_f32 v74, v116, v117
 v_cvt_pk_bf16_f32 v75, v118, v119
 buffer_store_dwordx2 v[72:73], v20, s[24:27], s58 offen
 buffer_store_dwordx2 v[74:75], v20, s[24:27], s58 offen offset:32
L_done:
 s_endpgm
L_G7:
 s_and_b32 s27, s3, 0xfffffe00
 buffer_load_dword v241, v254, s[4:7], s27 offen sc1
 s_add_u32 s55, s29, 0
 s_add_u32 m0, s38, 65536
 s_nop 0
 buffer_load_dwordx4 v247, s[12:15], s55 offen lds
 s_add_u32 m0, s38, 66560
 s_nop 0
 buffer_load_dwordx4 v248, s[12:15], s55 offen lds
 s_add_u32 m0, s38, 67584
 s_nop 0
 buffer_load_dwordx4 v249, s[12:15], s55 offen lds
 s_add_u32 m0, s38, 68608
 s_nop 0
 buffer_load_dwordx4 v250, s[12:15], s55 offen lds
 s_add_u32 m0, s38, 69632
 s_nop 0
 buffer_load_dwordx4 v251, s[12:15], s55 offen lds
 s_add_u32 s55, s29, 81920
 s_add_u32 m0, s38, 86016
 s_nop 0
 buffer_load_dwordx4 v247, s[12:15], s55 offen lds
 s_add_u32 m0, s38, 87040
 s_nop 0
 buffer_load_dwordx4 v248, s[12:15], s55 offen lds
 s_add_u32 m0, s38, 88064
 s_nop 0
 buffer_load_dwordx4 v249, s[12:15], s55 offen lds
 s_add_u32 m0, s38, 89088
 s_nop 0
 buffer_load_dwordx4 v250, s[12:15], s55 offen lds
 s_add_u32 m0, s38, 90112
 s_nop 0
 buffer_load_dwordx4 v251, s[12:15], s55 offen lds
 s_add_u32 s55, s29, 163840
 s_add_u32 m0, s38, 106496
 s_nop 0
 buffer_load_dwordx4 v247, s[12:15], s55 offen lds
 s_add_u32 m0, s38, 107520
 s_nop 0
 buffer_load_dwordx4 v248, s[12:15], s55 offen lds
 s_add_u32 m0, s38, 108544
 s_nop 0
 buffer_load_dwordx4 v249, s[12:15], s55 offen lds
 s_add_u32 m0, s38, 109568
 s_nop 0
 buffer_load_dwordx4 v250, s[12:15], s55 offen lds
 s_add_u32 m0, s38, 110592
 s_nop 0
 buffer_load_dwordx4 v251, s[12:15], s55 offen lds
 s_waitcnt vmcnt(15)
 v_cmp_eq_u32 vcc, s100, v241
 s_nop 1
 s_and_b32 s71, vcc_lo, -1
 s_cmp_eq_u32 s71, -1
 s_cbranch_scc0 L_slow_h7
L_back_h7:
 s_add_u32 s53, s31, 0
 buffer_load_dwordx4 a[192:195], v252, s[4:7], s53 offen sc1
 buffer_load_dwordx4 a[196:199], v253, s[4:7], s53 offen sc1
 s_add_u32 s53, s31, 1024
 buffer_load_dwordx4 a[200:203], v252, s[4:7], s53 offen sc1
 buffer_load_dwordx4 a[204:207], v253, s[4:7], s53 offen sc1
 s_add_u32 s53, s31, 2048
 buffer_load_dwordx4 a[208:211], v252, s[4:7], s53 offen sc1
 buffer_load_dwordx4 a[212:215], v253, s[4:7], s53 offen sc1
 s_add_u32 s53, s31, 3072
 buffer_load_dwordx4 a[216:219], v252, s[4:7], s53 offen sc1
 buffer_load_dwordx4 a[220:223], v253, s[4:7], s53 offen sc1
 s_add_u32 s53, s31, 4096
 buffer_load_dwordx4 a[224:227], v252, s[4:7], s53 offen sc1
 buffer_load_dwordx4 a[228:231], v253, s[4:7], s53 offen sc1
 s_add_u32 s53, s31, 5120
 buffer_load_dwordx4 a[232:235], v252, s[4:7], s53 offen sc1
 buffer_load_dwordx4 a[236:239], v253, s[4:7], s53 offen sc1
 s_add_u32 s53, s31, 6144
 buffer_load_dwordx4 a[240:243], v252, s[4:7], s53 offen sc1
 buffer_load_dwordx4 a[244:247], v253, s[4:7], s53 offen sc1
 s_add_u32 s53, s31, 7168
 buffer_load_dwordx4 a[248:251], v252, s[4:7], s53 offen sc1
 buffer_load_dwordx4 a[252:255], v253, s[4:7], s53 offen sc1
 s_branch L_N1
L_fb:
 s_waitcnt vmcnt(0) lgkmcnt(0)
 s_barrier
 s_lshl_b32 s52, s47, 19
 s_add_u32 s52, s52, 16777216
 s_lshl_b32 s49, s48, 2
 s_sub_u32 s57, s49, 60
 s_sub_u32 s58, 0, s49
 v_mov_b32 v2, v244
 v_mov_b32 v3, v244
 v_mov_b32 v10, v244
 v_mov_b32 v11, v244
L_floop:
 s_add_u32 s49, s52, 4096
 buffer_load_dwordx4 a[128:131], v1, s[4:7], s52 offen sc1
 buffer_load_dwordx4 a[132:135], v1, s[4:7], s52 offen offset:1024 sc1
 buffer_load_dwordx4 a[136:139], v1, s[4:7], s52 offen offset:2048 sc1
 buffer_load_dwordx4 a[140:143], v1, s[4:7], s52 offen offset:3072 sc1
 buffer_load_dwordx4 a[144:147], v1, s[4:7], s49 offen sc1
 buffer_load_dwordx4 a[148:151], v1, s[4:7], s49 offen offset:1024 sc1
 buffer_load_dwordx4 a[152:155], v1, s[4:7], s49 offen offset:2048 sc1
 buffer_load_dwordx4 a[156:159], v1, s[4:7], s49 offen offset:3072 sc1
 s_waitcnt vmcnt(0)
 v_mfma_f32_16x16x32_bf16 v[128:131], a[128:131], v[64:67], 0
 v_mfma_f32_16x16x32_bf16 v[128:131], a[132:135], v[68:71], v[128:131]
 v_mfma_f32_16x16x32_bf16 v[128:131], a[136:139], v[72:75], v[128:131]
 v_mfma_f32_16x16x32_bf16 v[128:131], a[140:143], v[76:79], v[128:131]
 v_mfma_f32_16x16x32_bf16 v[136:139], a[128:131], v[80:83], 0
 v_mfma_f32_16x16x32_bf16 v[136:139], a[132:135], v[84:87], v[136:139]
 v_mfma_f32_16x16x32_bf16 v[136:139], a[136:139], v[88:91], v[136:139]
 v_mfma_f32_16x16x32_bf16 v[136:139], a[140:143], v[92:95], v[136:139]
 v_mfma_f32_16x16x32_bf16 v[144:147], a[128:131], v[96:99], 0
 v_mfma_f32_16x16x32_bf16 v[144:147], a[132:135], v[100:103], v[144:147]
 v_mfma_f32_16x16x32_bf16 v[144:147], a[136:139], v[104:107], v[144:147]
 v_mfma_f32_16x16x32_bf16 v[144:147], a[140:143], v[108:111], v[144:147]
 v_mfma_f32_16x16x32_bf16 v[152:155], a[128:131], v[112:115], 0
 v_mfma_f32_16x16x32_bf16 v[152:155], a[132:135], v[116:119], v[152:155]
 v_mfma_f32_16x16x32_bf16 v[152:155], a[136:139], v[120:123], v[152:155]
 v_mfma_f32_16x16x32_bf16 v[152:155], a[140:143], v[124:127], v[152:155]
 v_mfma_f32_16x16x32_bf16 v[132:135], a[144:147], v[64:67], 0
 v_mfma_f32_16x16x32_bf16 v[132:135], a[148:151], v[68:71], v[132:135]
 v_mfma_f32_16x16x32_bf16 v[132:135], a[152:155], v[72:75], v[132:135]
 v_mfma_f32_16x16x32_bf16 v[132:135], a[156:159], v[76:79], v[132:135]
 v_mfma_f32_16x16x32_bf16 v[140:143], a[144:147], v[80:83], 0
 v_mfma_f32_16x16x32_bf16 v[140:143], a[148:151], v[84:87], v[140:143]
 v_mfma_f32_16x16x32_bf16 v[140:143], a[152:155], v[88:91], v[140:143]
 v_mfma_f32_16x16x32_bf16 v[140:143], a[156:159], v[92:95], v[140:143]
 v_mfma_f32_16x16x32_bf16 v[148:151], a[144:147], v[96:99], 0
 v_mfma_f32_16x16x32_bf16 v[148:151], a[148:151], v[100:103], v[148:151]
 v_mfma_f32_16x16x32_bf16 v[148:151], a[152:155], v[104:107], v[148:151]
 v_mfma_f32_16x16x32_bf16 v[148:151], a[156:159], v[108:111], v[148:151]
 v_mfma_f32_16x16x32_bf16 v[156:159], a[144:147], v[112:115], 0
 v_mfma_f32_16x16x32_bf16 v[156:159], a[148:151], v[116:119], v[156:159]
 v_mfma_f32_16x16x32_bf16 v[156:159], a[152:155], v[120:123], v[156:159]
 v_mfma_f32_16x16x32_bf16 v[156:159], a[156:159], v[124:127], v[156:159]
 s_nop 15
 s_cmp_lg_i32 s57, 0
 s_cbranch_scc1 L_fa0
 v_add_f32 v128, v128, v224
 v_add_f32 v129, v129, v225
 v_add_f32 v130, v130, v226
 v_add_f32 v131, v131, v227
 v_add_f32 v132, v132, v228
 v_add_f32 v133, v133, v229
 v_add_f32 v134, v134, v230
 v_add_f32 v135, v135, v231
L_fa0:
 s_cmp_lg_i32 s57, 1
 s_cbranch_scc1 L_fa1
 v_add_f32 v128, v128, v232
 v_add_f32 v129, v129, v233
 v_add_f32 v130, v130, v234
 v_add_f32 v131, v131, v235
 v_add_f32 v132, v132, v236
 v_add_f32 v133, v133, v237
 v_add_f32 v134, v134, v238
 v_add_f32 v135, v135, v239
L_fa1:
 s_cmp_lg_i32 s57, 2
 s_cbranch_scc1 L_fa2
 v_add_f32 v136, v136, v224
 v_add_f32 v137, v137, v225
 v_add_f32 v138, v138, v226
 v_add_f32 v139, v139, v227
 v_add_f32 v140, v140, v228
 v_add_f32 v141, v141, v229
 v_add_f32 v142, v142, v230
 v_add_f32 v143, v143, v231
L_fa2:
 s_cmp_lg_i32 s57, 3
 s_cbranch_scc1 L_fa3
 v_add_f32 v136, v136, v232
 v_add_f32 v137, v137, v233
 v_add_f32 v138, v138, v234
 v_add_f32 v139, v139, v235
 v_add_f32 v140, v140, v236
 v_add_f32 v141, v141, v237
 v_add_f32 v142, v142, v238
 v_add_f32 v143, v143, v239
L_fa3:
 s_cmp_ge_i32 s57, 2
 s_cbranch_scc1 L_fal
 v_max3_f32 v2, v2, v128, v129
 v_max3_f32 v2, v2, v130, v131
 v_max3_f32 v2, v2, v132, v133
 v_max3_f32 v2, v2, v134, v135
L_fal:
 s_cmp_ge_i32 s57, 4
 s_cbranch_scc1 L_fah
 v_max3_f32 v3, v3, v136, v137
 v_max3_f32 v3, v3, v138, v139
 v_max3_f32 v3, v3, v140, v141
 v_max3_f32 v3, v3, v142, v143
L_fah:
 s_cmp_lg_i32 s58, 0
 s_cbranch_scc1 L_fb0
 v_add_f32 v144, v144, v224
 v_add_f32 v145, v145, v225
 v_add_f32 v146, v146, v226
 v_add_f32 v147, v147, v227
 v_add_f32 v148, v148, v228
 v_add_f32 v149, v149, v229
 v_add_f32 v150, v150, v230
 v_add_f32 v151, v151, v231
L_fb0:
 s_cmp_lg_i32 s58, 1
 s_cbranch_scc1 L_fb1
 v_add_f32 v144, v144, v232
 v_add_f32 v145, v145, v233
 v_add_f32 v146, v146, v234
 v_add_f32 v147, v147, v235
 v_add_f32 v148, v148, v236
 v_add_f32 v149, v149, v237
 v_add_f32 v150, v150, v238
 v_add_f32 v151, v151, v239
L_fb1:
 s_cmp_lg_i32 s58, 2
 s_cbranch_scc1 L_fb2
 v_add_f32 v152, v152, v224
 v_add_f32 v153, v153, v225
 v_add_f32 v154, v154, v226
 v_add_f32 v155, v155, v227
 v_add_f32 v156, v156, v228
 v_add_f32 v157, v157, v229
 v_add_f32 v158, v158, v230
 v_add_f32 v159, v159, v231
L_fb2:
 s_cmp_lg_i32 s58, 3
 s_cbranch_scc1 L_fb3
 v_add_f32 v152, v152, v232
 v_add_f32 v153, v153, v233
 v_add_f32 v154, v154, v234
 v_add_f32 v155, v155, v235
 v_add_f32 v156, v156, v236
 v_add_f32 v157, v157, v237
 v_add_f32 v158, v158, v238
 v_add_f32 v159, v159, v239
L_fb3:
 s_cmp_ge_i32 s58, 2
 s_cbranch_scc1 L_fbl
 v_max3_f32 v10, v10, v144, v145
 v_max3_f32 v10, v10, v146, v147
 v_max3_f32 v10, v10, v148, v149
 v_max3_f32 v10, v10, v150, v151
L_fbl:
 s_cmp_ge_i32 s58, 4
 s_cbranch_scc1 L_fbh
 v_max3_f32 v11, v11, v152, v153
 v_max3_f32 v11, v11, v154, v155
 v_max3_f32 v11, v11, v156, v157
 v_max3_f32 v11, v11, v158, v159
L_fbh:
 s_add_u32 s52, s52, 0x2000
 s_add_u32 s58, s58, 1
 s_add_u32 s57, s57, 1
 s_cmp_lt_i32 s57, 4
 s_cbranch_scc1 L_floop
 v_mov_b32 v20, v2
 v_mov_b32 v21, v3
 v_mov_b32 v22, v10
 v_mov_b32 v23, v11
 v_permlane16_swap_b32 v20, v2
 v_permlane16_swap_b32 v21, v3
 v_permlane16_swap_b32 v22, v10
 v_permlane16_swap_b32 v23, v11
 v_max_f32 v2, v2, v20
 v_max_f32 v3, v3, v21
 v_max_f32 v10, v10, v22
 v_max_f32 v11, v11, v23
 v_mov_b32 v20, v2
 v_mov_b32 v21, v3
 v_mov_b32 v22, v10
 v_mov_b32 v23, v11
 v_permlane32_swap_b32 v20, v2
 v_permlane32_swap_b32 v21, v3
 v_permlane32_swap_b32 v22, v10
 v_permlane32_swap_b32 v23, v11
 v_max_f32 v2, v2, v20
 v_max_f32 v3, v3, v21
 v_max_f32 v10, v10, v22
 v_max_f32 v11, v11, v23
 v_sub_f32 v32, 0, v2
 v_sub_f32 v33, 0, v2
 v_sub_f32 v34, 0, v2
 v_sub_f32 v35, 0, v2
 v_sub_f32 v36, 0, v3
 v_sub_f32 v37, 0, v3
 v_sub_f32 v38, 0, v3
 v_sub_f32 v39, 0, v3
 v_sub_f32 v40, 0, v10
 v_sub_f32 v41, 0, v10
 v_sub_f32 v42, 0, v10
 v_sub_f32 v43, 0, v10
 v_sub_f32 v44, 0, v11
 v_sub_f32 v45, 0, v11
 v_sub_f32 v46, 0, v11
 v_sub_f32 v47, 0, v11
 s_lshl_b32 s52, s47, 19
 s_lshl_b32 s58, s44, 11
 s_add_u32 s52, s52, s58
 s_add_u32 s52, s52, 16777216
 s_or_b32 s57, s58, 131072
 s_mov_b32 s39, 1
 s_add_u32 m0, s57, 0
 s_nop 0
 buffer_load_dwordx4 v1, s[4:7], s52 offen sc1 lds
 buffer_load_dwordx4 v1, s[4:7], s52 offen offset:1024 sc1 lds
 s_add_u32 m0, s58, 0
 s_nop 0
 buffer_load_dwordx4 v13, s[4:7], s52 offen sc1 lds
 buffer_load_dwordx4 v13, s[4:7], s52 offen offset:1024 sc1 lds
 s_add_u32 m0, s57, 8192
 s_nop 0
 buffer_load_dwordx4 v12, s[4:7], s52 offen sc1 lds
 buffer_load_dwordx4 v12, s[4:7], s52 offen offset:1024 sc1 lds
 s_add_u32 m0, s58, 8192
 s_nop 0
 buffer_load_dwordx4 v14, s[4:7], s52 offen sc1 lds
 buffer_load_dwordx4 v14, s[4:7], s52 offen offset:1024 sc1 lds
 s_xor_b32 s57, s57, 0x4000
 s_add_u32 s58, s58, 0x4000
 s_and_b32 s58, s58, 0xffff
 s_add_u32 s52, s52, 0x4000
 s_add_u32 m0, s57, 0
 s_nop 0
 buffer_load_dwordx4 v1, s[4:7], s52 offen sc1 lds
 buffer_load_dwordx4 v1, s[4:7], s52 offen offset:1024 sc1 lds
 s_add_u32 m0, s58, 0
 s_nop 0
 buffer_load_dwordx4 v13, s[4:7], s52 offen sc1 lds
 buffer_load_dwordx4 v13, s[4:7], s52 offen offset:1024 sc1 lds
 s_add_u32 m0, s57, 8192
 s_nop 0
 buffer_load_dwordx4 v12, s[4:7], s52 offen sc1 lds
 buffer_load_dwordx4 v12, s[4:7], s52 offen offset:1024 sc1 lds
 s_add_u32 m0, s58, 8192
 s_nop 0
 buffer_load_dwordx4 v14, s[4:7], s52 offen sc1 lds
 buffer_load_dwordx4 v14, s[4:7], s52 offen offset:1024 sc1 lds
 s_xor_b32 s57, s57, 0x4000
 s_add_u32 s58, s58, 0x4000
 s_and_b32 s58, s58, 0xffff
 s_add_u32 s52, s52, 0x4000
 s_waitcnt vmcnt(0) lgkmcnt(0)
 s_branch L_pro
L_slow_ln:
 s_mov_b32 s101, 50000
L_spin_ln:
 s_sleep 4
 buffer_load_dword v62, v19, s[4:7], s62 offen sc1
 s_waitcnt vmcnt(0)
 v_cmp_eq_u32 vcc, s100, v62
 s_nop 1
 s_and_b32 s71, vcc_lo, -1
 s_cmp_eq_u32 s71, -1
 s_cbranch_scc1 L_back_ln
 s_sub_u32 s101, s101, 1
 s_cmp_lg_u32 s101, 0
 s_cbranch_scc1 L_spin_ln
 s_branch L_back_ln
L_slow_kv:
 s_mov_b32 s101, 50000
L_spin_kv:
 s_sleep 4
 buffer_load_dword v62, v19, s[4:7], s70 offen sc1
 s_waitcnt vmcnt(0)
 v_cmp_eq_u32 vcc, s100, v62
 s_nop 1
 s_and_b32 s71, vcc_lo, 255
 s_cmp_eq_u32 s71, 255
 s_cbranch_scc1 L_back_kv
 s_sub_u32 s101, s101, 1
 s_cmp_lg_u32 s101, 0
 s_cbranch_scc1 L_spin_kv
 s_branch L_back_kv
L_slow_h:
 s_mov_b32 s101, 50000
L_spin_h:
 s_sleep 4
 buffer_load_dword v241, v254, s[4:7], s27 offen sc1
 s_waitcnt vmcnt(0)
 v_cmp_eq_u32 vcc, s100, v241
 s_nop 1
 s_and_b32 s71, vcc_lo, -1
 s_cmp_eq_u32 s71, -1
 s_cbranch_scc1 L_back_h
 s_sub_u32 s101, s101, 1
 s_cmp_lg_u32 s101, 0
 s_cbranch_scc1 L_spin_h
 s_branch L_back_h
L_slow_cx:
 s_mov_b32 s101, 50000
L_spin_cx:
 s_sleep 4
 buffer_load_dword v240, v254, s[4:7], s36 offen sc1
 s_waitcnt vmcnt(0)
 v_cmp_eq_u32 vcc, s100, v240
 s_nop 1
 s_and_b32 s71, vcc_lo, 15
 s_cmp_eq_u32 s71, 15
 s_cbranch_scc1 L_back_cx
 s_sub_u32 s101, s101, 1
 s_cmp_lg_u32 s101, 0
 s_cbranch_scc1 L_spin_cx
 s_branch L_back_cx
L_slow_cy:
 s_mov_b32 s101, 50000
L_spin_cy:
 s_sleep 4
 buffer_load_dword v240, v254, s[4:7], s36 offen sc1
 s_waitcnt vmcnt(0)
 v_cmp_eq_u32 vcc, s100, v240
 s_nop 1
 s_and_b32 s71, vcc_lo, 15
 s_cmp_eq_u32 s71, 15
 s_cbranch_scc1 L_back_cy
 s_sub_u32 s101, s101, 1
 s_cmp_lg_u32 s101, 0
 s_cbranch_scc1 L_spin_cy
 s_branch L_back_cy
L_slow_pt:
 s_mov_b32 s101, 50000
L_spin_pt:
 s_sleep 1
 buffer_load_dword v240, v254, s[4:7], s66 offen sc1
 s_waitcnt vmcnt(0)
 v_cmp_eq_u32 vcc, s100, v240
 s_nop 1
 s_and_b32 s71, vcc_lo, 15
 s_cmp_eq_u32 s71, 15
 s_cbranch_scc1 L_back_pt
 s_sub_u32 s101, s101, 1
 s_cmp_lg_u32 s101, 0
 s_cbranch_scc1 L_spin_pt
 s_branch L_back_pt
L_slow_h7:
 s_mov_b32 s101, 50000
L_spin_h7:
 s_sleep 4
 buffer_load_dword v241, v254, s[4:7], s27 offen sc1
 s_waitcnt vmcnt(0)
 v_cmp_eq_u32 vcc, s100, v241
 s_nop 1
 s_and_b32 s71, vcc_lo, -1
 s_cmp_eq_u32 s71, -1
 s_cbranch_scc1 L_back_h7
 s_sub_u32 s101, s101, 1
 s_cmp_lg_u32 s101, 0
 s_cbranch_scc1 L_spin_h7
 s_branch L_back_h7
L_end:
.section .rodata,"a"
.p2align 6
.amdhsa_kernel parallel_sum__compressed_kv_cla__mixer_channel_mlp__prompt_kernel
 .amdhsa_next_free_vgpr 512
 .amdhsa_next_free_sgpr 102
 .amdhsa_accum_offset 256
 .amdhsa_group_segment_fixed_size 0
 .amdhsa_kernarg_size 112
 .amdhsa_user_sgpr_count 2
 .amdhsa_user_sgpr_kernarg_segment_ptr 1
 .amdhsa_system_sgpr_workgroup_id_x 1
 .amdhsa_float_denorm_mode_32 3
.end_amdhsa_kernel
```
